```python
import torch

def _softmax(x, axis=-1):
    return torch.softmax(x, dim=axis)
def _gelu(x):
    return torch.nn.functional.gelu(x, approximate="tanh")
def _silu(x):
    return torch.nn.functional.silu(x)
def _sigmoid(x):
    return torch.sigmoid(x)
def _layernorm(x, axis=-1, eps=1e-5):
    m = x.mean(dim=axis, keepdim=True)
    v = x.var(dim=axis, keepdim=True, unbiased=False)
    return (x - m) / torch.sqrt(v + eps)
def _scatter_add(tgt, idx, src, axis=0):
    return tgt.clone().index_add_(axis, idx, src)
def _segment_sum(src, seg, n):
    out = torch.zeros((n,) + src.shape[1:], dtype=src.dtype)
    return out.index_add_(0, seg, src)
def _pad(x, pw):
    flat = tuple(v for pair in reversed(pw) for v in pair)
    return torch.nn.functional.pad(x, flat)

kernel_name = 'standalone__mha_block_cached__near_ridge'

def setup_inputs():

    _w = (lambda a: (lambda t: t.to(torch.bfloat16) if t.is_floating_point() else t)(torch.as_tensor(a)))
    B, Sq, D = 16, 240, 448
    H, Sk, Dh = 16, 512, 256
    return {
        "x": _w((lambda *s: torch.randn(*s, dtype=torch.bfloat16) * 0.8)(B, Sq, D)),
        "k_cache": _w((lambda *s: torch.randn(*s, dtype=torch.bfloat16) * 0.8)(B, H, Sk, Dh)),
        "v_cache": _w((lambda *s: torch.randn(*s, dtype=torch.bfloat16) * 0.05)(B, H, Sk, Dh)),
        "wq": _w((lambda *s: torch.randn(*s, dtype=torch.bfloat16) * 0.8)(D, H * Dh) * (D ** -0.5)),
        "wo": _w((lambda *s: torch.randn(*s, dtype=torch.bfloat16) * 0.05)(H * Dh, D) * ((H * Dh) ** -0.5)),
    }

def reference(x, k_cache, v_cache, wq, wo):
    B, Sq, D = x.shape
    H, Dh = 16, 256
    q = (lambda x, *d: x.permute(*d))((x @ wq).reshape(B, Sq, H, Dh), 0, 2, 1, 3)
    scores = torch.einsum("bhqd,bhkd->bhqk", q, k_cache) * (Dh ** -0.5)
    p = _softmax(scores, axis=-1)
    o = torch.einsum("bhqk,bhkd->bhqd", p, v_cache)
    return (lambda x, *d: x.permute(*d))(o, 0, 2, 1, 3).reshape(B, Sq, H * Dh) @ wo
```

```asm
; @launch kernel=mha_attn_kernel grid=(256,1,1) block=(256,1,1) lds=152064
; @launch kernel=mha_oproj_kernel grid=(240,1,1) block=(256,1,1) lds=86016
.amdgcn_target "amdgcn-amd-amdhsa--gfx950"
.text
.globl mha_attn_kernel
.p2align 8
.type mha_attn_kernel,@function
mha_attn_kernel:
  s_cmp_ge_u32 s2, 256
  s_cbranch_scc1 mha_attn_kernel_exit
  s_load_dwordx8 s[48:55], s[0:1], 0
  s_load_dwordx2 s[56:57], s[0:1], 32
  s_load_dwordx2 s[58:59], s[0:1], 56
  v_lshrrev_b32 v1, 6, v0
  v_and_b32 v0, 63, v0
  s_and_b32 s42, s2, 7
  v_readfirstlane_b32 s32, v1
  s_lshr_b32 s43, s2, 3
  s_lshr_b32 s38, s42, 1
  s_lshl_b32 s38, s38, 2
  s_lshr_b32 s39, s43, 3
  s_add_u32 s38, s38, s39
  s_and_b32 s39, s42, 1
  s_lshl_b32 s39, s39, 3
  s_and_b32 s43, s43, 7
  s_add_u32 s39, s39, s43
  v_lshrrev_b32 v6, 4, v0
  v_and_b32 v7, 15, v0
  s_and_b32 s42, s32, 1
  s_lshl_b32 s42, s42, 3
  s_lshr_b32 s43, s32, 1
  s_lshl_b32 s43, s43, 2
  s_add_u32 s42, s42, s43
  v_lshlrev_b32 v8, 4, v6
  v_add_u32 v8, s42, v8
  v_lshlrev_b32 v4, 4, v7
  v_lshl_add_u32 v4, v8, 13, v4
  s_mul_i32 s34, s32, 4224
  s_mul_i32 s33, s32, 4160
  s_lshl_b32 s46, s32, 13
  s_lshl_b32 s42, s32, 6
  v_lshrrev_b32 v8, 3, v0
  v_add_u32 v8, s42, v8
  v_mul_u32_u24 v8, 896, v8
  v_and_b32 v9, 7, v0
  v_xor_b32 v9, v9, v6
  v_lshl_add_u32 v12, v9, 4, v8
  v_xor_b32 v9, 4, v9
  v_lshl_add_u32 v13, v9, 4, v8
  v_add_u32 v13, 7168, v13
  s_waitcnt lgkmcnt(0)
  s_lshl_b32 s42, s39, 9
  s_add_u32 s16, s54, s42
  s_addc_u32 s17, s55, 0
  s_sub_u32 s18, 3670016, s42
  s_mov_b32 s19, 0x20000
  s_mul_i32 s42, s38, 215040
  s_add_u32 s4, s48, s42
  s_addc_u32 s5, s49, 0
  s_mov_b32 s6, 215040
  s_mov_b32 s7, 0x20000
  s_getpc_b64 s[40:41]
mha_attn_kernel_pc:
  v_lshlrev_b32 v16, 7, v0
  v_add_u32 v16, s46, v16
  v_add_u32 v17, 0, v16
  v_min_u32 v17, mha_code_end-mha_attn_kernel_pc-4, v17
  global_load_dword v240, v17, s[40:41]
  v_add_u32 v18, 32768, v16
  v_min_u32 v18, mha_code_end-mha_attn_kernel_pc-4, v18
  global_load_dword v241, v18, s[40:41]
  v_add_u32 v19, 65536, v16
  v_min_u32 v19, mha_code_end-mha_attn_kernel_pc-4, v19
  global_load_dword v242, v19, s[40:41]
  s_add_u32 m0, s34, 0
  s_mov_b32 s35, 0
  buffer_load_dwordx4 v4, s[16:19], s35 offen lds
  s_add_u32 m0, s34, 1056
  s_mov_b32 s35, 8192
  buffer_load_dwordx4 v4, s[16:19], s35 offen lds
  s_add_u32 m0, s34, 2112
  s_mov_b32 s35, 16384
  buffer_load_dwordx4 v4, s[16:19], s35 offen lds
  s_add_u32 m0, s34, 3168
  s_mov_b32 s35, 24576
  buffer_load_dwordx4 v4, s[16:19], s35 offen lds
  s_add_u32 m0, s46, 84480
  s_mov_b32 s43, 0
  buffer_load_dwordx4 v12, s[4:7], s43 offen lds
  s_add_u32 m0, s46, 85504
  s_mov_b32 s43, 0
  buffer_load_dwordx4 v13, s[4:7], s43 offen lds
  s_add_u32 m0, s46, 86528
  s_mov_b32 s43, 14336
  buffer_load_dwordx4 v12, s[4:7], s43 offen lds
  s_add_u32 m0, s46, 87552
  s_mov_b32 s43, 14336
  buffer_load_dwordx4 v13, s[4:7], s43 offen lds
  s_add_u32 m0, s46, 88576
  s_mov_b32 s43, 28672
  buffer_load_dwordx4 v12, s[4:7], s43 offen lds
  s_add_u32 m0, s46, 89600
  s_mov_b32 s43, 28672
  buffer_load_dwordx4 v13, s[4:7], s43 offen lds
  s_add_u32 m0, s46, 90624
  s_mov_b32 s43, 43008
  buffer_load_dwordx4 v12, s[4:7], s43 offen lds
  s_add_u32 m0, s46, 91648
  s_mov_b32 s43, 43008
  buffer_load_dwordx4 v13, s[4:7], s43 offen lds
  s_add_u32 m0, s34, 16896
  s_mov_b32 s35, 256
  buffer_load_dwordx4 v4, s[16:19], s35 offen lds
  s_add_u32 m0, s34, 17952
  s_mov_b32 s35, 8448
  buffer_load_dwordx4 v4, s[16:19], s35 offen lds
  s_add_u32 m0, s34, 19008
  s_mov_b32 s35, 16640
  buffer_load_dwordx4 v4, s[16:19], s35 offen lds
  s_add_u32 m0, s34, 20064
  s_mov_b32 s35, 24832
  buffer_load_dwordx4 v4, s[16:19], s35 offen lds
  s_lshl_b32 s42, s38, 4
  s_add_u32 s42, s42, s39
  s_lshl_b32 s42, s42, 18
  s_add_u32 s8, s50, s42
  s_addc_u32 s9, s51, 0
  s_mov_b32 s10, 0x40000
  s_mov_b32 s11, 0x20000
  s_add_u32 s12, s52, s42
  s_addc_u32 s13, s53, 0
  s_mov_b32 s14, 0x40000
  s_mov_b32 s15, 0x20000
  s_mov_b32 s20, s56
  s_mov_b32 s21, s57
  s_mov_b32 s22, 3670016
  s_mov_b32 s23, 0x20000
  s_add_u32 s28, s58, 33554432
  s_addc_u32 s29, s59, 0
  s_mov_b32 s30, 3670016
  s_mov_b32 s31, 0x20000
  s_mul_i32 s42, s38, 1966080
  s_lshl_b32 s43, s39, 13
  s_add_u32 s42, s42, s43
  s_add_u32 s24, s58, s42
  s_addc_u32 s25, s59, 0
  s_sub_u32 s26, 1966080, s43
  s_mov_b32 s27, 0x20000
  s_mov_b32 s37, 0x3db8aa3b
  s_mov_b32 s94, 256
  s_add_u32 s64, s58, 50331648
  s_addc_u32 s65, s59, 0
  s_mov_b32 s66, 32768
  s_mov_b32 s67, 0x20000
  s_lshl_b32 s68, s2, 7
  s_cmp_eq_u32 s32, 0
  s_cselect_b32 s70, 1, 0
  s_mov_b32 s71, 0
  s_cmp_eq_u32 s2, 0
  s_cselect_b64 s[74:75], -1, 0
  s_and_b64 s[76:77], s[74:75], s[70:71]
  s_and_b32 s96, s2, 3
  s_lshl_b32 s96, s96, 6
  s_mov_b32 s95, 0x20000
  s_mov_b32 s36, 0x49800000
  s_mov_b32 s44, 0x05040100
  s_mov_b32 s45, 0x07060302
  s_cmp_eq_u32 s32, 3
  s_mov_b32 s42, 0x42700000
  s_cselect_b32 s47, 0x43480000, s42
  s_mov_b32 s61, s42
  s_add_u32 s84, s58, 41943040
  s_addc_u32 s85, s59, 0
  s_mov_b32 s86, 6881280
  s_mov_b32 s87, 0x20000
  s_mul_i32 s42, s2, 28672
  s_mul_i32 s43, s32, 7168
  s_add_u32 s42, s42, s43
  v_lshlrev_b32 v22, 4, v0
  v_add_u32 v22, s42, v22
  v_add_u32 v23, 0x1000, v22
  v_accvgpr_write_b32 a204, -1
  v_accvgpr_write_b32 a205, -1
  v_accvgpr_write_b32 a206, -1
  v_accvgpr_write_b32 a207, -1
  s_nop 1
  buffer_store_dwordx4 a[204:207], v22, s[84:87], 0 offen offset:0 sc1
  buffer_store_dwordx4 a[204:207], v22, s[84:87], 0 offen offset:1024 sc1
  buffer_store_dwordx4 a[204:207], v22, s[84:87], 0 offen offset:2048 sc1
  buffer_store_dwordx4 a[204:207], v22, s[84:87], 0 offen offset:3072 sc1
  buffer_store_dwordx4 a[204:207], v23, s[84:87], 0 offen offset:0 sc1
  buffer_store_dwordx4 a[204:207], v23, s[84:87], 0 offen offset:1024 sc1
  buffer_store_dwordx4 a[204:207], v23, s[84:87], 0 offen offset:2048 sc1
  s_lshr_b32 s42, s2, 3
  s_add_u32 s42, s42, s2
  s_and_b32 s3, s42, 0
  s_lshl_b32 s3, s3, 15
  s_lshr_b32 s42, s2, 6
  s_add_u32 s42, s42, s2
  s_and_b32 s42, s42, 0
  s_lshl_b32 s43, s42, 8
  s_or_b32 s3, s3, s43
  s_lshl_b32 s42, s42, 12
  s_xor_b32 s48, s42, 0
  s_xor_b32 s49, s42, 4096
  s_xor_b32 s50, s42, 131072
  s_xor_b32 s51, s42, 135168
  s_xor_b32 s52, s42, 262144
  s_xor_b32 s53, s42, 266240
  s_xor_b32 s54, s42, 393216
  s_xor_b32 s55, s42, 397312
  s_lshl_b32 s42, s32, 11
  v_lshrrev_b32 v8, 5, v0
  v_and_b32 v9, 31, v0
  v_lshlrev_b32 v3, 13, v8
  v_lshl_add_u32 v3, v9, 4, v3
  v_add_u32 v3, s42, v3
  v_lshlrev_b32 v10, 13, v6
  v_lshl_add_u32 v10, v7, 4, v10
  v_add_u32 v10, s42, v10
  v_mul_u32_u24 v1, 1040, v7
  v_and_b32 v9, 1, v6
  v_lshl_add_u32 v1, v9, 8, v1
  v_lshl_add_u32 v1, v8, 4, v1
  v_bfe_u32 v2, v0, 2, 3
  v_mul_u32_u24 v2, 1056, v2
  v_lshl_add_u32 v2, v8, 8, v2
  v_and_b32 v9, 3, v0
  v_lshl_add_u32 v2, v9, 3, v2
  v_lshrrev_b32 v14, 1, v7
  v_xor_b32 v14, v14, v6
  v_lshlrev_b32 v14, 4, v14
  v_lshl_add_u32 v14, v7, 7, v14
  v_add_u32 v14, s46, v14
  v_add_u32 v14, 84480, v14
  v_xor_b32 v15, 64, v14
  v_lshlrev_b32 v11, 4, v0
  v_add_u32 v11, s33, v11
  s_lshl_b32 s42, s32, 19
  v_lshlrev_b32 v5, 4, v0
  v_add_u32 v5, s42, v5
  v_lshrrev_b32 v8, 2, v0
  v_mul_u32_u24 v8, 1056, v8
  v_lshl_add_u32 v0, v9, 3, v8
  s_waitcnt vmcnt(11)
  s_barrier
  ds_read_b128 a[0:3], v14 offset:0
  ds_read_b128 a[4:7], v14 offset:2048
  ds_read_b128 a[8:11], v14 offset:4096
  ds_read_b128 a[12:15], v14 offset:6144
  ds_read_b64_tr_b16 v[240:241], v2 offset:0
  ds_read_b64_tr_b16 v[242:243], v2 offset:8448
  ds_read_b64_tr_b16 v[244:245], v2 offset:512
  ds_read_b64_tr_b16 v[246:247], v2 offset:8960
  ds_read_b64_tr_b16 v[248:249], v2 offset:32
  ds_read_b64_tr_b16 v[250:251], v2 offset:8480
  ds_read_b128 a[16:19], v15 offset:0
  ds_read_b128 a[20:23], v15 offset:2048
  ds_read_b128 a[24:27], v15 offset:4096
  ds_read_b128 a[28:31], v15 offset:6144
  s_waitcnt lgkmcnt(10)
  s_waitcnt lgkmcnt(8)
  v_mfma_f32_16x16x32_bf16 v[16:19], v[240:243], a[0:3], 0
  s_add_u32 m0, s34, 33792
  ds_read_b64_tr_b16 v[252:253], v2 offset:544
  v_mfma_f32_16x16x32_bf16 v[20:23], v[240:243], a[4:7], 0
  s_mov_b32 s35, 524288
  ds_read_b64_tr_b16 v[254:255], v2 offset:8992
  v_mfma_f32_16x16x32_bf16 v[24:27], v[240:243], a[8:11], 0
  buffer_load_dwordx4 v4, s[16:19], s35 offen lds
  v_mfma_f32_16x16x32_bf16 v[28:31], v[240:243], a[12:15], 0
  s_add_u32 m0, s34, 34848
  ds_read_b64_tr_b16 v[240:241], v2 offset:64
  s_waitcnt lgkmcnt(3)
  v_mfma_f32_16x16x32_bf16 v[16:19], v[244:247], a[16:19], v[16:19]
  s_mov_b32 s35, 532480
  ds_read_b64_tr_b16 v[242:243], v2 offset:8512
  v_mfma_f32_16x16x32_bf16 v[20:23], v[244:247], a[20:23], v[20:23]
  v_mfma_f32_16x16x32_bf16 v[24:27], v[244:247], a[24:27], v[24:27]
  v_mfma_f32_16x16x32_bf16 v[28:31], v[244:247], a[28:31], v[28:31]
  ds_read_b64_tr_b16 v[244:245], v2 offset:576
  buffer_load_dwordx4 v4, s[16:19], s35 offen lds
  v_mfma_f32_16x16x32_bf16 v[32:35], v[248:251], a[0:3], 0
  s_add_u32 m0, s34, 35904
  ds_read_b64_tr_b16 v[246:247], v2 offset:9024
  v_mfma_f32_16x16x32_bf16 v[36:39], v[248:251], a[4:7], 0
  s_mov_b32 s35, 540672
  v_mfma_f32_16x16x32_bf16 v[40:43], v[248:251], a[8:11], 0
  v_mfma_f32_16x16x32_bf16 v[44:47], v[248:251], a[12:15], 0
  ds_read_b64_tr_b16 v[248:249], v2 offset:96
  s_waitcnt lgkmcnt(5)
  v_mfma_f32_16x16x32_bf16 v[32:35], v[252:255], a[16:19], v[32:35]
  ds_read_b64_tr_b16 v[250:251], v2 offset:8544
  buffer_load_dwordx4 v4, s[16:19], s35 offen lds
  v_mfma_f32_16x16x32_bf16 v[36:39], v[252:255], a[20:23], v[36:39]
  s_add_u32 m0, s34, 36960
  v_mfma_f32_16x16x32_bf16 v[40:43], v[252:255], a[24:27], v[40:43]
  s_mov_b32 s35, 548864
  v_mfma_f32_16x16x32_bf16 v[44:47], v[252:255], a[28:31], v[44:47]
  ds_read_b64_tr_b16 v[252:253], v2 offset:608
  s_waitcnt lgkmcnt(5)
  v_mfma_f32_16x16x32_bf16 v[48:51], v[240:243], a[0:3], 0
  ds_read_b64_tr_b16 v[254:255], v2 offset:9056
  v_mfma_f32_16x16x32_bf16 v[52:55], v[240:243], a[4:7], 0
  buffer_load_dwordx4 v4, s[16:19], s35 offen lds
  v_mfma_f32_16x16x32_bf16 v[56:59], v[240:243], a[8:11], 0
  s_add_u32 m0, s46, 118272
  v_mfma_f32_16x16x32_bf16 v[60:63], v[240:243], a[12:15], 0
  s_mov_b32 s43, 128
  ds_read_b64_tr_b16 v[240:241], v2 offset:128
  s_waitcnt lgkmcnt(5)
  v_mfma_f32_16x16x32_bf16 v[48:51], v[244:247], a[16:19], v[48:51]
  ds_read_b64_tr_b16 v[242:243], v2 offset:8576
  v_mfma_f32_16x16x32_bf16 v[52:55], v[244:247], a[20:23], v[52:55]
  v_mfma_f32_16x16x32_bf16 v[56:59], v[244:247], a[24:27], v[56:59]
  buffer_load_dwordx4 v12, s[4:7], s43 offen lds
  v_mfma_f32_16x16x32_bf16 v[60:63], v[244:247], a[28:31], v[60:63]
  s_add_u32 m0, s46, 119296
  ds_read_b64_tr_b16 v[244:245], v2 offset:640
  s_waitcnt lgkmcnt(5)
  v_mfma_f32_16x16x32_bf16 v[64:67], v[248:251], a[0:3], 0
  s_mov_b32 s43, 128
  ds_read_b64_tr_b16 v[246:247], v2 offset:9088
  v_mfma_f32_16x16x32_bf16 v[68:71], v[248:251], a[4:7], 0
  v_mfma_f32_16x16x32_bf16 v[72:75], v[248:251], a[8:11], 0
  v_mfma_f32_16x16x32_bf16 v[76:79], v[248:251], a[12:15], 0
  ds_read_b64_tr_b16 v[248:249], v2 offset:160
  s_waitcnt lgkmcnt(5)
  v_mfma_f32_16x16x32_bf16 v[64:67], v[252:255], a[16:19], v[64:67]
  ds_read_b64_tr_b16 v[250:251], v2 offset:8608
  buffer_load_dwordx4 v13, s[4:7], s43 offen lds
  v_mfma_f32_16x16x32_bf16 v[68:71], v[252:255], a[20:23], v[68:71]
  s_add_u32 m0, s46, 120320
  v_mfma_f32_16x16x32_bf16 v[72:75], v[252:255], a[24:27], v[72:75]
  s_mov_b32 s43, 14464
  v_mfma_f32_16x16x32_bf16 v[76:79], v[252:255], a[28:31], v[76:79]
  ds_read_b64_tr_b16 v[252:253], v2 offset:672
  s_waitcnt lgkmcnt(5)
  v_mfma_f32_16x16x32_bf16 v[80:83], v[240:243], a[0:3], 0
  ds_read_b64_tr_b16 v[254:255], v2 offset:9120
  v_mfma_f32_16x16x32_bf16 v[84:87], v[240:243], a[4:7], 0
  buffer_load_dwordx4 v12, s[4:7], s43 offen lds
  v_mfma_f32_16x16x32_bf16 v[88:91], v[240:243], a[8:11], 0
  s_add_u32 m0, s46, 121344
  v_mfma_f32_16x16x32_bf16 v[92:95], v[240:243], a[12:15], 0
  s_mov_b32 s43, 14464
  ds_read_b64_tr_b16 v[240:241], v2 offset:192
  s_waitcnt lgkmcnt(5)
  v_mfma_f32_16x16x32_bf16 v[80:83], v[244:247], a[16:19], v[80:83]
  ds_read_b64_tr_b16 v[242:243], v2 offset:8640
  v_mfma_f32_16x16x32_bf16 v[84:87], v[244:247], a[20:23], v[84:87]
  v_mfma_f32_16x16x32_bf16 v[88:91], v[244:247], a[24:27], v[88:91]
  buffer_load_dwordx4 v13, s[4:7], s43 offen lds
  v_mfma_f32_16x16x32_bf16 v[92:95], v[244:247], a[28:31], v[92:95]
  s_add_u32 m0, s46, 122368
  ds_read_b64_tr_b16 v[244:245], v2 offset:704
  s_waitcnt lgkmcnt(5)
  v_mfma_f32_16x16x32_bf16 v[96:99], v[248:251], a[0:3], 0
  s_mov_b32 s43, 28800
  ds_read_b64_tr_b16 v[246:247], v2 offset:9152
  v_mfma_f32_16x16x32_bf16 v[100:103], v[248:251], a[4:7], 0
  v_mfma_f32_16x16x32_bf16 v[104:107], v[248:251], a[8:11], 0
  v_mfma_f32_16x16x32_bf16 v[108:111], v[248:251], a[12:15], 0
  ds_read_b64_tr_b16 v[248:249], v2 offset:224
  s_waitcnt lgkmcnt(5)
  v_mfma_f32_16x16x32_bf16 v[96:99], v[252:255], a[16:19], v[96:99]
  ds_read_b64_tr_b16 v[250:251], v2 offset:8672
  buffer_load_dwordx4 v12, s[4:7], s43 offen lds
  v_mfma_f32_16x16x32_bf16 v[100:103], v[252:255], a[20:23], v[100:103]
  s_add_u32 m0, s46, 123392
  v_mfma_f32_16x16x32_bf16 v[104:107], v[252:255], a[24:27], v[104:107]
  s_mov_b32 s43, 28800
  v_mfma_f32_16x16x32_bf16 v[108:111], v[252:255], a[28:31], v[108:111]
  ds_read_b64_tr_b16 v[252:253], v2 offset:736
  s_waitcnt vmcnt(16)
  s_barrier
  s_waitcnt lgkmcnt(5)
  v_mfma_f32_16x16x32_bf16 v[112:115], v[240:243], a[0:3], 0
  ds_read_b64_tr_b16 v[254:255], v2 offset:9184
  v_mfma_f32_16x16x32_bf16 v[116:119], v[240:243], a[4:7], 0
  buffer_load_dwordx4 v13, s[4:7], s43 offen lds
  v_mfma_f32_16x16x32_bf16 v[120:123], v[240:243], a[8:11], 0
  s_add_u32 m0, s46, 124416
  v_mfma_f32_16x16x32_bf16 v[124:127], v[240:243], a[12:15], 0
  s_mov_b32 s43, 43136
  ds_read_b64_tr_b16 v[240:241], v2 offset:16896
  s_waitcnt lgkmcnt(5)
  v_mfma_f32_16x16x32_bf16 v[112:115], v[244:247], a[16:19], v[112:115]
  ds_read_b64_tr_b16 v[242:243], v2 offset:25344
  v_mfma_f32_16x16x32_bf16 v[116:119], v[244:247], a[20:23], v[116:119]
  v_mfma_f32_16x16x32_bf16 v[120:123], v[244:247], a[24:27], v[120:123]
  buffer_load_dwordx4 v12, s[4:7], s43 offen lds
  v_mfma_f32_16x16x32_bf16 v[124:127], v[244:247], a[28:31], v[124:127]
  s_add_u32 m0, s46, 125440
  ds_read_b64_tr_b16 v[244:245], v2 offset:17408
  s_waitcnt lgkmcnt(5)
  v_mfma_f32_16x16x32_bf16 v[128:131], v[248:251], a[0:3], 0
  s_mov_b32 s43, 43136
  ds_read_b64_tr_b16 v[246:247], v2 offset:25856
  v_mfma_f32_16x16x32_bf16 v[132:135], v[248:251], a[4:7], 0
  v_mfma_f32_16x16x32_bf16 v[136:139], v[248:251], a[8:11], 0
  v_mfma_f32_16x16x32_bf16 v[140:143], v[248:251], a[12:15], 0
  ds_read_b64_tr_b16 v[248:249], v2 offset:16928
  s_waitcnt lgkmcnt(5)
  v_mfma_f32_16x16x32_bf16 v[128:131], v[252:255], a[16:19], v[128:131]
  ds_read_b64_tr_b16 v[250:251], v2 offset:25376
  buffer_load_dwordx4 v13, s[4:7], s43 offen lds
  v_mfma_f32_16x16x32_bf16 v[132:135], v[252:255], a[20:23], v[132:135]
  s_add_u32 m0, s34, 50688
  v_mfma_f32_16x16x32_bf16 v[136:139], v[252:255], a[24:27], v[136:139]
  s_mov_b32 s35, 524544
  v_mfma_f32_16x16x32_bf16 v[140:143], v[252:255], a[28:31], v[140:143]
  ds_read_b64_tr_b16 v[252:253], v2 offset:17440
  s_waitcnt lgkmcnt(5)
  v_mfma_f32_16x16x32_bf16 v[144:147], v[240:243], a[0:3], 0
  ds_read_b64_tr_b16 v[254:255], v2 offset:25888
  s_waitcnt vmcnt(0)
  v_mfma_f32_16x16x32_bf16 v[148:151], v[240:243], a[4:7], 0
  buffer_load_dwordx4 v4, s[16:19], s35 offen lds
  ds_read_b128 a[32:35], v14 offset:33792
  v_mfma_f32_16x16x32_bf16 v[152:155], v[240:243], a[8:11], 0
  s_add_u32 m0, s34, 51744
  ds_read_b128 a[36:39], v14 offset:35840
  ds_read_b128 a[40:43], v14 offset:37888
  v_mfma_f32_16x16x32_bf16 v[156:159], v[240:243], a[12:15], 0
  s_mov_b32 s35, 532736
  ds_read_b64_tr_b16 v[240:241], v2 offset:16960
  s_waitcnt lgkmcnt(8)
  v_mfma_f32_16x16x32_bf16 v[144:147], v[244:247], a[16:19], v[144:147]
  ds_read_b64_tr_b16 v[242:243], v2 offset:25408
  ds_read_b128 a[44:47], v14 offset:39936
  v_mfma_f32_16x16x32_bf16 v[148:151], v[244:247], a[20:23], v[148:151]
  ds_read_b128 a[48:51], v15 offset:33792
  ds_read_b128 a[52:55], v15 offset:35840
  v_mfma_f32_16x16x32_bf16 v[152:155], v[244:247], a[24:27], v[152:155]
  buffer_load_dwordx4 v4, s[16:19], s35 offen lds
  ds_read_b128 a[56:59], v15 offset:37888
  v_mfma_f32_16x16x32_bf16 v[156:159], v[244:247], a[28:31], v[156:159]
  s_add_u32 m0, s34, 52800
  ds_read_b64_tr_b16 v[244:245], v2 offset:17472
  s_waitcnt lgkmcnt(12)
  v_mfma_f32_16x16x32_bf16 v[160:163], v[248:251], a[0:3], 0
  s_mov_b32 s35, 540928
  ds_read_b64_tr_b16 v[246:247], v2 offset:25920
  ds_read_b128 a[60:63], v15 offset:39936
  v_mfma_f32_16x16x32_bf16 v[164:167], v[248:251], a[4:7], 0
  s_waitcnt lgkmcnt(0)
  v_mfma_f32_16x16x32_bf16 v[168:171], v[248:251], a[8:11], 0
  v_mfma_f32_16x16x32_bf16 v[172:175], v[248:251], a[12:15], 0
  ds_read_b64_tr_b16 v[248:249], v2 offset:16992
  buffer_load_dwordx4 v4, s[16:19], s35 offen lds
  v_mfma_f32_16x16x32_bf16 v[160:163], v[252:255], a[16:19], v[160:163]
  s_add_u32 m0, s34, 53856
  ds_read_b64_tr_b16 v[250:251], v2 offset:25440
  v_mfma_f32_16x16x32_bf16 v[164:167], v[252:255], a[20:23], v[164:167]
  s_mov_b32 s35, 549120
  v_mfma_f32_16x16x32_bf16 v[168:171], v[252:255], a[24:27], v[168:171]
  v_mfma_f32_16x16x32_bf16 v[172:175], v[252:255], a[28:31], v[172:175]
  ds_read_b64_tr_b16 v[252:253], v2 offset:17504
  v_mfma_f32_16x16x32_bf16 v[176:179], v[240:243], a[0:3], 0
  ds_read_b64_tr_b16 v[254:255], v2 offset:25952
  buffer_load_dwordx4 v4, s[16:19], s35 offen lds
  v_mfma_f32_16x16x32_bf16 v[180:183], v[240:243], a[4:7], 0
  s_add_u32 m0, s46, 84480
  v_mfma_f32_16x16x32_bf16 v[184:187], v[240:243], a[8:11], 0
  s_mov_b32 s43, 256
  v_mfma_f32_16x16x32_bf16 v[188:191], v[240:243], a[12:15], 0
  ds_read_b64_tr_b16 v[240:241], v2 offset:17024
  v_mfma_f32_16x16x32_bf16 v[176:179], v[244:247], a[16:19], v[176:179]
  ds_read_b64_tr_b16 v[242:243], v2 offset:25472
  v_mfma_f32_16x16x32_bf16 v[180:183], v[244:247], a[20:23], v[180:183]
  buffer_load_dwordx4 v12, s[4:7], s43 offen lds
  v_mfma_f32_16x16x32_bf16 v[184:187], v[244:247], a[24:27], v[184:187]
  s_add_u32 m0, s46, 85504
  v_mfma_f32_16x16x32_bf16 v[188:191], v[244:247], a[28:31], v[188:191]
  s_mov_b32 s43, 256
  ds_read_b64_tr_b16 v[244:245], v2 offset:17536
  s_waitcnt lgkmcnt(5)
  v_mfma_f32_16x16x32_bf16 v[192:195], v[248:251], a[0:3], 0
  ds_read_b64_tr_b16 v[246:247], v2 offset:25984
  v_mfma_f32_16x16x32_bf16 v[196:199], v[248:251], a[4:7], 0
  v_mfma_f32_16x16x32_bf16 v[200:203], v[248:251], a[8:11], 0
  buffer_load_dwordx4 v13, s[4:7], s43 offen lds
  v_mfma_f32_16x16x32_bf16 v[204:207], v[248:251], a[12:15], 0
  s_add_u32 m0, s46, 86528
  ds_read_b64_tr_b16 v[248:249], v2 offset:17056
  s_waitcnt lgkmcnt(5)
  v_mfma_f32_16x16x32_bf16 v[192:195], v[252:255], a[16:19], v[192:195]
  s_mov_b32 s43, 14592
  ds_read_b64_tr_b16 v[250:251], v2 offset:25504
  v_mfma_f32_16x16x32_bf16 v[196:199], v[252:255], a[20:23], v[196:199]
  v_mfma_f32_16x16x32_bf16 v[200:203], v[252:255], a[24:27], v[200:203]
  v_mfma_f32_16x16x32_bf16 v[204:207], v[252:255], a[28:31], v[204:207]
  ds_read_b64_tr_b16 v[252:253], v2 offset:17568
  s_waitcnt lgkmcnt(5)
  v_mfma_f32_16x16x32_bf16 v[208:211], v[240:243], a[0:3], 0
  ds_read_b64_tr_b16 v[254:255], v2 offset:26016
  buffer_load_dwordx4 v12, s[4:7], s43 offen lds
  v_mfma_f32_16x16x32_bf16 v[212:215], v[240:243], a[4:7], 0
  s_add_u32 m0, s46, 87552
  v_mfma_f32_16x16x32_bf16 v[216:219], v[240:243], a[8:11], 0
  s_mov_b32 s43, 14592
  v_mfma_f32_16x16x32_bf16 v[220:223], v[240:243], a[12:15], 0
  ds_read_b64_tr_b16 v[240:241], v2 offset:17088
  s_waitcnt lgkmcnt(5)
  v_mfma_f32_16x16x32_bf16 v[208:211], v[244:247], a[16:19], v[208:211]
  ds_read_b64_tr_b16 v[242:243], v2 offset:25536
  v_mfma_f32_16x16x32_bf16 v[212:215], v[244:247], a[20:23], v[212:215]
  buffer_load_dwordx4 v13, s[4:7], s43 offen lds
  v_mfma_f32_16x16x32_bf16 v[216:219], v[244:247], a[24:27], v[216:219]
  s_add_u32 m0, s46, 88576
  v_mfma_f32_16x16x32_bf16 v[220:223], v[244:247], a[28:31], v[220:223]
  s_mov_b32 s43, 28928
  ds_read_b64_tr_b16 v[244:245], v2 offset:17600
  s_waitcnt lgkmcnt(5)
  v_mfma_f32_16x16x32_bf16 v[224:227], v[248:251], a[0:3], 0
  ds_read_b64_tr_b16 v[246:247], v2 offset:26048
  v_mfma_f32_16x16x32_bf16 v[228:231], v[248:251], a[4:7], 0
  v_mfma_f32_16x16x32_bf16 v[232:235], v[248:251], a[8:11], 0
  buffer_load_dwordx4 v12, s[4:7], s43 offen lds
  v_mfma_f32_16x16x32_bf16 v[236:239], v[248:251], a[12:15], 0
  s_add_u32 m0, s46, 89600
  ds_read_b64_tr_b16 v[248:249], v2 offset:17120
  s_waitcnt lgkmcnt(5)
  v_mfma_f32_16x16x32_bf16 v[224:227], v[252:255], a[16:19], v[224:227]
  s_mov_b32 s43, 28928
  ds_read_b64_tr_b16 v[250:251], v2 offset:25568
  v_mfma_f32_16x16x32_bf16 v[228:231], v[252:255], a[20:23], v[228:231]
  v_mfma_f32_16x16x32_bf16 v[232:235], v[252:255], a[24:27], v[232:235]
  v_mfma_f32_16x16x32_bf16 v[236:239], v[252:255], a[28:31], v[236:239]
  ds_read_b64_tr_b16 v[252:253], v2 offset:17632
  s_barrier
  s_waitcnt lgkmcnt(5)
  v_mfma_f32_16x16x32_bf16 a[224:227], v[240:243], a[0:3], 0
  ds_read_b64_tr_b16 v[254:255], v2 offset:26080
  buffer_load_dwordx4 v13, s[4:7], s43 offen lds
  v_mfma_f32_16x16x32_bf16 a[228:231], v[240:243], a[4:7], 0
  s_add_u32 m0, s46, 90624
  v_mfma_f32_16x16x32_bf16 a[232:235], v[240:243], a[8:11], 0
  s_mov_b32 s43, 43264
  v_mfma_f32_16x16x32_bf16 a[236:239], v[240:243], a[12:15], 0
  ds_read_b64_tr_b16 v[240:241], v2 offset:33792
  s_waitcnt lgkmcnt(5)
  v_mfma_f32_16x16x32_bf16 a[224:227], v[244:247], a[16:19], a[224:227]
  ds_read_b64_tr_b16 v[242:243], v2 offset:42240
  v_mfma_f32_16x16x32_bf16 a[228:231], v[244:247], a[20:23], a[228:231]
  buffer_load_dwordx4 v12, s[4:7], s43 offen lds
  v_mfma_f32_16x16x32_bf16 a[232:235], v[244:247], a[24:27], a[232:235]
  s_add_u32 m0, s46, 91648
  v_mfma_f32_16x16x32_bf16 a[236:239], v[244:247], a[28:31], a[236:239]
  s_mov_b32 s43, 43264
  ds_read_b64_tr_b16 v[244:245], v2 offset:34304
  s_waitcnt lgkmcnt(5)
  v_mfma_f32_16x16x32_bf16 a[240:243], v[248:251], a[0:3], 0
  ds_read_b64_tr_b16 v[246:247], v2 offset:42752
  v_mfma_f32_16x16x32_bf16 a[244:247], v[248:251], a[4:7], 0
  v_mfma_f32_16x16x32_bf16 a[248:251], v[248:251], a[8:11], 0
  buffer_load_dwordx4 v13, s[4:7], s43 offen lds
  v_mfma_f32_16x16x32_bf16 a[252:255], v[248:251], a[12:15], 0
  s_mov_b32 s35, 0
  ds_read_b64_tr_b16 v[248:249], v2 offset:33824
  s_waitcnt lgkmcnt(5)
  v_mfma_f32_16x16x32_bf16 a[240:243], v[252:255], a[16:19], a[240:243]
  s_add_u32 m0, s33, 67584
  ds_read_b64_tr_b16 v[250:251], v2 offset:42272
  v_mfma_f32_16x16x32_bf16 a[244:247], v[252:255], a[20:23], a[244:247]
  v_mfma_f32_16x16x32_bf16 a[248:251], v[252:255], a[24:27], a[248:251]
  v_mfma_f32_16x16x32_bf16 a[252:255], v[252:255], a[28:31], a[252:255]
  ds_read_b64_tr_b16 v[252:253], v2 offset:34336
  s_waitcnt lgkmcnt(5)
  v_mfma_f32_16x16x32_bf16 v[16:19], v[240:243], a[32:35], v[16:19]
  ds_read_b64_tr_b16 v[254:255], v2 offset:42784
  buffer_load_dwordx4 v3, s[8:11], s35 offen offset:0 nt lds
  v_mfma_f32_16x16x32_bf16 v[20:23], v[240:243], a[36:39], v[20:23]
  s_add_u32 m0, s33, 68112
  v_mfma_f32_16x16x32_bf16 v[24:27], v[240:243], a[40:43], v[24:27]
  v_mfma_f32_16x16x32_bf16 v[28:31], v[240:243], a[44:47], v[28:31]
  ds_read_b64_tr_b16 v[240:241], v2 offset:33856
  s_waitcnt lgkmcnt(5)
  v_mfma_f32_16x16x32_bf16 v[16:19], v[244:247], a[48:51], v[16:19]
  ds_read_b64_tr_b16 v[242:243], v2 offset:42304
  v_mfma_f32_16x16x32_bf16 v[20:23], v[244:247], a[52:55], v[20:23]
  buffer_load_dwordx4 v3, s[8:11], s35 offen offset:512 nt lds
  v_mfma_f32_16x16x32_bf16 v[24:27], v[244:247], a[56:59], v[24:27]
  s_add_u32 m0, s33, 68640
  v_mfma_f32_16x16x32_bf16 v[28:31], v[244:247], a[60:63], v[28:31]
  ds_read_b64_tr_b16 v[244:245], v2 offset:34368
  s_waitcnt lgkmcnt(5)
  v_mfma_f32_16x16x32_bf16 v[32:35], v[248:251], a[32:35], v[32:35]
  ds_read_b64_tr_b16 v[246:247], v2 offset:42816
  v_mfma_f32_16x16x32_bf16 v[36:39], v[248:251], a[36:39], v[36:39]
  v_mfma_f32_16x16x32_bf16 v[40:43], v[248:251], a[40:43], v[40:43]
  buffer_load_dwordx4 v3, s[8:11], s35 offen offset:1024 nt lds
  v_mfma_f32_16x16x32_bf16 v[44:47], v[248:251], a[44:47], v[44:47]
  s_add_u32 m0, s33, 69168
  ds_read_b64_tr_b16 v[248:249], v2 offset:33888
  s_waitcnt lgkmcnt(5)
  v_mfma_f32_16x16x32_bf16 v[32:35], v[252:255], a[48:51], v[32:35]
  ds_read_b64_tr_b16 v[250:251], v2 offset:42336
  v_mfma_f32_16x16x32_bf16 v[36:39], v[252:255], a[52:55], v[36:39]
  v_mfma_f32_16x16x32_bf16 v[40:43], v[252:255], a[56:59], v[40:43]
  v_mfma_f32_16x16x32_bf16 v[44:47], v[252:255], a[60:63], v[44:47]
  ds_read_b64_tr_b16 v[252:253], v2 offset:34400
  s_waitcnt lgkmcnt(5)
  v_mfma_f32_16x16x32_bf16 v[48:51], v[240:243], a[32:35], v[48:51]
  ds_read_b64_tr_b16 v[254:255], v2 offset:42848
  buffer_load_dwordx4 v3, s[8:11], s35 offen offset:1536 nt lds
  v_mfma_f32_16x16x32_bf16 v[52:55], v[240:243], a[36:39], v[52:55]
  s_add_u32 m0, s46, 118272
  v_mfma_f32_16x16x32_bf16 v[56:59], v[240:243], a[40:43], v[56:59]
  s_mov_b32 s43, 384
  v_mfma_f32_16x16x32_bf16 v[60:63], v[240:243], a[44:47], v[60:63]
  ds_read_b64_tr_b16 v[240:241], v2 offset:33920
  s_waitcnt lgkmcnt(5)
  v_mfma_f32_16x16x32_bf16 v[48:51], v[244:247], a[48:51], v[48:51]
  ds_read_b64_tr_b16 v[242:243], v2 offset:42368
  v_mfma_f32_16x16x32_bf16 v[52:55], v[244:247], a[52:55], v[52:55]
  buffer_load_dwordx4 v12, s[4:7], s43 offen lds
  v_mfma_f32_16x16x32_bf16 v[56:59], v[244:247], a[56:59], v[56:59]
  s_add_u32 m0, s46, 119296
  v_mfma_f32_16x16x32_bf16 v[60:63], v[244:247], a[60:63], v[60:63]
  s_mov_b32 s43, 384
  ds_read_b64_tr_b16 v[244:245], v2 offset:34432
  s_waitcnt lgkmcnt(5)
  v_mfma_f32_16x16x32_bf16 v[64:67], v[248:251], a[32:35], v[64:67]
  ds_read_b64_tr_b16 v[246:247], v2 offset:42880
  v_mfma_f32_16x16x32_bf16 v[68:71], v[248:251], a[36:39], v[68:71]
  v_mfma_f32_16x16x32_bf16 v[72:75], v[248:251], a[40:43], v[72:75]
  buffer_load_dwordx4 v13, s[4:7], s43 offen lds
  v_mfma_f32_16x16x32_bf16 v[76:79], v[248:251], a[44:47], v[76:79]
  s_add_u32 m0, s46, 120320
  ds_read_b64_tr_b16 v[248:249], v2 offset:33952
  s_waitcnt lgkmcnt(5)
  v_mfma_f32_16x16x32_bf16 v[64:67], v[252:255], a[48:51], v[64:67]
  s_mov_b32 s43, 14720
  ds_read_b64_tr_b16 v[250:251], v2 offset:42400
  v_mfma_f32_16x16x32_bf16 v[68:71], v[252:255], a[52:55], v[68:71]
  v_mfma_f32_16x16x32_bf16 v[72:75], v[252:255], a[56:59], v[72:75]
  v_mfma_f32_16x16x32_bf16 v[76:79], v[252:255], a[60:63], v[76:79]
  ds_read_b64_tr_b16 v[252:253], v2 offset:34464
  s_waitcnt lgkmcnt(5)
  v_mfma_f32_16x16x32_bf16 v[80:83], v[240:243], a[32:35], v[80:83]
  ds_read_b64_tr_b16 v[254:255], v2 offset:42912
  buffer_load_dwordx4 v12, s[4:7], s43 offen lds
  v_mfma_f32_16x16x32_bf16 v[84:87], v[240:243], a[36:39], v[84:87]
  s_add_u32 m0, s46, 121344
  s_waitcnt vmcnt(7)
  ds_read_b128 a[64:67], v14 offset:0
  v_mfma_f32_16x16x32_bf16 v[88:91], v[240:243], a[40:43], v[88:91]
  s_mov_b32 s43, 14720
  ds_read_b128 a[68:71], v14 offset:2048
  ds_read_b128 a[72:75], v14 offset:4096
  v_mfma_f32_16x16x32_bf16 v[92:95], v[240:243], a[44:47], v[92:95]
  ds_read_b64_tr_b16 v[240:241], v2 offset:33984
  s_waitcnt lgkmcnt(8)
  v_mfma_f32_16x16x32_bf16 v[80:83], v[244:247], a[48:51], v[80:83]
  ds_read_b64_tr_b16 v[242:243], v2 offset:42432
  ds_read_b128 a[76:79], v14 offset:6144
  v_mfma_f32_16x16x32_bf16 v[84:87], v[244:247], a[52:55], v[84:87]
  buffer_load_dwordx4 v13, s[4:7], s43 offen lds
  ds_read_b128 a[80:83], v15 offset:0
  v_mfma_f32_16x16x32_bf16 v[88:91], v[244:247], a[56:59], v[88:91]
  s_add_u32 m0, s46, 122368
  ds_read_b128 a[84:87], v15 offset:2048
  ds_read_b128 a[88:91], v15 offset:4096
  v_mfma_f32_16x16x32_bf16 v[92:95], v[244:247], a[60:63], v[92:95]
  s_mov_b32 s43, 29056
  ds_read_b64_tr_b16 v[244:245], v2 offset:34496
  s_waitcnt lgkmcnt(12)
  v_mfma_f32_16x16x32_bf16 v[96:99], v[248:251], a[32:35], v[96:99]
  ds_read_b64_tr_b16 v[246:247], v2 offset:42944
  ds_read_b128 a[92:95], v15 offset:6144
  v_mfma_f32_16x16x32_bf16 v[100:103], v[248:251], a[36:39], v[100:103]
  s_waitcnt lgkmcnt(0)
  v_mfma_f32_16x16x32_bf16 v[104:107], v[248:251], a[40:43], v[104:107]
  buffer_load_dwordx4 v12, s[4:7], s43 offen lds
  v_mfma_f32_16x16x32_bf16 v[108:111], v[248:251], a[44:47], v[108:111]
  s_add_u32 m0, s46, 123392
  ds_read_b64_tr_b16 v[248:249], v2 offset:34016
  v_mfma_f32_16x16x32_bf16 v[96:99], v[252:255], a[48:51], v[96:99]
  s_mov_b32 s43, 29056
  ds_read_b64_tr_b16 v[250:251], v2 offset:42464
  v_mfma_f32_16x16x32_bf16 v[100:103], v[252:255], a[52:55], v[100:103]
  v_mfma_f32_16x16x32_bf16 v[104:107], v[252:255], a[56:59], v[104:107]
  v_mfma_f32_16x16x32_bf16 v[108:111], v[252:255], a[60:63], v[108:111]
  ds_read_b64_tr_b16 v[252:253], v2 offset:34528
  buffer_load_dwordx4 v13, s[4:7], s43 offen lds
  s_barrier
  v_mfma_f32_16x16x32_bf16 v[112:115], v[240:243], a[32:35], v[112:115]
  s_add_u32 m0, s46, 124416
  ds_read_b64_tr_b16 v[254:255], v2 offset:42976
  v_mfma_f32_16x16x32_bf16 v[116:119], v[240:243], a[36:39], v[116:119]
  s_mov_b32 s43, 43392
  v_mfma_f32_16x16x32_bf16 v[120:123], v[240:243], a[40:43], v[120:123]
  v_mfma_f32_16x16x32_bf16 v[124:127], v[240:243], a[44:47], v[124:127]
  v_add_u32 v2, 50688, v2
  ds_read_b64_tr_b16 v[240:241], v2 offset:0
  v_mfma_f32_16x16x32_bf16 v[112:115], v[244:247], a[48:51], v[112:115]
  ds_read_b64_tr_b16 v[242:243], v2 offset:8448
  buffer_load_dwordx4 v12, s[4:7], s43 offen lds
  v_mfma_f32_16x16x32_bf16 v[116:119], v[244:247], a[52:55], v[116:119]
  s_add_u32 m0, s46, 125440
  v_mfma_f32_16x16x32_bf16 v[120:123], v[244:247], a[56:59], v[120:123]
  s_mov_b32 s43, 43392
  v_mfma_f32_16x16x32_bf16 v[124:127], v[244:247], a[60:63], v[124:127]
  ds_read_b64_tr_b16 v[244:245], v2 offset:512
  s_waitcnt lgkmcnt(5)
  v_mfma_f32_16x16x32_bf16 v[128:131], v[248:251], a[32:35], v[128:131]
  ds_read_b64_tr_b16 v[246:247], v2 offset:8960
  v_mfma_f32_16x16x32_bf16 v[132:135], v[248:251], a[36:39], v[132:135]
  buffer_load_dwordx4 v13, s[4:7], s43 offen lds
  v_mfma_f32_16x16x32_bf16 v[136:139], v[248:251], a[40:43], v[136:139]
  s_add_u32 m0, s34, 0
  v_mfma_f32_16x16x32_bf16 v[140:143], v[248:251], a[44:47], v[140:143]
  s_mov_b32 s35, 1048576
  ds_read_b64_tr_b16 v[248:249], v2 offset:32
  s_waitcnt lgkmcnt(5)
  v_mfma_f32_16x16x32_bf16 v[128:131], v[252:255], a[48:51], v[128:131]
  ds_read_b64_tr_b16 v[250:251], v2 offset:8480
  v_mfma_f32_16x16x32_bf16 v[132:135], v[252:255], a[52:55], v[132:135]
  v_mfma_f32_16x16x32_bf16 v[136:139], v[252:255], a[56:59], v[136:139]
  buffer_load_dwordx4 v4, s[16:19], s35 offen lds
  v_mfma_f32_16x16x32_bf16 v[140:143], v[252:255], a[60:63], v[140:143]
  s_add_u32 m0, s34, 1056
  ds_read_b64_tr_b16 v[252:253], v2 offset:544
  s_waitcnt lgkmcnt(5)
  v_mfma_f32_16x16x32_bf16 v[144:147], v[240:243], a[32:35], v[144:147]
  s_mov_b32 s35, 1056768
  ds_read_b64_tr_b16 v[254:255], v2 offset:8992
  v_mfma_f32_16x16x32_bf16 v[148:151], v[240:243], a[36:39], v[148:151]
  v_mfma_f32_16x16x32_bf16 v[152:155], v[240:243], a[40:43], v[152:155]
  v_mfma_f32_16x16x32_bf16 v[156:159], v[240:243], a[44:47], v[156:159]
  ds_read_b64_tr_b16 v[240:241], v2 offset:64
  s_waitcnt lgkmcnt(5)
  v_mfma_f32_16x16x32_bf16 v[144:147], v[244:247], a[48:51], v[144:147]
  ds_read_b64_tr_b16 v[242:243], v2 offset:8512
  buffer_load_dwordx4 v4, s[16:19], s35 offen lds
  v_mfma_f32_16x16x32_bf16 v[148:151], v[244:247], a[52:55], v[148:151]
  s_add_u32 m0, s34, 2112
  v_mfma_f32_16x16x32_bf16 v[152:155], v[244:247], a[56:59], v[152:155]
  s_mov_b32 s35, 1064960
  v_mfma_f32_16x16x32_bf16 v[156:159], v[244:247], a[60:63], v[156:159]
  ds_read_b64_tr_b16 v[244:245], v2 offset:576
  s_waitcnt lgkmcnt(5)
  v_mfma_f32_16x16x32_bf16 v[160:163], v[248:251], a[32:35], v[160:163]
  ds_read_b64_tr_b16 v[246:247], v2 offset:9024
  v_mfma_f32_16x16x32_bf16 v[164:167], v[248:251], a[36:39], v[164:167]
  buffer_load_dwordx4 v4, s[16:19], s35 offen lds
  v_mfma_f32_16x16x32_bf16 v[168:171], v[248:251], a[40:43], v[168:171]
  s_add_u32 m0, s34, 3168
  v_mfma_f32_16x16x32_bf16 v[172:175], v[248:251], a[44:47], v[172:175]
  s_mov_b32 s35, 1073152
  ds_read_b64_tr_b16 v[248:249], v2 offset:96
  s_waitcnt lgkmcnt(5)
  v_mfma_f32_16x16x32_bf16 v[160:163], v[252:255], a[48:51], v[160:163]
  ds_read_b64_tr_b16 v[250:251], v2 offset:8544
  v_mfma_f32_16x16x32_bf16 v[164:167], v[252:255], a[52:55], v[164:167]
  v_mfma_f32_16x16x32_bf16 v[168:171], v[252:255], a[56:59], v[168:171]
  buffer_load_dwordx4 v4, s[16:19], s35 offen lds
  v_mfma_f32_16x16x32_bf16 v[172:175], v[252:255], a[60:63], v[172:175]
  s_add_u32 m0, s46, 84480
  ds_read_b64_tr_b16 v[252:253], v2 offset:608
  s_waitcnt lgkmcnt(5)
  v_mfma_f32_16x16x32_bf16 v[176:179], v[240:243], a[32:35], v[176:179]
  s_mov_b32 s43, 512
  ds_read_b64_tr_b16 v[254:255], v2 offset:9056
  v_mfma_f32_16x16x32_bf16 v[180:183], v[240:243], a[36:39], v[180:183]
  v_mfma_f32_16x16x32_bf16 v[184:187], v[240:243], a[40:43], v[184:187]
  v_mfma_f32_16x16x32_bf16 v[188:191], v[240:243], a[44:47], v[188:191]
  ds_read_b64_tr_b16 v[240:241], v2 offset:128
  s_waitcnt lgkmcnt(5)
  v_mfma_f32_16x16x32_bf16 v[176:179], v[244:247], a[48:51], v[176:179]
  ds_read_b64_tr_b16 v[242:243], v2 offset:8576
  buffer_load_dwordx4 v12, s[4:7], s43 offen lds
  v_mfma_f32_16x16x32_bf16 v[180:183], v[244:247], a[52:55], v[180:183]
  s_add_u32 m0, s46, 85504
  v_mfma_f32_16x16x32_bf16 v[184:187], v[244:247], a[56:59], v[184:187]
  s_mov_b32 s43, 512
  v_mfma_f32_16x16x32_bf16 v[188:191], v[244:247], a[60:63], v[188:191]
  ds_read_b64_tr_b16 v[244:245], v2 offset:640
  s_waitcnt lgkmcnt(5)
  v_mfma_f32_16x16x32_bf16 v[192:195], v[248:251], a[32:35], v[192:195]
  ds_read_b64_tr_b16 v[246:247], v2 offset:9088
  v_mfma_f32_16x16x32_bf16 v[196:199], v[248:251], a[36:39], v[196:199]
  buffer_load_dwordx4 v13, s[4:7], s43 offen lds
  v_mfma_f32_16x16x32_bf16 v[200:203], v[248:251], a[40:43], v[200:203]
  s_add_u32 m0, s46, 86528
  v_mfma_f32_16x16x32_bf16 v[204:207], v[248:251], a[44:47], v[204:207]
  s_mov_b32 s43, 14848
  ds_read_b64_tr_b16 v[248:249], v2 offset:160
  s_waitcnt lgkmcnt(5)
  v_mfma_f32_16x16x32_bf16 v[192:195], v[252:255], a[48:51], v[192:195]
  ds_read_b64_tr_b16 v[250:251], v2 offset:8608
  v_mfma_f32_16x16x32_bf16 v[196:199], v[252:255], a[52:55], v[196:199]
  v_mfma_f32_16x16x32_bf16 v[200:203], v[252:255], a[56:59], v[200:203]
  buffer_load_dwordx4 v12, s[4:7], s43 offen lds
  v_mfma_f32_16x16x32_bf16 v[204:207], v[252:255], a[60:63], v[204:207]
  s_add_u32 m0, s46, 87552
  ds_read_b64_tr_b16 v[252:253], v2 offset:672
  s_waitcnt lgkmcnt(5)
  v_mfma_f32_16x16x32_bf16 v[208:211], v[240:243], a[32:35], v[208:211]
  s_mov_b32 s43, 14848
  ds_read_b64_tr_b16 v[254:255], v2 offset:9120
  v_mfma_f32_16x16x32_bf16 v[212:215], v[240:243], a[36:39], v[212:215]
  v_mfma_f32_16x16x32_bf16 v[216:219], v[240:243], a[40:43], v[216:219]
  v_mfma_f32_16x16x32_bf16 v[220:223], v[240:243], a[44:47], v[220:223]
  ds_read_b64_tr_b16 v[240:241], v2 offset:192
  s_waitcnt lgkmcnt(5)
  v_mfma_f32_16x16x32_bf16 v[208:211], v[244:247], a[48:51], v[208:211]
  ds_read_b64_tr_b16 v[242:243], v2 offset:8640
  buffer_load_dwordx4 v13, s[4:7], s43 offen lds
  v_mfma_f32_16x16x32_bf16 v[212:215], v[244:247], a[52:55], v[212:215]
  s_add_u32 m0, s46, 88576
  v_mfma_f32_16x16x32_bf16 v[216:219], v[244:247], a[56:59], v[216:219]
  s_mov_b32 s43, 29184
  v_mfma_f32_16x16x32_bf16 v[220:223], v[244:247], a[60:63], v[220:223]
  ds_read_b64_tr_b16 v[244:245], v2 offset:704
  s_waitcnt lgkmcnt(5)
  v_mfma_f32_16x16x32_bf16 v[224:227], v[248:251], a[32:35], v[224:227]
  ds_read_b64_tr_b16 v[246:247], v2 offset:9152
  v_mfma_f32_16x16x32_bf16 v[228:231], v[248:251], a[36:39], v[228:231]
  buffer_load_dwordx4 v12, s[4:7], s43 offen lds
  v_mfma_f32_16x16x32_bf16 v[232:235], v[248:251], a[40:43], v[232:235]
  s_add_u32 m0, s46, 89600
  v_mfma_f32_16x16x32_bf16 v[236:239], v[248:251], a[44:47], v[236:239]
  s_mov_b32 s43, 29184
  ds_read_b64_tr_b16 v[248:249], v2 offset:224
  s_waitcnt lgkmcnt(5)
  v_mfma_f32_16x16x32_bf16 v[224:227], v[252:255], a[48:51], v[224:227]
  ds_read_b64_tr_b16 v[250:251], v2 offset:8672
  v_mfma_f32_16x16x32_bf16 v[228:231], v[252:255], a[52:55], v[228:231]
  v_mfma_f32_16x16x32_bf16 v[232:235], v[252:255], a[56:59], v[232:235]
  buffer_load_dwordx4 v13, s[4:7], s43 offen lds
  v_mfma_f32_16x16x32_bf16 v[236:239], v[252:255], a[60:63], v[236:239]
  s_add_u32 m0, s46, 90624
  ds_read_b64_tr_b16 v[252:253], v2 offset:736
  s_waitcnt vmcnt(6)
  s_barrier
  s_waitcnt lgkmcnt(5)
  v_mfma_f32_16x16x32_bf16 a[224:227], v[240:243], a[32:35], a[224:227]
  s_mov_b32 s43, 43520
  ds_read_b64_tr_b16 v[254:255], v2 offset:9184
  v_mfma_f32_16x16x32_bf16 a[228:231], v[240:243], a[36:39], a[228:231]
  v_mfma_f32_16x16x32_bf16 a[232:235], v[240:243], a[40:43], a[232:235]
  v_mfma_f32_16x16x32_bf16 a[236:239], v[240:243], a[44:47], a[236:239]
  v_subrev_u32 v2, 50688, v2
  ds_read_b64_tr_b16 v[240:241], v2 offset:0
  s_waitcnt lgkmcnt(5)
  v_mfma_f32_16x16x32_bf16 a[224:227], v[244:247], a[48:51], a[224:227]
  ds_read_b64_tr_b16 v[242:243], v2 offset:8448
  buffer_load_dwordx4 v12, s[4:7], s43 offen lds
  v_mfma_f32_16x16x32_bf16 a[228:231], v[244:247], a[52:55], a[228:231]
  s_add_u32 m0, s46, 91648
  v_mfma_f32_16x16x32_bf16 a[232:235], v[244:247], a[56:59], a[232:235]
  s_mov_b32 s43, 43520
  v_mfma_f32_16x16x32_bf16 a[236:239], v[244:247], a[60:63], a[236:239]
  ds_read_b64_tr_b16 v[244:245], v2 offset:512
  s_waitcnt lgkmcnt(5)
  v_mfma_f32_16x16x32_bf16 a[240:243], v[248:251], a[32:35], a[240:243]
  ds_read_b64_tr_b16 v[246:247], v2 offset:8960
  v_mfma_f32_16x16x32_bf16 a[244:247], v[248:251], a[36:39], a[244:247]
  buffer_load_dwordx4 v13, s[4:7], s43 offen lds
  v_mfma_f32_16x16x32_bf16 a[248:251], v[248:251], a[40:43], a[248:251]
  s_add_u32 m0, s34, 16896
  v_mfma_f32_16x16x32_bf16 a[252:255], v[248:251], a[44:47], a[252:255]
  s_mov_b32 s35, 1048832
  ds_read_b64_tr_b16 v[248:249], v2 offset:32
  s_waitcnt lgkmcnt(5)
  v_mfma_f32_16x16x32_bf16 a[240:243], v[252:255], a[48:51], a[240:243]
  ds_read_b64_tr_b16 v[250:251], v2 offset:8480
  v_mfma_f32_16x16x32_bf16 a[244:247], v[252:255], a[52:55], a[244:247]
  v_mfma_f32_16x16x32_bf16 a[248:251], v[252:255], a[56:59], a[248:251]
  buffer_load_dwordx4 v4, s[16:19], s35 offen lds
  v_mfma_f32_16x16x32_bf16 a[252:255], v[252:255], a[60:63], a[252:255]
  s_add_u32 m0, s34, 17952
  ds_read_b64_tr_b16 v[252:253], v2 offset:544
  s_waitcnt lgkmcnt(5)
  v_mfma_f32_16x16x32_bf16 v[16:19], v[240:243], a[64:67], v[16:19]
  s_mov_b32 s35, 1057024
  ds_read_b64_tr_b16 v[254:255], v2 offset:8992
  v_mfma_f32_16x16x32_bf16 v[20:23], v[240:243], a[68:71], v[20:23]
  ds_read_b128 a[0:3], v14 offset:33792
  ds_read_b128 a[4:7], v14 offset:35840
  v_mfma_f32_16x16x32_bf16 v[24:27], v[240:243], a[72:75], v[24:27]
  ds_read_b128 a[8:11], v14 offset:37888
  ds_read_b128 a[12:15], v14 offset:39936
  v_mfma_f32_16x16x32_bf16 v[28:31], v[240:243], a[76:79], v[28:31]
  ds_read_b64_tr_b16 v[240:241], v2 offset:64
  s_waitcnt lgkmcnt(9)
  v_mfma_f32_16x16x32_bf16 v[16:19], v[244:247], a[80:83], v[16:19]
  ds_read_b64_tr_b16 v[242:243], v2 offset:8512
  buffer_load_dwordx4 v4, s[16:19], s35 offen lds
  v_mfma_f32_16x16x32_bf16 v[20:23], v[244:247], a[84:87], v[20:23]
  s_add_u32 m0, s34, 19008
  ds_read_b128 a[16:19], v15 offset:33792
  ds_read_b128 a[20:23], v15 offset:35840
  v_mfma_f32_16x16x32_bf16 v[24:27], v[244:247], a[88:91], v[24:27]
  s_mov_b32 s35, 1065216
  ds_read_b128 a[24:27], v15 offset:37888
  ds_read_b128 a[28:31], v15 offset:39936
  v_mfma_f32_16x16x32_bf16 v[28:31], v[244:247], a[92:95], v[28:31]
  s_waitcnt lgkmcnt(12)
  ds_read_b64_tr_b16 v[244:245], v2 offset:576
  s_waitcnt lgkmcnt(1)
  v_mfma_f32_16x16x32_bf16 v[32:35], v[248:251], a[64:67], v[32:35]
  ds_read_b64_tr_b16 v[246:247], v2 offset:9024
  v_mfma_f32_16x16x32_bf16 v[36:39], v[248:251], a[68:71], v[36:39]
  buffer_load_dwordx4 v4, s[16:19], s35 offen lds
  v_mfma_f32_16x16x32_bf16 v[40:43], v[248:251], a[72:75], v[40:43]
  s_add_u32 m0, s34, 20064
  v_mfma_f32_16x16x32_bf16 v[44:47], v[248:251], a[76:79], v[44:47]
  s_mov_b32 s35, 1073408
  ds_read_b64_tr_b16 v[248:249], v2 offset:96
  v_mfma_f32_16x16x32_bf16 v[32:35], v[252:255], a[80:83], v[32:35]
  ds_read_b64_tr_b16 v[250:251], v2 offset:8544
  v_mfma_f32_16x16x32_bf16 v[36:39], v[252:255], a[84:87], v[36:39]
  v_mfma_f32_16x16x32_bf16 v[40:43], v[252:255], a[88:91], v[40:43]
  buffer_load_dwordx4 v4, s[16:19], s35 offen lds
  v_mfma_f32_16x16x32_bf16 v[44:47], v[252:255], a[92:95], v[44:47]
  s_add_u32 m0, s34, 33792
  ds_read_b64_tr_b16 v[252:253], v2 offset:608
  v_mfma_f32_16x16x32_bf16 v[48:51], v[240:243], a[64:67], v[48:51]
  s_mov_b32 s35, 1572864
  ds_read_b64_tr_b16 v[254:255], v2 offset:9056
  v_mfma_f32_16x16x32_bf16 v[52:55], v[240:243], a[68:71], v[52:55]
  v_mfma_f32_16x16x32_bf16 v[56:59], v[240:243], a[72:75], v[56:59]
  v_mfma_f32_16x16x32_bf16 v[60:63], v[240:243], a[76:79], v[60:63]
  ds_read_b64_tr_b16 v[240:241], v2 offset:128
  s_waitcnt lgkmcnt(5)
  v_mfma_f32_16x16x32_bf16 v[48:51], v[244:247], a[80:83], v[48:51]
  ds_read_b64_tr_b16 v[242:243], v2 offset:8576
  buffer_load_dwordx4 v4, s[16:19], s35 offen lds
  v_mfma_f32_16x16x32_bf16 v[52:55], v[244:247], a[84:87], v[52:55]
  s_add_u32 m0, s34, 34848
  v_mfma_f32_16x16x32_bf16 v[56:59], v[244:247], a[88:91], v[56:59]
  s_mov_b32 s35, 1581056
  v_mfma_f32_16x16x32_bf16 v[60:63], v[244:247], a[92:95], v[60:63]
  ds_read_b64_tr_b16 v[244:245], v2 offset:640
  s_waitcnt lgkmcnt(5)
  v_mfma_f32_16x16x32_bf16 v[64:67], v[248:251], a[64:67], v[64:67]
  ds_read_b64_tr_b16 v[246:247], v2 offset:9088
  v_mfma_f32_16x16x32_bf16 v[68:71], v[248:251], a[68:71], v[68:71]
  buffer_load_dwordx4 v4, s[16:19], s35 offen lds
  v_mfma_f32_16x16x32_bf16 v[72:75], v[248:251], a[72:75], v[72:75]
  s_add_u32 m0, s34, 35904
  v_mfma_f32_16x16x32_bf16 v[76:79], v[248:251], a[76:79], v[76:79]
  s_mov_b32 s35, 1589248
  ds_read_b64_tr_b16 v[248:249], v2 offset:160
  s_waitcnt lgkmcnt(5)
  v_mfma_f32_16x16x32_bf16 v[64:67], v[252:255], a[80:83], v[64:67]
  ds_read_b64_tr_b16 v[250:251], v2 offset:8608
  v_mfma_f32_16x16x32_bf16 v[68:71], v[252:255], a[84:87], v[68:71]
  v_mfma_f32_16x16x32_bf16 v[72:75], v[252:255], a[88:91], v[72:75]
  buffer_load_dwordx4 v4, s[16:19], s35 offen lds
  v_mfma_f32_16x16x32_bf16 v[76:79], v[252:255], a[92:95], v[76:79]
  s_add_u32 m0, s34, 36960
  ds_read_b64_tr_b16 v[252:253], v2 offset:672
  s_waitcnt lgkmcnt(5)
  v_mfma_f32_16x16x32_bf16 v[80:83], v[240:243], a[64:67], v[80:83]
  s_mov_b32 s35, 1597440
  ds_read_b64_tr_b16 v[254:255], v2 offset:9120
  v_mfma_f32_16x16x32_bf16 v[84:87], v[240:243], a[68:71], v[84:87]
  v_mfma_f32_16x16x32_bf16 v[88:91], v[240:243], a[72:75], v[88:91]
  v_mfma_f32_16x16x32_bf16 v[92:95], v[240:243], a[76:79], v[92:95]
  ds_read_b64_tr_b16 v[240:241], v2 offset:192
  s_waitcnt lgkmcnt(5)
  v_mfma_f32_16x16x32_bf16 v[80:83], v[244:247], a[80:83], v[80:83]
  ds_read_b64_tr_b16 v[242:243], v2 offset:8640
  buffer_load_dwordx4 v4, s[16:19], s35 offen lds
  v_mfma_f32_16x16x32_bf16 v[84:87], v[244:247], a[84:87], v[84:87]
  s_add_u32 m0, s46, 118272
  v_mfma_f32_16x16x32_bf16 v[88:91], v[244:247], a[88:91], v[88:91]
  s_mov_b32 s43, 640
  v_mfma_f32_16x16x32_bf16 v[92:95], v[244:247], a[92:95], v[92:95]
  ds_read_b64_tr_b16 v[244:245], v2 offset:704
  s_waitcnt lgkmcnt(5)
  v_mfma_f32_16x16x32_bf16 v[96:99], v[248:251], a[64:67], v[96:99]
  ds_read_b64_tr_b16 v[246:247], v2 offset:9152
  v_mfma_f32_16x16x32_bf16 v[100:103], v[248:251], a[68:71], v[100:103]
  buffer_load_dwordx4 v12, s[4:7], s43 offen lds
  v_mfma_f32_16x16x32_bf16 v[104:107], v[248:251], a[72:75], v[104:107]
  s_add_u32 m0, s46, 119296
  v_mfma_f32_16x16x32_bf16 v[108:111], v[248:251], a[76:79], v[108:111]
  s_mov_b32 s43, 640
  ds_read_b64_tr_b16 v[248:249], v2 offset:224
  s_waitcnt lgkmcnt(5)
  v_mfma_f32_16x16x32_bf16 v[96:99], v[252:255], a[80:83], v[96:99]
  ds_read_b64_tr_b16 v[250:251], v2 offset:8672
  v_mfma_f32_16x16x32_bf16 v[100:103], v[252:255], a[84:87], v[100:103]
  v_mfma_f32_16x16x32_bf16 v[104:107], v[252:255], a[88:91], v[104:107]
  buffer_load_dwordx4 v13, s[4:7], s43 offen lds
  v_mfma_f32_16x16x32_bf16 v[108:111], v[252:255], a[92:95], v[108:111]
  s_add_u32 m0, s46, 120320
  ds_read_b64_tr_b16 v[252:253], v2 offset:736
  s_waitcnt vmcnt(6)
  s_barrier
  s_waitcnt lgkmcnt(5)
  v_mfma_f32_16x16x32_bf16 v[112:115], v[240:243], a[64:67], v[112:115]
  s_mov_b32 s43, 14976
  ds_read_b64_tr_b16 v[254:255], v2 offset:9184
  v_mfma_f32_16x16x32_bf16 v[116:119], v[240:243], a[68:71], v[116:119]
  v_mfma_f32_16x16x32_bf16 v[120:123], v[240:243], a[72:75], v[120:123]
  v_mfma_f32_16x16x32_bf16 v[124:127], v[240:243], a[76:79], v[124:127]
  ds_read_b64_tr_b16 v[240:241], v2 offset:16896
  s_waitcnt lgkmcnt(5)
  v_mfma_f32_16x16x32_bf16 v[112:115], v[244:247], a[80:83], v[112:115]
  ds_read_b64_tr_b16 v[242:243], v2 offset:25344
  buffer_load_dwordx4 v12, s[4:7], s43 offen lds
  v_mfma_f32_16x16x32_bf16 v[116:119], v[244:247], a[84:87], v[116:119]
  s_add_u32 m0, s46, 121344
  v_mfma_f32_16x16x32_bf16 v[120:123], v[244:247], a[88:91], v[120:123]
  s_mov_b32 s43, 14976
  v_mfma_f32_16x16x32_bf16 v[124:127], v[244:247], a[92:95], v[124:127]
  ds_read_b64_tr_b16 v[244:245], v2 offset:17408
  s_waitcnt lgkmcnt(5)
  v_mfma_f32_16x16x32_bf16 v[128:131], v[248:251], a[64:67], v[128:131]
  ds_read_b64_tr_b16 v[246:247], v2 offset:25856
  v_mfma_f32_16x16x32_bf16 v[132:135], v[248:251], a[68:71], v[132:135]
  buffer_load_dwordx4 v13, s[4:7], s43 offen lds
  v_mfma_f32_16x16x32_bf16 v[136:139], v[248:251], a[72:75], v[136:139]
  s_add_u32 m0, s46, 122368
  v_mfma_f32_16x16x32_bf16 v[140:143], v[248:251], a[76:79], v[140:143]
  s_mov_b32 s43, 29312
  ds_read_b64_tr_b16 v[248:249], v2 offset:16928
  s_waitcnt lgkmcnt(5)
  v_mfma_f32_16x16x32_bf16 v[128:131], v[252:255], a[80:83], v[128:131]
  ds_read_b64_tr_b16 v[250:251], v2 offset:25376
  v_mfma_f32_16x16x32_bf16 v[132:135], v[252:255], a[84:87], v[132:135]
  v_mfma_f32_16x16x32_bf16 v[136:139], v[252:255], a[88:91], v[136:139]
  buffer_load_dwordx4 v12, s[4:7], s43 offen lds
  v_mfma_f32_16x16x32_bf16 v[140:143], v[252:255], a[92:95], v[140:143]
  s_add_u32 m0, s46, 123392
  ds_read_b64_tr_b16 v[252:253], v2 offset:17440
  s_waitcnt lgkmcnt(5)
  v_mfma_f32_16x16x32_bf16 v[144:147], v[240:243], a[64:67], v[144:147]
  s_mov_b32 s43, 29312
  ds_read_b64_tr_b16 v[254:255], v2 offset:25888
  v_mfma_f32_16x16x32_bf16 v[148:151], v[240:243], a[68:71], v[148:151]
  v_mfma_f32_16x16x32_bf16 v[152:155], v[240:243], a[72:75], v[152:155]
  v_mfma_f32_16x16x32_bf16 v[156:159], v[240:243], a[76:79], v[156:159]
  ds_read_b64_tr_b16 v[240:241], v2 offset:16960
  s_waitcnt lgkmcnt(5)
  v_mfma_f32_16x16x32_bf16 v[144:147], v[244:247], a[80:83], v[144:147]
  ds_read_b64_tr_b16 v[242:243], v2 offset:25408
  buffer_load_dwordx4 v13, s[4:7], s43 offen lds
  v_mfma_f32_16x16x32_bf16 v[148:151], v[244:247], a[84:87], v[148:151]
  s_add_u32 m0, s46, 124416
  v_mfma_f32_16x16x32_bf16 v[152:155], v[244:247], a[88:91], v[152:155]
  s_mov_b32 s43, 43648
  v_mfma_f32_16x16x32_bf16 v[156:159], v[244:247], a[92:95], v[156:159]
  ds_read_b64_tr_b16 v[244:245], v2 offset:17472
  s_waitcnt lgkmcnt(5)
  v_mfma_f32_16x16x32_bf16 v[160:163], v[248:251], a[64:67], v[160:163]
  ds_read_b64_tr_b16 v[246:247], v2 offset:25920
  v_mfma_f32_16x16x32_bf16 v[164:167], v[248:251], a[68:71], v[164:167]
  buffer_load_dwordx4 v12, s[4:7], s43 offen lds
  v_mfma_f32_16x16x32_bf16 v[168:171], v[248:251], a[72:75], v[168:171]
  s_add_u32 m0, s46, 125440
  v_mfma_f32_16x16x32_bf16 v[172:175], v[248:251], a[76:79], v[172:175]
  s_mov_b32 s43, 43648
  ds_read_b64_tr_b16 v[248:249], v2 offset:16992
  s_waitcnt lgkmcnt(5)
  v_mfma_f32_16x16x32_bf16 v[160:163], v[252:255], a[80:83], v[160:163]
  ds_read_b64_tr_b16 v[250:251], v2 offset:25440
  v_mfma_f32_16x16x32_bf16 v[164:167], v[252:255], a[84:87], v[164:167]
  v_mfma_f32_16x16x32_bf16 v[168:171], v[252:255], a[88:91], v[168:171]
  buffer_load_dwordx4 v13, s[4:7], s43 offen lds
  v_mfma_f32_16x16x32_bf16 v[172:175], v[252:255], a[92:95], v[172:175]
  s_add_u32 m0, s34, 50688
  ds_read_b64_tr_b16 v[252:253], v2 offset:17504
  s_waitcnt lgkmcnt(5)
  v_mfma_f32_16x16x32_bf16 v[176:179], v[240:243], a[64:67], v[176:179]
  s_mov_b32 s35, 1573120
  ds_read_b64_tr_b16 v[254:255], v2 offset:25952
  v_mfma_f32_16x16x32_bf16 v[180:183], v[240:243], a[68:71], v[180:183]
  v_mfma_f32_16x16x32_bf16 v[184:187], v[240:243], a[72:75], v[184:187]
  v_mfma_f32_16x16x32_bf16 v[188:191], v[240:243], a[76:79], v[188:191]
  ds_read_b64_tr_b16 v[240:241], v2 offset:17024
  s_waitcnt lgkmcnt(5)
  v_mfma_f32_16x16x32_bf16 v[176:179], v[244:247], a[80:83], v[176:179]
  ds_read_b64_tr_b16 v[242:243], v2 offset:25472
  buffer_load_dwordx4 v4, s[16:19], s35 offen lds
  v_mfma_f32_16x16x32_bf16 v[180:183], v[244:247], a[84:87], v[180:183]
  s_add_u32 m0, s34, 51744
  v_mfma_f32_16x16x32_bf16 v[184:187], v[244:247], a[88:91], v[184:187]
  s_mov_b32 s35, 1581312
  v_mfma_f32_16x16x32_bf16 v[188:191], v[244:247], a[92:95], v[188:191]
  ds_read_b64_tr_b16 v[244:245], v2 offset:17536
  s_waitcnt lgkmcnt(5)
  v_mfma_f32_16x16x32_bf16 v[192:195], v[248:251], a[64:67], v[192:195]
  ds_read_b64_tr_b16 v[246:247], v2 offset:25984
  v_mfma_f32_16x16x32_bf16 v[196:199], v[248:251], a[68:71], v[196:199]
  buffer_load_dwordx4 v4, s[16:19], s35 offen lds
  v_mfma_f32_16x16x32_bf16 v[200:203], v[248:251], a[72:75], v[200:203]
  s_add_u32 m0, s34, 52800
  v_mfma_f32_16x16x32_bf16 v[204:207], v[248:251], a[76:79], v[204:207]
  s_mov_b32 s35, 1589504
  ds_read_b64_tr_b16 v[248:249], v2 offset:17056
  s_waitcnt lgkmcnt(5)
  v_mfma_f32_16x16x32_bf16 v[192:195], v[252:255], a[80:83], v[192:195]
  ds_read_b64_tr_b16 v[250:251], v2 offset:25504
  v_mfma_f32_16x16x32_bf16 v[196:199], v[252:255], a[84:87], v[196:199]
  v_mfma_f32_16x16x32_bf16 v[200:203], v[252:255], a[88:91], v[200:203]
  buffer_load_dwordx4 v4, s[16:19], s35 offen lds
  v_mfma_f32_16x16x32_bf16 v[204:207], v[252:255], a[92:95], v[204:207]
  s_add_u32 m0, s34, 53856
  ds_read_b64_tr_b16 v[252:253], v2 offset:17568
  s_waitcnt lgkmcnt(5)
  v_mfma_f32_16x16x32_bf16 v[208:211], v[240:243], a[64:67], v[208:211]
  s_mov_b32 s35, 1597696
  ds_read_b64_tr_b16 v[254:255], v2 offset:26016
  v_mfma_f32_16x16x32_bf16 v[212:215], v[240:243], a[68:71], v[212:215]
  ds_read_b128 a[32:35], v14 offset:0
  ds_read_b128 a[36:39], v14 offset:2048
  v_mfma_f32_16x16x32_bf16 v[216:219], v[240:243], a[72:75], v[216:219]
  ds_read_b128 a[40:43], v14 offset:4096
  ds_read_b128 a[44:47], v14 offset:6144
  v_mfma_f32_16x16x32_bf16 v[220:223], v[240:243], a[76:79], v[220:223]
  ds_read_b64_tr_b16 v[240:241], v2 offset:17088
  s_waitcnt lgkmcnt(9)
  v_mfma_f32_16x16x32_bf16 v[208:211], v[244:247], a[80:83], v[208:211]
  ds_read_b64_tr_b16 v[242:243], v2 offset:25536
  buffer_load_dwordx4 v4, s[16:19], s35 offen lds
  v_mfma_f32_16x16x32_bf16 v[212:215], v[244:247], a[84:87], v[212:215]
  ds_read_b128 a[48:51], v15 offset:0
  ds_read_b128 a[52:55], v15 offset:2048
  v_mfma_f32_16x16x32_bf16 v[216:219], v[244:247], a[88:91], v[216:219]
  ds_read_b128 a[56:59], v15 offset:4096
  ds_read_b128 a[60:63], v15 offset:6144
  v_mfma_f32_16x16x32_bf16 v[220:223], v[244:247], a[92:95], v[220:223]
  s_waitcnt lgkmcnt(12)
  ds_read_b64_tr_b16 v[244:245], v2 offset:17600
  s_waitcnt lgkmcnt(1)
  v_mfma_f32_16x16x32_bf16 v[224:227], v[248:251], a[64:67], v[224:227]
  ds_read_b64_tr_b16 v[246:247], v2 offset:26048
  v_mfma_f32_16x16x32_bf16 v[228:231], v[248:251], a[68:71], v[228:231]
  s_add_u32 m0, s46, 84480
  v_mfma_f32_16x16x32_bf16 v[232:235], v[248:251], a[72:75], v[232:235]
  s_mov_b32 s43, 768
  v_mfma_f32_16x16x32_bf16 v[236:239], v[248:251], a[76:79], v[236:239]
  ds_read_b64_tr_b16 v[248:249], v2 offset:17120
  buffer_load_dwordx4 v12, s[4:7], s43 offen lds
  v_mfma_f32_16x16x32_bf16 v[224:227], v[252:255], a[80:83], v[224:227]
  s_add_u32 m0, s46, 85504
  ds_read_b64_tr_b16 v[250:251], v2 offset:25568
  v_mfma_f32_16x16x32_bf16 v[228:231], v[252:255], a[84:87], v[228:231]
  s_mov_b32 s43, 768
  v_mfma_f32_16x16x32_bf16 v[232:235], v[252:255], a[88:91], v[232:235]
  v_mfma_f32_16x16x32_bf16 v[236:239], v[252:255], a[92:95], v[236:239]
  ds_read_b64_tr_b16 v[252:253], v2 offset:17632
  s_waitcnt vmcnt(13)
  s_barrier
  v_mfma_f32_16x16x32_bf16 a[224:227], v[240:243], a[64:67], a[224:227]
  ds_read_b64_tr_b16 v[254:255], v2 offset:26080
  buffer_load_dwordx4 v13, s[4:7], s43 offen lds
  v_mfma_f32_16x16x32_bf16 a[228:231], v[240:243], a[68:71], a[228:231]
  s_add_u32 m0, s46, 86528
  v_mfma_f32_16x16x32_bf16 a[232:235], v[240:243], a[72:75], a[232:235]
  s_mov_b32 s43, 15104
  v_mfma_f32_16x16x32_bf16 a[236:239], v[240:243], a[76:79], a[236:239]
  ds_read_b64_tr_b16 v[240:241], v2 offset:33792
  s_waitcnt lgkmcnt(5)
  v_mfma_f32_16x16x32_bf16 a[224:227], v[244:247], a[80:83], a[224:227]
  ds_read_b64_tr_b16 v[242:243], v2 offset:42240
  v_mfma_f32_16x16x32_bf16 a[228:231], v[244:247], a[84:87], a[228:231]
  buffer_load_dwordx4 v12, s[4:7], s43 offen lds
  v_mfma_f32_16x16x32_bf16 a[232:235], v[244:247], a[88:91], a[232:235]
  s_add_u32 m0, s46, 87552
  v_mfma_f32_16x16x32_bf16 a[236:239], v[244:247], a[92:95], a[236:239]
  s_mov_b32 s43, 15104
  ds_read_b64_tr_b16 v[244:245], v2 offset:34304
  s_waitcnt lgkmcnt(5)
  v_mfma_f32_16x16x32_bf16 a[240:243], v[248:251], a[64:67], a[240:243]
  ds_read_b64_tr_b16 v[246:247], v2 offset:42752
  v_mfma_f32_16x16x32_bf16 a[244:247], v[248:251], a[68:71], a[244:247]
  v_mfma_f32_16x16x32_bf16 a[248:251], v[248:251], a[72:75], a[248:251]
  buffer_load_dwordx4 v13, s[4:7], s43 offen lds
  v_mfma_f32_16x16x32_bf16 a[252:255], v[248:251], a[76:79], a[252:255]
  s_add_u32 m0, s46, 88576
  ds_read_b64_tr_b16 v[248:249], v2 offset:33824
  s_waitcnt lgkmcnt(5)
  v_mfma_f32_16x16x32_bf16 a[240:243], v[252:255], a[80:83], a[240:243]
  s_mov_b32 s43, 29440
  ds_read_b64_tr_b16 v[250:251], v2 offset:42272
  v_mfma_f32_16x16x32_bf16 a[244:247], v[252:255], a[84:87], a[244:247]
  v_mfma_f32_16x16x32_bf16 a[248:251], v[252:255], a[88:91], a[248:251]
  v_mfma_f32_16x16x32_bf16 a[252:255], v[252:255], a[92:95], a[252:255]
  ds_read_b64_tr_b16 v[252:253], v2 offset:34336
  s_waitcnt lgkmcnt(5)
  v_mfma_f32_16x16x32_bf16 v[16:19], v[240:243], a[0:3], v[16:19]
  ds_read_b64_tr_b16 v[254:255], v2 offset:42784
  buffer_load_dwordx4 v12, s[4:7], s43 offen lds
  v_mfma_f32_16x16x32_bf16 v[20:23], v[240:243], a[4:7], v[20:23]
  s_add_u32 m0, s46, 89600
  v_mfma_f32_16x16x32_bf16 v[24:27], v[240:243], a[8:11], v[24:27]
  s_mov_b32 s43, 29440
  v_mfma_f32_16x16x32_bf16 v[28:31], v[240:243], a[12:15], v[28:31]
  ds_read_b64_tr_b16 v[240:241], v2 offset:33856
  s_waitcnt lgkmcnt(5)
  v_mfma_f32_16x16x32_bf16 v[16:19], v[244:247], a[16:19], v[16:19]
  ds_read_b64_tr_b16 v[242:243], v2 offset:42304
  v_mfma_f32_16x16x32_bf16 v[20:23], v[244:247], a[20:23], v[20:23]
  buffer_load_dwordx4 v13, s[4:7], s43 offen lds
  v_mfma_f32_16x16x32_bf16 v[24:27], v[244:247], a[24:27], v[24:27]
  s_add_u32 m0, s46, 90624
  v_mfma_f32_16x16x32_bf16 v[28:31], v[244:247], a[28:31], v[28:31]
  s_mov_b32 s43, 43776
  ds_read_b64_tr_b16 v[244:245], v2 offset:34368
  s_waitcnt lgkmcnt(5)
  v_mfma_f32_16x16x32_bf16 v[32:35], v[248:251], a[0:3], v[32:35]
  ds_read_b64_tr_b16 v[246:247], v2 offset:42816
  v_mfma_f32_16x16x32_bf16 v[36:39], v[248:251], a[4:7], v[36:39]
  v_mfma_f32_16x16x32_bf16 v[40:43], v[248:251], a[8:11], v[40:43]
  buffer_load_dwordx4 v12, s[4:7], s43 offen lds
  v_mfma_f32_16x16x32_bf16 v[44:47], v[248:251], a[12:15], v[44:47]
  s_add_u32 m0, s46, 91648
  ds_read_b64_tr_b16 v[248:249], v2 offset:33888
  s_waitcnt lgkmcnt(5)
  v_mfma_f32_16x16x32_bf16 v[32:35], v[252:255], a[16:19], v[32:35]
  s_mov_b32 s43, 43776
  ds_read_b64_tr_b16 v[250:251], v2 offset:42336
  v_mfma_f32_16x16x32_bf16 v[36:39], v[252:255], a[20:23], v[36:39]
  v_mfma_f32_16x16x32_bf16 v[40:43], v[252:255], a[24:27], v[40:43]
  v_mfma_f32_16x16x32_bf16 v[44:47], v[252:255], a[28:31], v[44:47]
  ds_read_b64_tr_b16 v[252:253], v2 offset:34400
  s_waitcnt lgkmcnt(5)
  v_mfma_f32_16x16x32_bf16 v[48:51], v[240:243], a[0:3], v[48:51]
  ds_read_b64_tr_b16 v[254:255], v2 offset:42848
  buffer_load_dwordx4 v13, s[4:7], s43 offen lds
  v_mfma_f32_16x16x32_bf16 v[52:55], v[240:243], a[4:7], v[52:55]
  s_add_u32 m0, s34, 0
  v_mfma_f32_16x16x32_bf16 v[56:59], v[240:243], a[8:11], v[56:59]
  s_mov_b32 s35, 2097152
  v_mfma_f32_16x16x32_bf16 v[60:63], v[240:243], a[12:15], v[60:63]
  ds_read_b64_tr_b16 v[240:241], v2 offset:33920
  s_waitcnt lgkmcnt(5)
  v_mfma_f32_16x16x32_bf16 v[48:51], v[244:247], a[16:19], v[48:51]
  ds_read_b64_tr_b16 v[242:243], v2 offset:42368
  v_mfma_f32_16x16x32_bf16 v[52:55], v[244:247], a[20:23], v[52:55]
  buffer_load_dwordx4 v4, s[16:19], s35 offen lds
  v_mfma_f32_16x16x32_bf16 v[56:59], v[244:247], a[24:27], v[56:59]
  s_add_u32 m0, s34, 1056
  v_mfma_f32_16x16x32_bf16 v[60:63], v[244:247], a[28:31], v[60:63]
  s_mov_b32 s35, 2105344
  ds_read_b64_tr_b16 v[244:245], v2 offset:34432
  s_waitcnt lgkmcnt(5)
  v_mfma_f32_16x16x32_bf16 v[64:67], v[248:251], a[0:3], v[64:67]
  ds_read_b64_tr_b16 v[246:247], v2 offset:42880
  v_mfma_f32_16x16x32_bf16 v[68:71], v[248:251], a[4:7], v[68:71]
  v_mfma_f32_16x16x32_bf16 v[72:75], v[248:251], a[8:11], v[72:75]
  buffer_load_dwordx4 v4, s[16:19], s35 offen lds
  v_mfma_f32_16x16x32_bf16 v[76:79], v[248:251], a[12:15], v[76:79]
  s_add_u32 m0, s34, 2112
  ds_read_b64_tr_b16 v[248:249], v2 offset:33952
  s_waitcnt lgkmcnt(5)
  v_mfma_f32_16x16x32_bf16 v[64:67], v[252:255], a[16:19], v[64:67]
  s_mov_b32 s35, 2113536
  ds_read_b64_tr_b16 v[250:251], v2 offset:42400
  v_mfma_f32_16x16x32_bf16 v[68:71], v[252:255], a[20:23], v[68:71]
  v_mfma_f32_16x16x32_bf16 v[72:75], v[252:255], a[24:27], v[72:75]
  v_mfma_f32_16x16x32_bf16 v[76:79], v[252:255], a[28:31], v[76:79]
  ds_read_b64_tr_b16 v[252:253], v2 offset:34464
  s_waitcnt lgkmcnt(5)
  v_mfma_f32_16x16x32_bf16 v[80:83], v[240:243], a[0:3], v[80:83]
  ds_read_b64_tr_b16 v[254:255], v2 offset:42912
  buffer_load_dwordx4 v4, s[16:19], s35 offen lds
  v_mfma_f32_16x16x32_bf16 v[84:87], v[240:243], a[4:7], v[84:87]
  s_add_u32 m0, s34, 3168
  v_mfma_f32_16x16x32_bf16 v[88:91], v[240:243], a[8:11], v[88:91]
  s_mov_b32 s35, 2121728
  v_mfma_f32_16x16x32_bf16 v[92:95], v[240:243], a[12:15], v[92:95]
  ds_read_b64_tr_b16 v[240:241], v2 offset:33984
  s_waitcnt lgkmcnt(5)
  v_mfma_f32_16x16x32_bf16 v[80:83], v[244:247], a[16:19], v[80:83]
  ds_read_b64_tr_b16 v[242:243], v2 offset:42432
  v_mfma_f32_16x16x32_bf16 v[84:87], v[244:247], a[20:23], v[84:87]
  buffer_load_dwordx4 v4, s[16:19], s35 offen lds
  v_mfma_f32_16x16x32_bf16 v[88:91], v[244:247], a[24:27], v[88:91]
  v_mfma_f32_16x16x32_bf16 v[92:95], v[244:247], a[28:31], v[92:95]
  ds_read_b64_tr_b16 v[244:245], v2 offset:34496
  s_waitcnt lgkmcnt(5)
  v_mfma_f32_16x16x32_bf16 v[96:99], v[248:251], a[0:3], v[96:99]
  ds_read_b64_tr_b16 v[246:247], v2 offset:42944
  v_mfma_f32_16x16x32_bf16 v[100:103], v[248:251], a[4:7], v[100:103]
  v_mfma_f32_16x16x32_bf16 v[104:107], v[248:251], a[8:11], v[104:107]
  v_mfma_f32_16x16x32_bf16 v[108:111], v[248:251], a[12:15], v[108:111]
  ds_read_b64_tr_b16 v[248:249], v2 offset:34016
  s_waitcnt lgkmcnt(5)
  v_mfma_f32_16x16x32_bf16 v[96:99], v[252:255], a[16:19], v[96:99]
  ds_read_b64_tr_b16 v[250:251], v2 offset:42464
  v_mfma_f32_16x16x32_bf16 v[100:103], v[252:255], a[20:23], v[100:103]
  v_mfma_f32_16x16x32_bf16 v[104:107], v[252:255], a[24:27], v[104:107]
  v_mfma_f32_16x16x32_bf16 v[108:111], v[252:255], a[28:31], v[108:111]
  ds_read_b64_tr_b16 v[252:253], v2 offset:34528
  s_waitcnt vmcnt(12)
  s_barrier
  s_waitcnt lgkmcnt(5)
  v_mfma_f32_16x16x32_bf16 v[112:115], v[240:243], a[0:3], v[112:115]
  s_add_u32 m0, s34, 16896
  ds_read_b64_tr_b16 v[254:255], v2 offset:42976
  v_mfma_f32_16x16x32_bf16 v[116:119], v[240:243], a[4:7], v[116:119]
  s_mov_b32 s35, 2097408
  v_mfma_f32_16x16x32_bf16 v[120:123], v[240:243], a[8:11], v[120:123]
  buffer_load_dwordx4 v4, s[16:19], s35 offen lds
  v_mfma_f32_16x16x32_bf16 v[124:127], v[240:243], a[12:15], v[124:127]
  s_add_u32 m0, s34, 17952
  v_add_u32 v2, 50688, v2
  ds_read_b64_tr_b16 v[240:241], v2 offset:0
  s_waitcnt lgkmcnt(5)
  v_mfma_f32_16x16x32_bf16 v[112:115], v[244:247], a[16:19], v[112:115]
  s_mov_b32 s35, 2105600
  ds_read_b64_tr_b16 v[242:243], v2 offset:8448
  v_mfma_f32_16x16x32_bf16 v[116:119], v[244:247], a[20:23], v[116:119]
  v_mfma_f32_16x16x32_bf16 v[120:123], v[244:247], a[24:27], v[120:123]
  v_mfma_f32_16x16x32_bf16 v[124:127], v[244:247], a[28:31], v[124:127]
  ds_read_b64_tr_b16 v[244:245], v2 offset:512
  s_waitcnt lgkmcnt(5)
  v_mfma_f32_16x16x32_bf16 v[128:131], v[248:251], a[0:3], v[128:131]
  ds_read_b64_tr_b16 v[246:247], v2 offset:8960
  buffer_load_dwordx4 v4, s[16:19], s35 offen lds
  v_mfma_f32_16x16x32_bf16 v[132:135], v[248:251], a[4:7], v[132:135]
  s_add_u32 m0, s34, 19008
  v_mfma_f32_16x16x32_bf16 v[136:139], v[248:251], a[8:11], v[136:139]
  s_mov_b32 s35, 2113792
  v_mfma_f32_16x16x32_bf16 v[140:143], v[248:251], a[12:15], v[140:143]
  ds_read_b64_tr_b16 v[248:249], v2 offset:32
  s_waitcnt lgkmcnt(5)
  v_mfma_f32_16x16x32_bf16 v[128:131], v[252:255], a[16:19], v[128:131]
  ds_read_b64_tr_b16 v[250:251], v2 offset:8480
  v_mfma_f32_16x16x32_bf16 v[132:135], v[252:255], a[20:23], v[132:135]
  buffer_load_dwordx4 v4, s[16:19], s35 offen lds
  v_mfma_f32_16x16x32_bf16 v[136:139], v[252:255], a[24:27], v[136:139]
  s_add_u32 m0, s34, 20064
  v_mfma_f32_16x16x32_bf16 v[140:143], v[252:255], a[28:31], v[140:143]
  s_mov_b32 s35, 2121984
  ds_read_b64_tr_b16 v[252:253], v2 offset:544
  s_waitcnt lgkmcnt(5)
  v_mfma_f32_16x16x32_bf16 v[144:147], v[240:243], a[0:3], v[144:147]
  ds_read_b64_tr_b16 v[254:255], v2 offset:8992
  v_mfma_f32_16x16x32_bf16 v[148:151], v[240:243], a[4:7], v[148:151]
  ds_read_b128 a[64:67], v14 offset:33792
  ds_read_b128 a[68:71], v14 offset:35840
  v_mfma_f32_16x16x32_bf16 v[152:155], v[240:243], a[8:11], v[152:155]
  buffer_load_dwordx4 v4, s[16:19], s35 offen lds
  ds_read_b128 a[72:75], v14 offset:37888
  v_mfma_f32_16x16x32_bf16 v[156:159], v[240:243], a[12:15], v[156:159]
  ds_read_b64_tr_b16 v[240:241], v2 offset:64
  s_waitcnt lgkmcnt(8)
  v_mfma_f32_16x16x32_bf16 v[144:147], v[244:247], a[16:19], v[144:147]
  ds_read_b64_tr_b16 v[242:243], v2 offset:8512
  ds_read_b128 a[76:79], v14 offset:39936
  v_mfma_f32_16x16x32_bf16 v[148:151], v[244:247], a[20:23], v[148:151]
  ds_read_b128 a[80:83], v15 offset:33792
  ds_read_b128 a[84:87], v15 offset:35840
  v_mfma_f32_16x16x32_bf16 v[152:155], v[244:247], a[24:27], v[152:155]
  ds_read_b128 a[88:91], v15 offset:37888
  ds_read_b128 a[92:95], v15 offset:39936
  v_mfma_f32_16x16x32_bf16 v[156:159], v[244:247], a[28:31], v[156:159]
  s_waitcnt lgkmcnt(12)
  ds_read_b64_tr_b16 v[244:245], v2 offset:576
  s_waitcnt lgkmcnt(1)
  v_mfma_f32_16x16x32_bf16 v[160:163], v[248:251], a[0:3], v[160:163]
  ds_read_b64_tr_b16 v[246:247], v2 offset:9024
  v_mfma_f32_16x16x32_bf16 v[164:167], v[248:251], a[4:7], v[164:167]
  v_mfma_f32_16x16x32_bf16 v[168:171], v[248:251], a[8:11], v[168:171]
  v_mfma_f32_16x16x32_bf16 v[172:175], v[248:251], a[12:15], v[172:175]
  ds_read_b64_tr_b16 v[248:249], v2 offset:96
  v_mfma_f32_16x16x32_bf16 v[160:163], v[252:255], a[16:19], v[160:163]
  ds_read_b64_tr_b16 v[250:251], v2 offset:8544
  v_mfma_f32_16x16x32_bf16 v[164:167], v[252:255], a[20:23], v[164:167]
  v_mfma_f32_16x16x32_bf16 v[168:171], v[252:255], a[24:27], v[168:171]
  v_mfma_f32_16x16x32_bf16 v[172:175], v[252:255], a[28:31], v[172:175]
  ds_read_b64_tr_b16 v[252:253], v2 offset:608
  v_mfma_f32_16x16x32_bf16 v[176:179], v[240:243], a[0:3], v[176:179]
  ds_read_b64_tr_b16 v[254:255], v2 offset:9056
  v_mfma_f32_16x16x32_bf16 v[180:183], v[240:243], a[4:7], v[180:183]
  v_mfma_f32_16x16x32_bf16 v[184:187], v[240:243], a[8:11], v[184:187]
  v_mfma_f32_16x16x32_bf16 v[188:191], v[240:243], a[12:15], v[188:191]
  ds_read_b64_tr_b16 v[240:241], v2 offset:128
  s_waitcnt lgkmcnt(5)
  v_mfma_f32_16x16x32_bf16 v[176:179], v[244:247], a[16:19], v[176:179]
  ds_read_b64_tr_b16 v[242:243], v2 offset:8576
  v_mfma_f32_16x16x32_bf16 v[180:183], v[244:247], a[20:23], v[180:183]
  v_mfma_f32_16x16x32_bf16 v[184:187], v[244:247], a[24:27], v[184:187]
  v_mfma_f32_16x16x32_bf16 v[188:191], v[244:247], a[28:31], v[188:191]
  ds_read_b64_tr_b16 v[244:245], v2 offset:640
  s_waitcnt lgkmcnt(5)
  v_mfma_f32_16x16x32_bf16 v[192:195], v[248:251], a[0:3], v[192:195]
  ds_read_b64_tr_b16 v[246:247], v2 offset:9088
  v_mfma_f32_16x16x32_bf16 v[196:199], v[248:251], a[4:7], v[196:199]
  v_mfma_f32_16x16x32_bf16 v[200:203], v[248:251], a[8:11], v[200:203]
  v_mfma_f32_16x16x32_bf16 v[204:207], v[248:251], a[12:15], v[204:207]
  ds_read_b64_tr_b16 v[248:249], v2 offset:160
  s_waitcnt lgkmcnt(5)
  v_mfma_f32_16x16x32_bf16 v[192:195], v[252:255], a[16:19], v[192:195]
  ds_read_b64_tr_b16 v[250:251], v2 offset:8608
  v_mfma_f32_16x16x32_bf16 v[196:199], v[252:255], a[20:23], v[196:199]
  v_mfma_f32_16x16x32_bf16 v[200:203], v[252:255], a[24:27], v[200:203]
  v_mfma_f32_16x16x32_bf16 v[204:207], v[252:255], a[28:31], v[204:207]
  ds_read_b64_tr_b16 v[252:253], v2 offset:672
  s_waitcnt lgkmcnt(5)
  v_mfma_f32_16x16x32_bf16 v[208:211], v[240:243], a[0:3], v[208:211]
  ds_read_b64_tr_b16 v[254:255], v2 offset:9120
  v_mfma_f32_16x16x32_bf16 v[212:215], v[240:243], a[4:7], v[212:215]
  v_mfma_f32_16x16x32_bf16 v[216:219], v[240:243], a[8:11], v[216:219]
  v_mfma_f32_16x16x32_bf16 v[220:223], v[240:243], a[12:15], v[220:223]
  ds_read_b64_tr_b16 v[240:241], v2 offset:192
  s_waitcnt lgkmcnt(5)
  v_mfma_f32_16x16x32_bf16 v[208:211], v[244:247], a[16:19], v[208:211]
  ds_read_b64_tr_b16 v[242:243], v2 offset:8640
  v_mfma_f32_16x16x32_bf16 v[212:215], v[244:247], a[20:23], v[212:215]
  v_mfma_f32_16x16x32_bf16 v[216:219], v[244:247], a[24:27], v[216:219]
  v_mfma_f32_16x16x32_bf16 v[220:223], v[244:247], a[28:31], v[220:223]
  ds_read_b64_tr_b16 v[244:245], v2 offset:704
  s_waitcnt lgkmcnt(5)
  v_mfma_f32_16x16x32_bf16 v[224:227], v[248:251], a[0:3], v[224:227]
  ds_read_b64_tr_b16 v[246:247], v2 offset:9152
  v_mfma_f32_16x16x32_bf16 v[228:231], v[248:251], a[4:7], v[228:231]
  v_mfma_f32_16x16x32_bf16 v[232:235], v[248:251], a[8:11], v[232:235]
  v_mfma_f32_16x16x32_bf16 v[236:239], v[248:251], a[12:15], v[236:239]
  ds_read_b64_tr_b16 v[248:249], v2 offset:224
  s_waitcnt lgkmcnt(5)
  v_mfma_f32_16x16x32_bf16 v[224:227], v[252:255], a[16:19], v[224:227]
  ds_read_b64_tr_b16 v[250:251], v2 offset:8672
  v_mfma_f32_16x16x32_bf16 v[228:231], v[252:255], a[20:23], v[228:231]
  v_mfma_f32_16x16x32_bf16 v[232:235], v[252:255], a[24:27], v[232:235]
  v_mfma_f32_16x16x32_bf16 v[236:239], v[252:255], a[28:31], v[236:239]
  ds_read_b64_tr_b16 v[252:253], v2 offset:736
  s_waitcnt vmcnt(4)
  s_barrier
  s_waitcnt lgkmcnt(5)
  v_mfma_f32_16x16x32_bf16 a[224:227], v[240:243], a[0:3], a[224:227]
  s_add_u32 m0, s34, 33792
  ds_read_b64_tr_b16 v[254:255], v2 offset:9184
  v_mfma_f32_16x16x32_bf16 a[228:231], v[240:243], a[4:7], a[228:231]
  s_mov_b32 s35, 2621440
  v_mfma_f32_16x16x32_bf16 a[232:235], v[240:243], a[8:11], a[232:235]
  buffer_load_dwordx4 v4, s[16:19], s35 offen lds
  v_mfma_f32_16x16x32_bf16 a[236:239], v[240:243], a[12:15], a[236:239]
  s_add_u32 m0, s34, 34848
  v_subrev_u32 v2, 50688, v2
  ds_read_b64_tr_b16 v[240:241], v2 offset:0
  s_waitcnt lgkmcnt(5)
  v_mfma_f32_16x16x32_bf16 a[224:227], v[244:247], a[16:19], a[224:227]
  s_mov_b32 s35, 2629632
  ds_read_b64_tr_b16 v[242:243], v2 offset:8448
  v_mfma_f32_16x16x32_bf16 a[228:231], v[244:247], a[20:23], a[228:231]
  v_mfma_f32_16x16x32_bf16 a[232:235], v[244:247], a[24:27], a[232:235]
  v_mfma_f32_16x16x32_bf16 a[236:239], v[244:247], a[28:31], a[236:239]
  ds_read_b64_tr_b16 v[244:245], v2 offset:512
  s_waitcnt lgkmcnt(5)
  v_mfma_f32_16x16x32_bf16 a[240:243], v[248:251], a[0:3], a[240:243]
  ds_read_b64_tr_b16 v[246:247], v2 offset:8960
  buffer_load_dwordx4 v4, s[16:19], s35 offen lds
  v_mfma_f32_16x16x32_bf16 a[244:247], v[248:251], a[4:7], a[244:247]
  s_add_u32 m0, s34, 35904
  v_mfma_f32_16x16x32_bf16 a[248:251], v[248:251], a[8:11], a[248:251]
  s_mov_b32 s35, 2637824
  v_mfma_f32_16x16x32_bf16 a[252:255], v[248:251], a[12:15], a[252:255]
  ds_read_b64_tr_b16 v[248:249], v2 offset:32
  s_waitcnt lgkmcnt(5)
  v_mfma_f32_16x16x32_bf16 a[240:243], v[252:255], a[16:19], a[240:243]
  ds_read_b64_tr_b16 v[250:251], v2 offset:8480
  v_mfma_f32_16x16x32_bf16 a[244:247], v[252:255], a[20:23], a[244:247]
  buffer_load_dwordx4 v4, s[16:19], s35 offen lds
  v_mfma_f32_16x16x32_bf16 a[248:251], v[252:255], a[24:27], a[248:251]
  s_add_u32 m0, s34, 36960
  v_mfma_f32_16x16x32_bf16 a[252:255], v[252:255], a[28:31], a[252:255]
  s_mov_b32 s35, 2646016
  ds_read_b64_tr_b16 v[252:253], v2 offset:544
  s_waitcnt lgkmcnt(5)
  v_mfma_f32_16x16x32_bf16 v[16:19], v[240:243], a[32:35], v[16:19]
  ds_read_b64_tr_b16 v[254:255], v2 offset:8992
  v_mfma_f32_16x16x32_bf16 v[20:23], v[240:243], a[36:39], v[20:23]
  v_mfma_f32_16x16x32_bf16 v[24:27], v[240:243], a[40:43], v[24:27]
  buffer_load_dwordx4 v4, s[16:19], s35 offen lds
  v_mfma_f32_16x16x32_bf16 v[28:31], v[240:243], a[44:47], v[28:31]
  s_mov_b32 s35, 16384
  ds_read_b64_tr_b16 v[240:241], v2 offset:64
  s_waitcnt lgkmcnt(5)
  v_mfma_f32_16x16x32_bf16 v[16:19], v[244:247], a[48:51], v[16:19]
  s_add_u32 m0, s33, 118272
  ds_read_b64_tr_b16 v[242:243], v2 offset:8512
  v_mfma_f32_16x16x32_bf16 v[20:23], v[244:247], a[52:55], v[20:23]
  v_mfma_f32_16x16x32_bf16 v[24:27], v[244:247], a[56:59], v[24:27]
  v_mfma_f32_16x16x32_bf16 v[28:31], v[244:247], a[60:63], v[28:31]
  ds_read_b64_tr_b16 v[244:245], v2 offset:576
  s_waitcnt lgkmcnt(5)
  v_mfma_f32_16x16x32_bf16 v[32:35], v[248:251], a[32:35], v[32:35]
  ds_read_b64_tr_b16 v[246:247], v2 offset:9024
  buffer_load_dwordx4 v3, s[8:11], s35 offen offset:0 nt lds
  v_mfma_f32_16x16x32_bf16 v[36:39], v[248:251], a[36:39], v[36:39]
  s_add_u32 m0, s33, 118800
  v_mfma_f32_16x16x32_bf16 v[40:43], v[248:251], a[40:43], v[40:43]
  v_mfma_f32_16x16x32_bf16 v[44:47], v[248:251], a[44:47], v[44:47]
  ds_read_b64_tr_b16 v[248:249], v2 offset:96
  s_waitcnt lgkmcnt(5)
  v_mfma_f32_16x16x32_bf16 v[32:35], v[252:255], a[48:51], v[32:35]
  ds_read_b64_tr_b16 v[250:251], v2 offset:8544
  v_mfma_f32_16x16x32_bf16 v[36:39], v[252:255], a[52:55], v[36:39]
  buffer_load_dwordx4 v3, s[8:11], s35 offen offset:512 nt lds
  v_mfma_f32_16x16x32_bf16 v[40:43], v[252:255], a[56:59], v[40:43]
  s_add_u32 m0, s33, 119328
  v_mfma_f32_16x16x32_bf16 v[44:47], v[252:255], a[60:63], v[44:47]
  ds_read_b64_tr_b16 v[252:253], v2 offset:608
  s_waitcnt lgkmcnt(5)
  v_mfma_f32_16x16x32_bf16 v[48:51], v[240:243], a[32:35], v[48:51]
  ds_read_b64_tr_b16 v[254:255], v2 offset:9056
  v_mfma_f32_16x16x32_bf16 v[52:55], v[240:243], a[36:39], v[52:55]
  v_mfma_f32_16x16x32_bf16 v[56:59], v[240:243], a[40:43], v[56:59]
  buffer_load_dwordx4 v3, s[8:11], s35 offen offset:1024 nt lds
  v_mfma_f32_16x16x32_bf16 v[60:63], v[240:243], a[44:47], v[60:63]
  s_add_u32 m0, s33, 119856
  ds_read_b64_tr_b16 v[240:241], v2 offset:128
  s_waitcnt lgkmcnt(5)
  v_mfma_f32_16x16x32_bf16 v[48:51], v[244:247], a[48:51], v[48:51]
  ds_read_b64_tr_b16 v[242:243], v2 offset:8576
  v_mfma_f32_16x16x32_bf16 v[52:55], v[244:247], a[52:55], v[52:55]
  v_mfma_f32_16x16x32_bf16 v[56:59], v[244:247], a[56:59], v[56:59]
  v_mfma_f32_16x16x32_bf16 v[60:63], v[244:247], a[60:63], v[60:63]
  ds_read_b64_tr_b16 v[244:245], v2 offset:640
  s_waitcnt lgkmcnt(5)
  v_mfma_f32_16x16x32_bf16 v[64:67], v[248:251], a[32:35], v[64:67]
  ds_read_b64_tr_b16 v[246:247], v2 offset:9088
  buffer_load_dwordx4 v3, s[8:11], s35 offen offset:1536 nt lds
  v_mfma_f32_16x16x32_bf16 v[68:71], v[248:251], a[36:39], v[68:71]
  v_mfma_f32_16x16x32_bf16 v[72:75], v[248:251], a[40:43], v[72:75]
  v_mfma_f32_16x16x32_bf16 v[76:79], v[248:251], a[44:47], v[76:79]
  ds_read_b64_tr_b16 v[248:249], v2 offset:160
  s_waitcnt lgkmcnt(5)
  v_mfma_f32_16x16x32_bf16 v[64:67], v[252:255], a[48:51], v[64:67]
  ds_read_b64_tr_b16 v[250:251], v2 offset:8608
  v_mfma_f32_16x16x32_bf16 v[68:71], v[252:255], a[52:55], v[68:71]
  v_mfma_f32_16x16x32_bf16 v[72:75], v[252:255], a[56:59], v[72:75]
  v_mfma_f32_16x16x32_bf16 v[76:79], v[252:255], a[60:63], v[76:79]
  ds_read_b64_tr_b16 v[252:253], v2 offset:672
  s_waitcnt lgkmcnt(5)
  v_mfma_f32_16x16x32_bf16 v[80:83], v[240:243], a[32:35], v[80:83]
  ds_read_b64_tr_b16 v[254:255], v2 offset:9120
  v_mfma_f32_16x16x32_bf16 v[84:87], v[240:243], a[36:39], v[84:87]
  ds_read_b128 a[0:3], v14 offset:0
  ds_read_b128 a[4:7], v14 offset:2048
  v_mfma_f32_16x16x32_bf16 v[88:91], v[240:243], a[40:43], v[88:91]
  ds_read_b128 a[8:11], v14 offset:4096
  ds_read_b128 a[12:15], v14 offset:6144
  v_mfma_f32_16x16x32_bf16 v[92:95], v[240:243], a[44:47], v[92:95]
  ds_read_b64_tr_b16 v[240:241], v2 offset:192
  s_waitcnt lgkmcnt(9)
  v_mfma_f32_16x16x32_bf16 v[80:83], v[244:247], a[48:51], v[80:83]
  ds_read_b64_tr_b16 v[242:243], v2 offset:8640
  ds_read_b128 a[16:19], v15 offset:0
  v_mfma_f32_16x16x32_bf16 v[84:87], v[244:247], a[52:55], v[84:87]
  ds_read_b128 a[20:23], v15 offset:2048
  ds_read_b128 a[24:27], v15 offset:4096
  v_mfma_f32_16x16x32_bf16 v[88:91], v[244:247], a[56:59], v[88:91]
  ds_read_b128 a[28:31], v15 offset:6144
  s_waitcnt lgkmcnt(0)
  v_mfma_f32_16x16x32_bf16 v[92:95], v[244:247], a[60:63], v[92:95]
  ds_read_b64_tr_b16 v[244:245], v2 offset:704
  v_mfma_f32_16x16x32_bf16 v[96:99], v[248:251], a[32:35], v[96:99]
  ds_read_b64_tr_b16 v[246:247], v2 offset:9152
  v_mfma_f32_16x16x32_bf16 v[100:103], v[248:251], a[36:39], v[100:103]
  v_mfma_f32_16x16x32_bf16 v[104:107], v[248:251], a[40:43], v[104:107]
  v_mfma_f32_16x16x32_bf16 v[108:111], v[248:251], a[44:47], v[108:111]
  ds_read_b64_tr_b16 v[248:249], v2 offset:224
  v_mfma_f32_16x16x32_bf16 v[96:99], v[252:255], a[48:51], v[96:99]
  ds_read_b64_tr_b16 v[250:251], v2 offset:8672
  v_mfma_f32_16x16x32_bf16 v[100:103], v[252:255], a[52:55], v[100:103]
  v_mfma_f32_16x16x32_bf16 v[104:107], v[252:255], a[56:59], v[104:107]
  v_mfma_f32_16x16x32_bf16 v[108:111], v[252:255], a[60:63], v[108:111]
  ds_read_b64_tr_b16 v[252:253], v2 offset:736
  s_waitcnt vmcnt(8)
  s_barrier
  v_mfma_f32_16x16x32_bf16 v[112:115], v[240:243], a[32:35], v[112:115]
  s_add_u32 m0, s34, 135168
  ds_read_b64_tr_b16 v[254:255], v2 offset:9184
  v_mfma_f32_16x16x32_bf16 v[116:119], v[240:243], a[36:39], v[116:119]
  s_mov_b32 s35, 3145728
  v_mfma_f32_16x16x32_bf16 v[120:123], v[240:243], a[40:43], v[120:123]
  buffer_load_dwordx4 v4, s[16:19], s35 offen lds
  v_mfma_f32_16x16x32_bf16 v[124:127], v[240:243], a[44:47], v[124:127]
  s_add_u32 m0, s34, 136224
  ds_read_b64_tr_b16 v[240:241], v2 offset:16896
  s_waitcnt lgkmcnt(5)
  v_mfma_f32_16x16x32_bf16 v[112:115], v[244:247], a[48:51], v[112:115]
  s_mov_b32 s35, 3153920
  ds_read_b64_tr_b16 v[242:243], v2 offset:25344
  v_mfma_f32_16x16x32_bf16 v[116:119], v[244:247], a[52:55], v[116:119]
  v_mfma_f32_16x16x32_bf16 v[120:123], v[244:247], a[56:59], v[120:123]
  v_mfma_f32_16x16x32_bf16 v[124:127], v[244:247], a[60:63], v[124:127]
  ds_read_b64_tr_b16 v[244:245], v2 offset:17408
  s_waitcnt lgkmcnt(5)
  v_mfma_f32_16x16x32_bf16 v[128:131], v[248:251], a[32:35], v[128:131]
  ds_read_b64_tr_b16 v[246:247], v2 offset:25856
  buffer_load_dwordx4 v4, s[16:19], s35 offen lds
  v_mfma_f32_16x16x32_bf16 v[132:135], v[248:251], a[36:39], v[132:135]
  s_add_u32 m0, s34, 137280
  v_mfma_f32_16x16x32_bf16 v[136:139], v[248:251], a[40:43], v[136:139]
  s_mov_b32 s35, 3162112
  v_mfma_f32_16x16x32_bf16 v[140:143], v[248:251], a[44:47], v[140:143]
  ds_read_b64_tr_b16 v[248:249], v2 offset:16928
  s_waitcnt lgkmcnt(5)
  v_mfma_f32_16x16x32_bf16 v[128:131], v[252:255], a[48:51], v[128:131]
  ds_read_b64_tr_b16 v[250:251], v2 offset:25376
  v_mfma_f32_16x16x32_bf16 v[132:135], v[252:255], a[52:55], v[132:135]
  buffer_load_dwordx4 v4, s[16:19], s35 offen lds
  v_mfma_f32_16x16x32_bf16 v[136:139], v[252:255], a[56:59], v[136:139]
  s_add_u32 m0, s34, 138336
  v_mfma_f32_16x16x32_bf16 v[140:143], v[252:255], a[60:63], v[140:143]
  s_mov_b32 s35, 3170304
  ds_read_b64_tr_b16 v[252:253], v2 offset:17440
  s_waitcnt lgkmcnt(5)
  v_mfma_f32_16x16x32_bf16 v[144:147], v[240:243], a[32:35], v[144:147]
  ds_read_b64_tr_b16 v[254:255], v2 offset:25888
  v_mfma_f32_16x16x32_bf16 v[148:151], v[240:243], a[36:39], v[148:151]
  v_mfma_f32_16x16x32_bf16 v[152:155], v[240:243], a[40:43], v[152:155]
  buffer_load_dwordx4 v4, s[16:19], s35 offen lds
  v_mfma_f32_16x16x32_bf16 v[156:159], v[240:243], a[44:47], v[156:159]
  s_mov_b32 s35, 32768
  ds_read_b64_tr_b16 v[240:241], v2 offset:16960
  s_waitcnt lgkmcnt(5)
  v_mfma_f32_16x16x32_bf16 v[144:147], v[244:247], a[48:51], v[144:147]
  s_add_u32 m0, s33, 50688
  ds_read_b64_tr_b16 v[242:243], v2 offset:25408
  v_mfma_f32_16x16x32_bf16 v[148:151], v[244:247], a[52:55], v[148:151]
  v_mfma_f32_16x16x32_bf16 v[152:155], v[244:247], a[56:59], v[152:155]
  v_mfma_f32_16x16x32_bf16 v[156:159], v[244:247], a[60:63], v[156:159]
  ds_read_b64_tr_b16 v[244:245], v2 offset:17472
  s_waitcnt lgkmcnt(5)
  v_mfma_f32_16x16x32_bf16 v[160:163], v[248:251], a[32:35], v[160:163]
  ds_read_b64_tr_b16 v[246:247], v2 offset:25920
  buffer_load_dwordx4 v3, s[8:11], s35 offen offset:0 nt lds
  v_mfma_f32_16x16x32_bf16 v[164:167], v[248:251], a[36:39], v[164:167]
  s_add_u32 m0, s33, 51216
  v_mfma_f32_16x16x32_bf16 v[168:171], v[248:251], a[40:43], v[168:171]
  v_mfma_f32_16x16x32_bf16 v[172:175], v[248:251], a[44:47], v[172:175]
  ds_read_b64_tr_b16 v[248:249], v2 offset:16992
  s_waitcnt lgkmcnt(5)
  v_mfma_f32_16x16x32_bf16 v[160:163], v[252:255], a[48:51], v[160:163]
  ds_read_b64_tr_b16 v[250:251], v2 offset:25440
  v_mfma_f32_16x16x32_bf16 v[164:167], v[252:255], a[52:55], v[164:167]
  buffer_load_dwordx4 v3, s[8:11], s35 offen offset:512 nt lds
  v_mfma_f32_16x16x32_bf16 v[168:171], v[252:255], a[56:59], v[168:171]
  s_add_u32 m0, s33, 51744
  v_mfma_f32_16x16x32_bf16 v[172:175], v[252:255], a[60:63], v[172:175]
  ds_read_b64_tr_b16 v[252:253], v2 offset:17504
  s_waitcnt lgkmcnt(5)
  v_mfma_f32_16x16x32_bf16 v[176:179], v[240:243], a[32:35], v[176:179]
  ds_read_b64_tr_b16 v[254:255], v2 offset:25952
  v_mfma_f32_16x16x32_bf16 v[180:183], v[240:243], a[36:39], v[180:183]
  v_mfma_f32_16x16x32_bf16 v[184:187], v[240:243], a[40:43], v[184:187]
  buffer_load_dwordx4 v3, s[8:11], s35 offen offset:1024 nt lds
  v_mfma_f32_16x16x32_bf16 v[188:191], v[240:243], a[44:47], v[188:191]
  s_add_u32 m0, s33, 52272
  ds_read_b64_tr_b16 v[240:241], v2 offset:17024
  s_waitcnt lgkmcnt(5)
  v_mfma_f32_16x16x32_bf16 v[176:179], v[244:247], a[48:51], v[176:179]
  ds_read_b64_tr_b16 v[242:243], v2 offset:25472
  v_mfma_f32_16x16x32_bf16 v[180:183], v[244:247], a[52:55], v[180:183]
  v_mfma_f32_16x16x32_bf16 v[184:187], v[244:247], a[56:59], v[184:187]
  v_mfma_f32_16x16x32_bf16 v[188:191], v[244:247], a[60:63], v[188:191]
  ds_read_b64_tr_b16 v[244:245], v2 offset:17536
  s_waitcnt lgkmcnt(5)
  v_mfma_f32_16x16x32_bf16 v[192:195], v[248:251], a[32:35], v[192:195]
  ds_read_b64_tr_b16 v[246:247], v2 offset:25984
  buffer_load_dwordx4 v3, s[8:11], s35 offen offset:1536 nt lds
  v_mfma_f32_16x16x32_bf16 v[196:199], v[248:251], a[36:39], v[196:199]
  v_mfma_f32_16x16x32_bf16 v[200:203], v[248:251], a[40:43], v[200:203]
  v_mfma_f32_16x16x32_bf16 v[204:207], v[248:251], a[44:47], v[204:207]
  ds_read_b64_tr_b16 v[248:249], v2 offset:17056
  s_waitcnt lgkmcnt(5)
  v_mfma_f32_16x16x32_bf16 v[192:195], v[252:255], a[48:51], v[192:195]
  ds_read_b64_tr_b16 v[250:251], v2 offset:25504
  v_mfma_f32_16x16x32_bf16 v[196:199], v[252:255], a[52:55], v[196:199]
  v_mfma_f32_16x16x32_bf16 v[200:203], v[252:255], a[56:59], v[200:203]
  v_mfma_f32_16x16x32_bf16 v[204:207], v[252:255], a[60:63], v[204:207]
  ds_read_b64_tr_b16 v[252:253], v2 offset:17568
  s_waitcnt lgkmcnt(5)
  v_mfma_f32_16x16x32_bf16 v[208:211], v[240:243], a[32:35], v[208:211]
  ds_read_b64_tr_b16 v[254:255], v2 offset:26016
  v_mfma_f32_16x16x32_bf16 v[212:215], v[240:243], a[36:39], v[212:215]
  v_mfma_f32_16x16x32_bf16 v[216:219], v[240:243], a[40:43], v[216:219]
  v_mfma_f32_16x16x32_bf16 v[220:223], v[240:243], a[44:47], v[220:223]
  ds_read_b64_tr_b16 v[240:241], v2 offset:17088
  s_waitcnt lgkmcnt(5)
  v_mfma_f32_16x16x32_bf16 v[208:211], v[244:247], a[48:51], v[208:211]
  ds_read_b64_tr_b16 v[242:243], v2 offset:25536
  v_mfma_f32_16x16x32_bf16 v[212:215], v[244:247], a[52:55], v[212:215]
  v_mfma_f32_16x16x32_bf16 v[216:219], v[244:247], a[56:59], v[216:219]
  v_mfma_f32_16x16x32_bf16 v[220:223], v[244:247], a[60:63], v[220:223]
  ds_read_b64_tr_b16 v[244:245], v2 offset:17600
  s_waitcnt lgkmcnt(5)
  v_mfma_f32_16x16x32_bf16 v[224:227], v[248:251], a[32:35], v[224:227]
  ds_read_b64_tr_b16 v[246:247], v2 offset:26048
  v_mfma_f32_16x16x32_bf16 v[228:231], v[248:251], a[36:39], v[228:231]
  v_mfma_f32_16x16x32_bf16 v[232:235], v[248:251], a[40:43], v[232:235]
  v_mfma_f32_16x16x32_bf16 v[236:239], v[248:251], a[44:47], v[236:239]
  ds_read_b64_tr_b16 v[248:249], v2 offset:17120
  s_waitcnt lgkmcnt(5)
  v_mfma_f32_16x16x32_bf16 v[224:227], v[252:255], a[48:51], v[224:227]
  ds_read_b64_tr_b16 v[250:251], v2 offset:25568
  v_mfma_f32_16x16x32_bf16 v[228:231], v[252:255], a[52:55], v[228:231]
  v_mfma_f32_16x16x32_bf16 v[232:235], v[252:255], a[56:59], v[232:235]
  v_mfma_f32_16x16x32_bf16 v[236:239], v[252:255], a[60:63], v[236:239]
  ds_read_b64_tr_b16 v[252:253], v2 offset:17632
  s_waitcnt vmcnt(12)
  s_barrier
  s_waitcnt lgkmcnt(5)
  v_mfma_f32_16x16x32_bf16 a[224:227], v[240:243], a[32:35], a[224:227]
  s_add_u32 m0, s34, 0
  ds_read_b64_tr_b16 v[254:255], v2 offset:26080
  v_mfma_f32_16x16x32_bf16 a[228:231], v[240:243], a[36:39], a[228:231]
  s_mov_b32 s35, 2621696
  v_mfma_f32_16x16x32_bf16 a[232:235], v[240:243], a[40:43], a[232:235]
  buffer_load_dwordx4 v4, s[16:19], s35 offen lds
  v_mfma_f32_16x16x32_bf16 a[236:239], v[240:243], a[44:47], a[236:239]
  s_add_u32 m0, s34, 1056
  ds_read_b64_tr_b16 v[240:241], v2 offset:33792
  s_waitcnt lgkmcnt(5)
  v_mfma_f32_16x16x32_bf16 a[224:227], v[244:247], a[48:51], a[224:227]
  s_mov_b32 s35, 2629888
  ds_read_b64_tr_b16 v[242:243], v2 offset:42240
  v_mfma_f32_16x16x32_bf16 a[228:231], v[244:247], a[52:55], a[228:231]
  v_mfma_f32_16x16x32_bf16 a[232:235], v[244:247], a[56:59], a[232:235]
  v_mfma_f32_16x16x32_bf16 a[236:239], v[244:247], a[60:63], a[236:239]
  ds_read_b64_tr_b16 v[244:245], v2 offset:34304
  s_waitcnt lgkmcnt(5)
  v_mfma_f32_16x16x32_bf16 a[240:243], v[248:251], a[32:35], a[240:243]
  ds_read_b64_tr_b16 v[246:247], v2 offset:42752
  buffer_load_dwordx4 v4, s[16:19], s35 offen lds
  v_mfma_f32_16x16x32_bf16 a[244:247], v[248:251], a[36:39], a[244:247]
  s_add_u32 m0, s34, 2112
  v_mfma_f32_16x16x32_bf16 a[248:251], v[248:251], a[40:43], a[248:251]
  s_mov_b32 s35, 2638080
  v_mfma_f32_16x16x32_bf16 a[252:255], v[248:251], a[44:47], a[252:255]
  ds_read_b64_tr_b16 v[248:249], v2 offset:33824
  s_waitcnt lgkmcnt(5)
  v_mfma_f32_16x16x32_bf16 a[240:243], v[252:255], a[48:51], a[240:243]
  ds_read_b64_tr_b16 v[250:251], v2 offset:42272
  v_mfma_f32_16x16x32_bf16 a[244:247], v[252:255], a[52:55], a[244:247]
  buffer_load_dwordx4 v4, s[16:19], s35 offen lds
  v_mfma_f32_16x16x32_bf16 a[248:251], v[252:255], a[56:59], a[248:251]
  s_add_u32 m0, s34, 3168
  v_mfma_f32_16x16x32_bf16 a[252:255], v[252:255], a[60:63], a[252:255]
  s_mov_b32 s35, 2646272
  ds_read_b64_tr_b16 v[252:253], v2 offset:34336
  s_waitcnt lgkmcnt(5)
  v_mfma_f32_16x16x32_bf16 v[16:19], v[240:243], a[64:67], v[16:19]
  ds_read_b64_tr_b16 v[254:255], v2 offset:42784
  v_mfma_f32_16x16x32_bf16 v[20:23], v[240:243], a[68:71], v[20:23]
  v_mfma_f32_16x16x32_bf16 v[24:27], v[240:243], a[72:75], v[24:27]
  buffer_load_dwordx4 v4, s[16:19], s35 offen lds
  v_mfma_f32_16x16x32_bf16 v[28:31], v[240:243], a[76:79], v[28:31]
  s_mov_b32 s35, 49152
  ds_read_b64_tr_b16 v[240:241], v2 offset:33856
  s_waitcnt lgkmcnt(5)
  v_mfma_f32_16x16x32_bf16 v[16:19], v[244:247], a[80:83], v[16:19]
  s_add_u32 m0, s33, 84480
  ds_read_b64_tr_b16 v[242:243], v2 offset:42304
  v_mfma_f32_16x16x32_bf16 v[20:23], v[244:247], a[84:87], v[20:23]
  v_mfma_f32_16x16x32_bf16 v[24:27], v[244:247], a[88:91], v[24:27]
  v_mfma_f32_16x16x32_bf16 v[28:31], v[244:247], a[92:95], v[28:31]
  ds_read_b64_tr_b16 v[244:245], v2 offset:34368
  s_waitcnt lgkmcnt(5)
  v_mfma_f32_16x16x32_bf16 v[32:35], v[248:251], a[64:67], v[32:35]
  ds_read_b64_tr_b16 v[246:247], v2 offset:42816
  buffer_load_dwordx4 v3, s[8:11], s35 offen offset:0 nt lds
  v_mfma_f32_16x16x32_bf16 v[36:39], v[248:251], a[68:71], v[36:39]
  s_add_u32 m0, s33, 85008
  v_mfma_f32_16x16x32_bf16 v[40:43], v[248:251], a[72:75], v[40:43]
  v_mfma_f32_16x16x32_bf16 v[44:47], v[248:251], a[76:79], v[44:47]
  ds_read_b64_tr_b16 v[248:249], v2 offset:33888
  s_waitcnt lgkmcnt(5)
  v_mfma_f32_16x16x32_bf16 v[32:35], v[252:255], a[80:83], v[32:35]
  ds_read_b64_tr_b16 v[250:251], v2 offset:42336
  v_mfma_f32_16x16x32_bf16 v[36:39], v[252:255], a[84:87], v[36:39]
  buffer_load_dwordx4 v3, s[8:11], s35 offen offset:512 nt lds
  v_mfma_f32_16x16x32_bf16 v[40:43], v[252:255], a[88:91], v[40:43]
  s_add_u32 m0, s33, 85536
  v_mfma_f32_16x16x32_bf16 v[44:47], v[252:255], a[92:95], v[44:47]
  ds_read_b64_tr_b16 v[252:253], v2 offset:34400
  s_waitcnt lgkmcnt(5)
  v_mfma_f32_16x16x32_bf16 v[48:51], v[240:243], a[64:67], v[48:51]
  ds_read_b64_tr_b16 v[254:255], v2 offset:42848
  v_mfma_f32_16x16x32_bf16 v[52:55], v[240:243], a[68:71], v[52:55]
  v_mfma_f32_16x16x32_bf16 v[56:59], v[240:243], a[72:75], v[56:59]
  buffer_load_dwordx4 v3, s[8:11], s35 offen offset:1024 nt lds
  v_mfma_f32_16x16x32_bf16 v[60:63], v[240:243], a[76:79], v[60:63]
  s_add_u32 m0, s33, 86064
  ds_read_b64_tr_b16 v[240:241], v2 offset:33920
  s_waitcnt lgkmcnt(5)
  v_mfma_f32_16x16x32_bf16 v[48:51], v[244:247], a[80:83], v[48:51]
  ds_read_b64_tr_b16 v[242:243], v2 offset:42368
  v_mfma_f32_16x16x32_bf16 v[52:55], v[244:247], a[84:87], v[52:55]
  v_mfma_f32_16x16x32_bf16 v[56:59], v[244:247], a[88:91], v[56:59]
  v_mfma_f32_16x16x32_bf16 v[60:63], v[244:247], a[92:95], v[60:63]
  ds_read_b64_tr_b16 v[244:245], v2 offset:34432
  s_waitcnt lgkmcnt(5)
  v_mfma_f32_16x16x32_bf16 v[64:67], v[248:251], a[64:67], v[64:67]
  ds_read_b64_tr_b16 v[246:247], v2 offset:42880
  buffer_load_dwordx4 v3, s[8:11], s35 offen offset:1536 nt lds
  v_mfma_f32_16x16x32_bf16 v[68:71], v[248:251], a[68:71], v[68:71]
  s_add_u32 m0, s34, 101376
  v_mfma_f32_16x16x32_bf16 v[72:75], v[248:251], a[72:75], v[72:75]
  s_mov_b32 s35, 3145984
  v_mfma_f32_16x16x32_bf16 v[76:79], v[248:251], a[76:79], v[76:79]
  ds_read_b64_tr_b16 v[248:249], v2 offset:33952
  s_waitcnt lgkmcnt(5)
  v_mfma_f32_16x16x32_bf16 v[64:67], v[252:255], a[80:83], v[64:67]
  ds_read_b64_tr_b16 v[250:251], v2 offset:42400
  v_mfma_f32_16x16x32_bf16 v[68:71], v[252:255], a[84:87], v[68:71]
  buffer_load_dwordx4 v4, s[16:19], s35 offen lds
  v_mfma_f32_16x16x32_bf16 v[72:75], v[252:255], a[88:91], v[72:75]
  s_add_u32 m0, s34, 102432
  v_mfma_f32_16x16x32_bf16 v[76:79], v[252:255], a[92:95], v[76:79]
  s_mov_b32 s35, 3154176
  ds_read_b64_tr_b16 v[252:253], v2 offset:34464
  s_waitcnt lgkmcnt(5)
  v_mfma_f32_16x16x32_bf16 v[80:83], v[240:243], a[64:67], v[80:83]
  ds_read_b64_tr_b16 v[254:255], v2 offset:42912
  v_mfma_f32_16x16x32_bf16 v[84:87], v[240:243], a[68:71], v[84:87]
  v_mfma_f32_16x16x32_bf16 v[88:91], v[240:243], a[72:75], v[88:91]
  buffer_load_dwordx4 v4, s[16:19], s35 offen lds
  v_mfma_f32_16x16x32_bf16 v[92:95], v[240:243], a[76:79], v[92:95]
  s_add_u32 m0, s34, 103488
  ds_read_b64_tr_b16 v[240:241], v2 offset:33984
  s_waitcnt lgkmcnt(5)
  v_mfma_f32_16x16x32_bf16 v[80:83], v[244:247], a[80:83], v[80:83]
  s_mov_b32 s35, 3162368
  ds_read_b64_tr_b16 v[242:243], v2 offset:42432
  v_mfma_f32_16x16x32_bf16 v[84:87], v[244:247], a[84:87], v[84:87]
  v_mfma_f32_16x16x32_bf16 v[88:91], v[244:247], a[88:91], v[88:91]
  v_mfma_f32_16x16x32_bf16 v[92:95], v[244:247], a[92:95], v[92:95]
  ds_read_b64_tr_b16 v[244:245], v2 offset:34496
  s_waitcnt lgkmcnt(5)
  v_mfma_f32_16x16x32_bf16 v[96:99], v[248:251], a[64:67], v[96:99]
  ds_read_b64_tr_b16 v[246:247], v2 offset:42944
  buffer_load_dwordx4 v4, s[16:19], s35 offen lds
  v_mfma_f32_16x16x32_bf16 v[100:103], v[248:251], a[68:71], v[100:103]
  s_add_u32 m0, s34, 104544
  v_mfma_f32_16x16x32_bf16 v[104:107], v[248:251], a[72:75], v[104:107]
  s_mov_b32 s35, 3170560
  v_mfma_f32_16x16x32_bf16 v[108:111], v[248:251], a[76:79], v[108:111]
  ds_read_b64_tr_b16 v[248:249], v2 offset:34016
  s_waitcnt lgkmcnt(5)
  v_mfma_f32_16x16x32_bf16 v[96:99], v[252:255], a[80:83], v[96:99]
  ds_read_b64_tr_b16 v[250:251], v2 offset:42464
  v_mfma_f32_16x16x32_bf16 v[100:103], v[252:255], a[84:87], v[100:103]
  buffer_load_dwordx4 v4, s[16:19], s35 offen lds
  v_mfma_f32_16x16x32_bf16 v[104:107], v[252:255], a[88:91], v[104:107]
  v_mfma_f32_16x16x32_bf16 v[108:111], v[252:255], a[92:95], v[108:111]
  ds_read_b64_tr_b16 v[252:253], v2 offset:34528
  s_waitcnt vmcnt(16)
  s_barrier
  s_waitcnt lgkmcnt(5)
  v_mfma_f32_16x16x32_bf16 v[112:115], v[240:243], a[64:67], v[112:115]
  s_mov_b32 s35, 65536
  ds_read_b64_tr_b16 v[254:255], v2 offset:42976
  v_mfma_f32_16x16x32_bf16 v[116:119], v[240:243], a[68:71], v[116:119]
  s_add_u32 m0, s33, 16896
  v_mfma_f32_16x16x32_bf16 v[120:123], v[240:243], a[72:75], v[120:123]
  buffer_load_dwordx4 v3, s[8:11], s35 offen offset:0 nt lds
  v_mfma_f32_16x16x32_bf16 v[124:127], v[240:243], a[76:79], v[124:127]
  s_add_u32 m0, s33, 17424
  v_add_u32 v2, 101376, v2
  ds_read_b64_tr_b16 v[240:241], v2 offset:33792
  s_waitcnt lgkmcnt(5)
  v_mfma_f32_16x16x32_bf16 v[112:115], v[244:247], a[80:83], v[112:115]
  ds_read_b64_tr_b16 v[242:243], v2 offset:42240
  v_mfma_f32_16x16x32_bf16 v[116:119], v[244:247], a[84:87], v[116:119]
  v_mfma_f32_16x16x32_bf16 v[120:123], v[244:247], a[88:91], v[120:123]
  v_mfma_f32_16x16x32_bf16 v[124:127], v[244:247], a[92:95], v[124:127]
  ds_read_b64_tr_b16 v[244:245], v2 offset:34304
  s_waitcnt lgkmcnt(5)
  v_mfma_f32_16x16x32_bf16 v[128:131], v[248:251], a[64:67], v[128:131]
  ds_read_b64_tr_b16 v[246:247], v2 offset:42752
  buffer_load_dwordx4 v3, s[8:11], s35 offen offset:512 nt lds
  v_mfma_f32_16x16x32_bf16 v[132:135], v[248:251], a[68:71], v[132:135]
  s_add_u32 m0, s33, 17952
  v_mfma_f32_16x16x32_bf16 v[136:139], v[248:251], a[72:75], v[136:139]
  v_mfma_f32_16x16x32_bf16 v[140:143], v[248:251], a[76:79], v[140:143]
  ds_read_b64_tr_b16 v[248:249], v2 offset:33824
  s_waitcnt lgkmcnt(5)
  v_mfma_f32_16x16x32_bf16 v[128:131], v[252:255], a[80:83], v[128:131]
  ds_read_b64_tr_b16 v[250:251], v2 offset:42272
  v_mfma_f32_16x16x32_bf16 v[132:135], v[252:255], a[84:87], v[132:135]
  buffer_load_dwordx4 v3, s[8:11], s35 offen offset:1024 nt lds
  v_mfma_f32_16x16x32_bf16 v[136:139], v[252:255], a[88:91], v[136:139]
  s_add_u32 m0, s33, 18480
  v_mfma_f32_16x16x32_bf16 v[140:143], v[252:255], a[92:95], v[140:143]
  ds_read_b64_tr_b16 v[252:253], v2 offset:34336
  s_waitcnt lgkmcnt(5)
  v_mfma_f32_16x16x32_bf16 v[16:19], v[240:243], a[0:3], v[16:19]
  ds_read_b64_tr_b16 v[254:255], v2 offset:42784
  v_mfma_f32_16x16x32_bf16 v[20:23], v[240:243], a[4:7], v[20:23]
  v_mfma_f32_16x16x32_bf16 v[24:27], v[240:243], a[8:11], v[24:27]
  buffer_load_dwordx4 v3, s[8:11], s35 offen offset:1536 nt lds
  v_mfma_f32_16x16x32_bf16 v[28:31], v[240:243], a[12:15], v[28:31]
  ds_read_b64_tr_b16 v[240:241], v2 offset:33856
  s_waitcnt lgkmcnt(5)
  v_mfma_f32_16x16x32_bf16 v[16:19], v[244:247], a[16:19], v[16:19]
  ds_read_b64_tr_b16 v[242:243], v2 offset:42304
  v_mfma_f32_16x16x32_bf16 v[20:23], v[244:247], a[20:23], v[20:23]
  v_mfma_f32_16x16x32_bf16 v[24:27], v[244:247], a[24:27], v[24:27]
  v_mfma_f32_16x16x32_bf16 v[28:31], v[244:247], a[28:31], v[28:31]
  ds_read_b64_tr_b16 v[244:245], v2 offset:34368
  s_waitcnt lgkmcnt(5)
  v_mfma_f32_16x16x32_bf16 v[32:35], v[248:251], a[0:3], v[32:35]
  ds_read_b64_tr_b16 v[246:247], v2 offset:42816
  v_mfma_f32_16x16x32_bf16 v[36:39], v[248:251], a[4:7], v[36:39]
  v_mfma_f32_16x16x32_bf16 v[40:43], v[248:251], a[8:11], v[40:43]
  v_mfma_f32_16x16x32_bf16 v[44:47], v[248:251], a[12:15], v[44:47]
  ds_read_b64_tr_b16 v[248:249], v2 offset:33888
  s_waitcnt lgkmcnt(5)
  v_mfma_f32_16x16x32_bf16 v[32:35], v[252:255], a[16:19], v[32:35]
  ds_read_b64_tr_b16 v[250:251], v2 offset:42336
  v_mul_f32 v16, s37, v16
  v_mfma_f32_16x16x32_bf16 v[36:39], v[252:255], a[20:23], v[36:39]
  v_mul_f32 v17, s37, v17
  v_mul_f32 v18, s37, v18
  v_mfma_f32_16x16x32_bf16 v[40:43], v[252:255], a[24:27], v[40:43]
  v_mul_f32 v19, s37, v19
  v_cvt_pk_bf16_f32 v16, v16, v17
  v_mfma_f32_16x16x32_bf16 v[44:47], v[252:255], a[28:31], v[44:47]
  ds_read_b64_tr_b16 v[252:253], v2 offset:34400
  s_waitcnt lgkmcnt(5)
  v_mfma_f32_16x16x32_bf16 v[48:51], v[240:243], a[0:3], v[48:51]
  ds_read_b64_tr_b16 v[254:255], v2 offset:42848
  v_cvt_pk_bf16_f32 v17, v18, v19
  v_mfma_f32_16x16x32_bf16 v[52:55], v[240:243], a[4:7], v[52:55]
  v_mul_f32 v20, s37, v20
  v_mul_f32 v21, s37, v21
  v_mfma_f32_16x16x32_bf16 v[56:59], v[240:243], a[8:11], v[56:59]
  v_mul_f32 v22, s37, v22
  v_mul_f32 v23, s37, v23
  v_mfma_f32_16x16x32_bf16 v[60:63], v[240:243], a[12:15], v[60:63]
  ds_read_b64_tr_b16 v[240:241], v2 offset:33920
  s_waitcnt lgkmcnt(5)
  v_mfma_f32_16x16x32_bf16 v[48:51], v[244:247], a[16:19], v[48:51]
  ds_read_b64_tr_b16 v[242:243], v2 offset:42368
  v_cvt_pk_bf16_f32 v20, v20, v21
  v_mfma_f32_16x16x32_bf16 v[52:55], v[244:247], a[20:23], v[52:55]
  v_cvt_pk_bf16_f32 v21, v22, v23
  v_mul_f32 v24, s37, v24
  v_mfma_f32_16x16x32_bf16 v[56:59], v[244:247], a[24:27], v[56:59]
  v_mul_f32 v25, s37, v25
  v_mul_f32 v26, s37, v26
  v_mfma_f32_16x16x32_bf16 v[60:63], v[244:247], a[28:31], v[60:63]
  ds_read_b64_tr_b16 v[244:245], v2 offset:34432
  s_waitcnt lgkmcnt(5)
  v_mfma_f32_16x16x32_bf16 v[64:67], v[248:251], a[0:3], v[64:67]
  ds_read_b64_tr_b16 v[246:247], v2 offset:42880
  v_mul_f32 v27, s37, v27
  v_mfma_f32_16x16x32_bf16 v[68:71], v[248:251], a[4:7], v[68:71]
  v_cvt_pk_bf16_f32 v24, v24, v25
  v_cvt_pk_bf16_f32 v25, v26, v27
  v_mfma_f32_16x16x32_bf16 v[72:75], v[248:251], a[8:11], v[72:75]
  v_mul_f32 v28, s37, v28
  v_mul_f32 v29, s37, v29
  v_mfma_f32_16x16x32_bf16 v[76:79], v[248:251], a[12:15], v[76:79]
  ds_read_b64_tr_b16 v[248:249], v2 offset:33952
  s_waitcnt lgkmcnt(5)
  v_mfma_f32_16x16x32_bf16 v[64:67], v[252:255], a[16:19], v[64:67]
  ds_read_b64_tr_b16 v[250:251], v2 offset:42400
  v_mul_f32 v30, s37, v30
  v_mfma_f32_16x16x32_bf16 v[68:71], v[252:255], a[20:23], v[68:71]
  v_mul_f32 v31, s37, v31
  v_cvt_pk_bf16_f32 v28, v28, v29
  v_mfma_f32_16x16x32_bf16 v[72:75], v[252:255], a[24:27], v[72:75]
  v_cvt_pk_bf16_f32 v29, v30, v31
  v_mul_f32 v32, s37, v32
  v_mfma_f32_16x16x32_bf16 v[76:79], v[252:255], a[28:31], v[76:79]
  ds_read_b64_tr_b16 v[252:253], v2 offset:34464
  s_waitcnt lgkmcnt(5)
  v_mfma_f32_16x16x32_bf16 v[80:83], v[240:243], a[0:3], v[80:83]
  ds_read_b64_tr_b16 v[254:255], v2 offset:42912
  v_mul_f32 v33, s37, v33
  v_mfma_f32_16x16x32_bf16 v[84:87], v[240:243], a[4:7], v[84:87]
  v_mul_f32 v34, s37, v34
  v_mul_f32 v35, s37, v35
  v_mfma_f32_16x16x32_bf16 v[88:91], v[240:243], a[8:11], v[88:91]
  v_cvt_pk_bf16_f32 v32, v32, v33
  v_cvt_pk_bf16_f32 v33, v34, v35
  v_mfma_f32_16x16x32_bf16 v[92:95], v[240:243], a[12:15], v[92:95]
  ds_read_b64_tr_b16 v[240:241], v2 offset:33984
  s_waitcnt lgkmcnt(5)
  v_mfma_f32_16x16x32_bf16 v[80:83], v[244:247], a[16:19], v[80:83]
  ds_read_b64_tr_b16 v[242:243], v2 offset:42432
  v_mul_f32 v36, s37, v36
  v_mfma_f32_16x16x32_bf16 v[84:87], v[244:247], a[20:23], v[84:87]
  v_mul_f32 v37, s37, v37
  v_mul_f32 v38, s37, v38
  v_mfma_f32_16x16x32_bf16 v[88:91], v[244:247], a[24:27], v[88:91]
  v_mul_f32 v39, s37, v39
  v_cvt_pk_bf16_f32 v36, v36, v37
  v_mfma_f32_16x16x32_bf16 v[92:95], v[244:247], a[28:31], v[92:95]
  ds_read_b64_tr_b16 v[244:245], v2 offset:34496
  s_waitcnt lgkmcnt(5)
  v_mfma_f32_16x16x32_bf16 v[96:99], v[248:251], a[0:3], v[96:99]
  ds_read_b64_tr_b16 v[246:247], v2 offset:42944
  v_cvt_pk_bf16_f32 v37, v38, v39
  v_mfma_f32_16x16x32_bf16 v[100:103], v[248:251], a[4:7], v[100:103]
  v_mul_f32 v40, s37, v40
  v_mul_f32 v41, s37, v41
  v_mfma_f32_16x16x32_bf16 v[104:107], v[248:251], a[8:11], v[104:107]
  v_mul_f32 v42, s37, v42
  v_mul_f32 v43, s37, v43
  v_mfma_f32_16x16x32_bf16 v[108:111], v[248:251], a[12:15], v[108:111]
  ds_read_b64_tr_b16 v[248:249], v2 offset:34016
  s_waitcnt lgkmcnt(5)
  v_mfma_f32_16x16x32_bf16 v[96:99], v[252:255], a[16:19], v[96:99]
  ds_read_b64_tr_b16 v[250:251], v2 offset:42464
  v_cvt_pk_bf16_f32 v40, v40, v41
  v_mfma_f32_16x16x32_bf16 v[100:103], v[252:255], a[20:23], v[100:103]
  v_cvt_pk_bf16_f32 v41, v42, v43
  v_mul_f32 v44, s37, v44
  v_mfma_f32_16x16x32_bf16 v[104:107], v[252:255], a[24:27], v[104:107]
  v_mul_f32 v45, s37, v45
  v_mul_f32 v46, s37, v46
  v_mfma_f32_16x16x32_bf16 v[108:111], v[252:255], a[28:31], v[108:111]
  ds_read_b64_tr_b16 v[252:253], v2 offset:34528
  s_waitcnt vmcnt(12)
  s_barrier
  s_waitcnt lgkmcnt(5)
  v_mfma_f32_16x16x32_bf16 v[112:115], v[240:243], a[0:3], v[112:115]
  s_mov_b32 s35, 81920
  ds_read_b64_tr_b16 v[254:255], v2 offset:42976
  v_mul_f32 v47, s37, v47
  v_mfma_f32_16x16x32_bf16 v[116:119], v[240:243], a[4:7], v[116:119]
  s_add_u32 m0, s33, 33792
  v_cvt_pk_bf16_f32 v44, v44, v45
  v_cvt_pk_bf16_f32 v45, v46, v47
  v_mfma_f32_16x16x32_bf16 v[120:123], v[240:243], a[8:11], v[120:123]
  buffer_load_dwordx4 v3, s[8:11], s35 offen offset:0 nt lds
  v_mul_f32 v48, s37, v48
  v_mfma_f32_16x16x32_bf16 v[124:127], v[240:243], a[12:15], v[124:127]
  s_add_u32 m0, s33, 34320
  v_subrev_u32 v2, 101376, v2
  ds_read_b64_tr_b16 v[240:241], v2 offset:0
  s_waitcnt lgkmcnt(5)
  v_mfma_f32_16x16x32_bf16 v[112:115], v[244:247], a[16:19], v[112:115]
  ds_read_b64_tr_b16 v[242:243], v2 offset:8448
  v_mul_f32 v49, s37, v49
  v_mfma_f32_16x16x32_bf16 v[116:119], v[244:247], a[20:23], v[116:119]
  v_mul_f32 v50, s37, v50
  v_mul_f32 v51, s37, v51
  v_mfma_f32_16x16x32_bf16 v[120:123], v[244:247], a[24:27], v[120:123]
  v_cvt_pk_bf16_f32 v48, v48, v49
  v_cvt_pk_bf16_f32 v49, v50, v51
  v_mfma_f32_16x16x32_bf16 v[124:127], v[244:247], a[28:31], v[124:127]
  ds_read_b64_tr_b16 v[244:245], v2 offset:512
  s_waitcnt lgkmcnt(5)
  v_mfma_f32_16x16x32_bf16 v[128:131], v[248:251], a[0:3], v[128:131]
  ds_read_b64_tr_b16 v[246:247], v2 offset:8960
  buffer_load_dwordx4 v3, s[8:11], s35 offen offset:512 nt lds
  v_mfma_f32_16x16x32_bf16 v[132:135], v[248:251], a[4:7], v[132:135]
  s_add_u32 m0, s33, 34848
  v_mul_f32 v52, s37, v52
  v_mul_f32 v53, s37, v53
  v_mfma_f32_16x16x32_bf16 v[136:139], v[248:251], a[8:11], v[136:139]
  v_mul_f32 v54, s37, v54
  v_mul_f32 v55, s37, v55
  v_mfma_f32_16x16x32_bf16 v[140:143], v[248:251], a[12:15], v[140:143]
  ds_read_b64_tr_b16 v[248:249], v2 offset:32
  s_waitcnt lgkmcnt(5)
  v_mfma_f32_16x16x32_bf16 v[128:131], v[252:255], a[16:19], v[128:131]
  ds_read_b64_tr_b16 v[250:251], v2 offset:8480
  v_cvt_pk_bf16_f32 v52, v52, v53
  v_mfma_f32_16x16x32_bf16 v[132:135], v[252:255], a[20:23], v[132:135]
  buffer_load_dwordx4 v3, s[8:11], s35 offen offset:1024 nt lds
  v_cvt_pk_bf16_f32 v53, v54, v55
  v_mfma_f32_16x16x32_bf16 v[136:139], v[252:255], a[24:27], v[136:139]
  s_add_u32 m0, s33, 35376
  v_mul_f32 v56, s37, v56
  v_mul_f32 v57, s37, v57
  v_mfma_f32_16x16x32_bf16 v[140:143], v[252:255], a[28:31], v[140:143]
  ds_read_b64_tr_b16 v[252:253], v2 offset:544
  s_waitcnt lgkmcnt(5)
  v_mfma_f32_16x16x32_bf16 v[144:147], v[240:243], a[64:67], v[144:147]
  ds_read_b64_tr_b16 v[254:255], v2 offset:8992
  v_mul_f32 v58, s37, v58
  v_mfma_f32_16x16x32_bf16 v[148:151], v[240:243], a[68:71], v[148:151]
  v_mul_f32 v59, s37, v59
  v_cvt_pk_bf16_f32 v56, v56, v57
  v_mfma_f32_16x16x32_bf16 v[152:155], v[240:243], a[72:75], v[152:155]
  buffer_load_dwordx4 v3, s[8:11], s35 offen offset:1536 nt lds
  v_cvt_pk_bf16_f32 v57, v58, v59
  v_mfma_f32_16x16x32_bf16 v[156:159], v[240:243], a[76:79], v[156:159]
  ds_read_b64_tr_b16 v[240:241], v2 offset:64
  s_waitcnt lgkmcnt(5)
  v_mfma_f32_16x16x32_bf16 v[144:147], v[244:247], a[80:83], v[144:147]
  ds_read_b64_tr_b16 v[242:243], v2 offset:8512
  v_mul_f32 v60, s37, v60
  v_mfma_f32_16x16x32_bf16 v[148:151], v[244:247], a[84:87], v[148:151]
  v_mul_f32 v61, s37, v61
  v_mul_f32 v62, s37, v62
  v_mfma_f32_16x16x32_bf16 v[152:155], v[244:247], a[88:91], v[152:155]
  v_mul_f32 v63, s37, v63
  v_cvt_pk_bf16_f32 v60, v60, v61
  v_mfma_f32_16x16x32_bf16 v[156:159], v[244:247], a[92:95], v[156:159]
  ds_read_b64_tr_b16 v[244:245], v2 offset:576
  s_waitcnt lgkmcnt(5)
  v_mfma_f32_16x16x32_bf16 v[160:163], v[248:251], a[64:67], v[160:163]
  ds_read_b64_tr_b16 v[246:247], v2 offset:9024
  v_cvt_pk_bf16_f32 v61, v62, v63
  v_mfma_f32_16x16x32_bf16 v[164:167], v[248:251], a[68:71], v[164:167]
  v_mul_f32 v64, s37, v64
  v_mul_f32 v65, s37, v65
  v_mfma_f32_16x16x32_bf16 v[168:171], v[248:251], a[72:75], v[168:171]
  v_mul_f32 v66, s37, v66
  v_mul_f32 v67, s37, v67
  v_mfma_f32_16x16x32_bf16 v[172:175], v[248:251], a[76:79], v[172:175]
  ds_read_b64_tr_b16 v[248:249], v2 offset:96
  s_waitcnt lgkmcnt(5)
  v_mfma_f32_16x16x32_bf16 v[160:163], v[252:255], a[80:83], v[160:163]
  ds_read_b64_tr_b16 v[250:251], v2 offset:8544
  v_cvt_pk_bf16_f32 v64, v64, v65
  v_mfma_f32_16x16x32_bf16 v[164:167], v[252:255], a[84:87], v[164:167]
  v_cvt_pk_bf16_f32 v65, v66, v67
  v_mul_f32 v68, s37, v68
  v_mfma_f32_16x16x32_bf16 v[168:171], v[252:255], a[88:91], v[168:171]
  v_mul_f32 v69, s37, v69
  v_mul_f32 v70, s37, v70
  v_mfma_f32_16x16x32_bf16 v[172:175], v[252:255], a[92:95], v[172:175]
  ds_read_b64_tr_b16 v[252:253], v2 offset:608
  s_waitcnt lgkmcnt(5)
  v_mfma_f32_16x16x32_bf16 v[176:179], v[240:243], a[64:67], v[176:179]
  ds_read_b64_tr_b16 v[254:255], v2 offset:9056
  v_mul_f32 v71, s37, v71
  v_mfma_f32_16x16x32_bf16 v[180:183], v[240:243], a[68:71], v[180:183]
  v_cvt_pk_bf16_f32 v68, v68, v69
  v_cvt_pk_bf16_f32 v69, v70, v71
  v_mfma_f32_16x16x32_bf16 v[184:187], v[240:243], a[72:75], v[184:187]
  v_mul_f32 v72, s37, v72
  v_mul_f32 v73, s37, v73
  v_mfma_f32_16x16x32_bf16 v[188:191], v[240:243], a[76:79], v[188:191]
  ds_read_b64_tr_b16 v[240:241], v2 offset:128
  s_waitcnt lgkmcnt(5)
  v_mfma_f32_16x16x32_bf16 v[176:179], v[244:247], a[80:83], v[176:179]
  ds_read_b64_tr_b16 v[242:243], v2 offset:8576
  v_mul_f32 v74, s37, v74
  v_mfma_f32_16x16x32_bf16 v[180:183], v[244:247], a[84:87], v[180:183]
  v_mul_f32 v75, s37, v75
  v_cvt_pk_bf16_f32 v72, v72, v73
  v_mfma_f32_16x16x32_bf16 v[184:187], v[244:247], a[88:91], v[184:187]
  v_cvt_pk_bf16_f32 v73, v74, v75
  v_mul_f32 v76, s37, v76
  v_mfma_f32_16x16x32_bf16 v[188:191], v[244:247], a[92:95], v[188:191]
  ds_read_b64_tr_b16 v[244:245], v2 offset:640
  s_waitcnt lgkmcnt(5)
  v_mfma_f32_16x16x32_bf16 v[192:195], v[248:251], a[64:67], v[192:195]
  ds_read_b64_tr_b16 v[246:247], v2 offset:9088
  v_mul_f32 v77, s37, v77
  v_mfma_f32_16x16x32_bf16 v[196:199], v[248:251], a[68:71], v[196:199]
  v_mul_f32 v78, s37, v78
  v_mul_f32 v79, s37, v79
  v_mfma_f32_16x16x32_bf16 v[200:203], v[248:251], a[72:75], v[200:203]
  v_cvt_pk_bf16_f32 v76, v76, v77
  v_cvt_pk_bf16_f32 v77, v78, v79
  v_mfma_f32_16x16x32_bf16 v[204:207], v[248:251], a[76:79], v[204:207]
  ds_read_b64_tr_b16 v[248:249], v2 offset:160
  s_waitcnt lgkmcnt(5)
  v_mfma_f32_16x16x32_bf16 v[192:195], v[252:255], a[80:83], v[192:195]
  ds_read_b64_tr_b16 v[250:251], v2 offset:8608
  v_mul_f32 v80, s37, v80
  v_mfma_f32_16x16x32_bf16 v[196:199], v[252:255], a[84:87], v[196:199]
  v_mul_f32 v81, s37, v81
  v_mul_f32 v82, s37, v82
  v_mfma_f32_16x16x32_bf16 v[200:203], v[252:255], a[88:91], v[200:203]
  v_mul_f32 v83, s37, v83
  v_cvt_pk_bf16_f32 v80, v80, v81
  v_mfma_f32_16x16x32_bf16 v[204:207], v[252:255], a[92:95], v[204:207]
  ds_read_b64_tr_b16 v[252:253], v2 offset:672
  s_waitcnt lgkmcnt(5)
  v_mfma_f32_16x16x32_bf16 v[208:211], v[240:243], a[64:67], v[208:211]
  ds_read_b64_tr_b16 v[254:255], v2 offset:9120
  v_cvt_pk_bf16_f32 v81, v82, v83
  v_mfma_f32_16x16x32_bf16 v[212:215], v[240:243], a[68:71], v[212:215]
  v_mul_f32 v84, s37, v84
  v_mul_f32 v85, s37, v85
  v_mfma_f32_16x16x32_bf16 v[216:219], v[240:243], a[72:75], v[216:219]
  v_mul_f32 v86, s37, v86
  v_mul_f32 v87, s37, v87
  v_mfma_f32_16x16x32_bf16 v[220:223], v[240:243], a[76:79], v[220:223]
  ds_read_b64_tr_b16 v[240:241], v2 offset:192
  s_waitcnt lgkmcnt(5)
  v_mfma_f32_16x16x32_bf16 v[208:211], v[244:247], a[80:83], v[208:211]
  ds_read_b64_tr_b16 v[242:243], v2 offset:8640
  v_cvt_pk_bf16_f32 v84, v84, v85
  v_mfma_f32_16x16x32_bf16 v[212:215], v[244:247], a[84:87], v[212:215]
  v_cvt_pk_bf16_f32 v85, v86, v87
  v_mul_f32 v88, s37, v88
  v_mfma_f32_16x16x32_bf16 v[216:219], v[244:247], a[88:91], v[216:219]
  v_mul_f32 v89, s37, v89
  v_mul_f32 v90, s37, v90
  v_mfma_f32_16x16x32_bf16 v[220:223], v[244:247], a[92:95], v[220:223]
  ds_read_b64_tr_b16 v[244:245], v2 offset:704
  s_waitcnt lgkmcnt(5)
  v_mfma_f32_16x16x32_bf16 v[224:227], v[248:251], a[64:67], v[224:227]
  ds_read_b64_tr_b16 v[246:247], v2 offset:9152
  v_mul_f32 v91, s37, v91
  v_mfma_f32_16x16x32_bf16 v[228:231], v[248:251], a[68:71], v[228:231]
  v_cvt_pk_bf16_f32 v88, v88, v89
  v_cvt_pk_bf16_f32 v89, v90, v91
  v_mfma_f32_16x16x32_bf16 v[232:235], v[248:251], a[72:75], v[232:235]
  v_mul_f32 v92, s37, v92
  v_mul_f32 v93, s37, v93
  v_mfma_f32_16x16x32_bf16 v[236:239], v[248:251], a[76:79], v[236:239]
  ds_read_b64_tr_b16 v[248:249], v2 offset:224
  s_waitcnt lgkmcnt(5)
  v_mfma_f32_16x16x32_bf16 v[224:227], v[252:255], a[80:83], v[224:227]
  ds_read_b64_tr_b16 v[250:251], v2 offset:8672
  v_mul_f32 v94, s37, v94
  v_mfma_f32_16x16x32_bf16 v[228:231], v[252:255], a[84:87], v[228:231]
  v_mul_f32 v95, s37, v95
  v_cvt_pk_bf16_f32 v92, v92, v93
  v_mfma_f32_16x16x32_bf16 v[232:235], v[252:255], a[88:91], v[232:235]
  v_cvt_pk_bf16_f32 v93, v94, v95
  v_mul_f32 v96, s37, v96
  v_mfma_f32_16x16x32_bf16 v[236:239], v[252:255], a[92:95], v[236:239]
  ds_read_b64_tr_b16 v[252:253], v2 offset:736
  s_waitcnt vmcnt(8)
  s_barrier
  s_waitcnt lgkmcnt(5)
  v_mfma_f32_16x16x32_bf16 a[224:227], v[240:243], a[64:67], a[224:227]
  s_mov_b32 s35, 98304
  ds_read_b64_tr_b16 v[254:255], v2 offset:9184
  v_mul_f32 v97, s37, v97
  v_mfma_f32_16x16x32_bf16 a[228:231], v[240:243], a[68:71], a[228:231]
  s_add_u32 m0, s33, 135168
  v_mul_f32 v98, s37, v98
  v_mul_f32 v99, s37, v99
  v_mfma_f32_16x16x32_bf16 a[232:235], v[240:243], a[72:75], a[232:235]
  buffer_load_dwordx4 v3, s[8:11], s35 offen offset:0 nt lds
  v_cvt_pk_bf16_f32 v96, v96, v97
  v_mfma_f32_16x16x32_bf16 a[236:239], v[240:243], a[76:79], a[236:239]
  s_add_u32 m0, s33, 135696
  v_add_u32 v2, 101376, v2
  ds_read_b64_tr_b16 v[240:241], v2 offset:0
  s_waitcnt lgkmcnt(5)
  v_mfma_f32_16x16x32_bf16 a[224:227], v[244:247], a[80:83], a[224:227]
  ds_read_b64_tr_b16 v[242:243], v2 offset:8448
  v_cvt_pk_bf16_f32 v97, v98, v99
  v_mfma_f32_16x16x32_bf16 a[228:231], v[244:247], a[84:87], a[228:231]
  v_mul_f32 v100, s37, v100
  v_mul_f32 v101, s37, v101
  v_mfma_f32_16x16x32_bf16 a[232:235], v[244:247], a[88:91], a[232:235]
  v_mul_f32 v102, s37, v102
  v_mul_f32 v103, s37, v103
  v_mfma_f32_16x16x32_bf16 a[236:239], v[244:247], a[92:95], a[236:239]
  ds_read_b64_tr_b16 v[244:245], v2 offset:512
  s_waitcnt lgkmcnt(5)
  v_mfma_f32_16x16x32_bf16 a[240:243], v[248:251], a[64:67], a[240:243]
  ds_read_b64_tr_b16 v[246:247], v2 offset:8960
  buffer_load_dwordx4 v3, s[8:11], s35 offen offset:512 nt lds
  v_mfma_f32_16x16x32_bf16 a[244:247], v[248:251], a[68:71], a[244:247]
  s_add_u32 m0, s33, 136224
  v_cvt_pk_bf16_f32 v100, v100, v101
  v_cvt_pk_bf16_f32 v101, v102, v103
  v_mfma_f32_16x16x32_bf16 a[248:251], v[248:251], a[72:75], a[248:251]
  v_mul_f32 v104, s37, v104
  v_mul_f32 v105, s37, v105
  v_mfma_f32_16x16x32_bf16 a[252:255], v[248:251], a[76:79], a[252:255]
  ds_read_b64_tr_b16 v[248:249], v2 offset:32
  s_waitcnt lgkmcnt(5)
  v_mfma_f32_16x16x32_bf16 a[240:243], v[252:255], a[80:83], a[240:243]
  ds_read_b64_tr_b16 v[250:251], v2 offset:8480
  v_mul_f32 v106, s37, v106
  v_mfma_f32_16x16x32_bf16 a[244:247], v[252:255], a[84:87], a[244:247]
  buffer_load_dwordx4 v3, s[8:11], s35 offen offset:1024 nt lds
  v_mul_f32 v107, s37, v107
  v_mfma_f32_16x16x32_bf16 a[248:251], v[252:255], a[88:91], a[248:251]
  s_add_u32 m0, s33, 136752
  v_cvt_pk_bf16_f32 v104, v104, v105
  v_cvt_pk_bf16_f32 v105, v106, v107
  v_mfma_f32_16x16x32_bf16 a[252:255], v[252:255], a[92:95], a[252:255]
  ds_read_b64_tr_b16 v[252:253], v2 offset:544
  v_mul_f32 v108, s37, v108
  v_mul_f32 v109, s37, v109
  v_mul_f32 v110, s37, v110
  v_mul_f32 v111, s37, v111
  v_cvt_pk_bf16_f32 v108, v108, v109
  v_cvt_pk_bf16_f32 v109, v110, v111
  v_mul_f32 v112, s37, v112
  v_mul_f32 v113, s37, v113
  v_mul_f32 v114, s37, v114
  v_mul_f32 v115, s37, v115
  v_cvt_pk_bf16_f32 v112, v112, v113
  v_cvt_pk_bf16_f32 v113, v114, v115
  v_mul_f32 v116, s37, v116
  v_mul_f32 v117, s37, v117
  v_mul_f32 v118, s37, v118
  v_mul_f32 v119, s37, v119
  v_cvt_pk_bf16_f32 v116, v116, v117
  v_cvt_pk_bf16_f32 v117, v118, v119
  v_mul_f32 v120, s37, v120
  v_mul_f32 v121, s37, v121
  v_mul_f32 v122, s37, v122
  v_mul_f32 v123, s37, v123
  v_cvt_pk_bf16_f32 v120, v120, v121
  v_cvt_pk_bf16_f32 v121, v122, v123
  v_mul_f32 v124, s37, v124
  v_mul_f32 v125, s37, v125
  v_mul_f32 v126, s37, v126
  v_mul_f32 v127, s37, v127
  v_cvt_pk_bf16_f32 v124, v124, v125
  v_cvt_pk_bf16_f32 v125, v126, v127
  v_mul_f32 v128, s37, v128
  v_mul_f32 v129, s37, v129
  v_mul_f32 v130, s37, v130
  v_mul_f32 v131, s37, v131
  v_cvt_pk_bf16_f32 v128, v128, v129
  v_cvt_pk_bf16_f32 v129, v130, v131
  v_mul_f32 v132, s37, v132
  v_mul_f32 v133, s37, v133
  v_mul_f32 v134, s37, v134
  v_mul_f32 v135, s37, v135
  v_cvt_pk_bf16_f32 v132, v132, v133
  v_cvt_pk_bf16_f32 v133, v134, v135
  v_mul_f32 v136, s37, v136
  v_mul_f32 v137, s37, v137
  v_mul_f32 v138, s37, v138
  v_mul_f32 v139, s37, v139
  v_cvt_pk_bf16_f32 v136, v136, v137
  v_cvt_pk_bf16_f32 v137, v138, v139
  v_mul_f32 v140, s37, v140
  v_mul_f32 v141, s37, v141
  v_mul_f32 v142, s37, v142
  v_mul_f32 v143, s37, v143
  v_cvt_pk_bf16_f32 v140, v140, v141
  v_cvt_pk_bf16_f32 v141, v142, v143
  s_waitcnt lgkmcnt(5)
  v_mfma_f32_16x16x32_bf16 v[144:147], v[240:243], a[0:3], v[144:147]
  ds_read_b64_tr_b16 v[254:255], v2 offset:8992
  v_mfma_f32_16x16x32_bf16 v[148:151], v[240:243], a[4:7], v[148:151]
  v_mfma_f32_16x16x32_bf16 v[152:155], v[240:243], a[8:11], v[152:155]
  buffer_load_dwordx4 v3, s[8:11], s35 offen offset:1536 nt lds
  v_mfma_f32_16x16x32_bf16 v[156:159], v[240:243], a[12:15], v[156:159]
  ds_read_b64_tr_b16 v[240:241], v2 offset:64
  s_waitcnt lgkmcnt(5)
  v_mfma_f32_16x16x32_bf16 v[144:147], v[244:247], a[16:19], v[144:147]
  ds_read_b64_tr_b16 v[242:243], v2 offset:8512
  v_mfma_f32_16x16x32_bf16 v[148:151], v[244:247], a[20:23], v[148:151]
  v_mfma_f32_16x16x32_bf16 v[152:155], v[244:247], a[24:27], v[152:155]
  v_mfma_f32_16x16x32_bf16 v[156:159], v[244:247], a[28:31], v[156:159]
  ds_read_b64_tr_b16 v[244:245], v2 offset:576
  s_waitcnt lgkmcnt(5)
  v_mfma_f32_16x16x32_bf16 v[160:163], v[248:251], a[0:3], v[160:163]
  ds_read_b64_tr_b16 v[246:247], v2 offset:9024
  v_mfma_f32_16x16x32_bf16 v[164:167], v[248:251], a[4:7], v[164:167]
  v_mfma_f32_16x16x32_bf16 v[168:171], v[248:251], a[8:11], v[168:171]
  v_mfma_f32_16x16x32_bf16 v[172:175], v[248:251], a[12:15], v[172:175]
  ds_read_b64_tr_b16 v[248:249], v2 offset:96
  s_waitcnt lgkmcnt(5)
  v_mfma_f32_16x16x32_bf16 v[160:163], v[252:255], a[16:19], v[160:163]
  ds_read_b64_tr_b16 v[250:251], v2 offset:8544
  v_mul_f32 v144, s37, v144
  v_mfma_f32_16x16x32_bf16 v[164:167], v[252:255], a[20:23], v[164:167]
  v_mul_f32 v145, s37, v145
  v_mul_f32 v146, s37, v146
  v_mfma_f32_16x16x32_bf16 v[168:171], v[252:255], a[24:27], v[168:171]
  v_mul_f32 v147, s37, v147
  v_cvt_pk_bf16_f32 v18, v144, v145
  v_mfma_f32_16x16x32_bf16 v[172:175], v[252:255], a[28:31], v[172:175]
  ds_read_b64_tr_b16 v[252:253], v2 offset:608
  s_waitcnt lgkmcnt(5)
  v_mfma_f32_16x16x32_bf16 v[176:179], v[240:243], a[0:3], v[176:179]
  ds_read_b64_tr_b16 v[254:255], v2 offset:9056
  v_cvt_pk_bf16_f32 v19, v146, v147
  v_mfma_f32_16x16x32_bf16 v[180:183], v[240:243], a[4:7], v[180:183]
  v_mul_f32 v148, s37, v148
  v_mul_f32 v149, s37, v149
  v_mfma_f32_16x16x32_bf16 v[184:187], v[240:243], a[8:11], v[184:187]
  v_mul_f32 v150, s37, v150
  v_mul_f32 v151, s37, v151
  v_mfma_f32_16x16x32_bf16 v[188:191], v[240:243], a[12:15], v[188:191]
  ds_read_b64_tr_b16 v[240:241], v2 offset:128
  s_waitcnt lgkmcnt(5)
  v_mfma_f32_16x16x32_bf16 v[176:179], v[244:247], a[16:19], v[176:179]
  ds_read_b64_tr_b16 v[242:243], v2 offset:8576
  v_cvt_pk_bf16_f32 v22, v148, v149
  v_mfma_f32_16x16x32_bf16 v[180:183], v[244:247], a[20:23], v[180:183]
  v_cvt_pk_bf16_f32 v23, v150, v151
  v_mul_f32 v152, s37, v152
  v_mfma_f32_16x16x32_bf16 v[184:187], v[244:247], a[24:27], v[184:187]
  v_mul_f32 v153, s37, v153
  v_mul_f32 v154, s37, v154
  v_mfma_f32_16x16x32_bf16 v[188:191], v[244:247], a[28:31], v[188:191]
  ds_read_b64_tr_b16 v[244:245], v2 offset:640
  s_waitcnt lgkmcnt(5)
  v_mfma_f32_16x16x32_bf16 v[192:195], v[248:251], a[0:3], v[192:195]
  ds_read_b64_tr_b16 v[246:247], v2 offset:9088
  v_mul_f32 v155, s37, v155
  v_mfma_f32_16x16x32_bf16 v[196:199], v[248:251], a[4:7], v[196:199]
  v_cvt_pk_bf16_f32 v26, v152, v153
  v_cvt_pk_bf16_f32 v27, v154, v155
  v_mfma_f32_16x16x32_bf16 v[200:203], v[248:251], a[8:11], v[200:203]
  v_mul_f32 v156, s37, v156
  v_mul_f32 v157, s37, v157
  v_mfma_f32_16x16x32_bf16 v[204:207], v[248:251], a[12:15], v[204:207]
  ds_read_b64_tr_b16 v[248:249], v2 offset:160
  s_waitcnt lgkmcnt(5)
  v_mfma_f32_16x16x32_bf16 v[192:195], v[252:255], a[16:19], v[192:195]
  ds_read_b64_tr_b16 v[250:251], v2 offset:8608
  v_mul_f32 v158, s37, v158
  v_mfma_f32_16x16x32_bf16 v[196:199], v[252:255], a[20:23], v[196:199]
  v_mul_f32 v159, s37, v159
  v_cvt_pk_bf16_f32 v30, v156, v157
  v_mfma_f32_16x16x32_bf16 v[200:203], v[252:255], a[24:27], v[200:203]
  v_cvt_pk_bf16_f32 v31, v158, v159
  v_permlane16_swap_b32 v16, v18
  v_mfma_f32_16x16x32_bf16 v[204:207], v[252:255], a[28:31], v[204:207]
  ds_read_b64_tr_b16 v[252:253], v2 offset:672
  s_waitcnt lgkmcnt(5)
  v_mfma_f32_16x16x32_bf16 v[208:211], v[240:243], a[0:3], v[208:211]
  ds_read_b64_tr_b16 v[254:255], v2 offset:9120
  v_permlane16_swap_b32 v17, v19
  v_mfma_f32_16x16x32_bf16 v[212:215], v[240:243], a[4:7], v[212:215]
  v_permlane16_swap_b32 v20, v22
  v_permlane16_swap_b32 v21, v23
  v_mfma_f32_16x16x32_bf16 v[216:219], v[240:243], a[8:11], v[216:219]
  v_permlane16_swap_b32 v24, v26
  v_permlane16_swap_b32 v25, v27
  v_mfma_f32_16x16x32_bf16 v[220:223], v[240:243], a[12:15], v[220:223]
  ds_read_b64_tr_b16 v[240:241], v2 offset:192
  s_waitcnt lgkmcnt(5)
  v_mfma_f32_16x16x32_bf16 v[208:211], v[244:247], a[16:19], v[208:211]
  ds_read_b64_tr_b16 v[242:243], v2 offset:8640
  v_permlane16_swap_b32 v28, v30
  v_mfma_f32_16x16x32_bf16 v[212:215], v[244:247], a[20:23], v[212:215]
  v_permlane16_swap_b32 v29, v31
  v_mul_f32 v160, s37, v160
  v_mfma_f32_16x16x32_bf16 v[216:219], v[244:247], a[24:27], v[216:219]
  v_mul_f32 v161, s37, v161
  v_mul_f32 v162, s37, v162
  v_mfma_f32_16x16x32_bf16 v[220:223], v[244:247], a[28:31], v[220:223]
  ds_read_b64_tr_b16 v[244:245], v2 offset:704
  s_waitcnt lgkmcnt(5)
  v_mfma_f32_16x16x32_bf16 v[224:227], v[248:251], a[0:3], v[224:227]
  ds_read_b64_tr_b16 v[246:247], v2 offset:9152
  v_mul_f32 v163, s37, v163
  v_mfma_f32_16x16x32_bf16 v[228:231], v[248:251], a[4:7], v[228:231]
  v_cvt_pk_bf16_f32 v34, v160, v161
  v_cvt_pk_bf16_f32 v35, v162, v163
  v_mfma_f32_16x16x32_bf16 v[232:235], v[248:251], a[8:11], v[232:235]
  v_mul_f32 v164, s37, v164
  v_mul_f32 v165, s37, v165
  v_mfma_f32_16x16x32_bf16 v[236:239], v[248:251], a[12:15], v[236:239]
  ds_read_b64_tr_b16 v[248:249], v2 offset:224
  s_waitcnt lgkmcnt(5)
  v_mfma_f32_16x16x32_bf16 v[224:227], v[252:255], a[16:19], v[224:227]
  ds_read_b64_tr_b16 v[250:251], v2 offset:8672
  v_mul_f32 v166, s37, v166
  v_mfma_f32_16x16x32_bf16 v[228:231], v[252:255], a[20:23], v[228:231]
  v_mul_f32 v167, s37, v167
  v_cvt_pk_bf16_f32 v38, v164, v165
  v_mfma_f32_16x16x32_bf16 v[232:235], v[252:255], a[24:27], v[232:235]
  v_cvt_pk_bf16_f32 v39, v166, v167
  v_mul_f32 v168, s37, v168
  v_mfma_f32_16x16x32_bf16 v[236:239], v[252:255], a[28:31], v[236:239]
  ds_read_b64_tr_b16 v[252:253], v2 offset:736
  s_barrier
  s_waitcnt lgkmcnt(5)
  v_mfma_f32_16x16x32_bf16 a[224:227], v[240:243], a[0:3], a[224:227]
  s_mov_b32 s35, 114688
  ds_read_b64_tr_b16 v[254:255], v2 offset:9184
  v_mul_f32 v169, s37, v169
  v_mfma_f32_16x16x32_bf16 a[228:231], v[240:243], a[4:7], a[228:231]
  s_add_u32 m0, s33, 0
  v_mul_f32 v170, s37, v170
  v_mul_f32 v171, s37, v171
  v_mfma_f32_16x16x32_bf16 a[232:235], v[240:243], a[8:11], a[232:235]
  buffer_load_dwordx4 v3, s[8:11], s35 offen offset:0 nt lds
  v_cvt_pk_bf16_f32 v42, v168, v169
  v_mfma_f32_16x16x32_bf16 a[236:239], v[240:243], a[12:15], a[236:239]
  s_add_u32 m0, s33, 528
  v_add_u32 v1, 50688, v1
  ds_read_b128 v[240:243], v1 offset:16896
  s_waitcnt lgkmcnt(5)
  v_mfma_f32_16x16x32_bf16 a[224:227], v[244:247], a[16:19], a[224:227]
  v_cvt_pk_bf16_f32 v43, v170, v171
  v_mul_f32 v172, s37, v172
  v_mfma_f32_16x16x32_bf16 a[228:231], v[244:247], a[20:23], a[228:231]
  v_mul_f32 v173, s37, v173
  v_mul_f32 v174, s37, v174
  v_mfma_f32_16x16x32_bf16 a[232:235], v[244:247], a[24:27], a[232:235]
  v_mul_f32 v175, s37, v175
  v_cvt_pk_bf16_f32 v46, v172, v173
  v_mfma_f32_16x16x32_bf16 a[236:239], v[244:247], a[28:31], a[236:239]
  ds_read_b128 v[244:247], v1 offset:17408
  s_waitcnt lgkmcnt(4)
  v_mfma_f32_16x16x32_bf16 a[240:243], v[248:251], a[0:3], a[240:243]
  buffer_load_dwordx4 v3, s[8:11], s35 offen offset:512 nt lds
  v_cvt_pk_bf16_f32 v47, v174, v175
  v_mfma_f32_16x16x32_bf16 a[244:247], v[248:251], a[4:7], a[244:247]
  s_add_u32 m0, s33, 1056
  v_permlane16_swap_b32 v32, v34
  v_permlane16_swap_b32 v33, v35
  v_mfma_f32_16x16x32_bf16 a[248:251], v[248:251], a[8:11], a[248:251]
  v_permlane16_swap_b32 v36, v38
  v_permlane16_swap_b32 v37, v39
  v_mfma_f32_16x16x32_bf16 a[252:255], v[248:251], a[12:15], a[252:255]
  ds_read_b128 v[248:251], v1 offset:16928
  s_waitcnt lgkmcnt(3)
  v_mfma_f32_16x16x32_bf16 a[240:243], v[252:255], a[16:19], a[240:243]
  v_permlane16_swap_b32 v40, v42
  v_permlane16_swap_b32 v41, v43
  v_mfma_f32_16x16x32_bf16 a[244:247], v[252:255], a[20:23], a[244:247]
  buffer_load_dwordx4 v3, s[8:11], s35 offen offset:1024 nt lds
  v_permlane16_swap_b32 v44, v46
  v_mfma_f32_16x16x32_bf16 a[248:251], v[252:255], a[24:27], a[248:251]
  s_add_u32 m0, s33, 1584
  v_permlane16_swap_b32 v45, v47
  v_mul_f32 v176, s37, v176
  v_mfma_f32_16x16x32_bf16 a[252:255], v[252:255], a[28:31], a[252:255]
  ds_read_b128 v[252:255], v1 offset:17440
  s_waitcnt lgkmcnt(3)
  v_mfma_f32_16x16x32_bf16 v[144:147], v[240:243], v[16:19], 0
  v_mul_f32 v177, s37, v177
  v_mul_f32 v178, s37, v178
  v_mfma_f32_16x16x32_bf16 v[152:155], v[240:243], v[20:23], 0
  v_mul_f32 v179, s37, v179
  v_cvt_pk_bf16_f32 v50, v176, v177
  v_mfma_f32_16x16x32_bf16 v[160:163], v[240:243], v[24:27], 0
  buffer_load_dwordx4 v3, s[8:11], s35 offen offset:1536 nt lds
  v_cvt_pk_bf16_f32 v51, v178, v179
  v_mfma_f32_16x16x32_bf16 v[168:171], v[240:243], v[28:31], 0
  ds_read_b128 v[240:243], v1 offset:16960
  s_waitcnt lgkmcnt(3)
  v_mfma_f32_16x16x32_bf16 v[148:151], v[244:247], v[16:19], 0
  v_mul_f32 v180, s37, v180
  v_mul_f32 v181, s37, v181
  v_mfma_f32_16x16x32_bf16 v[156:159], v[244:247], v[20:23], 0
  v_mul_f32 v182, s37, v182
  v_mul_f32 v183, s37, v183
  v_mfma_f32_16x16x32_bf16 v[164:167], v[244:247], v[24:27], 0
  v_cvt_pk_bf16_f32 v54, v180, v181
  v_cvt_pk_bf16_f32 v55, v182, v183
  v_mfma_f32_16x16x32_bf16 v[172:175], v[244:247], v[28:31], 0
  ds_read_b128 v[244:247], v1 offset:17472
  s_waitcnt lgkmcnt(3)
  v_mfma_f32_16x16x32_bf16 v[144:147], v[248:251], v[32:35], v[144:147]
  v_mul_f32 v184, s37, v184
  v_mul_f32 v185, s37, v185
  v_mfma_f32_16x16x32_bf16 v[152:155], v[248:251], v[36:39], v[152:155]
  v_mul_f32 v186, s37, v186
  v_mul_f32 v187, s37, v187
  v_mfma_f32_16x16x32_bf16 v[160:163], v[248:251], v[40:43], v[160:163]
  v_cvt_pk_bf16_f32 v58, v184, v185
  v_cvt_pk_bf16_f32 v59, v186, v187
  v_mfma_f32_16x16x32_bf16 v[168:171], v[248:251], v[44:47], v[168:171]
  ds_read_b128 v[248:251], v1 offset:16992
  s_waitcnt lgkmcnt(3)
  v_mfma_f32_16x16x32_bf16 v[148:151], v[252:255], v[32:35], v[148:151]
  v_mul_f32 v188, s37, v188
  v_mul_f32 v189, s37, v189
  v_mfma_f32_16x16x32_bf16 v[156:159], v[252:255], v[36:39], v[156:159]
  v_mul_f32 v190, s37, v190
  v_mul_f32 v191, s37, v191
  v_mfma_f32_16x16x32_bf16 v[164:167], v[252:255], v[40:43], v[164:167]
  v_cvt_pk_bf16_f32 v62, v188, v189
  v_cvt_pk_bf16_f32 v63, v190, v191
  v_permlane16_swap_b32 v48, v50
  v_permlane16_swap_b32 v49, v51
  v_permlane16_swap_b32 v52, v54
  v_permlane16_swap_b32 v53, v55
  v_permlane16_swap_b32 v56, v58
  v_permlane16_swap_b32 v57, v59
  v_permlane16_swap_b32 v60, v62
  v_permlane16_swap_b32 v61, v63
  v_mfma_f32_16x16x32_bf16 v[172:175], v[252:255], v[44:47], v[172:175]
  ds_read_b128 v[252:255], v1 offset:17504
  s_waitcnt lgkmcnt(3)
  v_mfma_f32_16x16x32_bf16 v[144:147], v[240:243], v[48:51], v[144:147]
  v_mul_f32 v192, s37, v192
  v_mul_f32 v193, s37, v193
  v_mfma_f32_16x16x32_bf16 v[152:155], v[240:243], v[52:55], v[152:155]
  v_mul_f32 v194, s37, v194
  v_mul_f32 v195, s37, v195
  v_mfma_f32_16x16x32_bf16 v[160:163], v[240:243], v[56:59], v[160:163]
  v_cvt_pk_bf16_f32 v66, v192, v193
  v_cvt_pk_bf16_f32 v67, v194, v195
  v_mfma_f32_16x16x32_bf16 v[168:171], v[240:243], v[60:63], v[168:171]
  ds_read_b128 v[240:243], v1 offset:17024
  s_waitcnt lgkmcnt(3)
  v_mfma_f32_16x16x32_bf16 v[148:151], v[244:247], v[48:51], v[148:151]
  v_mul_f32 v196, s37, v196
  v_mul_f32 v197, s37, v197
  v_mfma_f32_16x16x32_bf16 v[156:159], v[244:247], v[52:55], v[156:159]
  v_mul_f32 v198, s37, v198
  v_mul_f32 v199, s37, v199
  v_mfma_f32_16x16x32_bf16 v[164:167], v[244:247], v[56:59], v[164:167]
  v_cvt_pk_bf16_f32 v70, v196, v197
  v_cvt_pk_bf16_f32 v71, v198, v199
  v_mul_f32 v200, s37, v200
  v_mul_f32 v201, s37, v201
  v_mul_f32 v202, s37, v202
  v_mul_f32 v203, s37, v203
  v_cvt_pk_bf16_f32 v74, v200, v201
  v_cvt_pk_bf16_f32 v75, v202, v203
  v_mul_f32 v204, s37, v204
  v_mul_f32 v205, s37, v205
  v_mul_f32 v206, s37, v206
  v_mul_f32 v207, s37, v207
  v_cvt_pk_bf16_f32 v78, v204, v205
  v_cvt_pk_bf16_f32 v79, v206, v207
  v_permlane16_swap_b32 v64, v66
  v_permlane16_swap_b32 v65, v67
  v_permlane16_swap_b32 v68, v70
  v_permlane16_swap_b32 v69, v71
  v_permlane16_swap_b32 v72, v74
  v_permlane16_swap_b32 v73, v75
  v_permlane16_swap_b32 v76, v78
  v_permlane16_swap_b32 v77, v79
  v_mfma_f32_16x16x32_bf16 v[172:175], v[244:247], v[60:63], v[172:175]
  ds_read_b128 v[244:247], v1 offset:17536
  s_waitcnt lgkmcnt(3)
  v_mfma_f32_16x16x32_bf16 v[144:147], v[248:251], v[64:67], v[144:147]
  v_mul_f32 v208, s37, v208
  v_mul_f32 v209, s37, v209
  v_mfma_f32_16x16x32_bf16 v[152:155], v[248:251], v[68:71], v[152:155]
  v_mul_f32 v210, s37, v210
  v_mul_f32 v211, s37, v211
  v_mfma_f32_16x16x32_bf16 v[160:163], v[248:251], v[72:75], v[160:163]
  v_cvt_pk_bf16_f32 v82, v208, v209
  v_cvt_pk_bf16_f32 v83, v210, v211
  v_mfma_f32_16x16x32_bf16 v[168:171], v[248:251], v[76:79], v[168:171]
  ds_read_b128 v[248:251], v1 offset:17056
  s_waitcnt lgkmcnt(3)
  v_mfma_f32_16x16x32_bf16 v[148:151], v[252:255], v[64:67], v[148:151]
  v_mul_f32 v212, s37, v212
  v_mul_f32 v213, s37, v213
  v_mfma_f32_16x16x32_bf16 v[156:159], v[252:255], v[68:71], v[156:159]
  v_mul_f32 v214, s37, v214
  v_mul_f32 v215, s37, v215
  v_mfma_f32_16x16x32_bf16 v[164:167], v[252:255], v[72:75], v[164:167]
  v_cvt_pk_bf16_f32 v86, v212, v213
  v_cvt_pk_bf16_f32 v87, v214, v215
  v_mul_f32 v216, s37, v216
  v_mul_f32 v217, s37, v217
  v_mul_f32 v218, s37, v218
  v_mul_f32 v219, s37, v219
  v_cvt_pk_bf16_f32 v90, v216, v217
  v_cvt_pk_bf16_f32 v91, v218, v219
  v_mul_f32 v220, s37, v220
  v_mul_f32 v221, s37, v221
  v_mul_f32 v222, s37, v222
  v_mul_f32 v223, s37, v223
  v_cvt_pk_bf16_f32 v94, v220, v221
  v_cvt_pk_bf16_f32 v95, v222, v223
  v_permlane16_swap_b32 v80, v82
  v_permlane16_swap_b32 v81, v83
  v_permlane16_swap_b32 v84, v86
  v_permlane16_swap_b32 v85, v87
  v_permlane16_swap_b32 v88, v90
  v_permlane16_swap_b32 v89, v91
  v_permlane16_swap_b32 v92, v94
  v_permlane16_swap_b32 v93, v95
  v_mfma_f32_16x16x32_bf16 v[172:175], v[252:255], v[76:79], v[172:175]
  ds_read_b128 v[252:255], v1 offset:17568
  s_waitcnt lgkmcnt(3)
  v_mfma_f32_16x16x32_bf16 v[144:147], v[240:243], v[80:83], v[144:147]
  v_mul_f32 v224, s37, v224
  v_mul_f32 v225, s37, v225
  v_mfma_f32_16x16x32_bf16 v[152:155], v[240:243], v[84:87], v[152:155]
  v_mul_f32 v226, s37, v226
  v_mul_f32 v227, s37, v227
  v_mfma_f32_16x16x32_bf16 v[160:163], v[240:243], v[88:91], v[160:163]
  v_cvt_pk_bf16_f32 v98, v224, v225
  v_cvt_pk_bf16_f32 v99, v226, v227
  v_mfma_f32_16x16x32_bf16 v[168:171], v[240:243], v[92:95], v[168:171]
  ds_read_b128 v[240:243], v1 offset:17088
  s_waitcnt lgkmcnt(3)
  v_mfma_f32_16x16x32_bf16 v[148:151], v[244:247], v[80:83], v[148:151]
  v_mul_f32 v228, s37, v228
  v_mul_f32 v229, s37, v229
  v_mfma_f32_16x16x32_bf16 v[156:159], v[244:247], v[84:87], v[156:159]
  v_mul_f32 v230, s37, v230
  v_mul_f32 v231, s37, v231
  v_mfma_f32_16x16x32_bf16 v[164:167], v[244:247], v[88:91], v[164:167]
  v_cvt_pk_bf16_f32 v102, v228, v229
  v_cvt_pk_bf16_f32 v103, v230, v231
  v_mul_f32 v232, s37, v232
  v_mul_f32 v233, s37, v233
  v_mul_f32 v234, s37, v234
  v_mul_f32 v235, s37, v235
  v_cvt_pk_bf16_f32 v106, v232, v233
  v_cvt_pk_bf16_f32 v107, v234, v235
  v_mul_f32 v236, s37, v236
  v_mul_f32 v237, s37, v237
  v_mul_f32 v238, s37, v238
  v_mul_f32 v239, s37, v239
  v_cvt_pk_bf16_f32 v110, v236, v237
  v_cvt_pk_bf16_f32 v111, v238, v239
  v_permlane16_swap_b32 v96, v98
  v_permlane16_swap_b32 v97, v99
  v_permlane16_swap_b32 v100, v102
  v_permlane16_swap_b32 v101, v103
  v_permlane16_swap_b32 v104, v106
  v_permlane16_swap_b32 v105, v107
  v_permlane16_swap_b32 v108, v110
  v_permlane16_swap_b32 v109, v111
  v_mfma_f32_16x16x32_bf16 v[172:175], v[244:247], v[92:95], v[172:175]
  ds_read_b128 v[244:247], v1 offset:17600
  s_waitcnt lgkmcnt(3)
  v_mfma_f32_16x16x32_bf16 v[144:147], v[248:251], v[96:99], v[144:147]
  v_accvgpr_read_b32 v176, a224
  v_accvgpr_read_b32 v177, a225
  v_mfma_f32_16x16x32_bf16 v[152:155], v[248:251], v[100:103], v[152:155]
  v_accvgpr_read_b32 v178, a226
  v_accvgpr_read_b32 v179, a227
  v_mfma_f32_16x16x32_bf16 v[160:163], v[248:251], v[104:107], v[160:163]
  v_mul_f32 v176, s37, v176
  v_mul_f32 v177, s37, v177
  v_mfma_f32_16x16x32_bf16 v[168:171], v[248:251], v[108:111], v[168:171]
  ds_read_b128 v[248:251], v1 offset:17120
  s_waitcnt lgkmcnt(3)
  v_mfma_f32_16x16x32_bf16 v[148:151], v[252:255], v[96:99], v[148:151]
  v_mul_f32 v178, s37, v178
  v_mul_f32 v179, s37, v179
  v_mfma_f32_16x16x32_bf16 v[156:159], v[252:255], v[100:103], v[156:159]
  v_cvt_pk_bf16_f32 v114, v176, v177
  v_cvt_pk_bf16_f32 v115, v178, v179
  v_mfma_f32_16x16x32_bf16 v[164:167], v[252:255], v[104:107], v[164:167]
  v_accvgpr_read_b32 v180, a228
  v_accvgpr_read_b32 v181, a229
  v_accvgpr_read_b32 v182, a230
  v_accvgpr_read_b32 v183, a231
  v_mul_f32 v180, s37, v180
  v_mul_f32 v181, s37, v181
  v_mul_f32 v182, s37, v182
  v_mul_f32 v183, s37, v183
  v_cvt_pk_bf16_f32 v118, v180, v181
  v_cvt_pk_bf16_f32 v119, v182, v183
  v_accvgpr_read_b32 v184, a232
  v_accvgpr_read_b32 v185, a233
  v_accvgpr_read_b32 v186, a234
  v_accvgpr_read_b32 v187, a235
  v_mul_f32 v184, s37, v184
  v_mul_f32 v185, s37, v185
  v_mul_f32 v186, s37, v186
  v_mul_f32 v187, s37, v187
  v_cvt_pk_bf16_f32 v122, v184, v185
  v_cvt_pk_bf16_f32 v123, v186, v187
  v_accvgpr_read_b32 v188, a236
  v_accvgpr_read_b32 v189, a237
  v_accvgpr_read_b32 v190, a238
  v_accvgpr_read_b32 v191, a239
  v_mul_f32 v188, s37, v188
  v_mul_f32 v189, s37, v189
  v_mul_f32 v190, s37, v190
  v_mul_f32 v191, s37, v191
  v_cvt_pk_bf16_f32 v126, v188, v189
  v_cvt_pk_bf16_f32 v127, v190, v191
  v_permlane16_swap_b32 v112, v114
  v_permlane16_swap_b32 v113, v115
  v_permlane16_swap_b32 v116, v118
  v_permlane16_swap_b32 v117, v119
  v_permlane16_swap_b32 v120, v122
  v_permlane16_swap_b32 v121, v123
  v_permlane16_swap_b32 v124, v126
  v_permlane16_swap_b32 v125, v127
  v_mfma_f32_16x16x32_bf16 v[172:175], v[252:255], v[108:111], v[172:175]
  ds_read_b128 v[252:255], v1 offset:17632
  s_barrier
  s_waitcnt lgkmcnt(3)
  v_mfma_f32_16x16x32_bf16 v[144:147], v[240:243], v[112:115], v[144:147]
  s_mov_b32 s35, 131072
  v_accvgpr_read_b32 v192, a240
  v_accvgpr_read_b32 v193, a241
  v_mfma_f32_16x16x32_bf16 v[152:155], v[240:243], v[116:119], v[152:155]
  s_add_u32 m0, s33, 101376
  v_accvgpr_read_b32 v194, a242
  v_accvgpr_read_b32 v195, a243
  v_mfma_f32_16x16x32_bf16 v[160:163], v[240:243], v[120:123], v[160:163]
  buffer_load_dwordx4 v3, s[8:11], s35 offen offset:0 nt lds
  v_mul_f32 v192, s37, v192
  v_mfma_f32_16x16x32_bf16 v[168:171], v[240:243], v[124:127], v[168:171]
  s_add_u32 m0, s33, 101904
  v_add_u32 v1, 50688, v1
  ds_read_b128 v[240:243], v1 offset:16896
  s_waitcnt lgkmcnt(3)
  v_mfma_f32_16x16x32_bf16 v[148:151], v[244:247], v[112:115], v[148:151]
  v_mul_f32 v193, s37, v193
  v_mul_f32 v194, s37, v194
  v_mfma_f32_16x16x32_bf16 v[156:159], v[244:247], v[116:119], v[156:159]
  v_mul_f32 v195, s37, v195
  v_cvt_pk_bf16_f32 v130, v192, v193
  v_mfma_f32_16x16x32_bf16 v[164:167], v[244:247], v[120:123], v[164:167]
  v_cvt_pk_bf16_f32 v131, v194, v195
  v_accvgpr_read_b32 v196, a244
  v_accvgpr_read_b32 v197, a245
  v_accvgpr_read_b32 v198, a246
  v_accvgpr_read_b32 v199, a247
  v_mul_f32 v196, s37, v196
  v_mul_f32 v197, s37, v197
  v_mul_f32 v198, s37, v198
  v_mul_f32 v199, s37, v199
  v_cvt_pk_bf16_f32 v134, v196, v197
  v_cvt_pk_bf16_f32 v135, v198, v199
  v_accvgpr_read_b32 v200, a248
  v_accvgpr_read_b32 v201, a249
  v_accvgpr_read_b32 v202, a250
  v_accvgpr_read_b32 v203, a251
  v_mul_f32 v200, s37, v200
  v_mul_f32 v201, s37, v201
  v_mul_f32 v202, s37, v202
  v_mul_f32 v203, s37, v203
  v_cvt_pk_bf16_f32 v138, v200, v201
  v_cvt_pk_bf16_f32 v139, v202, v203
  v_accvgpr_read_b32 v204, a252
  v_accvgpr_read_b32 v205, a253
  v_accvgpr_read_b32 v206, a254
  v_accvgpr_read_b32 v207, a255
  v_mul_f32 v204, s37, v204
  v_mul_f32 v205, s37, v205
  v_mul_f32 v206, s37, v206
  v_mul_f32 v207, s37, v207
  v_cvt_pk_bf16_f32 v142, v204, v205
  v_cvt_pk_bf16_f32 v143, v206, v207
  v_permlane16_swap_b32 v128, v130
  v_permlane16_swap_b32 v129, v131
  v_permlane16_swap_b32 v132, v134
  v_permlane16_swap_b32 v133, v135
  v_permlane16_swap_b32 v136, v138
  v_permlane16_swap_b32 v137, v139
  v_permlane16_swap_b32 v140, v142
  v_permlane16_swap_b32 v141, v143
  v_mfma_f32_16x16x32_bf16 v[172:175], v[244:247], v[124:127], v[172:175]
  ds_read_b128 v[244:247], v1 offset:17408
  s_waitcnt lgkmcnt(3)
  v_mfma_f32_16x16x32_bf16 v[144:147], v[248:251], v[128:131], v[144:147]
  buffer_load_dwordx4 v3, s[8:11], s35 offen offset:512 nt lds
  v_mfma_f32_16x16x32_bf16 v[152:155], v[248:251], v[132:135], v[152:155]
  s_add_u32 m0, s33, 102432
  v_mfma_f32_16x16x32_bf16 v[160:163], v[248:251], v[136:139], v[160:163]
  v_mfma_f32_16x16x32_bf16 v[168:171], v[248:251], v[140:143], v[168:171]
  ds_read_b128 v[248:251], v1 offset:16928
  s_waitcnt lgkmcnt(3)
  v_mfma_f32_16x16x32_bf16 v[148:151], v[252:255], v[128:131], v[148:151]
  v_mfma_f32_16x16x32_bf16 v[156:159], v[252:255], v[132:135], v[156:159]
  buffer_load_dwordx4 v3, s[8:11], s35 offen offset:1024 nt lds
  v_mfma_f32_16x16x32_bf16 v[164:167], v[252:255], v[136:139], v[164:167]
  s_add_u32 m0, s33, 102960
  v_mfma_f32_16x16x32_bf16 v[172:175], v[252:255], v[140:143], v[172:175]
  ds_read_b128 v[252:255], v1 offset:17440
  s_waitcnt lgkmcnt(3)
  v_mfma_f32_16x16x32_bf16 v[176:179], v[240:243], v[16:19], 0
  ds_read_b128 v[232:235], v1 offset:16960
  v_mfma_f32_16x16x32_bf16 v[184:187], v[240:243], v[20:23], 0
  ds_read_b128 v[236:239], v1 offset:17472
  v_mfma_f32_16x16x32_bf16 v[192:195], v[240:243], v[24:27], 0
  buffer_load_dwordx4 v3, s[8:11], s35 offen offset:1536 nt lds
  v_mfma_f32_16x16x32_bf16 v[200:203], v[240:243], v[28:31], 0
  ds_read_b128 v[240:243], v1 offset:16992
  s_waitcnt lgkmcnt(5)
  v_mfma_f32_16x16x32_bf16 v[180:183], v[244:247], v[16:19], 0
  v_max3_f32 v6, v144, v145, v146
  v_max3_f32 v7, v152, v153, v154
  v_mfma_f32_16x16x32_bf16 v[188:191], v[244:247], v[20:23], 0
  v_max3_f32 v8, v160, v161, v162
  v_max3_f32 v9, v168, v169, v170
  v_mfma_f32_16x16x32_bf16 v[196:199], v[244:247], v[24:27], 0
  v_max3_f32 v6, v6, v147, v148
  v_max3_f32 v7, v7, v155, v156
  v_mfma_f32_16x16x32_bf16 v[204:207], v[244:247], v[28:31], 0
  ds_read_b128 v[244:247], v1 offset:17504
  s_waitcnt lgkmcnt(5)
  v_mfma_f32_16x16x32_bf16 v[176:179], v[248:251], v[32:35], v[176:179]
  v_max3_f32 v8, v8, v163, v164
  v_max3_f32 v9, v9, v171, v172
  v_mfma_f32_16x16x32_bf16 v[184:187], v[248:251], v[36:39], v[184:187]
  v_max3_f32 v6, v6, v149, v150
  v_max3_f32 v7, v7, v157, v158
  v_mfma_f32_16x16x32_bf16 v[192:195], v[248:251], v[40:43], v[192:195]
  v_max3_f32 v8, v8, v165, v166
  v_max3_f32 v9, v9, v173, v174
  v_mfma_f32_16x16x32_bf16 v[200:203], v[248:251], v[44:47], v[200:203]
  ds_read_b128 v[248:251], v1 offset:17024
  s_waitcnt lgkmcnt(5)
  v_mfma_f32_16x16x32_bf16 v[180:183], v[252:255], v[32:35], v[180:183]
  v_max_f32 v6, v6, v151
  v_max_f32 v7, v7, v159
  v_mfma_f32_16x16x32_bf16 v[188:191], v[252:255], v[36:39], v[188:191]
  v_max_f32 v8, v8, v167
  v_max_f32 v9, v9, v175
  v_mfma_f32_16x16x32_bf16 v[196:199], v[252:255], v[40:43], v[196:199]
  v_mov_b32 v228, v6
  v_mov_b32 v229, v7
  v_mfma_f32_16x16x32_bf16 v[204:207], v[252:255], v[44:47], v[204:207]
  ds_read_b128 v[252:255], v1 offset:17536
  s_waitcnt lgkmcnt(5)
  v_mfma_f32_16x16x32_bf16 v[176:179], v[232:235], v[48:51], v[176:179]
  v_mov_b32 v230, v8
  v_mov_b32 v231, v9
  v_mfma_f32_16x16x32_bf16 v[184:187], v[232:235], v[52:55], v[184:187]
  v_permlane16_swap_b32 v228, v6
  v_permlane16_swap_b32 v229, v7
  v_mfma_f32_16x16x32_bf16 v[192:195], v[232:235], v[56:59], v[192:195]
  v_permlane16_swap_b32 v230, v8
  v_permlane16_swap_b32 v231, v9
  v_mfma_f32_16x16x32_bf16 v[200:203], v[232:235], v[60:63], v[200:203]
  ds_read_b128 v[232:235], v1 offset:17056
  s_waitcnt lgkmcnt(5)
  v_mfma_f32_16x16x32_bf16 v[180:183], v[236:239], v[48:51], v[180:183]
  v_max_f32 v6, v6, v228
  v_max_f32 v7, v7, v229
  v_mfma_f32_16x16x32_bf16 v[188:191], v[236:239], v[52:55], v[188:191]
  v_max_f32 v8, v8, v230
  v_max_f32 v9, v9, v231
  v_mfma_f32_16x16x32_bf16 v[196:199], v[236:239], v[56:59], v[196:199]
  v_mov_b32 v228, v6
  v_mov_b32 v229, v7
  v_mfma_f32_16x16x32_bf16 v[204:207], v[236:239], v[60:63], v[204:207]
  ds_read_b128 v[236:239], v1 offset:17568
  s_waitcnt lgkmcnt(4)
  v_mfma_f32_16x16x32_bf16 v[176:179], v[240:243], v[64:67], v[176:179]
  v_mov_b32 v230, v8
  v_mov_b32 v231, v9
  v_mfma_f32_16x16x32_bf16 v[184:187], v[240:243], v[68:71], v[184:187]
  v_permlane32_swap_b32 v228, v6
  v_permlane32_swap_b32 v229, v7
  v_mfma_f32_16x16x32_bf16 v[192:195], v[240:243], v[72:75], v[192:195]
  v_permlane32_swap_b32 v230, v8
  v_permlane32_swap_b32 v231, v9
  v_mfma_f32_16x16x32_bf16 v[200:203], v[240:243], v[76:79], v[200:203]
  ds_read_b128 v[240:243], v1 offset:17088
  v_max_f32 v6, v6, v228
  v_mfma_f32_16x16x32_bf16 v[180:183], v[244:247], v[64:67], v[180:183]
  v_max_f32 v7, v7, v229
  v_max_f32 v8, v8, v230
  v_mfma_f32_16x16x32_bf16 v[188:191], v[244:247], v[68:71], v[188:191]
  v_max_f32 v9, v9, v231
  v_add_f32 v6, s61, v6
  v_mfma_f32_16x16x32_bf16 v[196:199], v[244:247], v[72:75], v[196:199]
  v_add_f32 v7, s61, v7
  v_add_f32 v8, s61, v8
  v_mfma_f32_16x16x32_bf16 v[204:207], v[244:247], v[76:79], v[204:207]
  ds_read_b128 v[244:247], v1 offset:17600
  s_waitcnt lgkmcnt(4)
  v_mfma_f32_16x16x32_bf16 v[176:179], v[248:251], v[80:83], v[176:179]
  v_add_f32 v9, s47, v9
  v_sub_f32 v208, 0, v6
  v_mfma_f32_16x16x32_bf16 v[184:187], v[248:251], v[84:87], v[184:187]
  v_sub_f32 v209, 0, v6
  v_sub_f32 v210, 0, v6
  v_mfma_f32_16x16x32_bf16 v[192:195], v[248:251], v[88:91], v[192:195]
  v_sub_f32 v211, 0, v6
  v_sub_f32 v212, 0, v7
  v_mfma_f32_16x16x32_bf16 v[200:203], v[248:251], v[92:95], v[200:203]
  ds_read_b128 v[248:251], v1 offset:17120
  v_sub_f32 v213, 0, v7
  v_mfma_f32_16x16x32_bf16 v[180:183], v[252:255], v[80:83], v[180:183]
  v_sub_f32 v214, 0, v7
  v_sub_f32 v215, 0, v7
  v_mfma_f32_16x16x32_bf16 v[188:191], v[252:255], v[84:87], v[188:191]
  v_sub_f32 v216, 0, v8
  v_sub_f32 v217, 0, v8
  v_mfma_f32_16x16x32_bf16 v[196:199], v[252:255], v[88:91], v[196:199]
  v_sub_f32 v218, 0, v8
  v_sub_f32 v219, 0, v8
  v_mfma_f32_16x16x32_bf16 v[204:207], v[252:255], v[92:95], v[204:207]
  ds_read_b128 v[252:255], v1 offset:17632
  s_barrier
  s_waitcnt lgkmcnt(4)
  v_mfma_f32_16x16x32_bf16 v[176:179], v[232:235], v[96:99], v[176:179]
  s_mov_b32 s35, 147456
  v_sub_f32 v220, 0, v9
  v_sub_f32 v221, 0, v9
  v_mfma_f32_16x16x32_bf16 v[184:187], v[232:235], v[100:103], v[184:187]
  s_add_u32 m0, s33, 67584
  v_sub_f32 v222, 0, v9
  v_sub_f32 v223, 0, v9
  v_mfma_f32_16x16x32_bf16 v[192:195], v[232:235], v[104:107], v[192:195]
  buffer_load_dwordx4 v3, s[8:11], s35 offen offset:0 nt lds
  v_mov_b32 v224, 0x3f803f80
  v_mfma_f32_16x16x32_bf16 v[200:203], v[232:235], v[108:111], v[200:203]
  s_add_u32 m0, s33, 68112
  v_subrev_u32 v1, 50688, v1
  ds_read_b128 v[232:235], v1 offset:0
  v_mfma_f32_16x16x32_bf16 v[180:183], v[236:239], v[96:99], v[180:183]
  v_mov_b32 v225, 0x3f803f80
  v_mov_b32 v226, 0x3f803f80
  v_mfma_f32_16x16x32_bf16 v[188:191], v[236:239], v[100:103], v[188:191]
  v_mov_b32 v227, 0x3f803f80
  v_add_f32 v144, v144, v208
  v_mfma_f32_16x16x32_bf16 v[196:199], v[236:239], v[104:107], v[196:199]
  v_exp_f32 v144, v144
  v_mfma_f32_16x16x32_bf16 v[204:207], v[236:239], v[108:111], v[204:207]
  ds_read_b128 v[236:239], v1 offset:512
  s_waitcnt lgkmcnt(4)
  v_mfma_f32_16x16x32_bf16 v[176:179], v[240:243], v[112:115], v[176:179]
  buffer_load_dwordx4 v3, s[8:11], s35 offen offset:512 nt lds
  v_add_f32 v145, v145, v208
  v_mfma_f32_16x16x32_bf16 v[184:187], v[240:243], v[116:119], v[184:187]
  s_add_u32 m0, s33, 68640
  v_exp_f32 v145, v145
  v_mfma_f32_16x16x32_bf16 v[192:195], v[240:243], v[120:123], v[192:195]
  v_add_f32 v146, v146, v208
  v_mfma_f32_16x16x32_bf16 v[200:203], v[240:243], v[124:127], v[200:203]
  ds_read_b128 v[240:243], v1 offset:32
  v_mfma_f32_16x16x32_bf16 v[180:183], v[244:247], v[112:115], v[180:183]
  v_exp_f32 v146, v146
  v_mfma_f32_16x16x32_bf16 v[188:191], v[244:247], v[116:119], v[188:191]
  buffer_load_dwordx4 v3, s[8:11], s35 offen offset:1024 nt lds
  v_add_f32 v147, v147, v208
  v_mfma_f32_16x16x32_bf16 v[196:199], v[244:247], v[120:123], v[196:199]
  s_add_u32 m0, s33, 69168
  v_exp_f32 v147, v147
  v_mfma_f32_16x16x32_bf16 v[204:207], v[244:247], v[124:127], v[204:207]
  ds_read_b128 v[244:247], v1 offset:544
  s_waitcnt lgkmcnt(4)
  v_mfma_f32_16x16x32_bf16 v[176:179], v[248:251], v[128:131], v[176:179]
  v_cvt_pk_bf16_f32 v144, v144, v145
  v_add_f32 v148, v148, v208
  v_mfma_f32_16x16x32_bf16 v[184:187], v[248:251], v[132:135], v[184:187]
  v_exp_f32 v148, v148
  v_mfma_f32_16x16x32_bf16 v[192:195], v[248:251], v[136:139], v[192:195]
  buffer_load_dwordx4 v3, s[8:11], s35 offen offset:1536 nt lds
  v_cvt_pk_bf16_f32 v145, v146, v147
  v_mfma_f32_16x16x32_bf16 v[200:203], v[248:251], v[140:143], v[200:203]
  ds_read_b128 v[248:251], v1 offset:64
  v_accvgpr_write_b32 a0, v144
  v_mfma_f32_16x16x32_bf16 v[180:183], v[252:255], v[128:131], v[180:183]
  v_add_f32 v149, v149, v208
  v_mfma_f32_16x16x32_bf16 v[188:191], v[252:255], v[132:135], v[188:191]
  v_exp_f32 v149, v149
  v_mfma_f32_16x16x32_bf16 v[196:199], v[252:255], v[136:139], v[196:199]
  v_accvgpr_write_b32 a1, v145
  v_add_f32 v150, v150, v208
  v_exp_f32 v150, v150
  v_cvt_pk_bf16_f32 v146, v148, v149
  v_add_f32 v151, v151, v208
  v_exp_f32 v151, v151
  v_accvgpr_write_b32 a2, v146
  v_cvt_pk_bf16_f32 v147, v150, v151
  v_accvgpr_write_b32 a3, v147
  v_add_f32 v152, v152, v212
  v_exp_f32 v152, v152
  v_add_f32 v153, v153, v212
  v_exp_f32 v153, v153
  v_add_f32 v154, v154, v212
  v_exp_f32 v154, v154
  v_add_f32 v155, v155, v212
  v_exp_f32 v155, v155
  v_cvt_pk_bf16_f32 v152, v152, v153
  v_add_f32 v156, v156, v212
  v_exp_f32 v156, v156
  v_cvt_pk_bf16_f32 v153, v154, v155
  v_accvgpr_write_b32 a4, v152
  v_add_f32 v157, v157, v212
  v_exp_f32 v157, v157
  v_accvgpr_write_b32 a5, v153
  v_add_f32 v158, v158, v212
  v_exp_f32 v158, v158
  v_cvt_pk_bf16_f32 v154, v156, v157
  v_add_f32 v159, v159, v212
  v_exp_f32 v159, v159
  v_accvgpr_write_b32 a6, v154
  v_cvt_pk_bf16_f32 v155, v158, v159
  v_accvgpr_write_b32 a7, v155
  v_add_f32 v160, v160, v216
  v_exp_f32 v160, v160
  v_add_f32 v161, v161, v216
  v_exp_f32 v161, v161
  v_add_f32 v162, v162, v216
  v_exp_f32 v162, v162
  v_add_f32 v163, v163, v216
  v_exp_f32 v163, v163
  v_cvt_pk_bf16_f32 v160, v160, v161
  v_add_f32 v164, v164, v216
  v_exp_f32 v164, v164
  v_cvt_pk_bf16_f32 v161, v162, v163
  v_accvgpr_write_b32 a8, v160
  v_add_f32 v165, v165, v216
  v_exp_f32 v165, v165
  v_accvgpr_write_b32 a9, v161
  v_add_f32 v166, v166, v216
  v_exp_f32 v166, v166
  v_cvt_pk_bf16_f32 v162, v164, v165
  v_add_f32 v167, v167, v216
  v_exp_f32 v167, v167
  v_accvgpr_write_b32 a10, v162
  v_cvt_pk_bf16_f32 v163, v166, v167
  v_accvgpr_write_b32 a11, v163
  v_add_f32 v168, v168, v220
  v_exp_f32 v168, v168
  v_add_f32 v169, v169, v220
  v_exp_f32 v169, v169
  v_add_f32 v170, v170, v220
  v_exp_f32 v170, v170
  v_add_f32 v171, v171, v220
  v_exp_f32 v171, v171
  v_cvt_pk_bf16_f32 v168, v168, v169
  v_add_f32 v172, v172, v220
  v_exp_f32 v172, v172
  v_cvt_pk_bf16_f32 v169, v170, v171
  v_accvgpr_write_b32 a12, v168
  v_add_f32 v173, v173, v220
  v_exp_f32 v173, v173
  v_accvgpr_write_b32 a13, v169
  v_add_f32 v174, v174, v220
  v_exp_f32 v174, v174
  v_cvt_pk_bf16_f32 v170, v172, v173
  v_add_f32 v175, v175, v220
  v_exp_f32 v175, v175
  v_accvgpr_write_b32 a14, v170
  v_cvt_pk_bf16_f32 v171, v174, v175
  v_accvgpr_write_b32 a15, v171
  v_mfma_f32_16x16x32_bf16 v[204:207], v[252:255], v[140:143], v[204:207]
  ds_read_b128 v[252:255], v1 offset:576
  s_waitcnt lgkmcnt(4)
  v_mfma_f32_16x16x32_bf16 v[144:147], v[232:235], v[16:19], v[208:211]
  v_mfma_f32_16x16x32_bf16 v[152:155], v[232:235], v[20:23], v[212:215]
  v_mfma_f32_16x16x32_bf16 v[160:163], v[232:235], v[24:27], v[216:219]
  v_mfma_f32_16x16x32_bf16 v[168:171], v[232:235], v[28:31], v[220:223]
  ds_read_b128 v[232:235], v1 offset:96
  v_add_f32 v176, v176, v208
  v_mfma_f32_16x16x32_bf16 v[148:151], v[236:239], v[16:19], v[208:211]
  v_exp_f32 v176, v176
  v_mfma_f32_16x16x32_bf16 v[156:159], v[236:239], v[20:23], v[212:215]
  v_add_f32 v177, v177, v208
  v_mfma_f32_16x16x32_bf16 v[164:167], v[236:239], v[24:27], v[216:219]
  v_exp_f32 v177, v177
  v_mfma_f32_16x16x32_bf16 v[172:175], v[236:239], v[28:31], v[220:223]
  ds_read_b128 v[236:239], v1 offset:608
  s_waitcnt lgkmcnt(4)
  v_mfma_f32_16x16x32_bf16 v[144:147], v[240:243], v[32:35], v[144:147]
  v_add_f32 v178, v178, v208
  v_mfma_f32_16x16x32_bf16 v[152:155], v[240:243], v[36:39], v[152:155]
  v_exp_f32 v178, v178
  v_mfma_f32_16x16x32_bf16 v[160:163], v[240:243], v[40:43], v[160:163]
  v_add_f32 v179, v179, v208
  v_mfma_f32_16x16x32_bf16 v[168:171], v[240:243], v[44:47], v[168:171]
  ds_read_b128 v[240:243], v1 offset:128
  v_mfma_f32_16x16x32_bf16 v[148:151], v[244:247], v[32:35], v[148:151]
  v_exp_f32 v179, v179
  v_mfma_f32_16x16x32_bf16 v[156:159], v[244:247], v[36:39], v[156:159]
  v_cvt_pk_bf16_f32 v176, v176, v177
  v_add_f32 v180, v180, v208
  v_mfma_f32_16x16x32_bf16 v[164:167], v[244:247], v[40:43], v[164:167]
  v_exp_f32 v180, v180
  v_mfma_f32_16x16x32_bf16 v[172:175], v[244:247], v[44:47], v[172:175]
  ds_read_b128 v[244:247], v1 offset:640
  s_waitcnt lgkmcnt(4)
  v_mfma_f32_16x16x32_bf16 v[144:147], v[248:251], v[48:51], v[144:147]
  v_cvt_pk_bf16_f32 v177, v178, v179
  v_accvgpr_write_b32 a16, v176
  v_mfma_f32_16x16x32_bf16 v[152:155], v[248:251], v[52:55], v[152:155]
  v_add_f32 v181, v181, v208
  v_mfma_f32_16x16x32_bf16 v[160:163], v[248:251], v[56:59], v[160:163]
  v_exp_f32 v181, v181
  v_mfma_f32_16x16x32_bf16 v[168:171], v[248:251], v[60:63], v[168:171]
  ds_read_b128 v[248:251], v1 offset:160
  v_accvgpr_write_b32 a17, v177
  v_mfma_f32_16x16x32_bf16 v[148:151], v[252:255], v[48:51], v[148:151]
  v_add_f32 v182, v182, v208
  v_mfma_f32_16x16x32_bf16 v[156:159], v[252:255], v[52:55], v[156:159]
  v_exp_f32 v182, v182
  v_mfma_f32_16x16x32_bf16 v[164:167], v[252:255], v[56:59], v[164:167]
  v_cvt_pk_bf16_f32 v178, v180, v181
  v_add_f32 v183, v183, v208
  v_mfma_f32_16x16x32_bf16 v[172:175], v[252:255], v[60:63], v[172:175]
  ds_read_b128 v[252:255], v1 offset:672
  s_waitcnt lgkmcnt(4)
  v_mfma_f32_16x16x32_bf16 v[144:147], v[232:235], v[64:67], v[144:147]
  v_exp_f32 v183, v183
  v_mfma_f32_16x16x32_bf16 v[152:155], v[232:235], v[68:71], v[152:155]
  v_accvgpr_write_b32 a18, v178
  v_cvt_pk_bf16_f32 v179, v182, v183
  v_mfma_f32_16x16x32_bf16 v[160:163], v[232:235], v[72:75], v[160:163]
  v_accvgpr_write_b32 a19, v179
  v_add_f32 v184, v184, v212
  v_mfma_f32_16x16x32_bf16 v[168:171], v[232:235], v[76:79], v[168:171]
  ds_read_b128 v[232:235], v1 offset:192
  v_mfma_f32_16x16x32_bf16 v[148:151], v[236:239], v[64:67], v[148:151]
  v_exp_f32 v184, v184
  v_mfma_f32_16x16x32_bf16 v[156:159], v[236:239], v[68:71], v[156:159]
  v_add_f32 v185, v185, v212
  v_mfma_f32_16x16x32_bf16 v[164:167], v[236:239], v[72:75], v[164:167]
  v_exp_f32 v185, v185
  v_mfma_f32_16x16x32_bf16 v[172:175], v[236:239], v[76:79], v[172:175]
  ds_read_b128 v[236:239], v1 offset:704
  v_add_f32 v186, v186, v212
  v_mfma_f32_16x16x32_bf16 a[240:243], v[224:227], a[0:3], 0
  v_exp_f32 v186, v186
  v_mfma_f32_16x16x32_bf16 a[244:247], v[224:227], a[4:7], 0
  v_add_f32 v187, v187, v212
  v_mfma_f32_16x16x32_bf16 a[248:251], v[224:227], a[8:11], 0
  v_exp_f32 v187, v187
  v_mfma_f32_16x16x32_bf16 a[252:255], v[224:227], a[12:15], 0
  v_cvt_pk_bf16_f32 v184, v184, v185
  s_waitcnt lgkmcnt(4)
  v_mfma_f32_16x16x32_bf16 v[144:147], v[240:243], v[80:83], v[144:147]
  v_add_f32 v188, v188, v212
  v_mfma_f32_16x16x32_bf16 v[152:155], v[240:243], v[84:87], v[152:155]
  v_exp_f32 v188, v188
  v_mfma_f32_16x16x32_bf16 v[160:163], v[240:243], v[88:91], v[160:163]
  v_cvt_pk_bf16_f32 v185, v186, v187
  v_accvgpr_write_b32 a20, v184
  v_mfma_f32_16x16x32_bf16 v[168:171], v[240:243], v[92:95], v[168:171]
  ds_read_b128 v[240:243], v1 offset:224
  v_add_f32 v189, v189, v212
  v_mfma_f32_16x16x32_bf16 v[148:151], v[244:247], v[80:83], v[148:151]
  v_exp_f32 v189, v189
  v_mfma_f32_16x16x32_bf16 v[156:159], v[244:247], v[84:87], v[156:159]
  v_accvgpr_write_b32 a21, v185
  v_add_f32 v190, v190, v212
  v_mfma_f32_16x16x32_bf16 v[164:167], v[244:247], v[88:91], v[164:167]
  v_exp_f32 v190, v190
  v_mfma_f32_16x16x32_bf16 v[172:175], v[244:247], v[92:95], v[172:175]
  ds_read_b128 v[244:247], v1 offset:736
  s_barrier
  s_waitcnt lgkmcnt(4)
  v_mfma_f32_16x16x32_bf16 v[144:147], v[248:251], v[96:99], v[144:147]
  s_mov_b32 s35, 163840
  v_cvt_pk_bf16_f32 v186, v188, v189
  v_add_f32 v191, v191, v212
  v_mfma_f32_16x16x32_bf16 v[152:155], v[248:251], v[100:103], v[152:155]
  s_add_u32 m0, s33, 118272
  v_exp_f32 v191, v191
  v_mfma_f32_16x16x32_bf16 v[160:163], v[248:251], v[104:107], v[160:163]
  buffer_load_dwordx4 v3, s[8:11], s35 offen offset:0 nt lds
  v_accvgpr_write_b32 a22, v186
  v_mfma_f32_16x16x32_bf16 v[168:171], v[248:251], v[108:111], v[168:171]
  s_add_u32 m0, s33, 118800
  ds_read_b128 v[248:251], v1 offset:33792
  v_cvt_pk_bf16_f32 v187, v190, v191
  v_mfma_f32_16x16x32_bf16 v[148:151], v[252:255], v[96:99], v[148:151]
  v_accvgpr_write_b32 a23, v187
  v_add_f32 v192, v192, v216
  v_mfma_f32_16x16x32_bf16 v[156:159], v[252:255], v[100:103], v[156:159]
  v_exp_f32 v192, v192
  v_mfma_f32_16x16x32_bf16 v[164:167], v[252:255], v[104:107], v[164:167]
  v_add_f32 v193, v193, v216
  v_mfma_f32_16x16x32_bf16 v[172:175], v[252:255], v[108:111], v[172:175]
  ds_read_b128 v[252:255], v1 offset:34304
  s_waitcnt lgkmcnt(4)
  v_mfma_f32_16x16x32_bf16 v[144:147], v[232:235], v[112:115], v[144:147]
  v_exp_f32 v193, v193
  v_mfma_f32_16x16x32_bf16 v[152:155], v[232:235], v[116:119], v[152:155]
  buffer_load_dwordx4 v3, s[8:11], s35 offen offset:512 nt lds
  v_add_f32 v194, v194, v216
  v_mfma_f32_16x16x32_bf16 v[160:163], v[232:235], v[120:123], v[160:163]
  s_add_u32 m0, s33, 119328
  v_exp_f32 v194, v194
  v_mfma_f32_16x16x32_bf16 v[168:171], v[232:235], v[124:127], v[168:171]
  ds_read_b128 v[232:235], v1 offset:33824
  v_add_f32 v195, v195, v216
  v_mfma_f32_16x16x32_bf16 v[148:151], v[236:239], v[112:115], v[148:151]
  v_exp_f32 v195, v195
  v_mfma_f32_16x16x32_bf16 v[156:159], v[236:239], v[116:119], v[156:159]
  v_cvt_pk_bf16_f32 v192, v192, v193
  v_add_f32 v196, v196, v216
  v_mfma_f32_16x16x32_bf16 v[164:167], v[236:239], v[120:123], v[164:167]
  v_exp_f32 v196, v196
  v_mfma_f32_16x16x32_bf16 v[172:175], v[236:239], v[124:127], v[172:175]
  ds_read_b128 v[236:239], v1 offset:34336
  s_waitcnt lgkmcnt(4)
  v_mfma_f32_16x16x32_bf16 v[144:147], v[240:243], v[128:131], v[144:147]
  buffer_load_dwordx4 v3, s[8:11], s35 offen offset:1024 nt lds
  v_cvt_pk_bf16_f32 v193, v194, v195
  v_mfma_f32_16x16x32_bf16 v[152:155], v[240:243], v[132:135], v[152:155]
  s_add_u32 m0, s33, 119856
  v_accvgpr_write_b32 a24, v192
  v_add_f32 v197, v197, v216
  v_mfma_f32_16x16x32_bf16 v[160:163], v[240:243], v[136:139], v[160:163]
  v_exp_f32 v197, v197
  v_mfma_f32_16x16x32_bf16 v[168:171], v[240:243], v[140:143], v[168:171]
  ds_read_b128 v[240:243], v1 offset:33856
  v_accvgpr_write_b32 a25, v193
  v_mfma_f32_16x16x32_bf16 v[148:151], v[244:247], v[128:131], v[148:151]
  v_add_f32 v198, v198, v216
  v_mfma_f32_16x16x32_bf16 v[156:159], v[244:247], v[132:135], v[156:159]
  v_exp_f32 v198, v198
  v_mfma_f32_16x16x32_bf16 v[164:167], v[244:247], v[136:139], v[164:167]
  buffer_load_dwordx4 v3, s[8:11], s35 offen offset:1536 nt lds
  v_cvt_pk_bf16_f32 v194, v196, v197
  v_add_f32 v199, v199, v216
  v_exp_f32 v199, v199
  v_accvgpr_write_b32 a26, v194
  v_cvt_pk_bf16_f32 v195, v198, v199
  v_accvgpr_write_b32 a27, v195
  v_add_f32 v200, v200, v220
  v_exp_f32 v200, v200
  v_add_f32 v201, v201, v220
  v_exp_f32 v201, v201
  v_add_f32 v202, v202, v220
  v_exp_f32 v202, v202
  v_add_f32 v203, v203, v220
  v_exp_f32 v203, v203
  v_cvt_pk_bf16_f32 v200, v200, v201
  v_add_f32 v204, v204, v220
  v_exp_f32 v204, v204
  v_cvt_pk_bf16_f32 v201, v202, v203
  v_accvgpr_write_b32 a28, v200
  v_add_f32 v205, v205, v220
  v_exp_f32 v205, v205
  v_accvgpr_write_b32 a29, v201
  v_add_f32 v206, v206, v220
  v_exp_f32 v206, v206
  v_cvt_pk_bf16_f32 v202, v204, v205
  v_add_f32 v207, v207, v220
  v_exp_f32 v207, v207
  v_accvgpr_write_b32 a30, v202
  v_cvt_pk_bf16_f32 v203, v206, v207
  v_accvgpr_write_b32 a31, v203
  v_mfma_f32_16x16x32_bf16 v[172:175], v[244:247], v[140:143], v[172:175]
  ds_read_b128 v[244:247], v1 offset:34368
  s_waitcnt lgkmcnt(4)
  v_mfma_f32_16x16x32_bf16 v[176:179], v[248:251], v[16:19], v[208:211]
  v_mfma_f32_16x16x32_bf16 v[184:187], v[248:251], v[20:23], v[212:215]
  v_mfma_f32_16x16x32_bf16 v[192:195], v[248:251], v[24:27], v[216:219]
  v_mfma_f32_16x16x32_bf16 v[200:203], v[248:251], v[28:31], v[220:223]
  ds_read_b128 v[248:251], v1 offset:33888
  v_mfma_f32_16x16x32_bf16 v[180:183], v[252:255], v[16:19], v[208:211]
  v_exp_f32 v144, v144
  v_mfma_f32_16x16x32_bf16 v[188:191], v[252:255], v[20:23], v[212:215]
  v_exp_f32 v145, v145
  v_mfma_f32_16x16x32_bf16 v[196:199], v[252:255], v[24:27], v[216:219]
  v_exp_f32 v146, v146
  v_mfma_f32_16x16x32_bf16 v[204:207], v[252:255], v[28:31], v[220:223]
  ds_read_b128 v[252:255], v1 offset:34400
  s_waitcnt lgkmcnt(4)
  v_mfma_f32_16x16x32_bf16 v[176:179], v[232:235], v[32:35], v[176:179]
  v_exp_f32 v147, v147
  v_mfma_f32_16x16x32_bf16 v[184:187], v[232:235], v[36:39], v[184:187]
  v_exp_f32 v148, v148
  v_mfma_f32_16x16x32_bf16 v[192:195], v[232:235], v[40:43], v[192:195]
  v_exp_f32 v149, v149
  v_mfma_f32_16x16x32_bf16 v[200:203], v[232:235], v[44:47], v[200:203]
  ds_read_b128 v[232:235], v1 offset:33920
  v_mfma_f32_16x16x32_bf16 v[180:183], v[236:239], v[32:35], v[180:183]
  v_cvt_pk_bf16_f32 v144, v144, v145
  v_cvt_pk_bf16_f32 v145, v146, v147
  v_mfma_f32_16x16x32_bf16 v[188:191], v[236:239], v[36:39], v[188:191]
  v_exp_f32 v150, v150
  v_mfma_f32_16x16x32_bf16 v[196:199], v[236:239], v[40:43], v[196:199]
  v_accvgpr_write_b32 a32, v144
  v_accvgpr_write_b32 a33, v145
  v_mfma_f32_16x16x32_bf16 v[204:207], v[236:239], v[44:47], v[204:207]
  ds_read_b128 v[236:239], v1 offset:34432
  s_waitcnt lgkmcnt(4)
  v_mfma_f32_16x16x32_bf16 v[176:179], v[240:243], v[48:51], v[176:179]
  v_exp_f32 v151, v151
  v_mfma_f32_16x16x32_bf16 v[184:187], v[240:243], v[52:55], v[184:187]
  v_exp_f32 v152, v152
  v_mfma_f32_16x16x32_bf16 v[192:195], v[240:243], v[56:59], v[192:195]
  v_cvt_pk_bf16_f32 v146, v148, v149
  v_accvgpr_write_b32 a34, v146
  v_mfma_f32_16x16x32_bf16 v[200:203], v[240:243], v[60:63], v[200:203]
  ds_read_b128 v[240:243], v1 offset:33952
  v_mfma_f32_16x16x32_bf16 v[180:183], v[244:247], v[48:51], v[180:183]
  v_exp_f32 v153, v153
  v_mfma_f32_16x16x32_bf16 v[188:191], v[244:247], v[52:55], v[188:191]
  v_cvt_pk_bf16_f32 v147, v150, v151
  v_accvgpr_write_b32 a35, v147
  v_mfma_f32_16x16x32_bf16 v[196:199], v[244:247], v[56:59], v[196:199]
  v_exp_f32 v154, v154
  v_mfma_f32_16x16x32_bf16 v[204:207], v[244:247], v[60:63], v[204:207]
  ds_read_b128 v[244:247], v1 offset:34464
  s_waitcnt lgkmcnt(4)
  v_mfma_f32_16x16x32_bf16 v[176:179], v[248:251], v[64:67], v[176:179]
  v_exp_f32 v155, v155
  v_mfma_f32_16x16x32_bf16 v[184:187], v[248:251], v[68:71], v[184:187]
  v_exp_f32 v156, v156
  v_mfma_f32_16x16x32_bf16 v[192:195], v[248:251], v[72:75], v[192:195]
  v_exp_f32 v157, v157
  v_mfma_f32_16x16x32_bf16 v[200:203], v[248:251], v[76:79], v[200:203]
  ds_read_b128 v[248:251], v1 offset:33984
  v_mfma_f32_16x16x32_bf16 v[180:183], v[252:255], v[64:67], v[180:183]
  v_cvt_pk_bf16_f32 v152, v152, v153
  v_cvt_pk_bf16_f32 v153, v154, v155
  v_mfma_f32_16x16x32_bf16 v[188:191], v[252:255], v[68:71], v[188:191]
  v_exp_f32 v158, v158
  v_mfma_f32_16x16x32_bf16 v[196:199], v[252:255], v[72:75], v[196:199]
  v_accvgpr_write_b32 a36, v152
  v_accvgpr_write_b32 a37, v153
  v_mfma_f32_16x16x32_bf16 v[204:207], v[252:255], v[76:79], v[204:207]
  ds_read_b128 v[252:255], v1 offset:34496
  v_mfma_f32_16x16x32_bf16 a[240:243], v[224:227], a[16:19], a[240:243]
  v_exp_f32 v159, v159
  v_mfma_f32_16x16x32_bf16 a[244:247], v[224:227], a[20:23], a[244:247]
  v_exp_f32 v160, v160
  v_mfma_f32_16x16x32_bf16 a[248:251], v[224:227], a[24:27], a[248:251]
  v_cvt_pk_bf16_f32 v154, v156, v157
  v_accvgpr_write_b32 a38, v154
  v_mfma_f32_16x16x32_bf16 a[252:255], v[224:227], a[28:31], a[252:255]
  s_waitcnt lgkmcnt(4)
  v_mfma_f32_16x16x32_bf16 v[176:179], v[232:235], v[80:83], v[176:179]
  v_exp_f32 v161, v161
  v_mfma_f32_16x16x32_bf16 v[184:187], v[232:235], v[84:87], v[184:187]
  v_cvt_pk_bf16_f32 v155, v158, v159
  v_accvgpr_write_b32 a39, v155
  v_mfma_f32_16x16x32_bf16 v[192:195], v[232:235], v[88:91], v[192:195]
  v_exp_f32 v162, v162
  v_mfma_f32_16x16x32_bf16 v[200:203], v[232:235], v[92:95], v[200:203]
  ds_read_b128 v[232:235], v1 offset:34016
  v_mfma_f32_16x16x32_bf16 v[180:183], v[236:239], v[80:83], v[180:183]
  v_exp_f32 v163, v163
  v_mfma_f32_16x16x32_bf16 v[188:191], v[236:239], v[84:87], v[188:191]
  v_exp_f32 v164, v164
  v_mfma_f32_16x16x32_bf16 v[196:199], v[236:239], v[88:91], v[196:199]
  v_exp_f32 v165, v165
  v_mfma_f32_16x16x32_bf16 v[204:207], v[236:239], v[92:95], v[204:207]
  ds_read_b128 v[236:239], v1 offset:34528
  s_waitcnt vmcnt(24)
  s_barrier
  s_waitcnt lgkmcnt(4)
  v_mfma_f32_16x16x32_bf16 v[176:179], v[240:243], v[96:99], v[176:179]
  s_mov_b32 s35, 180224
  v_cvt_pk_bf16_f32 v160, v160, v161
  v_cvt_pk_bf16_f32 v161, v162, v163
  v_mfma_f32_16x16x32_bf16 v[184:187], v[240:243], v[100:103], v[184:187]
  s_add_u32 m0, s33, 50688
  v_exp_f32 v166, v166
  v_mfma_f32_16x16x32_bf16 v[192:195], v[240:243], v[104:107], v[192:195]
  buffer_load_dwordx4 v3, s[8:11], s35 offen offset:0 nt lds
  v_mfma_f32_16x16x32_bf16 v[200:203], v[240:243], v[108:111], v[200:203]
  s_add_u32 m0, s33, 51216
  v_subrev_u32 v1, 50688, v1
  ds_read_b128 v[240:243], v1 offset:16896
  v_mfma_f32_16x16x32_bf16 v[180:183], v[244:247], v[96:99], v[180:183]
  v_accvgpr_write_b32 a40, v160
  v_accvgpr_write_b32 a41, v161
  v_mfma_f32_16x16x32_bf16 v[188:191], v[244:247], v[100:103], v[188:191]
  v_exp_f32 v167, v167
  v_mfma_f32_16x16x32_bf16 v[196:199], v[244:247], v[104:107], v[196:199]
  v_exp_f32 v168, v168
  v_mfma_f32_16x16x32_bf16 v[204:207], v[244:247], v[108:111], v[204:207]
  ds_read_b128 v[244:247], v1 offset:17408
  s_waitcnt lgkmcnt(4)
  v_mfma_f32_16x16x32_bf16 v[176:179], v[248:251], v[112:115], v[176:179]
  v_cvt_pk_bf16_f32 v162, v164, v165
  v_accvgpr_write_b32 a42, v162
  v_mfma_f32_16x16x32_bf16 v[184:187], v[248:251], v[116:119], v[184:187]
  v_exp_f32 v169, v169
  v_mfma_f32_16x16x32_bf16 v[192:195], v[248:251], v[120:123], v[192:195]
  v_cvt_pk_bf16_f32 v163, v166, v167
  v_accvgpr_write_b32 a43, v163
  v_mfma_f32_16x16x32_bf16 v[200:203], v[248:251], v[124:127], v[200:203]
  ds_read_b128 v[248:251], v1 offset:16928
  buffer_load_dwordx4 v3, s[8:11], s35 offen offset:512 nt lds
  v_mfma_f32_16x16x32_bf16 v[180:183], v[252:255], v[112:115], v[180:183]
  s_add_u32 m0, s33, 51744
  v_exp_f32 v170, v170
  v_mfma_f32_16x16x32_bf16 v[188:191], v[252:255], v[116:119], v[188:191]
  v_exp_f32 v171, v171
  v_mfma_f32_16x16x32_bf16 v[196:199], v[252:255], v[120:123], v[196:199]
  v_exp_f32 v172, v172
  v_mfma_f32_16x16x32_bf16 v[204:207], v[252:255], v[124:127], v[204:207]
  ds_read_b128 v[252:255], v1 offset:17440
  s_waitcnt lgkmcnt(4)
  v_mfma_f32_16x16x32_bf16 v[176:179], v[232:235], v[128:131], v[176:179]
  v_exp_f32 v173, v173
  v_mfma_f32_16x16x32_bf16 v[184:187], v[232:235], v[132:135], v[184:187]
  v_cvt_pk_bf16_f32 v168, v168, v169
  v_cvt_pk_bf16_f32 v169, v170, v171
  v_mfma_f32_16x16x32_bf16 v[192:195], v[232:235], v[136:139], v[192:195]
  v_exp_f32 v174, v174
  v_mfma_f32_16x16x32_bf16 v[200:203], v[232:235], v[140:143], v[200:203]
  ds_read_b128 v[232:235], v1 offset:16960
  buffer_load_dwordx4 v3, s[8:11], s35 offen offset:1024 nt lds
  v_mfma_f32_16x16x32_bf16 v[180:183], v[236:239], v[128:131], v[180:183]
  s_add_u32 m0, s33, 52272
  v_accvgpr_write_b32 a44, v168
  v_accvgpr_write_b32 a45, v169
  v_mfma_f32_16x16x32_bf16 v[188:191], v[236:239], v[132:135], v[188:191]
  v_exp_f32 v175, v175
  v_mfma_f32_16x16x32_bf16 v[196:199], v[236:239], v[136:139], v[196:199]
  v_cvt_pk_bf16_f32 v170, v172, v173
  v_accvgpr_write_b32 a46, v170
  v_cvt_pk_bf16_f32 v171, v174, v175
  v_accvgpr_write_b32 a47, v171
  v_mfma_f32_16x16x32_bf16 v[204:207], v[236:239], v[140:143], v[204:207]
  ds_read_b128 v[236:239], v1 offset:17472
  s_waitcnt lgkmcnt(4)
  v_mfma_f32_16x16x32_bf16 v[144:147], v[240:243], v[16:19], v[208:211]
  buffer_load_dwordx4 v3, s[8:11], s35 offen offset:1536 nt lds
  v_mfma_f32_16x16x32_bf16 v[152:155], v[240:243], v[20:23], v[212:215]
  v_mfma_f32_16x16x32_bf16 v[160:163], v[240:243], v[24:27], v[216:219]
  v_mfma_f32_16x16x32_bf16 v[168:171], v[240:243], v[28:31], v[220:223]
  ds_read_b128 v[240:243], v1 offset:16992
  v_mfma_f32_16x16x32_bf16 v[148:151], v[244:247], v[16:19], v[208:211]
  v_exp_f32 v176, v176
  v_mfma_f32_16x16x32_bf16 v[156:159], v[244:247], v[20:23], v[212:215]
  v_exp_f32 v177, v177
  v_mfma_f32_16x16x32_bf16 v[164:167], v[244:247], v[24:27], v[216:219]
  v_exp_f32 v178, v178
  v_mfma_f32_16x16x32_bf16 v[172:175], v[244:247], v[28:31], v[220:223]
  ds_read_b128 v[244:247], v1 offset:17504
  s_waitcnt lgkmcnt(4)
  v_mfma_f32_16x16x32_bf16 v[144:147], v[248:251], v[32:35], v[144:147]
  v_exp_f32 v179, v179
  v_mfma_f32_16x16x32_bf16 v[152:155], v[248:251], v[36:39], v[152:155]
  v_exp_f32 v180, v180
  v_mfma_f32_16x16x32_bf16 v[160:163], v[248:251], v[40:43], v[160:163]
  v_exp_f32 v181, v181
  v_mfma_f32_16x16x32_bf16 v[168:171], v[248:251], v[44:47], v[168:171]
  ds_read_b128 v[248:251], v1 offset:17024
  v_mfma_f32_16x16x32_bf16 v[148:151], v[252:255], v[32:35], v[148:151]
  v_cvt_pk_bf16_f32 v176, v176, v177
  v_cvt_pk_bf16_f32 v177, v178, v179
  v_mfma_f32_16x16x32_bf16 v[156:159], v[252:255], v[36:39], v[156:159]
  v_exp_f32 v182, v182
  v_mfma_f32_16x16x32_bf16 v[164:167], v[252:255], v[40:43], v[164:167]
  v_accvgpr_write_b32 a48, v176
  v_accvgpr_write_b32 a49, v177
  v_mfma_f32_16x16x32_bf16 v[172:175], v[252:255], v[44:47], v[172:175]
  ds_read_b128 v[252:255], v1 offset:17536
  s_waitcnt lgkmcnt(4)
  v_mfma_f32_16x16x32_bf16 v[144:147], v[232:235], v[48:51], v[144:147]
  v_exp_f32 v183, v183
  v_mfma_f32_16x16x32_bf16 v[152:155], v[232:235], v[52:55], v[152:155]
  v_exp_f32 v184, v184
  v_mfma_f32_16x16x32_bf16 v[160:163], v[232:235], v[56:59], v[160:163]
  v_cvt_pk_bf16_f32 v178, v180, v181
  v_accvgpr_write_b32 a50, v178
  v_mfma_f32_16x16x32_bf16 v[168:171], v[232:235], v[60:63], v[168:171]
  ds_read_b128 v[232:235], v1 offset:17056
  v_mfma_f32_16x16x32_bf16 v[148:151], v[236:239], v[48:51], v[148:151]
  v_exp_f32 v185, v185
  v_mfma_f32_16x16x32_bf16 v[156:159], v[236:239], v[52:55], v[156:159]
  v_cvt_pk_bf16_f32 v179, v182, v183
  v_accvgpr_write_b32 a51, v179
  v_mfma_f32_16x16x32_bf16 v[164:167], v[236:239], v[56:59], v[164:167]
  v_exp_f32 v186, v186
  v_mfma_f32_16x16x32_bf16 v[172:175], v[236:239], v[60:63], v[172:175]
  ds_read_b128 v[236:239], v1 offset:17568
  s_waitcnt lgkmcnt(4)
  v_mfma_f32_16x16x32_bf16 v[144:147], v[240:243], v[64:67], v[144:147]
  v_exp_f32 v187, v187
  v_mfma_f32_16x16x32_bf16 v[152:155], v[240:243], v[68:71], v[152:155]
  v_exp_f32 v188, v188
  v_mfma_f32_16x16x32_bf16 v[160:163], v[240:243], v[72:75], v[160:163]
  v_exp_f32 v189, v189
  v_mfma_f32_16x16x32_bf16 v[168:171], v[240:243], v[76:79], v[168:171]
  ds_read_b128 v[240:243], v1 offset:17088
  v_mfma_f32_16x16x32_bf16 v[148:151], v[244:247], v[64:67], v[148:151]
  v_cvt_pk_bf16_f32 v184, v184, v185
  v_cvt_pk_bf16_f32 v185, v186, v187
  v_mfma_f32_16x16x32_bf16 v[156:159], v[244:247], v[68:71], v[156:159]
  v_exp_f32 v190, v190
  v_mfma_f32_16x16x32_bf16 v[164:167], v[244:247], v[72:75], v[164:167]
  v_accvgpr_write_b32 a52, v184
  v_accvgpr_write_b32 a53, v185
  v_mfma_f32_16x16x32_bf16 v[172:175], v[244:247], v[76:79], v[172:175]
  ds_read_b128 v[244:247], v1 offset:17600
  v_mfma_f32_16x16x32_bf16 a[240:243], v[224:227], a[32:35], a[240:243]
  v_exp_f32 v191, v191
  v_mfma_f32_16x16x32_bf16 a[244:247], v[224:227], a[36:39], a[244:247]
  v_exp_f32 v192, v192
  v_mfma_f32_16x16x32_bf16 a[248:251], v[224:227], a[40:43], a[248:251]
  v_cvt_pk_bf16_f32 v186, v188, v189
  v_accvgpr_write_b32 a54, v186
  v_mfma_f32_16x16x32_bf16 a[252:255], v[224:227], a[44:47], a[252:255]
  s_waitcnt lgkmcnt(4)
  v_mfma_f32_16x16x32_bf16 v[144:147], v[248:251], v[80:83], v[144:147]
  v_exp_f32 v193, v193
  v_mfma_f32_16x16x32_bf16 v[152:155], v[248:251], v[84:87], v[152:155]
  v_cvt_pk_bf16_f32 v187, v190, v191
  v_accvgpr_write_b32 a55, v187
  v_mfma_f32_16x16x32_bf16 v[160:163], v[248:251], v[88:91], v[160:163]
  v_exp_f32 v194, v194
  v_mfma_f32_16x16x32_bf16 v[168:171], v[248:251], v[92:95], v[168:171]
  ds_read_b128 v[248:251], v1 offset:17120
  v_mfma_f32_16x16x32_bf16 v[148:151], v[252:255], v[80:83], v[148:151]
  v_exp_f32 v195, v195
  v_mfma_f32_16x16x32_bf16 v[156:159], v[252:255], v[84:87], v[156:159]
  v_exp_f32 v196, v196
  v_mfma_f32_16x16x32_bf16 v[164:167], v[252:255], v[88:91], v[164:167]
  v_exp_f32 v197, v197
  v_mfma_f32_16x16x32_bf16 v[172:175], v[252:255], v[92:95], v[172:175]
  ds_read_b128 v[252:255], v1 offset:17632
  s_waitcnt vmcnt(24)
  s_barrier
  s_waitcnt lgkmcnt(4)
  v_mfma_f32_16x16x32_bf16 v[144:147], v[232:235], v[96:99], v[144:147]
  s_mov_b32 s35, 196608
  v_cvt_pk_bf16_f32 v192, v192, v193
  v_cvt_pk_bf16_f32 v193, v194, v195
  v_mfma_f32_16x16x32_bf16 v[152:155], v[232:235], v[100:103], v[152:155]
  s_add_u32 m0, s33, 84480
  v_exp_f32 v198, v198
  v_mfma_f32_16x16x32_bf16 v[160:163], v[232:235], v[104:107], v[160:163]
  buffer_load_dwordx4 v3, s[8:11], s35 offen offset:0 nt lds
  v_mfma_f32_16x16x32_bf16 v[168:171], v[232:235], v[108:111], v[168:171]
  s_add_u32 m0, s33, 85008
  ds_read_b128 v[232:235], v1 offset:33792
  v_mfma_f32_16x16x32_bf16 v[148:151], v[236:239], v[96:99], v[148:151]
  v_accvgpr_write_b32 a56, v192
  v_accvgpr_write_b32 a57, v193
  v_mfma_f32_16x16x32_bf16 v[156:159], v[236:239], v[100:103], v[156:159]
  v_exp_f32 v199, v199
  v_mfma_f32_16x16x32_bf16 v[164:167], v[236:239], v[104:107], v[164:167]
  v_exp_f32 v200, v200
  v_mfma_f32_16x16x32_bf16 v[172:175], v[236:239], v[108:111], v[172:175]
  ds_read_b128 v[236:239], v1 offset:34304
  s_waitcnt lgkmcnt(4)
  v_mfma_f32_16x16x32_bf16 v[144:147], v[240:243], v[112:115], v[144:147]
  v_cvt_pk_bf16_f32 v194, v196, v197
  v_accvgpr_write_b32 a58, v194
  v_mfma_f32_16x16x32_bf16 v[152:155], v[240:243], v[116:119], v[152:155]
  v_exp_f32 v201, v201
  v_mfma_f32_16x16x32_bf16 v[160:163], v[240:243], v[120:123], v[160:163]
  v_cvt_pk_bf16_f32 v195, v198, v199
  v_accvgpr_write_b32 a59, v195
  v_mfma_f32_16x16x32_bf16 v[168:171], v[240:243], v[124:127], v[168:171]
  ds_read_b128 v[240:243], v1 offset:33824
  buffer_load_dwordx4 v3, s[8:11], s35 offen offset:512 nt lds
  v_mfma_f32_16x16x32_bf16 v[148:151], v[244:247], v[112:115], v[148:151]
  s_add_u32 m0, s33, 85536
  v_exp_f32 v202, v202
  v_mfma_f32_16x16x32_bf16 v[156:159], v[244:247], v[116:119], v[156:159]
  v_exp_f32 v203, v203
  v_mfma_f32_16x16x32_bf16 v[164:167], v[244:247], v[120:123], v[164:167]
  v_exp_f32 v204, v204
  v_mfma_f32_16x16x32_bf16 v[172:175], v[244:247], v[124:127], v[172:175]
  ds_read_b128 v[244:247], v1 offset:34336
  s_waitcnt lgkmcnt(4)
  v_mfma_f32_16x16x32_bf16 v[144:147], v[248:251], v[128:131], v[144:147]
  v_exp_f32 v205, v205
  v_mfma_f32_16x16x32_bf16 v[152:155], v[248:251], v[132:135], v[152:155]
  v_cvt_pk_bf16_f32 v200, v200, v201
  v_cvt_pk_bf16_f32 v201, v202, v203
  v_mfma_f32_16x16x32_bf16 v[160:163], v[248:251], v[136:139], v[160:163]
  v_exp_f32 v206, v206
  v_mfma_f32_16x16x32_bf16 v[168:171], v[248:251], v[140:143], v[168:171]
  ds_read_b128 v[248:251], v1 offset:33856
  buffer_load_dwordx4 v3, s[8:11], s35 offen offset:1024 nt lds
  v_mfma_f32_16x16x32_bf16 v[148:151], v[252:255], v[128:131], v[148:151]
  s_add_u32 m0, s33, 86064
  v_accvgpr_write_b32 a60, v200
  v_accvgpr_write_b32 a61, v201
  v_mfma_f32_16x16x32_bf16 v[156:159], v[252:255], v[132:135], v[156:159]
  v_exp_f32 v207, v207
  v_mfma_f32_16x16x32_bf16 v[164:167], v[252:255], v[136:139], v[164:167]
  v_cvt_pk_bf16_f32 v202, v204, v205
  v_accvgpr_write_b32 a62, v202
  v_cvt_pk_bf16_f32 v203, v206, v207
  v_accvgpr_write_b32 a63, v203
  v_mfma_f32_16x16x32_bf16 v[172:175], v[252:255], v[140:143], v[172:175]
  ds_read_b128 v[252:255], v1 offset:34368
  s_waitcnt lgkmcnt(4)
  v_mfma_f32_16x16x32_bf16 v[176:179], v[232:235], v[16:19], v[208:211]
  buffer_load_dwordx4 v3, s[8:11], s35 offen offset:1536 nt lds
  v_mfma_f32_16x16x32_bf16 v[184:187], v[232:235], v[20:23], v[212:215]
  v_mfma_f32_16x16x32_bf16 v[192:195], v[232:235], v[24:27], v[216:219]
  v_mfma_f32_16x16x32_bf16 v[200:203], v[232:235], v[28:31], v[220:223]
  ds_read_b128 v[232:235], v1 offset:33888
  v_mfma_f32_16x16x32_bf16 v[180:183], v[236:239], v[16:19], v[208:211]
  v_exp_f32 v144, v144
  v_mfma_f32_16x16x32_bf16 v[188:191], v[236:239], v[20:23], v[212:215]
  v_exp_f32 v145, v145
  v_mfma_f32_16x16x32_bf16 v[196:199], v[236:239], v[24:27], v[216:219]
  v_exp_f32 v146, v146
  v_mfma_f32_16x16x32_bf16 v[204:207], v[236:239], v[28:31], v[220:223]
  ds_read_b128 v[236:239], v1 offset:34400
  s_waitcnt lgkmcnt(4)
  v_mfma_f32_16x16x32_bf16 v[176:179], v[240:243], v[32:35], v[176:179]
  v_exp_f32 v147, v147
  v_mfma_f32_16x16x32_bf16 v[184:187], v[240:243], v[36:39], v[184:187]
  v_exp_f32 v148, v148
  v_mfma_f32_16x16x32_bf16 v[192:195], v[240:243], v[40:43], v[192:195]
  v_exp_f32 v149, v149
  v_mfma_f32_16x16x32_bf16 v[200:203], v[240:243], v[44:47], v[200:203]
  ds_read_b128 v[240:243], v1 offset:33920
  v_mfma_f32_16x16x32_bf16 v[180:183], v[244:247], v[32:35], v[180:183]
  v_cvt_pk_bf16_f32 v144, v144, v145
  v_cvt_pk_bf16_f32 v145, v146, v147
  v_mfma_f32_16x16x32_bf16 v[188:191], v[244:247], v[36:39], v[188:191]
  v_exp_f32 v150, v150
  v_mfma_f32_16x16x32_bf16 v[196:199], v[244:247], v[40:43], v[196:199]
  v_accvgpr_write_b32 a64, v144
  v_accvgpr_write_b32 a65, v145
  v_mfma_f32_16x16x32_bf16 v[204:207], v[244:247], v[44:47], v[204:207]
  ds_read_b128 v[244:247], v1 offset:34432
  s_waitcnt lgkmcnt(4)
  v_mfma_f32_16x16x32_bf16 v[176:179], v[248:251], v[48:51], v[176:179]
  v_exp_f32 v151, v151
  v_mfma_f32_16x16x32_bf16 v[184:187], v[248:251], v[52:55], v[184:187]
  v_exp_f32 v152, v152
  v_mfma_f32_16x16x32_bf16 v[192:195], v[248:251], v[56:59], v[192:195]
  v_cvt_pk_bf16_f32 v146, v148, v149
  v_accvgpr_write_b32 a66, v146
  v_mfma_f32_16x16x32_bf16 v[200:203], v[248:251], v[60:63], v[200:203]
  ds_read_b128 v[248:251], v1 offset:33952
  v_mfma_f32_16x16x32_bf16 v[180:183], v[252:255], v[48:51], v[180:183]
  v_exp_f32 v153, v153
  v_mfma_f32_16x16x32_bf16 v[188:191], v[252:255], v[52:55], v[188:191]
  v_cvt_pk_bf16_f32 v147, v150, v151
  v_accvgpr_write_b32 a67, v147
  v_mfma_f32_16x16x32_bf16 v[196:199], v[252:255], v[56:59], v[196:199]
  v_exp_f32 v154, v154
  v_mfma_f32_16x16x32_bf16 v[204:207], v[252:255], v[60:63], v[204:207]
  ds_read_b128 v[252:255], v1 offset:34464
  s_waitcnt lgkmcnt(4)
  v_mfma_f32_16x16x32_bf16 v[176:179], v[232:235], v[64:67], v[176:179]
  v_exp_f32 v155, v155
  v_mfma_f32_16x16x32_bf16 v[184:187], v[232:235], v[68:71], v[184:187]
  v_exp_f32 v156, v156
  v_mfma_f32_16x16x32_bf16 v[192:195], v[232:235], v[72:75], v[192:195]
  v_exp_f32 v157, v157
  v_mfma_f32_16x16x32_bf16 v[200:203], v[232:235], v[76:79], v[200:203]
  ds_read_b128 v[232:235], v1 offset:33984
  v_mfma_f32_16x16x32_bf16 v[180:183], v[236:239], v[64:67], v[180:183]
  v_cvt_pk_bf16_f32 v152, v152, v153
  v_cvt_pk_bf16_f32 v153, v154, v155
  v_mfma_f32_16x16x32_bf16 v[188:191], v[236:239], v[68:71], v[188:191]
  v_exp_f32 v158, v158
  v_mfma_f32_16x16x32_bf16 v[196:199], v[236:239], v[72:75], v[196:199]
  v_accvgpr_write_b32 a68, v152
  v_accvgpr_write_b32 a69, v153
  v_mfma_f32_16x16x32_bf16 v[204:207], v[236:239], v[76:79], v[204:207]
  ds_read_b128 v[236:239], v1 offset:34496
  v_mfma_f32_16x16x32_bf16 a[240:243], v[224:227], a[48:51], a[240:243]
  v_exp_f32 v159, v159
  v_mfma_f32_16x16x32_bf16 a[244:247], v[224:227], a[52:55], a[244:247]
  v_exp_f32 v160, v160
  v_mfma_f32_16x16x32_bf16 a[248:251], v[224:227], a[56:59], a[248:251]
  v_cvt_pk_bf16_f32 v154, v156, v157
  v_accvgpr_write_b32 a70, v154
  v_mfma_f32_16x16x32_bf16 a[252:255], v[224:227], a[60:63], a[252:255]
  s_waitcnt lgkmcnt(4)
  v_mfma_f32_16x16x32_bf16 v[176:179], v[240:243], v[80:83], v[176:179]
  v_exp_f32 v161, v161
  v_mfma_f32_16x16x32_bf16 v[184:187], v[240:243], v[84:87], v[184:187]
  v_cvt_pk_bf16_f32 v155, v158, v159
  v_accvgpr_write_b32 a71, v155
  v_mfma_f32_16x16x32_bf16 v[192:195], v[240:243], v[88:91], v[192:195]
  v_exp_f32 v162, v162
  v_mfma_f32_16x16x32_bf16 v[200:203], v[240:243], v[92:95], v[200:203]
  ds_read_b128 v[240:243], v1 offset:34016
  v_mfma_f32_16x16x32_bf16 v[180:183], v[244:247], v[80:83], v[180:183]
  v_exp_f32 v163, v163
  v_mfma_f32_16x16x32_bf16 v[188:191], v[244:247], v[84:87], v[188:191]
  v_exp_f32 v164, v164
  v_mfma_f32_16x16x32_bf16 v[196:199], v[244:247], v[88:91], v[196:199]
  v_exp_f32 v165, v165
  v_mfma_f32_16x16x32_bf16 v[204:207], v[244:247], v[92:95], v[204:207]
  ds_read_b128 v[244:247], v1 offset:34528
  s_waitcnt vmcnt(24)
  s_barrier
  s_waitcnt lgkmcnt(4)
  v_mfma_f32_16x16x32_bf16 v[176:179], v[248:251], v[96:99], v[176:179]
  s_mov_b32 s35, 212992
  v_cvt_pk_bf16_f32 v160, v160, v161
  v_cvt_pk_bf16_f32 v161, v162, v163
  v_mfma_f32_16x16x32_bf16 v[184:187], v[248:251], v[100:103], v[184:187]
  s_add_u32 m0, s33, 16896
  v_exp_f32 v166, v166
  v_mfma_f32_16x16x32_bf16 v[192:195], v[248:251], v[104:107], v[192:195]
  buffer_load_dwordx4 v3, s[8:11], s35 offen offset:0 nt lds
  v_mfma_f32_16x16x32_bf16 v[200:203], v[248:251], v[108:111], v[200:203]
  s_add_u32 m0, s33, 17424
  v_add_u32 v1, 101376, v1
  ds_read_b128 v[248:251], v1 offset:33792
  v_mfma_f32_16x16x32_bf16 v[180:183], v[252:255], v[96:99], v[180:183]
  v_accvgpr_write_b32 a72, v160
  v_accvgpr_write_b32 a73, v161
  v_mfma_f32_16x16x32_bf16 v[188:191], v[252:255], v[100:103], v[188:191]
  v_exp_f32 v167, v167
  v_mfma_f32_16x16x32_bf16 v[196:199], v[252:255], v[104:107], v[196:199]
  v_exp_f32 v168, v168
  v_mfma_f32_16x16x32_bf16 v[204:207], v[252:255], v[108:111], v[204:207]
  ds_read_b128 v[252:255], v1 offset:34304
  s_waitcnt lgkmcnt(4)
  v_mfma_f32_16x16x32_bf16 v[176:179], v[232:235], v[112:115], v[176:179]
  v_cvt_pk_bf16_f32 v162, v164, v165
  v_accvgpr_write_b32 a74, v162
  v_mfma_f32_16x16x32_bf16 v[184:187], v[232:235], v[116:119], v[184:187]
  v_exp_f32 v169, v169
  v_mfma_f32_16x16x32_bf16 v[192:195], v[232:235], v[120:123], v[192:195]
  v_cvt_pk_bf16_f32 v163, v166, v167
  v_accvgpr_write_b32 a75, v163
  v_mfma_f32_16x16x32_bf16 v[200:203], v[232:235], v[124:127], v[200:203]
  ds_read_b128 v[232:235], v1 offset:33824
  buffer_load_dwordx4 v3, s[8:11], s35 offen offset:512 nt lds
  v_mfma_f32_16x16x32_bf16 v[180:183], v[236:239], v[112:115], v[180:183]
  s_add_u32 m0, s33, 17952
  v_exp_f32 v170, v170
  v_mfma_f32_16x16x32_bf16 v[188:191], v[236:239], v[116:119], v[188:191]
  v_exp_f32 v171, v171
  v_mfma_f32_16x16x32_bf16 v[196:199], v[236:239], v[120:123], v[196:199]
  v_exp_f32 v172, v172
  v_mfma_f32_16x16x32_bf16 v[204:207], v[236:239], v[124:127], v[204:207]
  ds_read_b128 v[236:239], v1 offset:34336
  s_waitcnt lgkmcnt(4)
  v_mfma_f32_16x16x32_bf16 v[176:179], v[240:243], v[128:131], v[176:179]
  v_exp_f32 v173, v173
  v_mfma_f32_16x16x32_bf16 v[184:187], v[240:243], v[132:135], v[184:187]
  v_cvt_pk_bf16_f32 v168, v168, v169
  v_cvt_pk_bf16_f32 v169, v170, v171
  v_mfma_f32_16x16x32_bf16 v[192:195], v[240:243], v[136:139], v[192:195]
  v_exp_f32 v174, v174
  v_mfma_f32_16x16x32_bf16 v[200:203], v[240:243], v[140:143], v[200:203]
  ds_read_b128 v[240:243], v1 offset:33856
  buffer_load_dwordx4 v3, s[8:11], s35 offen offset:1024 nt lds
  v_mfma_f32_16x16x32_bf16 v[180:183], v[244:247], v[128:131], v[180:183]
  s_add_u32 m0, s33, 18480
  v_accvgpr_write_b32 a76, v168
  v_accvgpr_write_b32 a77, v169
  v_mfma_f32_16x16x32_bf16 v[188:191], v[244:247], v[132:135], v[188:191]
  v_exp_f32 v175, v175
  v_mfma_f32_16x16x32_bf16 v[196:199], v[244:247], v[136:139], v[196:199]
  v_cvt_pk_bf16_f32 v170, v172, v173
  v_accvgpr_write_b32 a78, v170
  v_cvt_pk_bf16_f32 v171, v174, v175
  v_accvgpr_write_b32 a79, v171
  v_mfma_f32_16x16x32_bf16 v[204:207], v[244:247], v[140:143], v[204:207]
  ds_read_b128 v[244:247], v1 offset:34368
  s_waitcnt lgkmcnt(4)
  v_mfma_f32_16x16x32_bf16 v[144:147], v[248:251], v[16:19], v[208:211]
  buffer_load_dwordx4 v3, s[8:11], s35 offen offset:1536 nt lds
  v_mfma_f32_16x16x32_bf16 v[152:155], v[248:251], v[20:23], v[212:215]
  v_mfma_f32_16x16x32_bf16 v[160:163], v[248:251], v[24:27], v[216:219]
  v_mfma_f32_16x16x32_bf16 v[168:171], v[248:251], v[28:31], v[220:223]
  ds_read_b128 v[248:251], v1 offset:33888
  v_mfma_f32_16x16x32_bf16 v[148:151], v[252:255], v[16:19], v[208:211]
  v_exp_f32 v176, v176
  v_mfma_f32_16x16x32_bf16 v[156:159], v[252:255], v[20:23], v[212:215]
  v_exp_f32 v177, v177
  v_mfma_f32_16x16x32_bf16 v[164:167], v[252:255], v[24:27], v[216:219]
  v_exp_f32 v178, v178
  v_mfma_f32_16x16x32_bf16 v[172:175], v[252:255], v[28:31], v[220:223]
  ds_read_b128 v[252:255], v1 offset:34400
  s_waitcnt lgkmcnt(4)
  v_mfma_f32_16x16x32_bf16 v[144:147], v[232:235], v[32:35], v[144:147]
  v_exp_f32 v179, v179
  v_mfma_f32_16x16x32_bf16 v[152:155], v[232:235], v[36:39], v[152:155]
  v_exp_f32 v180, v180
  v_mfma_f32_16x16x32_bf16 v[160:163], v[232:235], v[40:43], v[160:163]
  v_exp_f32 v181, v181
  v_mfma_f32_16x16x32_bf16 v[168:171], v[232:235], v[44:47], v[168:171]
  ds_read_b128 v[232:235], v1 offset:33920
  v_mfma_f32_16x16x32_bf16 v[148:151], v[236:239], v[32:35], v[148:151]
  v_cvt_pk_bf16_f32 v176, v176, v177
  v_cvt_pk_bf16_f32 v177, v178, v179
  v_mfma_f32_16x16x32_bf16 v[156:159], v[236:239], v[36:39], v[156:159]
  v_exp_f32 v182, v182
  v_mfma_f32_16x16x32_bf16 v[164:167], v[236:239], v[40:43], v[164:167]
  v_accvgpr_write_b32 a80, v176
  v_accvgpr_write_b32 a81, v177
  v_mfma_f32_16x16x32_bf16 v[172:175], v[236:239], v[44:47], v[172:175]
  ds_read_b128 v[236:239], v1 offset:34432
  s_waitcnt lgkmcnt(4)
  v_mfma_f32_16x16x32_bf16 v[144:147], v[240:243], v[48:51], v[144:147]
  v_exp_f32 v183, v183
  v_mfma_f32_16x16x32_bf16 v[152:155], v[240:243], v[52:55], v[152:155]
  v_exp_f32 v184, v184
  v_mfma_f32_16x16x32_bf16 v[160:163], v[240:243], v[56:59], v[160:163]
  v_cvt_pk_bf16_f32 v178, v180, v181
  v_accvgpr_write_b32 a82, v178
  v_mfma_f32_16x16x32_bf16 v[168:171], v[240:243], v[60:63], v[168:171]
  ds_read_b128 v[240:243], v1 offset:33952
  v_mfma_f32_16x16x32_bf16 v[148:151], v[244:247], v[48:51], v[148:151]
  v_exp_f32 v185, v185
  v_mfma_f32_16x16x32_bf16 v[156:159], v[244:247], v[52:55], v[156:159]
  v_cvt_pk_bf16_f32 v179, v182, v183
  v_accvgpr_write_b32 a83, v179
  v_mfma_f32_16x16x32_bf16 v[164:167], v[244:247], v[56:59], v[164:167]
  v_exp_f32 v186, v186
  v_mfma_f32_16x16x32_bf16 v[172:175], v[244:247], v[60:63], v[172:175]
  ds_read_b128 v[244:247], v1 offset:34464
  s_waitcnt lgkmcnt(4)
  v_mfma_f32_16x16x32_bf16 v[144:147], v[248:251], v[64:67], v[144:147]
  v_exp_f32 v187, v187
  v_mfma_f32_16x16x32_bf16 v[152:155], v[248:251], v[68:71], v[152:155]
  v_exp_f32 v188, v188
  v_mfma_f32_16x16x32_bf16 v[160:163], v[248:251], v[72:75], v[160:163]
  v_exp_f32 v189, v189
  v_mfma_f32_16x16x32_bf16 v[168:171], v[248:251], v[76:79], v[168:171]
  ds_read_b128 v[248:251], v1 offset:33984
  v_mfma_f32_16x16x32_bf16 v[148:151], v[252:255], v[64:67], v[148:151]
  v_cvt_pk_bf16_f32 v184, v184, v185
  v_cvt_pk_bf16_f32 v185, v186, v187
  v_mfma_f32_16x16x32_bf16 v[156:159], v[252:255], v[68:71], v[156:159]
  v_exp_f32 v190, v190
  v_mfma_f32_16x16x32_bf16 v[164:167], v[252:255], v[72:75], v[164:167]
  v_accvgpr_write_b32 a84, v184
  v_accvgpr_write_b32 a85, v185
  v_mfma_f32_16x16x32_bf16 v[172:175], v[252:255], v[76:79], v[172:175]
  ds_read_b128 v[252:255], v1 offset:34496
  v_mfma_f32_16x16x32_bf16 a[240:243], v[224:227], a[64:67], a[240:243]
  v_exp_f32 v191, v191
  v_mfma_f32_16x16x32_bf16 a[244:247], v[224:227], a[68:71], a[244:247]
  v_exp_f32 v192, v192
  v_mfma_f32_16x16x32_bf16 a[248:251], v[224:227], a[72:75], a[248:251]
  v_cvt_pk_bf16_f32 v186, v188, v189
  v_accvgpr_write_b32 a86, v186
  v_mfma_f32_16x16x32_bf16 a[252:255], v[224:227], a[76:79], a[252:255]
  s_waitcnt lgkmcnt(4)
  v_mfma_f32_16x16x32_bf16 v[144:147], v[232:235], v[80:83], v[144:147]
  v_exp_f32 v193, v193
  v_mfma_f32_16x16x32_bf16 v[152:155], v[232:235], v[84:87], v[152:155]
  v_cvt_pk_bf16_f32 v187, v190, v191
  v_accvgpr_write_b32 a87, v187
  v_mfma_f32_16x16x32_bf16 v[160:163], v[232:235], v[88:91], v[160:163]
  v_exp_f32 v194, v194
  v_mfma_f32_16x16x32_bf16 v[168:171], v[232:235], v[92:95], v[168:171]
  ds_read_b128 v[232:235], v1 offset:34016
  v_mfma_f32_16x16x32_bf16 v[148:151], v[236:239], v[80:83], v[148:151]
  v_exp_f32 v195, v195
  v_mfma_f32_16x16x32_bf16 v[156:159], v[236:239], v[84:87], v[156:159]
  v_exp_f32 v196, v196
  v_mfma_f32_16x16x32_bf16 v[164:167], v[236:239], v[88:91], v[164:167]
  v_exp_f32 v197, v197
  v_mfma_f32_16x16x32_bf16 v[172:175], v[236:239], v[92:95], v[172:175]
  ds_read_b128 v[236:239], v1 offset:34528
  s_waitcnt vmcnt(24)
  s_barrier
  s_waitcnt lgkmcnt(4)
  v_mfma_f32_16x16x32_bf16 v[144:147], v[240:243], v[96:99], v[144:147]
  s_mov_b32 s35, 229376
  v_cvt_pk_bf16_f32 v192, v192, v193
  v_cvt_pk_bf16_f32 v193, v194, v195
  v_mfma_f32_16x16x32_bf16 v[152:155], v[240:243], v[100:103], v[152:155]
  s_add_u32 m0, s33, 33792
  v_exp_f32 v198, v198
  v_mfma_f32_16x16x32_bf16 v[160:163], v[240:243], v[104:107], v[160:163]
  buffer_load_dwordx4 v3, s[8:11], s35 offen offset:0 nt lds
  v_mfma_f32_16x16x32_bf16 v[168:171], v[240:243], v[108:111], v[168:171]
  s_add_u32 m0, s33, 34320
  v_subrev_u32 v1, 101376, v1
  ds_read_b128 v[240:243], v1 offset:0
  v_mfma_f32_16x16x32_bf16 v[148:151], v[244:247], v[96:99], v[148:151]
  v_accvgpr_write_b32 a88, v192
  v_accvgpr_write_b32 a89, v193
  v_mfma_f32_16x16x32_bf16 v[156:159], v[244:247], v[100:103], v[156:159]
  v_exp_f32 v199, v199
  v_mfma_f32_16x16x32_bf16 v[164:167], v[244:247], v[104:107], v[164:167]
  v_exp_f32 v200, v200
  v_mfma_f32_16x16x32_bf16 v[172:175], v[244:247], v[108:111], v[172:175]
  ds_read_b128 v[244:247], v1 offset:512
  s_waitcnt lgkmcnt(4)
  v_mfma_f32_16x16x32_bf16 v[144:147], v[248:251], v[112:115], v[144:147]
  v_cvt_pk_bf16_f32 v194, v196, v197
  v_accvgpr_write_b32 a90, v194
  v_mfma_f32_16x16x32_bf16 v[152:155], v[248:251], v[116:119], v[152:155]
  v_exp_f32 v201, v201
  v_mfma_f32_16x16x32_bf16 v[160:163], v[248:251], v[120:123], v[160:163]
  v_cvt_pk_bf16_f32 v195, v198, v199
  v_accvgpr_write_b32 a91, v195
  v_mfma_f32_16x16x32_bf16 v[168:171], v[248:251], v[124:127], v[168:171]
  ds_read_b128 v[248:251], v1 offset:32
  buffer_load_dwordx4 v3, s[8:11], s35 offen offset:512 nt lds
  v_mfma_f32_16x16x32_bf16 v[148:151], v[252:255], v[112:115], v[148:151]
  s_add_u32 m0, s33, 34848
  v_exp_f32 v202, v202
  v_mfma_f32_16x16x32_bf16 v[156:159], v[252:255], v[116:119], v[156:159]
  v_exp_f32 v203, v203
  v_mfma_f32_16x16x32_bf16 v[164:167], v[252:255], v[120:123], v[164:167]
  v_exp_f32 v204, v204
  v_mfma_f32_16x16x32_bf16 v[172:175], v[252:255], v[124:127], v[172:175]
  ds_read_b128 v[252:255], v1 offset:544
  s_waitcnt lgkmcnt(4)
  v_mfma_f32_16x16x32_bf16 v[144:147], v[232:235], v[128:131], v[144:147]
  v_exp_f32 v205, v205
  v_mfma_f32_16x16x32_bf16 v[152:155], v[232:235], v[132:135], v[152:155]
  v_cvt_pk_bf16_f32 v200, v200, v201
  v_cvt_pk_bf16_f32 v201, v202, v203
  v_mfma_f32_16x16x32_bf16 v[160:163], v[232:235], v[136:139], v[160:163]
  v_exp_f32 v206, v206
  v_mfma_f32_16x16x32_bf16 v[168:171], v[232:235], v[140:143], v[168:171]
  ds_read_b128 v[232:235], v1 offset:64
  buffer_load_dwordx4 v3, s[8:11], s35 offen offset:1024 nt lds
  v_mfma_f32_16x16x32_bf16 v[148:151], v[236:239], v[128:131], v[148:151]
  s_add_u32 m0, s33, 35376
  v_accvgpr_write_b32 a92, v200
  v_accvgpr_write_b32 a93, v201
  v_mfma_f32_16x16x32_bf16 v[156:159], v[236:239], v[132:135], v[156:159]
  v_exp_f32 v207, v207
  v_mfma_f32_16x16x32_bf16 v[164:167], v[236:239], v[136:139], v[164:167]
  v_cvt_pk_bf16_f32 v202, v204, v205
  v_accvgpr_write_b32 a94, v202
  v_cvt_pk_bf16_f32 v203, v206, v207
  v_accvgpr_write_b32 a95, v203
  v_mfma_f32_16x16x32_bf16 v[172:175], v[236:239], v[140:143], v[172:175]
  ds_read_b128 v[236:239], v1 offset:576
  s_waitcnt lgkmcnt(4)
  v_mfma_f32_16x16x32_bf16 v[176:179], v[240:243], v[16:19], v[208:211]
  buffer_load_dwordx4 v3, s[8:11], s35 offen offset:1536 nt lds
  v_mfma_f32_16x16x32_bf16 v[184:187], v[240:243], v[20:23], v[212:215]
  v_mfma_f32_16x16x32_bf16 v[192:195], v[240:243], v[24:27], v[216:219]
  v_mfma_f32_16x16x32_bf16 v[200:203], v[240:243], v[28:31], v[220:223]
  ds_read_b128 v[240:243], v1 offset:96
  v_mfma_f32_16x16x32_bf16 v[180:183], v[244:247], v[16:19], v[208:211]
  v_exp_f32 v144, v144
  v_mfma_f32_16x16x32_bf16 v[188:191], v[244:247], v[20:23], v[212:215]
  v_exp_f32 v145, v145
  v_mfma_f32_16x16x32_bf16 v[196:199], v[244:247], v[24:27], v[216:219]
  v_exp_f32 v146, v146
  v_mfma_f32_16x16x32_bf16 v[204:207], v[244:247], v[28:31], v[220:223]
  ds_read_b128 v[244:247], v1 offset:608
  s_waitcnt lgkmcnt(4)
  v_mfma_f32_16x16x32_bf16 v[176:179], v[248:251], v[32:35], v[176:179]
  v_exp_f32 v147, v147
  v_mfma_f32_16x16x32_bf16 v[184:187], v[248:251], v[36:39], v[184:187]
  v_exp_f32 v148, v148
  v_mfma_f32_16x16x32_bf16 v[192:195], v[248:251], v[40:43], v[192:195]
  v_exp_f32 v149, v149
  v_mfma_f32_16x16x32_bf16 v[200:203], v[248:251], v[44:47], v[200:203]
  ds_read_b128 v[248:251], v1 offset:128
  v_mfma_f32_16x16x32_bf16 v[180:183], v[252:255], v[32:35], v[180:183]
  v_cvt_pk_bf16_f32 v144, v144, v145
  v_cvt_pk_bf16_f32 v145, v146, v147
  v_mfma_f32_16x16x32_bf16 v[188:191], v[252:255], v[36:39], v[188:191]
  v_exp_f32 v150, v150
  v_mfma_f32_16x16x32_bf16 v[196:199], v[252:255], v[40:43], v[196:199]
  v_accvgpr_write_b32 a96, v144
  v_accvgpr_write_b32 a97, v145
  v_mfma_f32_16x16x32_bf16 v[204:207], v[252:255], v[44:47], v[204:207]
  ds_read_b128 v[252:255], v1 offset:640
  s_waitcnt lgkmcnt(4)
  v_mfma_f32_16x16x32_bf16 v[176:179], v[232:235], v[48:51], v[176:179]
  v_exp_f32 v151, v151
  v_mfma_f32_16x16x32_bf16 v[184:187], v[232:235], v[52:55], v[184:187]
  v_exp_f32 v152, v152
  v_mfma_f32_16x16x32_bf16 v[192:195], v[232:235], v[56:59], v[192:195]
  v_cvt_pk_bf16_f32 v146, v148, v149
  v_accvgpr_write_b32 a98, v146
  v_mfma_f32_16x16x32_bf16 v[200:203], v[232:235], v[60:63], v[200:203]
  ds_read_b128 v[232:235], v1 offset:160
  v_mfma_f32_16x16x32_bf16 v[180:183], v[236:239], v[48:51], v[180:183]
  v_exp_f32 v153, v153
  v_mfma_f32_16x16x32_bf16 v[188:191], v[236:239], v[52:55], v[188:191]
  v_cvt_pk_bf16_f32 v147, v150, v151
  v_accvgpr_write_b32 a99, v147
  v_mfma_f32_16x16x32_bf16 v[196:199], v[236:239], v[56:59], v[196:199]
  v_exp_f32 v154, v154
  v_mfma_f32_16x16x32_bf16 v[204:207], v[236:239], v[60:63], v[204:207]
  ds_read_b128 v[236:239], v1 offset:672
  s_waitcnt lgkmcnt(4)
  v_mfma_f32_16x16x32_bf16 v[176:179], v[240:243], v[64:67], v[176:179]
  v_exp_f32 v155, v155
  v_mfma_f32_16x16x32_bf16 v[184:187], v[240:243], v[68:71], v[184:187]
  v_exp_f32 v156, v156
  v_mfma_f32_16x16x32_bf16 v[192:195], v[240:243], v[72:75], v[192:195]
  v_exp_f32 v157, v157
  v_mfma_f32_16x16x32_bf16 v[200:203], v[240:243], v[76:79], v[200:203]
  ds_read_b128 v[240:243], v1 offset:192
  v_mfma_f32_16x16x32_bf16 v[180:183], v[244:247], v[64:67], v[180:183]
  v_cvt_pk_bf16_f32 v152, v152, v153
  v_cvt_pk_bf16_f32 v153, v154, v155
  v_mfma_f32_16x16x32_bf16 v[188:191], v[244:247], v[68:71], v[188:191]
  v_exp_f32 v158, v158
  v_mfma_f32_16x16x32_bf16 v[196:199], v[244:247], v[72:75], v[196:199]
  v_accvgpr_write_b32 a100, v152
  v_accvgpr_write_b32 a101, v153
  v_mfma_f32_16x16x32_bf16 v[204:207], v[244:247], v[76:79], v[204:207]
  ds_read_b128 v[244:247], v1 offset:704
  v_mfma_f32_16x16x32_bf16 a[240:243], v[224:227], a[80:83], a[240:243]
  v_exp_f32 v159, v159
  v_mfma_f32_16x16x32_bf16 a[244:247], v[224:227], a[84:87], a[244:247]
  v_exp_f32 v160, v160
  v_mfma_f32_16x16x32_bf16 a[248:251], v[224:227], a[88:91], a[248:251]
  v_cvt_pk_bf16_f32 v154, v156, v157
  v_accvgpr_write_b32 a102, v154
  v_mfma_f32_16x16x32_bf16 a[252:255], v[224:227], a[92:95], a[252:255]
  s_waitcnt lgkmcnt(4)
  v_mfma_f32_16x16x32_bf16 v[176:179], v[248:251], v[80:83], v[176:179]
  v_exp_f32 v161, v161
  v_mfma_f32_16x16x32_bf16 v[184:187], v[248:251], v[84:87], v[184:187]
  v_cvt_pk_bf16_f32 v155, v158, v159
  v_accvgpr_write_b32 a103, v155
  v_mfma_f32_16x16x32_bf16 v[192:195], v[248:251], v[88:91], v[192:195]
  v_exp_f32 v162, v162
  v_mfma_f32_16x16x32_bf16 v[200:203], v[248:251], v[92:95], v[200:203]
  ds_read_b128 v[248:251], v1 offset:224
  v_mfma_f32_16x16x32_bf16 v[180:183], v[252:255], v[80:83], v[180:183]
  v_exp_f32 v163, v163
  v_mfma_f32_16x16x32_bf16 v[188:191], v[252:255], v[84:87], v[188:191]
  v_exp_f32 v164, v164
  v_mfma_f32_16x16x32_bf16 v[196:199], v[252:255], v[88:91], v[196:199]
  v_exp_f32 v165, v165
  v_mfma_f32_16x16x32_bf16 v[204:207], v[252:255], v[92:95], v[204:207]
  ds_read_b128 v[252:255], v1 offset:736
  s_waitcnt vmcnt(24)
  s_barrier
  s_waitcnt lgkmcnt(4)
  v_mfma_f32_16x16x32_bf16 v[176:179], v[232:235], v[96:99], v[176:179]
  s_mov_b32 s35, 245760
  v_cvt_pk_bf16_f32 v160, v160, v161
  v_cvt_pk_bf16_f32 v161, v162, v163
  v_mfma_f32_16x16x32_bf16 v[184:187], v[232:235], v[100:103], v[184:187]
  s_add_u32 m0, s33, 135168
  v_exp_f32 v166, v166
  v_mfma_f32_16x16x32_bf16 v[192:195], v[232:235], v[104:107], v[192:195]
  buffer_load_dwordx4 v3, s[8:11], s35 offen offset:0 nt lds
  v_mfma_f32_16x16x32_bf16 v[200:203], v[232:235], v[108:111], v[200:203]
  s_add_u32 m0, s33, 135696
  v_add_u32 v1, 101376, v1
  ds_read_b128 v[232:235], v1 offset:0
  v_mfma_f32_16x16x32_bf16 v[180:183], v[236:239], v[96:99], v[180:183]
  v_accvgpr_write_b32 a104, v160
  v_accvgpr_write_b32 a105, v161
  v_mfma_f32_16x16x32_bf16 v[188:191], v[236:239], v[100:103], v[188:191]
  v_exp_f32 v167, v167
  v_mfma_f32_16x16x32_bf16 v[196:199], v[236:239], v[104:107], v[196:199]
  v_exp_f32 v168, v168
  v_mfma_f32_16x16x32_bf16 v[204:207], v[236:239], v[108:111], v[204:207]
  ds_read_b128 v[236:239], v1 offset:512
  s_waitcnt lgkmcnt(4)
  v_mfma_f32_16x16x32_bf16 v[176:179], v[240:243], v[112:115], v[176:179]
  v_cvt_pk_bf16_f32 v162, v164, v165
  v_accvgpr_write_b32 a106, v162
  v_mfma_f32_16x16x32_bf16 v[184:187], v[240:243], v[116:119], v[184:187]
  v_exp_f32 v169, v169
  v_mfma_f32_16x16x32_bf16 v[192:195], v[240:243], v[120:123], v[192:195]
  v_cvt_pk_bf16_f32 v163, v166, v167
  v_accvgpr_write_b32 a107, v163
  v_mfma_f32_16x16x32_bf16 v[200:203], v[240:243], v[124:127], v[200:203]
  ds_read_b128 v[240:243], v1 offset:32
  buffer_load_dwordx4 v3, s[8:11], s35 offen offset:512 nt lds
  v_mfma_f32_16x16x32_bf16 v[180:183], v[244:247], v[112:115], v[180:183]
  s_add_u32 m0, s33, 136224
  v_exp_f32 v170, v170
  v_mfma_f32_16x16x32_bf16 v[188:191], v[244:247], v[116:119], v[188:191]
  v_exp_f32 v171, v171
  v_mfma_f32_16x16x32_bf16 v[196:199], v[244:247], v[120:123], v[196:199]
  v_exp_f32 v172, v172
  v_mfma_f32_16x16x32_bf16 v[204:207], v[244:247], v[124:127], v[204:207]
  ds_read_b128 v[244:247], v1 offset:544
  s_waitcnt lgkmcnt(4)
  v_mfma_f32_16x16x32_bf16 v[176:179], v[248:251], v[128:131], v[176:179]
  v_exp_f32 v173, v173
  v_mfma_f32_16x16x32_bf16 v[184:187], v[248:251], v[132:135], v[184:187]
  v_cvt_pk_bf16_f32 v168, v168, v169
  v_cvt_pk_bf16_f32 v169, v170, v171
  v_mfma_f32_16x16x32_bf16 v[192:195], v[248:251], v[136:139], v[192:195]
  v_exp_f32 v174, v174
  v_mfma_f32_16x16x32_bf16 v[200:203], v[248:251], v[140:143], v[200:203]
  ds_read_b128 v[248:251], v1 offset:64
  buffer_load_dwordx4 v3, s[8:11], s35 offen offset:1024 nt lds
  v_mfma_f32_16x16x32_bf16 v[180:183], v[252:255], v[128:131], v[180:183]
  s_add_u32 m0, s33, 136752
  v_accvgpr_write_b32 a108, v168
  v_accvgpr_write_b32 a109, v169
  v_mfma_f32_16x16x32_bf16 v[188:191], v[252:255], v[132:135], v[188:191]
  v_exp_f32 v175, v175
  v_mfma_f32_16x16x32_bf16 v[196:199], v[252:255], v[136:139], v[196:199]
  v_cvt_pk_bf16_f32 v170, v172, v173
  v_accvgpr_write_b32 a110, v170
  v_cvt_pk_bf16_f32 v171, v174, v175
  v_accvgpr_write_b32 a111, v171
  v_mfma_f32_16x16x32_bf16 v[204:207], v[252:255], v[140:143], v[204:207]
  ds_read_b128 v[252:255], v1 offset:576
  s_waitcnt lgkmcnt(4)
  v_mfma_f32_16x16x32_bf16 v[144:147], v[232:235], v[16:19], v[208:211]
  buffer_load_dwordx4 v3, s[8:11], s35 offen offset:1536 nt lds
  v_mfma_f32_16x16x32_bf16 v[152:155], v[232:235], v[20:23], v[212:215]
  v_mfma_f32_16x16x32_bf16 v[160:163], v[232:235], v[24:27], v[216:219]
  v_mfma_f32_16x16x32_bf16 v[168:171], v[232:235], v[28:31], v[220:223]
  ds_read_b128 v[232:235], v1 offset:96
  v_mfma_f32_16x16x32_bf16 v[148:151], v[236:239], v[16:19], v[208:211]
  v_exp_f32 v176, v176
  v_mfma_f32_16x16x32_bf16 v[156:159], v[236:239], v[20:23], v[212:215]
  v_exp_f32 v177, v177
  v_mfma_f32_16x16x32_bf16 v[164:167], v[236:239], v[24:27], v[216:219]
  v_exp_f32 v178, v178
  v_mfma_f32_16x16x32_bf16 v[172:175], v[236:239], v[28:31], v[220:223]
  ds_read_b128 v[236:239], v1 offset:608
  s_waitcnt lgkmcnt(4)
  v_mfma_f32_16x16x32_bf16 v[144:147], v[240:243], v[32:35], v[144:147]
  v_exp_f32 v179, v179
  v_mfma_f32_16x16x32_bf16 v[152:155], v[240:243], v[36:39], v[152:155]
  v_exp_f32 v180, v180
  v_mfma_f32_16x16x32_bf16 v[160:163], v[240:243], v[40:43], v[160:163]
  v_exp_f32 v181, v181
  v_mfma_f32_16x16x32_bf16 v[168:171], v[240:243], v[44:47], v[168:171]
  ds_read_b128 v[240:243], v1 offset:128
  v_mfma_f32_16x16x32_bf16 v[148:151], v[244:247], v[32:35], v[148:151]
  v_cvt_pk_bf16_f32 v176, v176, v177
  v_cvt_pk_bf16_f32 v177, v178, v179
  v_mfma_f32_16x16x32_bf16 v[156:159], v[244:247], v[36:39], v[156:159]
  v_exp_f32 v182, v182
  v_mfma_f32_16x16x32_bf16 v[164:167], v[244:247], v[40:43], v[164:167]
  v_accvgpr_write_b32 a112, v176
  v_accvgpr_write_b32 a113, v177
  v_mfma_f32_16x16x32_bf16 v[172:175], v[244:247], v[44:47], v[172:175]
  ds_read_b128 v[244:247], v1 offset:640
  s_waitcnt lgkmcnt(4)
  v_mfma_f32_16x16x32_bf16 v[144:147], v[248:251], v[48:51], v[144:147]
  v_exp_f32 v183, v183
  v_mfma_f32_16x16x32_bf16 v[152:155], v[248:251], v[52:55], v[152:155]
  v_exp_f32 v184, v184
  v_mfma_f32_16x16x32_bf16 v[160:163], v[248:251], v[56:59], v[160:163]
  v_cvt_pk_bf16_f32 v178, v180, v181
  v_accvgpr_write_b32 a114, v178
  v_mfma_f32_16x16x32_bf16 v[168:171], v[248:251], v[60:63], v[168:171]
  ds_read_b128 v[248:251], v1 offset:160
  v_mfma_f32_16x16x32_bf16 v[148:151], v[252:255], v[48:51], v[148:151]
  v_exp_f32 v185, v185
  v_mfma_f32_16x16x32_bf16 v[156:159], v[252:255], v[52:55], v[156:159]
  v_cvt_pk_bf16_f32 v179, v182, v183
  v_accvgpr_write_b32 a115, v179
  v_mfma_f32_16x16x32_bf16 v[164:167], v[252:255], v[56:59], v[164:167]
  v_exp_f32 v186, v186
  v_mfma_f32_16x16x32_bf16 v[172:175], v[252:255], v[60:63], v[172:175]
  ds_read_b128 v[252:255], v1 offset:672
  s_waitcnt lgkmcnt(4)
  v_mfma_f32_16x16x32_bf16 v[144:147], v[232:235], v[64:67], v[144:147]
  v_exp_f32 v187, v187
  v_mfma_f32_16x16x32_bf16 v[152:155], v[232:235], v[68:71], v[152:155]
  v_exp_f32 v188, v188
  v_mfma_f32_16x16x32_bf16 v[160:163], v[232:235], v[72:75], v[160:163]
  v_exp_f32 v189, v189
  v_mfma_f32_16x16x32_bf16 v[168:171], v[232:235], v[76:79], v[168:171]
  ds_read_b128 v[232:235], v1 offset:192
  v_mfma_f32_16x16x32_bf16 v[148:151], v[236:239], v[64:67], v[148:151]
  v_cvt_pk_bf16_f32 v184, v184, v185
  v_cvt_pk_bf16_f32 v185, v186, v187
  v_mfma_f32_16x16x32_bf16 v[156:159], v[236:239], v[68:71], v[156:159]
  v_exp_f32 v190, v190
  v_mfma_f32_16x16x32_bf16 v[164:167], v[236:239], v[72:75], v[164:167]
  v_accvgpr_write_b32 a116, v184
  v_accvgpr_write_b32 a117, v185
  v_mfma_f32_16x16x32_bf16 v[172:175], v[236:239], v[76:79], v[172:175]
  ds_read_b128 v[236:239], v1 offset:704
  v_mfma_f32_16x16x32_bf16 a[240:243], v[224:227], a[96:99], a[240:243]
  v_exp_f32 v191, v191
  v_mfma_f32_16x16x32_bf16 a[244:247], v[224:227], a[100:103], a[244:247]
  v_exp_f32 v192, v192
  v_mfma_f32_16x16x32_bf16 a[248:251], v[224:227], a[104:107], a[248:251]
  v_cvt_pk_bf16_f32 v186, v188, v189
  v_accvgpr_write_b32 a118, v186
  v_mfma_f32_16x16x32_bf16 a[252:255], v[224:227], a[108:111], a[252:255]
  s_waitcnt lgkmcnt(4)
  v_mfma_f32_16x16x32_bf16 v[144:147], v[240:243], v[80:83], v[144:147]
  v_exp_f32 v193, v193
  v_mfma_f32_16x16x32_bf16 v[152:155], v[240:243], v[84:87], v[152:155]
  v_cvt_pk_bf16_f32 v187, v190, v191
  v_accvgpr_write_b32 a119, v187
  v_mfma_f32_16x16x32_bf16 v[160:163], v[240:243], v[88:91], v[160:163]
  v_exp_f32 v194, v194
  v_mfma_f32_16x16x32_bf16 v[168:171], v[240:243], v[92:95], v[168:171]
  ds_read_b128 v[240:243], v1 offset:224
  v_mfma_f32_16x16x32_bf16 v[148:151], v[244:247], v[80:83], v[148:151]
  v_exp_f32 v195, v195
  v_mfma_f32_16x16x32_bf16 v[156:159], v[244:247], v[84:87], v[156:159]
  v_exp_f32 v196, v196
  v_mfma_f32_16x16x32_bf16 v[164:167], v[244:247], v[88:91], v[164:167]
  v_exp_f32 v197, v197
  v_mfma_f32_16x16x32_bf16 v[172:175], v[244:247], v[92:95], v[172:175]
  ds_read_b128 v[244:247], v1 offset:736
  s_waitcnt vmcnt(24)
  s_barrier
  s_waitcnt lgkmcnt(4)
  v_mfma_f32_16x16x32_bf16 v[144:147], v[248:251], v[96:99], v[144:147]
  s_mov_b32 s35, 0
  v_cvt_pk_bf16_f32 v192, v192, v193
  v_cvt_pk_bf16_f32 v193, v194, v195
  v_mfma_f32_16x16x32_bf16 v[152:155], v[248:251], v[100:103], v[152:155]
  s_add_u32 m0, s34, 0
  v_exp_f32 v198, v198
  v_mfma_f32_16x16x32_bf16 v[160:163], v[248:251], v[104:107], v[160:163]
  buffer_load_dwordx4 v10, s[12:15], s35 offen offset:0 nt lds
  v_mfma_f32_16x16x32_bf16 v[168:171], v[248:251], v[108:111], v[168:171]
  s_add_u32 m0, s34, 544
  v_subrev_u32 v1, 50688, v1
  ds_read_b128 v[248:251], v1 offset:16896
  v_mfma_f32_16x16x32_bf16 v[148:151], v[252:255], v[96:99], v[148:151]
  v_accvgpr_write_b32 a120, v192
  v_accvgpr_write_b32 a121, v193
  v_mfma_f32_16x16x32_bf16 v[156:159], v[252:255], v[100:103], v[156:159]
  v_exp_f32 v199, v199
  v_mfma_f32_16x16x32_bf16 v[164:167], v[252:255], v[104:107], v[164:167]
  v_exp_f32 v200, v200
  v_mfma_f32_16x16x32_bf16 v[172:175], v[252:255], v[108:111], v[172:175]
  ds_read_b128 v[252:255], v1 offset:17408
  s_waitcnt lgkmcnt(4)
  v_mfma_f32_16x16x32_bf16 v[144:147], v[232:235], v[112:115], v[144:147]
  v_cvt_pk_bf16_f32 v194, v196, v197
  v_accvgpr_write_b32 a122, v194
  v_mfma_f32_16x16x32_bf16 v[152:155], v[232:235], v[116:119], v[152:155]
  v_exp_f32 v201, v201
  v_mfma_f32_16x16x32_bf16 v[160:163], v[232:235], v[120:123], v[160:163]
  v_cvt_pk_bf16_f32 v195, v198, v199
  v_accvgpr_write_b32 a123, v195
  v_mfma_f32_16x16x32_bf16 v[168:171], v[232:235], v[124:127], v[168:171]
  ds_read_b128 v[232:235], v1 offset:16928
  buffer_load_dwordx4 v10, s[12:15], s35 offen offset:512 nt lds
  v_mfma_f32_16x16x32_bf16 v[148:151], v[236:239], v[112:115], v[148:151]
  s_add_u32 m0, s34, 1088
  v_exp_f32 v202, v202
  v_mfma_f32_16x16x32_bf16 v[156:159], v[236:239], v[116:119], v[156:159]
  v_exp_f32 v203, v203
  v_mfma_f32_16x16x32_bf16 v[164:167], v[236:239], v[120:123], v[164:167]
  v_exp_f32 v204, v204
  v_mfma_f32_16x16x32_bf16 v[172:175], v[236:239], v[124:127], v[172:175]
  ds_read_b128 v[236:239], v1 offset:17440
  s_waitcnt lgkmcnt(4)
  v_mfma_f32_16x16x32_bf16 v[144:147], v[240:243], v[128:131], v[144:147]
  v_exp_f32 v205, v205
  v_mfma_f32_16x16x32_bf16 v[152:155], v[240:243], v[132:135], v[152:155]
  v_cvt_pk_bf16_f32 v200, v200, v201
  v_cvt_pk_bf16_f32 v201, v202, v203
  v_mfma_f32_16x16x32_bf16 v[160:163], v[240:243], v[136:139], v[160:163]
  v_exp_f32 v206, v206
  v_mfma_f32_16x16x32_bf16 v[168:171], v[240:243], v[140:143], v[168:171]
  ds_read_b128 v[240:243], v1 offset:16960
  buffer_load_dwordx4 v10, s[12:15], s35 offen offset:1024 nt lds
  v_mfma_f32_16x16x32_bf16 v[148:151], v[244:247], v[128:131], v[148:151]
  s_add_u32 m0, s34, 1632
  v_accvgpr_write_b32 a124, v200
  v_accvgpr_write_b32 a125, v201
  v_mfma_f32_16x16x32_bf16 v[156:159], v[244:247], v[132:135], v[156:159]
  v_exp_f32 v207, v207
  v_mfma_f32_16x16x32_bf16 v[164:167], v[244:247], v[136:139], v[164:167]
  v_cvt_pk_bf16_f32 v202, v204, v205
  v_accvgpr_write_b32 a126, v202
  v_cvt_pk_bf16_f32 v203, v206, v207
  v_accvgpr_write_b32 a127, v203
  v_mfma_f32_16x16x32_bf16 v[172:175], v[244:247], v[140:143], v[172:175]
  ds_read_b128 v[244:247], v1 offset:17472
  s_waitcnt lgkmcnt(4)
  v_mfma_f32_16x16x32_bf16 v[176:179], v[248:251], v[16:19], v[208:211]
  buffer_load_dwordx4 v10, s[12:15], s35 offen offset:1536 nt lds
  v_mfma_f32_16x16x32_bf16 v[184:187], v[248:251], v[20:23], v[212:215]
  v_mfma_f32_16x16x32_bf16 v[192:195], v[248:251], v[24:27], v[216:219]
  v_mfma_f32_16x16x32_bf16 v[200:203], v[248:251], v[28:31], v[220:223]
  ds_read_b128 v[248:251], v1 offset:16992
  v_mfma_f32_16x16x32_bf16 v[180:183], v[252:255], v[16:19], v[208:211]
  v_exp_f32 v144, v144
  v_mfma_f32_16x16x32_bf16 v[188:191], v[252:255], v[20:23], v[212:215]
  v_exp_f32 v145, v145
  v_mfma_f32_16x16x32_bf16 v[196:199], v[252:255], v[24:27], v[216:219]
  v_exp_f32 v146, v146
  v_mfma_f32_16x16x32_bf16 v[204:207], v[252:255], v[28:31], v[220:223]
  ds_read_b128 v[252:255], v1 offset:17504
  s_waitcnt lgkmcnt(4)
  v_mfma_f32_16x16x32_bf16 v[176:179], v[232:235], v[32:35], v[176:179]
  v_exp_f32 v147, v147
  v_mfma_f32_16x16x32_bf16 v[184:187], v[232:235], v[36:39], v[184:187]
  v_exp_f32 v148, v148
  v_mfma_f32_16x16x32_bf16 v[192:195], v[232:235], v[40:43], v[192:195]
  v_exp_f32 v149, v149
  v_mfma_f32_16x16x32_bf16 v[200:203], v[232:235], v[44:47], v[200:203]
  ds_read_b128 v[232:235], v1 offset:17024
  v_mfma_f32_16x16x32_bf16 v[180:183], v[236:239], v[32:35], v[180:183]
  v_cvt_pk_bf16_f32 v144, v144, v145
  v_cvt_pk_bf16_f32 v145, v146, v147
  v_mfma_f32_16x16x32_bf16 v[188:191], v[236:239], v[36:39], v[188:191]
  v_exp_f32 v150, v150
  v_mfma_f32_16x16x32_bf16 v[196:199], v[236:239], v[40:43], v[196:199]
  v_accvgpr_write_b32 a128, v144
  v_accvgpr_write_b32 a129, v145
  v_mfma_f32_16x16x32_bf16 v[204:207], v[236:239], v[44:47], v[204:207]
  ds_read_b128 v[236:239], v1 offset:17536
  s_waitcnt lgkmcnt(4)
  v_mfma_f32_16x16x32_bf16 v[176:179], v[240:243], v[48:51], v[176:179]
  v_exp_f32 v151, v151
  v_mfma_f32_16x16x32_bf16 v[184:187], v[240:243], v[52:55], v[184:187]
  v_exp_f32 v152, v152
  v_mfma_f32_16x16x32_bf16 v[192:195], v[240:243], v[56:59], v[192:195]
  v_cvt_pk_bf16_f32 v146, v148, v149
  v_accvgpr_write_b32 a130, v146
  v_mfma_f32_16x16x32_bf16 v[200:203], v[240:243], v[60:63], v[200:203]
  ds_read_b128 v[240:243], v1 offset:17056
  v_mfma_f32_16x16x32_bf16 v[180:183], v[244:247], v[48:51], v[180:183]
  v_exp_f32 v153, v153
  v_mfma_f32_16x16x32_bf16 v[188:191], v[244:247], v[52:55], v[188:191]
  v_cvt_pk_bf16_f32 v147, v150, v151
  v_accvgpr_write_b32 a131, v147
  v_mfma_f32_16x16x32_bf16 v[196:199], v[244:247], v[56:59], v[196:199]
  v_exp_f32 v154, v154
  v_mfma_f32_16x16x32_bf16 v[204:207], v[244:247], v[60:63], v[204:207]
  ds_read_b128 v[244:247], v1 offset:17568
  s_waitcnt lgkmcnt(4)
  v_mfma_f32_16x16x32_bf16 v[176:179], v[248:251], v[64:67], v[176:179]
  v_exp_f32 v155, v155
  v_mfma_f32_16x16x32_bf16 v[184:187], v[248:251], v[68:71], v[184:187]
  v_exp_f32 v156, v156
  v_mfma_f32_16x16x32_bf16 v[192:195], v[248:251], v[72:75], v[192:195]
  v_exp_f32 v157, v157
  v_mfma_f32_16x16x32_bf16 v[200:203], v[248:251], v[76:79], v[200:203]
  ds_read_b128 v[248:251], v1 offset:17088
  v_mfma_f32_16x16x32_bf16 v[180:183], v[252:255], v[64:67], v[180:183]
  v_cvt_pk_bf16_f32 v152, v152, v153
  v_cvt_pk_bf16_f32 v153, v154, v155
  v_mfma_f32_16x16x32_bf16 v[188:191], v[252:255], v[68:71], v[188:191]
  v_exp_f32 v158, v158
  v_mfma_f32_16x16x32_bf16 v[196:199], v[252:255], v[72:75], v[196:199]
  v_accvgpr_write_b32 a132, v152
  v_accvgpr_write_b32 a133, v153
  v_mfma_f32_16x16x32_bf16 v[204:207], v[252:255], v[76:79], v[204:207]
  ds_read_b128 v[252:255], v1 offset:17600
  v_mfma_f32_16x16x32_bf16 a[240:243], v[224:227], a[112:115], a[240:243]
  v_exp_f32 v159, v159
  v_mfma_f32_16x16x32_bf16 a[244:247], v[224:227], a[116:119], a[244:247]
  v_exp_f32 v160, v160
  v_mfma_f32_16x16x32_bf16 a[248:251], v[224:227], a[120:123], a[248:251]
  v_cvt_pk_bf16_f32 v154, v156, v157
  v_accvgpr_write_b32 a134, v154
  v_mfma_f32_16x16x32_bf16 a[252:255], v[224:227], a[124:127], a[252:255]
  s_waitcnt lgkmcnt(4)
  v_mfma_f32_16x16x32_bf16 v[176:179], v[232:235], v[80:83], v[176:179]
  v_exp_f32 v161, v161
  v_mfma_f32_16x16x32_bf16 v[184:187], v[232:235], v[84:87], v[184:187]
  v_cvt_pk_bf16_f32 v155, v158, v159
  v_accvgpr_write_b32 a135, v155
  v_mfma_f32_16x16x32_bf16 v[192:195], v[232:235], v[88:91], v[192:195]
  v_exp_f32 v162, v162
  v_mfma_f32_16x16x32_bf16 v[200:203], v[232:235], v[92:95], v[200:203]
  ds_read_b128 v[232:235], v1 offset:17120
  v_mfma_f32_16x16x32_bf16 v[180:183], v[236:239], v[80:83], v[180:183]
  v_exp_f32 v163, v163
  v_mfma_f32_16x16x32_bf16 v[188:191], v[236:239], v[84:87], v[188:191]
  v_exp_f32 v164, v164
  v_mfma_f32_16x16x32_bf16 v[196:199], v[236:239], v[88:91], v[196:199]
  v_exp_f32 v165, v165
  v_mfma_f32_16x16x32_bf16 v[204:207], v[236:239], v[92:95], v[204:207]
  ds_read_b128 v[236:239], v1 offset:17632
  s_waitcnt vmcnt(24)
  s_barrier
  s_waitcnt lgkmcnt(4)
  v_mfma_f32_16x16x32_bf16 v[176:179], v[240:243], v[96:99], v[176:179]
  s_mov_b32 s35, 32768
  v_cvt_pk_bf16_f32 v160, v160, v161
  v_cvt_pk_bf16_f32 v161, v162, v163
  v_mfma_f32_16x16x32_bf16 v[184:187], v[240:243], v[100:103], v[184:187]
  s_add_u32 m0, s34, 101376
  v_exp_f32 v166, v166
  v_mfma_f32_16x16x32_bf16 v[192:195], v[240:243], v[104:107], v[192:195]
  buffer_load_dwordx4 v10, s[12:15], s35 offen offset:0 nt lds
  v_mfma_f32_16x16x32_bf16 v[200:203], v[240:243], v[108:111], v[200:203]
  s_add_u32 m0, s34, 101920
  v_add_u32 v1, 50688, v1
  ds_read_b128 v[240:243], v1 offset:16896
  v_mfma_f32_16x16x32_bf16 v[180:183], v[244:247], v[96:99], v[180:183]
  v_accvgpr_write_b32 a136, v160
  v_accvgpr_write_b32 a137, v161
  v_mfma_f32_16x16x32_bf16 v[188:191], v[244:247], v[100:103], v[188:191]
  v_exp_f32 v167, v167
  v_mfma_f32_16x16x32_bf16 v[196:199], v[244:247], v[104:107], v[196:199]
  v_exp_f32 v168, v168
  v_mfma_f32_16x16x32_bf16 v[204:207], v[244:247], v[108:111], v[204:207]
  ds_read_b128 v[244:247], v1 offset:17408
  s_waitcnt lgkmcnt(4)
  v_mfma_f32_16x16x32_bf16 v[176:179], v[248:251], v[112:115], v[176:179]
  v_cvt_pk_bf16_f32 v162, v164, v165
  v_accvgpr_write_b32 a138, v162
  v_mfma_f32_16x16x32_bf16 v[184:187], v[248:251], v[116:119], v[184:187]
  v_exp_f32 v169, v169
  v_mfma_f32_16x16x32_bf16 v[192:195], v[248:251], v[120:123], v[192:195]
  v_cvt_pk_bf16_f32 v163, v166, v167
  v_accvgpr_write_b32 a139, v163
  v_mfma_f32_16x16x32_bf16 v[200:203], v[248:251], v[124:127], v[200:203]
  ds_read_b128 v[248:251], v1 offset:16928
  buffer_load_dwordx4 v10, s[12:15], s35 offen offset:512 nt lds
  v_mfma_f32_16x16x32_bf16 v[180:183], v[252:255], v[112:115], v[180:183]
  s_add_u32 m0, s34, 102464
  v_exp_f32 v170, v170
  v_mfma_f32_16x16x32_bf16 v[188:191], v[252:255], v[116:119], v[188:191]
  v_exp_f32 v171, v171
  v_mfma_f32_16x16x32_bf16 v[196:199], v[252:255], v[120:123], v[196:199]
  v_exp_f32 v172, v172
  v_mfma_f32_16x16x32_bf16 v[204:207], v[252:255], v[124:127], v[204:207]
  ds_read_b128 v[252:255], v1 offset:17440
  s_waitcnt lgkmcnt(4)
  v_mfma_f32_16x16x32_bf16 v[176:179], v[232:235], v[128:131], v[176:179]
  v_exp_f32 v173, v173
  v_mfma_f32_16x16x32_bf16 v[184:187], v[232:235], v[132:135], v[184:187]
  v_cvt_pk_bf16_f32 v168, v168, v169
  v_cvt_pk_bf16_f32 v169, v170, v171
  v_mfma_f32_16x16x32_bf16 v[192:195], v[232:235], v[136:139], v[192:195]
  v_exp_f32 v174, v174
  v_mfma_f32_16x16x32_bf16 v[200:203], v[232:235], v[140:143], v[200:203]
  ds_read_b128 v[232:235], v1 offset:16960
  buffer_load_dwordx4 v10, s[12:15], s35 offen offset:1024 nt lds
  v_mfma_f32_16x16x32_bf16 v[180:183], v[236:239], v[128:131], v[180:183]
  s_add_u32 m0, s34, 103008
  v_accvgpr_write_b32 a140, v168
  v_accvgpr_write_b32 a141, v169
  v_mfma_f32_16x16x32_bf16 v[188:191], v[236:239], v[132:135], v[188:191]
  v_exp_f32 v175, v175
  v_mfma_f32_16x16x32_bf16 v[196:199], v[236:239], v[136:139], v[196:199]
  v_cvt_pk_bf16_f32 v170, v172, v173
  v_accvgpr_write_b32 a142, v170
  v_cvt_pk_bf16_f32 v171, v174, v175
  v_accvgpr_write_b32 a143, v171
  v_mfma_f32_16x16x32_bf16 v[204:207], v[236:239], v[140:143], v[204:207]
  ds_read_b128 v[236:239], v1 offset:17472
  s_waitcnt lgkmcnt(4)
  v_mfma_f32_16x16x32_bf16 v[144:147], v[240:243], v[16:19], v[208:211]
  buffer_load_dwordx4 v10, s[12:15], s35 offen offset:1536 nt lds
  v_mfma_f32_16x16x32_bf16 v[152:155], v[240:243], v[20:23], v[212:215]
  v_mfma_f32_16x16x32_bf16 v[160:163], v[240:243], v[24:27], v[216:219]
  v_mfma_f32_16x16x32_bf16 v[168:171], v[240:243], v[28:31], v[220:223]
  ds_read_b128 v[240:243], v1 offset:16992
  v_mfma_f32_16x16x32_bf16 v[148:151], v[244:247], v[16:19], v[208:211]
  v_exp_f32 v176, v176
  v_mfma_f32_16x16x32_bf16 v[156:159], v[244:247], v[20:23], v[212:215]
  v_exp_f32 v177, v177
  v_mfma_f32_16x16x32_bf16 v[164:167], v[244:247], v[24:27], v[216:219]
  v_exp_f32 v178, v178
  v_mfma_f32_16x16x32_bf16 v[172:175], v[244:247], v[28:31], v[220:223]
  ds_read_b128 v[244:247], v1 offset:17504
  s_waitcnt lgkmcnt(4)
  v_mfma_f32_16x16x32_bf16 v[144:147], v[248:251], v[32:35], v[144:147]
  v_exp_f32 v179, v179
  v_mfma_f32_16x16x32_bf16 v[152:155], v[248:251], v[36:39], v[152:155]
  v_exp_f32 v180, v180
  v_mfma_f32_16x16x32_bf16 v[160:163], v[248:251], v[40:43], v[160:163]
  v_exp_f32 v181, v181
  v_mfma_f32_16x16x32_bf16 v[168:171], v[248:251], v[44:47], v[168:171]
  ds_read_b128 v[248:251], v1 offset:17024
  v_mfma_f32_16x16x32_bf16 v[148:151], v[252:255], v[32:35], v[148:151]
  v_cvt_pk_bf16_f32 v176, v176, v177
  v_cvt_pk_bf16_f32 v177, v178, v179
  v_mfma_f32_16x16x32_bf16 v[156:159], v[252:255], v[36:39], v[156:159]
  v_exp_f32 v182, v182
  v_mfma_f32_16x16x32_bf16 v[164:167], v[252:255], v[40:43], v[164:167]
  v_accvgpr_write_b32 a144, v176
  v_accvgpr_write_b32 a145, v177
  v_mfma_f32_16x16x32_bf16 v[172:175], v[252:255], v[44:47], v[172:175]
  ds_read_b128 v[252:255], v1 offset:17536
  s_waitcnt lgkmcnt(4)
  v_mfma_f32_16x16x32_bf16 v[144:147], v[232:235], v[48:51], v[144:147]
  v_exp_f32 v183, v183
  v_mfma_f32_16x16x32_bf16 v[152:155], v[232:235], v[52:55], v[152:155]
  v_exp_f32 v184, v184
  v_mfma_f32_16x16x32_bf16 v[160:163], v[232:235], v[56:59], v[160:163]
  v_cvt_pk_bf16_f32 v178, v180, v181
  v_accvgpr_write_b32 a146, v178
  v_mfma_f32_16x16x32_bf16 v[168:171], v[232:235], v[60:63], v[168:171]
  ds_read_b128 v[232:235], v1 offset:17056
  v_mfma_f32_16x16x32_bf16 v[148:151], v[236:239], v[48:51], v[148:151]
  v_exp_f32 v185, v185
  v_mfma_f32_16x16x32_bf16 v[156:159], v[236:239], v[52:55], v[156:159]
  v_cvt_pk_bf16_f32 v179, v182, v183
  v_accvgpr_write_b32 a147, v179
  v_mfma_f32_16x16x32_bf16 v[164:167], v[236:239], v[56:59], v[164:167]
  v_exp_f32 v186, v186
  v_mfma_f32_16x16x32_bf16 v[172:175], v[236:239], v[60:63], v[172:175]
  ds_read_b128 v[236:239], v1 offset:17568
  s_waitcnt lgkmcnt(4)
  v_mfma_f32_16x16x32_bf16 v[144:147], v[240:243], v[64:67], v[144:147]
  v_exp_f32 v187, v187
  v_mfma_f32_16x16x32_bf16 v[152:155], v[240:243], v[68:71], v[152:155]
  v_exp_f32 v188, v188
  v_mfma_f32_16x16x32_bf16 v[160:163], v[240:243], v[72:75], v[160:163]
  v_exp_f32 v189, v189
  v_mfma_f32_16x16x32_bf16 v[168:171], v[240:243], v[76:79], v[168:171]
  ds_read_b128 v[240:243], v1 offset:17088
  v_mfma_f32_16x16x32_bf16 v[148:151], v[244:247], v[64:67], v[148:151]
  v_cvt_pk_bf16_f32 v184, v184, v185
  v_cvt_pk_bf16_f32 v185, v186, v187
  v_mfma_f32_16x16x32_bf16 v[156:159], v[244:247], v[68:71], v[156:159]
  v_exp_f32 v190, v190
  v_mfma_f32_16x16x32_bf16 v[164:167], v[244:247], v[72:75], v[164:167]
  v_accvgpr_write_b32 a148, v184
  v_accvgpr_write_b32 a149, v185
  v_mfma_f32_16x16x32_bf16 v[172:175], v[244:247], v[76:79], v[172:175]
  ds_read_b128 v[244:247], v1 offset:17600
  v_mfma_f32_16x16x32_bf16 a[240:243], v[224:227], a[128:131], a[240:243]
  v_exp_f32 v191, v191
  v_mfma_f32_16x16x32_bf16 a[244:247], v[224:227], a[132:135], a[244:247]
  v_exp_f32 v192, v192
  v_mfma_f32_16x16x32_bf16 a[248:251], v[224:227], a[136:139], a[248:251]
  v_cvt_pk_bf16_f32 v186, v188, v189
  v_accvgpr_write_b32 a150, v186
  v_mfma_f32_16x16x32_bf16 a[252:255], v[224:227], a[140:143], a[252:255]
  s_waitcnt lgkmcnt(4)
  v_mfma_f32_16x16x32_bf16 v[144:147], v[248:251], v[80:83], v[144:147]
  v_exp_f32 v193, v193
  v_mfma_f32_16x16x32_bf16 v[152:155], v[248:251], v[84:87], v[152:155]
  v_cvt_pk_bf16_f32 v187, v190, v191
  v_accvgpr_write_b32 a151, v187
  v_mfma_f32_16x16x32_bf16 v[160:163], v[248:251], v[88:91], v[160:163]
  v_exp_f32 v194, v194
  v_mfma_f32_16x16x32_bf16 v[168:171], v[248:251], v[92:95], v[168:171]
  ds_read_b128 v[248:251], v1 offset:17120
  v_mfma_f32_16x16x32_bf16 v[148:151], v[252:255], v[80:83], v[148:151]
  v_exp_f32 v195, v195
  v_mfma_f32_16x16x32_bf16 v[156:159], v[252:255], v[84:87], v[156:159]
  v_exp_f32 v196, v196
  v_mfma_f32_16x16x32_bf16 v[164:167], v[252:255], v[88:91], v[164:167]
  v_exp_f32 v197, v197
  v_mfma_f32_16x16x32_bf16 v[172:175], v[252:255], v[92:95], v[172:175]
  ds_read_b128 v[252:255], v1 offset:17632
  s_waitcnt vmcnt(24)
  s_barrier
  s_waitcnt lgkmcnt(4)
  v_mfma_f32_16x16x32_bf16 v[144:147], v[232:235], v[96:99], v[144:147]
  s_mov_b32 s35, 65536
  v_cvt_pk_bf16_f32 v192, v192, v193
  v_cvt_pk_bf16_f32 v193, v194, v195
  v_mfma_f32_16x16x32_bf16 v[152:155], v[232:235], v[100:103], v[152:155]
  s_add_u32 m0, s34, 67584
  v_exp_f32 v198, v198
  v_mfma_f32_16x16x32_bf16 v[160:163], v[232:235], v[104:107], v[160:163]
  buffer_load_dwordx4 v10, s[12:15], s35 offen offset:0 nt lds
  v_mfma_f32_16x16x32_bf16 v[168:171], v[232:235], v[108:111], v[168:171]
  s_add_u32 m0, s34, 68128
  v_subrev_u32 v1, 50688, v1
  ds_read_b128 v[232:235], v1 offset:0
  v_mfma_f32_16x16x32_bf16 v[148:151], v[236:239], v[96:99], v[148:151]
  v_accvgpr_write_b32 a152, v192
  v_accvgpr_write_b32 a153, v193
  v_mfma_f32_16x16x32_bf16 v[156:159], v[236:239], v[100:103], v[156:159]
  v_exp_f32 v199, v199
  v_mfma_f32_16x16x32_bf16 v[164:167], v[236:239], v[104:107], v[164:167]
  v_exp_f32 v200, v200
  v_mfma_f32_16x16x32_bf16 v[172:175], v[236:239], v[108:111], v[172:175]
  ds_read_b128 v[236:239], v1 offset:512
  s_waitcnt lgkmcnt(4)
  v_mfma_f32_16x16x32_bf16 v[144:147], v[240:243], v[112:115], v[144:147]
  v_cvt_pk_bf16_f32 v194, v196, v197
  v_accvgpr_write_b32 a154, v194
  v_mfma_f32_16x16x32_bf16 v[152:155], v[240:243], v[116:119], v[152:155]
  v_exp_f32 v201, v201
  v_mfma_f32_16x16x32_bf16 v[160:163], v[240:243], v[120:123], v[160:163]
  v_cvt_pk_bf16_f32 v195, v198, v199
  v_accvgpr_write_b32 a155, v195
  v_mfma_f32_16x16x32_bf16 v[168:171], v[240:243], v[124:127], v[168:171]
  ds_read_b128 v[240:243], v1 offset:32
  buffer_load_dwordx4 v10, s[12:15], s35 offen offset:512 nt lds
  v_mfma_f32_16x16x32_bf16 v[148:151], v[244:247], v[112:115], v[148:151]
  s_add_u32 m0, s34, 68672
  v_exp_f32 v202, v202
  v_mfma_f32_16x16x32_bf16 v[156:159], v[244:247], v[116:119], v[156:159]
  v_exp_f32 v203, v203
  v_mfma_f32_16x16x32_bf16 v[164:167], v[244:247], v[120:123], v[164:167]
  v_exp_f32 v204, v204
  v_mfma_f32_16x16x32_bf16 v[172:175], v[244:247], v[124:127], v[172:175]
  ds_read_b128 v[244:247], v1 offset:544
  s_waitcnt lgkmcnt(4)
  v_mfma_f32_16x16x32_bf16 v[144:147], v[248:251], v[128:131], v[144:147]
  v_exp_f32 v205, v205
  v_mfma_f32_16x16x32_bf16 v[152:155], v[248:251], v[132:135], v[152:155]
  v_cvt_pk_bf16_f32 v200, v200, v201
  v_cvt_pk_bf16_f32 v201, v202, v203
  v_mfma_f32_16x16x32_bf16 v[160:163], v[248:251], v[136:139], v[160:163]
  v_exp_f32 v206, v206
  v_mfma_f32_16x16x32_bf16 v[168:171], v[248:251], v[140:143], v[168:171]
  ds_read_b128 v[248:251], v1 offset:64
  buffer_load_dwordx4 v10, s[12:15], s35 offen offset:1024 nt lds
  v_mfma_f32_16x16x32_bf16 v[148:151], v[252:255], v[128:131], v[148:151]
  s_add_u32 m0, s34, 69216
  v_accvgpr_write_b32 a156, v200
  v_accvgpr_write_b32 a157, v201
  v_mfma_f32_16x16x32_bf16 v[156:159], v[252:255], v[132:135], v[156:159]
  v_exp_f32 v207, v207
  v_mfma_f32_16x16x32_bf16 v[164:167], v[252:255], v[136:139], v[164:167]
  v_cvt_pk_bf16_f32 v202, v204, v205
  v_accvgpr_write_b32 a158, v202
  v_cvt_pk_bf16_f32 v203, v206, v207
  v_accvgpr_write_b32 a159, v203
  v_mfma_f32_16x16x32_bf16 v[172:175], v[252:255], v[140:143], v[172:175]
  ds_read_b128 v[252:255], v1 offset:576
  s_waitcnt lgkmcnt(4)
  v_mfma_f32_16x16x32_bf16 v[176:179], v[232:235], v[16:19], v[208:211]
  buffer_load_dwordx4 v10, s[12:15], s35 offen offset:1536 nt lds
  v_mfma_f32_16x16x32_bf16 v[184:187], v[232:235], v[20:23], v[212:215]
  v_mfma_f32_16x16x32_bf16 v[192:195], v[232:235], v[24:27], v[216:219]
  v_mfma_f32_16x16x32_bf16 v[200:203], v[232:235], v[28:31], v[220:223]
  ds_read_b128 v[232:235], v1 offset:96
  v_mfma_f32_16x16x32_bf16 v[180:183], v[236:239], v[16:19], v[208:211]
  v_exp_f32 v144, v144
  v_mfma_f32_16x16x32_bf16 v[188:191], v[236:239], v[20:23], v[212:215]
  v_exp_f32 v145, v145
  v_mfma_f32_16x16x32_bf16 v[196:199], v[236:239], v[24:27], v[216:219]
  v_exp_f32 v146, v146
  v_mfma_f32_16x16x32_bf16 v[204:207], v[236:239], v[28:31], v[220:223]
  ds_read_b128 v[236:239], v1 offset:608
  s_waitcnt lgkmcnt(4)
  v_mfma_f32_16x16x32_bf16 v[176:179], v[240:243], v[32:35], v[176:179]
  v_exp_f32 v147, v147
  v_mfma_f32_16x16x32_bf16 v[184:187], v[240:243], v[36:39], v[184:187]
  v_exp_f32 v148, v148
  v_mfma_f32_16x16x32_bf16 v[192:195], v[240:243], v[40:43], v[192:195]
  v_exp_f32 v149, v149
  v_mfma_f32_16x16x32_bf16 v[200:203], v[240:243], v[44:47], v[200:203]
  ds_read_b128 v[240:243], v1 offset:128
  v_mfma_f32_16x16x32_bf16 v[180:183], v[244:247], v[32:35], v[180:183]
  v_cvt_pk_bf16_f32 v144, v144, v145
  v_cvt_pk_bf16_f32 v145, v146, v147
  v_mfma_f32_16x16x32_bf16 v[188:191], v[244:247], v[36:39], v[188:191]
  v_exp_f32 v150, v150
  v_mfma_f32_16x16x32_bf16 v[196:199], v[244:247], v[40:43], v[196:199]
  v_accvgpr_write_b32 a160, v144
  v_accvgpr_write_b32 a161, v145
  v_mfma_f32_16x16x32_bf16 v[204:207], v[244:247], v[44:47], v[204:207]
  ds_read_b128 v[244:247], v1 offset:640
  s_waitcnt lgkmcnt(4)
  v_mfma_f32_16x16x32_bf16 v[176:179], v[248:251], v[48:51], v[176:179]
  v_exp_f32 v151, v151
  v_mfma_f32_16x16x32_bf16 v[184:187], v[248:251], v[52:55], v[184:187]
  v_exp_f32 v152, v152
  v_mfma_f32_16x16x32_bf16 v[192:195], v[248:251], v[56:59], v[192:195]
  v_cvt_pk_bf16_f32 v146, v148, v149
  v_accvgpr_write_b32 a162, v146
  v_mfma_f32_16x16x32_bf16 v[200:203], v[248:251], v[60:63], v[200:203]
  ds_read_b128 v[248:251], v1 offset:160
  v_mfma_f32_16x16x32_bf16 v[180:183], v[252:255], v[48:51], v[180:183]
  v_exp_f32 v153, v153
  v_mfma_f32_16x16x32_bf16 v[188:191], v[252:255], v[52:55], v[188:191]
  v_cvt_pk_bf16_f32 v147, v150, v151
  v_accvgpr_write_b32 a163, v147
  v_mfma_f32_16x16x32_bf16 v[196:199], v[252:255], v[56:59], v[196:199]
  v_exp_f32 v154, v154
  v_mfma_f32_16x16x32_bf16 v[204:207], v[252:255], v[60:63], v[204:207]
  ds_read_b128 v[252:255], v1 offset:672
  s_waitcnt lgkmcnt(4)
  v_mfma_f32_16x16x32_bf16 v[176:179], v[232:235], v[64:67], v[176:179]
  v_exp_f32 v155, v155
  v_mfma_f32_16x16x32_bf16 v[184:187], v[232:235], v[68:71], v[184:187]
  v_exp_f32 v156, v156
  v_mfma_f32_16x16x32_bf16 v[192:195], v[232:235], v[72:75], v[192:195]
  v_exp_f32 v157, v157
  v_mfma_f32_16x16x32_bf16 v[200:203], v[232:235], v[76:79], v[200:203]
  ds_read_b128 v[232:235], v1 offset:192
  v_mfma_f32_16x16x32_bf16 v[180:183], v[236:239], v[64:67], v[180:183]
  v_cvt_pk_bf16_f32 v152, v152, v153
  v_cvt_pk_bf16_f32 v153, v154, v155
  v_mfma_f32_16x16x32_bf16 v[188:191], v[236:239], v[68:71], v[188:191]
  v_exp_f32 v158, v158
  v_mfma_f32_16x16x32_bf16 v[196:199], v[236:239], v[72:75], v[196:199]
  v_accvgpr_write_b32 a164, v152
  v_accvgpr_write_b32 a165, v153
  v_mfma_f32_16x16x32_bf16 v[204:207], v[236:239], v[76:79], v[204:207]
  ds_read_b128 v[236:239], v1 offset:704
  v_mfma_f32_16x16x32_bf16 a[240:243], v[224:227], a[144:147], a[240:243]
  v_exp_f32 v159, v159
  v_mfma_f32_16x16x32_bf16 a[244:247], v[224:227], a[148:151], a[244:247]
  v_exp_f32 v160, v160
  v_mfma_f32_16x16x32_bf16 a[248:251], v[224:227], a[152:155], a[248:251]
  v_cvt_pk_bf16_f32 v154, v156, v157
  v_accvgpr_write_b32 a166, v154
  v_mfma_f32_16x16x32_bf16 a[252:255], v[224:227], a[156:159], a[252:255]
  s_waitcnt lgkmcnt(4)
  v_mfma_f32_16x16x32_bf16 v[176:179], v[240:243], v[80:83], v[176:179]
  v_exp_f32 v161, v161
  v_mfma_f32_16x16x32_bf16 v[184:187], v[240:243], v[84:87], v[184:187]
  v_cvt_pk_bf16_f32 v155, v158, v159
  v_accvgpr_write_b32 a167, v155
  v_mfma_f32_16x16x32_bf16 v[192:195], v[240:243], v[88:91], v[192:195]
  v_exp_f32 v162, v162
  v_mfma_f32_16x16x32_bf16 v[200:203], v[240:243], v[92:95], v[200:203]
  ds_read_b128 v[240:243], v1 offset:224
  v_mfma_f32_16x16x32_bf16 v[180:183], v[244:247], v[80:83], v[180:183]
  v_exp_f32 v163, v163
  v_mfma_f32_16x16x32_bf16 v[188:191], v[244:247], v[84:87], v[188:191]
  v_exp_f32 v164, v164
  v_mfma_f32_16x16x32_bf16 v[196:199], v[244:247], v[88:91], v[196:199]
  v_exp_f32 v165, v165
  v_mfma_f32_16x16x32_bf16 v[204:207], v[244:247], v[92:95], v[204:207]
  ds_read_b128 v[244:247], v1 offset:736
  s_waitcnt vmcnt(24)
  s_barrier
  s_waitcnt lgkmcnt(4)
  v_mfma_f32_16x16x32_bf16 v[176:179], v[248:251], v[96:99], v[176:179]
  s_mov_b32 s35, 98304
  v_cvt_pk_bf16_f32 v160, v160, v161
  v_cvt_pk_bf16_f32 v161, v162, v163
  v_mfma_f32_16x16x32_bf16 v[184:187], v[248:251], v[100:103], v[184:187]
  s_add_u32 m0, s34, 118272
  v_exp_f32 v166, v166
  v_mfma_f32_16x16x32_bf16 v[192:195], v[248:251], v[104:107], v[192:195]
  buffer_load_dwordx4 v10, s[12:15], s35 offen offset:0 nt lds
  v_mfma_f32_16x16x32_bf16 v[200:203], v[248:251], v[108:111], v[200:203]
  s_add_u32 m0, s34, 118816
  ds_read_b128 v[248:251], v1 offset:33792
  v_mfma_f32_16x16x32_bf16 v[180:183], v[252:255], v[96:99], v[180:183]
  v_accvgpr_write_b32 a168, v160
  v_accvgpr_write_b32 a169, v161
  v_mfma_f32_16x16x32_bf16 v[188:191], v[252:255], v[100:103], v[188:191]
  v_exp_f32 v167, v167
  v_mfma_f32_16x16x32_bf16 v[196:199], v[252:255], v[104:107], v[196:199]
  v_exp_f32 v168, v168
  v_mfma_f32_16x16x32_bf16 v[204:207], v[252:255], v[108:111], v[204:207]
  ds_read_b128 v[252:255], v1 offset:34304
  s_waitcnt lgkmcnt(4)
  v_mfma_f32_16x16x32_bf16 v[176:179], v[232:235], v[112:115], v[176:179]
  v_cvt_pk_bf16_f32 v162, v164, v165
  v_accvgpr_write_b32 a170, v162
  v_mfma_f32_16x16x32_bf16 v[184:187], v[232:235], v[116:119], v[184:187]
  v_exp_f32 v169, v169
  v_mfma_f32_16x16x32_bf16 v[192:195], v[232:235], v[120:123], v[192:195]
  v_cvt_pk_bf16_f32 v163, v166, v167
  v_accvgpr_write_b32 a171, v163
  v_mfma_f32_16x16x32_bf16 v[200:203], v[232:235], v[124:127], v[200:203]
  ds_read_b128 v[232:235], v1 offset:33824
  buffer_load_dwordx4 v10, s[12:15], s35 offen offset:512 nt lds
  v_mfma_f32_16x16x32_bf16 v[180:183], v[236:239], v[112:115], v[180:183]
  s_add_u32 m0, s34, 119360
  v_exp_f32 v170, v170
  v_mfma_f32_16x16x32_bf16 v[188:191], v[236:239], v[116:119], v[188:191]
  v_exp_f32 v171, v171
  v_mfma_f32_16x16x32_bf16 v[196:199], v[236:239], v[120:123], v[196:199]
  v_exp_f32 v172, v172
  v_mfma_f32_16x16x32_bf16 v[204:207], v[236:239], v[124:127], v[204:207]
  ds_read_b128 v[236:239], v1 offset:34336
  s_waitcnt lgkmcnt(4)
  v_mfma_f32_16x16x32_bf16 v[176:179], v[240:243], v[128:131], v[176:179]
  v_exp_f32 v173, v173
  v_mfma_f32_16x16x32_bf16 v[184:187], v[240:243], v[132:135], v[184:187]
  v_cvt_pk_bf16_f32 v168, v168, v169
  v_cvt_pk_bf16_f32 v169, v170, v171
  v_mfma_f32_16x16x32_bf16 v[192:195], v[240:243], v[136:139], v[192:195]
  v_exp_f32 v174, v174
  v_mfma_f32_16x16x32_bf16 v[200:203], v[240:243], v[140:143], v[200:203]
  ds_read_b128 v[240:243], v1 offset:33856
  buffer_load_dwordx4 v10, s[12:15], s35 offen offset:1024 nt lds
  v_mfma_f32_16x16x32_bf16 v[180:183], v[244:247], v[128:131], v[180:183]
  s_add_u32 m0, s34, 119904
  v_accvgpr_write_b32 a172, v168
  v_accvgpr_write_b32 a173, v169
  v_mfma_f32_16x16x32_bf16 v[188:191], v[244:247], v[132:135], v[188:191]
  v_exp_f32 v175, v175
  v_mfma_f32_16x16x32_bf16 v[196:199], v[244:247], v[136:139], v[196:199]
  v_cvt_pk_bf16_f32 v170, v172, v173
  v_accvgpr_write_b32 a174, v170
  v_cvt_pk_bf16_f32 v171, v174, v175
  v_accvgpr_write_b32 a175, v171
  v_mfma_f32_16x16x32_bf16 v[204:207], v[244:247], v[140:143], v[204:207]
  ds_read_b128 v[244:247], v1 offset:34368
  s_waitcnt lgkmcnt(4)
  v_mfma_f32_16x16x32_bf16 v[144:147], v[248:251], v[16:19], v[208:211]
  buffer_load_dwordx4 v10, s[12:15], s35 offen offset:1536 nt lds
  v_mfma_f32_16x16x32_bf16 v[152:155], v[248:251], v[20:23], v[212:215]
  v_mfma_f32_16x16x32_bf16 v[160:163], v[248:251], v[24:27], v[216:219]
  v_mfma_f32_16x16x32_bf16 v[168:171], v[248:251], v[28:31], v[220:223]
  ds_read_b128 v[248:251], v1 offset:33888
  v_mfma_f32_16x16x32_bf16 v[148:151], v[252:255], v[16:19], v[208:211]
  v_exp_f32 v176, v176
  v_mfma_f32_16x16x32_bf16 v[156:159], v[252:255], v[20:23], v[212:215]
  v_exp_f32 v177, v177
  v_mfma_f32_16x16x32_bf16 v[164:167], v[252:255], v[24:27], v[216:219]
  v_exp_f32 v178, v178
  v_mfma_f32_16x16x32_bf16 v[172:175], v[252:255], v[28:31], v[220:223]
  ds_read_b128 v[252:255], v1 offset:34400
  s_waitcnt lgkmcnt(4)
  v_mfma_f32_16x16x32_bf16 v[144:147], v[232:235], v[32:35], v[144:147]
  v_exp_f32 v179, v179
  v_mfma_f32_16x16x32_bf16 v[152:155], v[232:235], v[36:39], v[152:155]
  v_exp_f32 v180, v180
  v_mfma_f32_16x16x32_bf16 v[160:163], v[232:235], v[40:43], v[160:163]
  v_exp_f32 v181, v181
  v_mfma_f32_16x16x32_bf16 v[168:171], v[232:235], v[44:47], v[168:171]
  ds_read_b128 v[232:235], v1 offset:33920
  v_mfma_f32_16x16x32_bf16 v[148:151], v[236:239], v[32:35], v[148:151]
  v_cvt_pk_bf16_f32 v176, v176, v177
  v_cvt_pk_bf16_f32 v177, v178, v179
  v_mfma_f32_16x16x32_bf16 v[156:159], v[236:239], v[36:39], v[156:159]
  v_exp_f32 v182, v182
  v_mfma_f32_16x16x32_bf16 v[164:167], v[236:239], v[40:43], v[164:167]
  v_accvgpr_write_b32 a176, v176
  v_accvgpr_write_b32 a177, v177
  v_mfma_f32_16x16x32_bf16 v[172:175], v[236:239], v[44:47], v[172:175]
  ds_read_b128 v[236:239], v1 offset:34432
  s_waitcnt lgkmcnt(4)
  v_mfma_f32_16x16x32_bf16 v[144:147], v[240:243], v[48:51], v[144:147]
  v_exp_f32 v183, v183
  v_mfma_f32_16x16x32_bf16 v[152:155], v[240:243], v[52:55], v[152:155]
  v_exp_f32 v184, v184
  v_mfma_f32_16x16x32_bf16 v[160:163], v[240:243], v[56:59], v[160:163]
  v_cvt_pk_bf16_f32 v178, v180, v181
  v_accvgpr_write_b32 a178, v178
  v_mfma_f32_16x16x32_bf16 v[168:171], v[240:243], v[60:63], v[168:171]
  ds_read_b128 v[240:243], v1 offset:33952
  v_mfma_f32_16x16x32_bf16 v[148:151], v[244:247], v[48:51], v[148:151]
  v_exp_f32 v185, v185
  v_mfma_f32_16x16x32_bf16 v[156:159], v[244:247], v[52:55], v[156:159]
  v_cvt_pk_bf16_f32 v179, v182, v183
  v_accvgpr_write_b32 a179, v179
  v_mfma_f32_16x16x32_bf16 v[164:167], v[244:247], v[56:59], v[164:167]
  v_exp_f32 v186, v186
  v_mfma_f32_16x16x32_bf16 v[172:175], v[244:247], v[60:63], v[172:175]
  ds_read_b128 v[244:247], v1 offset:34464
  s_waitcnt lgkmcnt(4)
  v_mfma_f32_16x16x32_bf16 v[144:147], v[248:251], v[64:67], v[144:147]
  v_exp_f32 v187, v187
  v_mfma_f32_16x16x32_bf16 v[152:155], v[248:251], v[68:71], v[152:155]
  v_exp_f32 v188, v188
  v_mfma_f32_16x16x32_bf16 v[160:163], v[248:251], v[72:75], v[160:163]
  v_exp_f32 v189, v189
  v_mfma_f32_16x16x32_bf16 v[168:171], v[248:251], v[76:79], v[168:171]
  ds_read_b128 v[248:251], v1 offset:33984
  v_mfma_f32_16x16x32_bf16 v[148:151], v[252:255], v[64:67], v[148:151]
  v_cvt_pk_bf16_f32 v184, v184, v185
  v_cvt_pk_bf16_f32 v185, v186, v187
  v_mfma_f32_16x16x32_bf16 v[156:159], v[252:255], v[68:71], v[156:159]
  v_exp_f32 v190, v190
  v_mfma_f32_16x16x32_bf16 v[164:167], v[252:255], v[72:75], v[164:167]
  v_accvgpr_write_b32 a180, v184
  v_accvgpr_write_b32 a181, v185
  v_mfma_f32_16x16x32_bf16 v[172:175], v[252:255], v[76:79], v[172:175]
  ds_read_b128 v[252:255], v1 offset:34496
  v_mfma_f32_16x16x32_bf16 a[240:243], v[224:227], a[160:163], a[240:243]
  v_exp_f32 v191, v191
  v_mfma_f32_16x16x32_bf16 a[244:247], v[224:227], a[164:167], a[244:247]
  v_exp_f32 v192, v192
  v_mfma_f32_16x16x32_bf16 a[248:251], v[224:227], a[168:171], a[248:251]
  v_cvt_pk_bf16_f32 v186, v188, v189
  v_accvgpr_write_b32 a182, v186
  v_mfma_f32_16x16x32_bf16 a[252:255], v[224:227], a[172:175], a[252:255]
  s_waitcnt lgkmcnt(4)
  v_mfma_f32_16x16x32_bf16 v[144:147], v[232:235], v[80:83], v[144:147]
  v_exp_f32 v193, v193
  v_mfma_f32_16x16x32_bf16 v[152:155], v[232:235], v[84:87], v[152:155]
  v_cvt_pk_bf16_f32 v187, v190, v191
  v_accvgpr_write_b32 a183, v187
  v_mfma_f32_16x16x32_bf16 v[160:163], v[232:235], v[88:91], v[160:163]
  v_exp_f32 v194, v194
  v_mfma_f32_16x16x32_bf16 v[168:171], v[232:235], v[92:95], v[168:171]
  ds_read_b128 v[232:235], v1 offset:34016
  v_mfma_f32_16x16x32_bf16 v[148:151], v[236:239], v[80:83], v[148:151]
  v_exp_f32 v195, v195
  v_mfma_f32_16x16x32_bf16 v[156:159], v[236:239], v[84:87], v[156:159]
  v_exp_f32 v196, v196
  v_mfma_f32_16x16x32_bf16 v[164:167], v[236:239], v[88:91], v[164:167]
  v_exp_f32 v197, v197
  v_mfma_f32_16x16x32_bf16 v[172:175], v[236:239], v[92:95], v[172:175]
  ds_read_b128 v[236:239], v1 offset:34528
  s_waitcnt vmcnt(24)
  s_barrier
  s_waitcnt lgkmcnt(4)
  v_mfma_f32_16x16x32_bf16 v[144:147], v[240:243], v[96:99], v[144:147]
  s_mov_b32 s35, 131072
  v_cvt_pk_bf16_f32 v192, v192, v193
  v_cvt_pk_bf16_f32 v193, v194, v195
  v_mfma_f32_16x16x32_bf16 v[152:155], v[240:243], v[100:103], v[152:155]
  s_add_u32 m0, s34, 50688
  v_exp_f32 v198, v198
  v_mfma_f32_16x16x32_bf16 v[160:163], v[240:243], v[104:107], v[160:163]
  buffer_load_dwordx4 v10, s[12:15], s35 offen offset:0 nt lds
  v_mfma_f32_16x16x32_bf16 v[168:171], v[240:243], v[108:111], v[168:171]
  s_add_u32 m0, s34, 51232
  v_subrev_u32 v1, 50688, v1
  ds_read_b128 v[240:243], v1 offset:16896
  v_mfma_f32_16x16x32_bf16 v[148:151], v[244:247], v[96:99], v[148:151]
  v_accvgpr_write_b32 a184, v192
  v_accvgpr_write_b32 a185, v193
  v_mfma_f32_16x16x32_bf16 v[156:159], v[244:247], v[100:103], v[156:159]
  v_exp_f32 v199, v199
  v_mfma_f32_16x16x32_bf16 v[164:167], v[244:247], v[104:107], v[164:167]
  v_exp_f32 v200, v200
  v_mfma_f32_16x16x32_bf16 v[172:175], v[244:247], v[108:111], v[172:175]
  ds_read_b128 v[244:247], v1 offset:17408
  s_waitcnt lgkmcnt(4)
  v_mfma_f32_16x16x32_bf16 v[144:147], v[248:251], v[112:115], v[144:147]
  v_cvt_pk_bf16_f32 v194, v196, v197
  v_accvgpr_write_b32 a186, v194
  v_mfma_f32_16x16x32_bf16 v[152:155], v[248:251], v[116:119], v[152:155]
  v_exp_f32 v201, v201
  v_mfma_f32_16x16x32_bf16 v[160:163], v[248:251], v[120:123], v[160:163]
  v_cvt_pk_bf16_f32 v195, v198, v199
  v_accvgpr_write_b32 a187, v195
  v_mfma_f32_16x16x32_bf16 v[168:171], v[248:251], v[124:127], v[168:171]
  ds_read_b128 v[248:251], v1 offset:16928
  buffer_load_dwordx4 v10, s[12:15], s35 offen offset:512 nt lds
  v_mfma_f32_16x16x32_bf16 v[148:151], v[252:255], v[112:115], v[148:151]
  s_add_u32 m0, s34, 51776
  v_exp_f32 v202, v202
  v_mfma_f32_16x16x32_bf16 v[156:159], v[252:255], v[116:119], v[156:159]
  v_exp_f32 v203, v203
  v_mfma_f32_16x16x32_bf16 v[164:167], v[252:255], v[120:123], v[164:167]
  v_exp_f32 v204, v204
  v_mfma_f32_16x16x32_bf16 v[172:175], v[252:255], v[124:127], v[172:175]
  ds_read_b128 v[252:255], v1 offset:17440
  s_waitcnt lgkmcnt(4)
  v_mfma_f32_16x16x32_bf16 v[144:147], v[232:235], v[128:131], v[144:147]
  v_exp_f32 v205, v205
  v_mfma_f32_16x16x32_bf16 v[152:155], v[232:235], v[132:135], v[152:155]
  v_cvt_pk_bf16_f32 v200, v200, v201
  v_cvt_pk_bf16_f32 v201, v202, v203
  v_mfma_f32_16x16x32_bf16 v[160:163], v[232:235], v[136:139], v[160:163]
  v_exp_f32 v206, v206
  v_mfma_f32_16x16x32_bf16 v[168:171], v[232:235], v[140:143], v[168:171]
  ds_read_b128 v[232:235], v1 offset:16960
  buffer_load_dwordx4 v10, s[12:15], s35 offen offset:1024 nt lds
  v_mfma_f32_16x16x32_bf16 v[148:151], v[236:239], v[128:131], v[148:151]
  s_add_u32 m0, s34, 52320
  v_accvgpr_write_b32 a188, v200
  v_accvgpr_write_b32 a189, v201
  v_mfma_f32_16x16x32_bf16 v[156:159], v[236:239], v[132:135], v[156:159]
  v_exp_f32 v207, v207
  v_mfma_f32_16x16x32_bf16 v[164:167], v[236:239], v[136:139], v[164:167]
  v_cvt_pk_bf16_f32 v202, v204, v205
  v_accvgpr_write_b32 a190, v202
  v_cvt_pk_bf16_f32 v203, v206, v207
  v_accvgpr_write_b32 a191, v203
  v_mfma_f32_16x16x32_bf16 v[172:175], v[236:239], v[140:143], v[172:175]
  ds_read_b128 v[236:239], v1 offset:17472
  s_waitcnt lgkmcnt(4)
  v_mfma_f32_16x16x32_bf16 v[176:179], v[240:243], v[16:19], v[208:211]
  buffer_load_dwordx4 v10, s[12:15], s35 offen offset:1536 nt lds
  v_mfma_f32_16x16x32_bf16 v[184:187], v[240:243], v[20:23], v[212:215]
  v_mfma_f32_16x16x32_bf16 v[192:195], v[240:243], v[24:27], v[216:219]
  v_mfma_f32_16x16x32_bf16 v[200:203], v[240:243], v[28:31], v[220:223]
  ds_read_b128 v[240:243], v1 offset:16992
  v_mfma_f32_16x16x32_bf16 v[180:183], v[244:247], v[16:19], v[208:211]
  v_exp_f32 v144, v144
  v_mfma_f32_16x16x32_bf16 v[188:191], v[244:247], v[20:23], v[212:215]
  v_exp_f32 v145, v145
  v_mfma_f32_16x16x32_bf16 v[196:199], v[244:247], v[24:27], v[216:219]
  v_exp_f32 v146, v146
  v_mfma_f32_16x16x32_bf16 v[204:207], v[244:247], v[28:31], v[220:223]
  ds_read_b128 v[244:247], v1 offset:17504
  s_waitcnt lgkmcnt(4)
  v_mfma_f32_16x16x32_bf16 v[176:179], v[248:251], v[32:35], v[176:179]
  v_exp_f32 v147, v147
  v_mfma_f32_16x16x32_bf16 v[184:187], v[248:251], v[36:39], v[184:187]
  v_exp_f32 v148, v148
  v_mfma_f32_16x16x32_bf16 v[192:195], v[248:251], v[40:43], v[192:195]
  v_exp_f32 v149, v149
  v_mfma_f32_16x16x32_bf16 v[200:203], v[248:251], v[44:47], v[200:203]
  ds_read_b128 v[248:251], v1 offset:17024
  v_mfma_f32_16x16x32_bf16 v[180:183], v[252:255], v[32:35], v[180:183]
  v_cvt_pk_bf16_f32 v144, v144, v145
  v_cvt_pk_bf16_f32 v145, v146, v147
  v_mfma_f32_16x16x32_bf16 v[188:191], v[252:255], v[36:39], v[188:191]
  v_exp_f32 v150, v150
  v_mfma_f32_16x16x32_bf16 v[196:199], v[252:255], v[40:43], v[196:199]
  v_accvgpr_write_b32 a192, v144
  v_accvgpr_write_b32 a193, v145
  v_mfma_f32_16x16x32_bf16 v[204:207], v[252:255], v[44:47], v[204:207]
  ds_read_b128 v[252:255], v1 offset:17536
  s_waitcnt lgkmcnt(4)
  v_mfma_f32_16x16x32_bf16 v[176:179], v[232:235], v[48:51], v[176:179]
  v_exp_f32 v151, v151
  v_mfma_f32_16x16x32_bf16 v[184:187], v[232:235], v[52:55], v[184:187]
  v_exp_f32 v152, v152
  v_mfma_f32_16x16x32_bf16 v[192:195], v[232:235], v[56:59], v[192:195]
  v_cvt_pk_bf16_f32 v146, v148, v149
  v_accvgpr_write_b32 a194, v146
  v_mfma_f32_16x16x32_bf16 v[200:203], v[232:235], v[60:63], v[200:203]
  ds_read_b128 v[232:235], v1 offset:17056
  v_mfma_f32_16x16x32_bf16 v[180:183], v[236:239], v[48:51], v[180:183]
  v_exp_f32 v153, v153
  v_mfma_f32_16x16x32_bf16 v[188:191], v[236:239], v[52:55], v[188:191]
  v_cvt_pk_bf16_f32 v147, v150, v151
  v_accvgpr_write_b32 a195, v147
  v_mfma_f32_16x16x32_bf16 v[196:199], v[236:239], v[56:59], v[196:199]
  v_exp_f32 v154, v154
  v_mfma_f32_16x16x32_bf16 v[204:207], v[236:239], v[60:63], v[204:207]
  ds_read_b128 v[236:239], v1 offset:17568
  s_waitcnt lgkmcnt(4)
  v_mfma_f32_16x16x32_bf16 v[176:179], v[240:243], v[64:67], v[176:179]
  v_exp_f32 v155, v155
  v_mfma_f32_16x16x32_bf16 v[184:187], v[240:243], v[68:71], v[184:187]
  v_exp_f32 v156, v156
  v_mfma_f32_16x16x32_bf16 v[192:195], v[240:243], v[72:75], v[192:195]
  v_exp_f32 v157, v157
  v_mfma_f32_16x16x32_bf16 v[200:203], v[240:243], v[76:79], v[200:203]
  ds_read_b128 v[240:243], v1 offset:17088
  v_mfma_f32_16x16x32_bf16 v[180:183], v[244:247], v[64:67], v[180:183]
  v_cvt_pk_bf16_f32 v152, v152, v153
  v_cvt_pk_bf16_f32 v153, v154, v155
  v_mfma_f32_16x16x32_bf16 v[188:191], v[244:247], v[68:71], v[188:191]
  v_exp_f32 v158, v158
  v_mfma_f32_16x16x32_bf16 v[196:199], v[244:247], v[72:75], v[196:199]
  v_accvgpr_write_b32 a196, v152
  v_accvgpr_write_b32 a197, v153
  v_mfma_f32_16x16x32_bf16 v[204:207], v[244:247], v[76:79], v[204:207]
  ds_read_b128 v[244:247], v1 offset:17600
  v_mfma_f32_16x16x32_bf16 a[240:243], v[224:227], a[176:179], a[240:243]
  v_exp_f32 v159, v159
  v_mfma_f32_16x16x32_bf16 a[244:247], v[224:227], a[180:183], a[244:247]
  v_exp_f32 v160, v160
  v_mfma_f32_16x16x32_bf16 a[248:251], v[224:227], a[184:187], a[248:251]
  v_cvt_pk_bf16_f32 v154, v156, v157
  v_accvgpr_write_b32 a198, v154
  v_mfma_f32_16x16x32_bf16 a[252:255], v[224:227], a[188:191], a[252:255]
  s_waitcnt lgkmcnt(4)
  v_mfma_f32_16x16x32_bf16 v[176:179], v[248:251], v[80:83], v[176:179]
  v_exp_f32 v161, v161
  v_mfma_f32_16x16x32_bf16 v[184:187], v[248:251], v[84:87], v[184:187]
  v_cvt_pk_bf16_f32 v155, v158, v159
  v_accvgpr_write_b32 a199, v155
  v_mfma_f32_16x16x32_bf16 v[192:195], v[248:251], v[88:91], v[192:195]
  v_exp_f32 v162, v162
  v_mfma_f32_16x16x32_bf16 v[200:203], v[248:251], v[92:95], v[200:203]
  ds_read_b128 v[248:251], v1 offset:17120
  v_mfma_f32_16x16x32_bf16 v[180:183], v[252:255], v[80:83], v[180:183]
  v_exp_f32 v163, v163
  v_mfma_f32_16x16x32_bf16 v[188:191], v[252:255], v[84:87], v[188:191]
  v_exp_f32 v164, v164
  v_mfma_f32_16x16x32_bf16 v[196:199], v[252:255], v[88:91], v[196:199]
  v_exp_f32 v165, v165
  v_mfma_f32_16x16x32_bf16 v[204:207], v[252:255], v[92:95], v[204:207]
  ds_read_b128 v[252:255], v1 offset:17632
  s_waitcnt vmcnt(24)
  s_barrier
  s_waitcnt lgkmcnt(4)
  v_mfma_f32_16x16x32_bf16 v[176:179], v[232:235], v[96:99], v[176:179]
  s_mov_b32 s35, 163840
  v_cvt_pk_bf16_f32 v160, v160, v161
  v_cvt_pk_bf16_f32 v161, v162, v163
  v_mfma_f32_16x16x32_bf16 v[184:187], v[232:235], v[100:103], v[184:187]
  s_add_u32 m0, s34, 84480
  v_exp_f32 v166, v166
  v_mfma_f32_16x16x32_bf16 v[192:195], v[232:235], v[104:107], v[192:195]
  buffer_load_dwordx4 v10, s[12:15], s35 offen offset:0 nt lds
  v_mfma_f32_16x16x32_bf16 v[200:203], v[232:235], v[108:111], v[200:203]
  s_add_u32 m0, s34, 85024
  ds_read_b128 v[232:235], v1 offset:33792
  v_mfma_f32_16x16x32_bf16 v[180:183], v[236:239], v[96:99], v[180:183]
  v_accvgpr_write_b32 a200, v160
  v_accvgpr_write_b32 a201, v161
  v_mfma_f32_16x16x32_bf16 v[188:191], v[236:239], v[100:103], v[188:191]
  v_exp_f32 v167, v167
  v_mfma_f32_16x16x32_bf16 v[196:199], v[236:239], v[104:107], v[196:199]
  v_exp_f32 v168, v168
  v_mfma_f32_16x16x32_bf16 v[204:207], v[236:239], v[108:111], v[204:207]
  ds_read_b128 v[236:239], v1 offset:34304
  s_waitcnt lgkmcnt(4)
  v_mfma_f32_16x16x32_bf16 v[176:179], v[240:243], v[112:115], v[176:179]
  v_cvt_pk_bf16_f32 v162, v164, v165
  v_accvgpr_write_b32 a202, v162
  v_mfma_f32_16x16x32_bf16 v[184:187], v[240:243], v[116:119], v[184:187]
  v_exp_f32 v169, v169
  v_mfma_f32_16x16x32_bf16 v[192:195], v[240:243], v[120:123], v[192:195]
  v_cvt_pk_bf16_f32 v163, v166, v167
  v_accvgpr_write_b32 a203, v163
  v_mfma_f32_16x16x32_bf16 v[200:203], v[240:243], v[124:127], v[200:203]
  ds_read_b128 v[240:243], v1 offset:33824
  buffer_load_dwordx4 v10, s[12:15], s35 offen offset:512 nt lds
  v_mfma_f32_16x16x32_bf16 v[180:183], v[244:247], v[112:115], v[180:183]
  s_add_u32 m0, s34, 85568
  v_exp_f32 v170, v170
  v_mfma_f32_16x16x32_bf16 v[188:191], v[244:247], v[116:119], v[188:191]
  v_exp_f32 v171, v171
  v_mfma_f32_16x16x32_bf16 v[196:199], v[244:247], v[120:123], v[196:199]
  v_exp_f32 v172, v172
  v_mfma_f32_16x16x32_bf16 v[204:207], v[244:247], v[124:127], v[204:207]
  ds_read_b128 v[244:247], v1 offset:34336
  s_waitcnt lgkmcnt(4)
  v_mfma_f32_16x16x32_bf16 v[176:179], v[248:251], v[128:131], v[176:179]
  v_exp_f32 v173, v173
  v_mfma_f32_16x16x32_bf16 v[184:187], v[248:251], v[132:135], v[184:187]
  v_cvt_pk_bf16_f32 v168, v168, v169
  v_cvt_pk_bf16_f32 v169, v170, v171
  v_mfma_f32_16x16x32_bf16 v[192:195], v[248:251], v[136:139], v[192:195]
  v_exp_f32 v174, v174
  v_mfma_f32_16x16x32_bf16 v[200:203], v[248:251], v[140:143], v[200:203]
  ds_read_b128 v[248:251], v1 offset:33856
  buffer_load_dwordx4 v10, s[12:15], s35 offen offset:1024 nt lds
  v_mfma_f32_16x16x32_bf16 v[180:183], v[252:255], v[128:131], v[180:183]
  s_add_u32 m0, s34, 86112
  v_accvgpr_write_b32 a204, v168
  v_accvgpr_write_b32 a205, v169
  v_mfma_f32_16x16x32_bf16 v[188:191], v[252:255], v[132:135], v[188:191]
  v_exp_f32 v175, v175
  v_mfma_f32_16x16x32_bf16 v[196:199], v[252:255], v[136:139], v[196:199]
  v_cvt_pk_bf16_f32 v170, v172, v173
  v_accvgpr_write_b32 a206, v170
  v_cvt_pk_bf16_f32 v171, v174, v175
  v_accvgpr_write_b32 a207, v171
  v_mfma_f32_16x16x32_bf16 v[204:207], v[252:255], v[140:143], v[204:207]
  ds_read_b128 v[252:255], v1 offset:34368
  s_waitcnt lgkmcnt(4)
  v_mfma_f32_16x16x32_bf16 v[144:147], v[232:235], v[16:19], v[208:211]
  buffer_load_dwordx4 v10, s[12:15], s35 offen offset:1536 nt lds
  v_mfma_f32_16x16x32_bf16 v[152:155], v[232:235], v[20:23], v[212:215]
  v_mfma_f32_16x16x32_bf16 v[160:163], v[232:235], v[24:27], v[216:219]
  v_mfma_f32_16x16x32_bf16 v[168:171], v[232:235], v[28:31], v[220:223]
  ds_read_b128 v[232:235], v1 offset:33888
  v_mfma_f32_16x16x32_bf16 v[148:151], v[236:239], v[16:19], v[208:211]
  v_exp_f32 v176, v176
  v_mfma_f32_16x16x32_bf16 v[156:159], v[236:239], v[20:23], v[212:215]
  v_exp_f32 v177, v177
  v_mfma_f32_16x16x32_bf16 v[164:167], v[236:239], v[24:27], v[216:219]
  v_exp_f32 v178, v178
  v_mfma_f32_16x16x32_bf16 v[172:175], v[236:239], v[28:31], v[220:223]
  ds_read_b128 v[236:239], v1 offset:34400
  s_waitcnt lgkmcnt(4)
  v_mfma_f32_16x16x32_bf16 v[144:147], v[240:243], v[32:35], v[144:147]
  v_exp_f32 v179, v179
  v_mfma_f32_16x16x32_bf16 v[152:155], v[240:243], v[36:39], v[152:155]
  v_exp_f32 v180, v180
  v_mfma_f32_16x16x32_bf16 v[160:163], v[240:243], v[40:43], v[160:163]
  v_exp_f32 v181, v181
  v_mfma_f32_16x16x32_bf16 v[168:171], v[240:243], v[44:47], v[168:171]
  ds_read_b128 v[240:243], v1 offset:33920
  v_mfma_f32_16x16x32_bf16 v[148:151], v[244:247], v[32:35], v[148:151]
  v_cvt_pk_bf16_f32 v176, v176, v177
  v_cvt_pk_bf16_f32 v177, v178, v179
  v_mfma_f32_16x16x32_bf16 v[156:159], v[244:247], v[36:39], v[156:159]
  v_exp_f32 v182, v182
  v_mfma_f32_16x16x32_bf16 v[164:167], v[244:247], v[40:43], v[164:167]
  v_accvgpr_write_b32 a208, v176
  v_accvgpr_write_b32 a209, v177
  v_mfma_f32_16x16x32_bf16 v[172:175], v[244:247], v[44:47], v[172:175]
  ds_read_b128 v[244:247], v1 offset:34432
  s_waitcnt lgkmcnt(4)
  v_mfma_f32_16x16x32_bf16 v[144:147], v[248:251], v[48:51], v[144:147]
  v_exp_f32 v183, v183
  v_mfma_f32_16x16x32_bf16 v[152:155], v[248:251], v[52:55], v[152:155]
  v_exp_f32 v184, v184
  v_mfma_f32_16x16x32_bf16 v[160:163], v[248:251], v[56:59], v[160:163]
  v_cvt_pk_bf16_f32 v178, v180, v181
  v_accvgpr_write_b32 a210, v178
  v_mfma_f32_16x16x32_bf16 v[168:171], v[248:251], v[60:63], v[168:171]
  ds_read_b128 v[248:251], v1 offset:33952
  v_mfma_f32_16x16x32_bf16 v[148:151], v[252:255], v[48:51], v[148:151]
  v_exp_f32 v185, v185
  v_mfma_f32_16x16x32_bf16 v[156:159], v[252:255], v[52:55], v[156:159]
  v_cvt_pk_bf16_f32 v179, v182, v183
  v_accvgpr_write_b32 a211, v179
  v_mfma_f32_16x16x32_bf16 v[164:167], v[252:255], v[56:59], v[164:167]
  v_exp_f32 v186, v186
  v_mfma_f32_16x16x32_bf16 v[172:175], v[252:255], v[60:63], v[172:175]
  ds_read_b128 v[252:255], v1 offset:34464
  s_waitcnt lgkmcnt(4)
  v_mfma_f32_16x16x32_bf16 v[144:147], v[232:235], v[64:67], v[144:147]
  v_exp_f32 v187, v187
  v_mfma_f32_16x16x32_bf16 v[152:155], v[232:235], v[68:71], v[152:155]
  v_exp_f32 v188, v188
  v_mfma_f32_16x16x32_bf16 v[160:163], v[232:235], v[72:75], v[160:163]
  v_exp_f32 v189, v189
  v_mfma_f32_16x16x32_bf16 v[168:171], v[232:235], v[76:79], v[168:171]
  ds_read_b128 v[232:235], v1 offset:33984
  v_mfma_f32_16x16x32_bf16 v[148:151], v[236:239], v[64:67], v[148:151]
  v_cvt_pk_bf16_f32 v184, v184, v185
  v_cvt_pk_bf16_f32 v185, v186, v187
  v_mfma_f32_16x16x32_bf16 v[156:159], v[236:239], v[68:71], v[156:159]
  v_exp_f32 v190, v190
  v_mfma_f32_16x16x32_bf16 v[164:167], v[236:239], v[72:75], v[164:167]
  v_accvgpr_write_b32 a212, v184
  v_accvgpr_write_b32 a213, v185
  v_mfma_f32_16x16x32_bf16 v[172:175], v[236:239], v[76:79], v[172:175]
  ds_read_b128 v[236:239], v1 offset:34496
  v_mfma_f32_16x16x32_bf16 a[240:243], v[224:227], a[192:195], a[240:243]
  v_exp_f32 v191, v191
  v_mfma_f32_16x16x32_bf16 a[244:247], v[224:227], a[196:199], a[244:247]
  v_exp_f32 v192, v192
  v_mfma_f32_16x16x32_bf16 a[248:251], v[224:227], a[200:203], a[248:251]
  v_cvt_pk_bf16_f32 v186, v188, v189
  v_accvgpr_write_b32 a214, v186
  v_mfma_f32_16x16x32_bf16 a[252:255], v[224:227], a[204:207], a[252:255]
  s_waitcnt lgkmcnt(4)
  v_mfma_f32_16x16x32_bf16 v[144:147], v[240:243], v[80:83], v[144:147]
  v_exp_f32 v193, v193
  v_mfma_f32_16x16x32_bf16 v[152:155], v[240:243], v[84:87], v[152:155]
  v_cvt_pk_bf16_f32 v187, v190, v191
  v_accvgpr_write_b32 a215, v187
  v_mfma_f32_16x16x32_bf16 v[160:163], v[240:243], v[88:91], v[160:163]
  v_exp_f32 v194, v194
  v_mfma_f32_16x16x32_bf16 v[168:171], v[240:243], v[92:95], v[168:171]
  ds_read_b128 v[240:243], v1 offset:34016
  v_mfma_f32_16x16x32_bf16 v[148:151], v[244:247], v[80:83], v[148:151]
  v_exp_f32 v195, v195
  v_mfma_f32_16x16x32_bf16 v[156:159], v[244:247], v[84:87], v[156:159]
  v_exp_f32 v196, v196
  v_mfma_f32_16x16x32_bf16 v[164:167], v[244:247], v[88:91], v[164:167]
  v_exp_f32 v197, v197
  v_mfma_f32_16x16x32_bf16 v[172:175], v[244:247], v[92:95], v[172:175]
  ds_read_b128 v[244:247], v1 offset:34528
  s_waitcnt vmcnt(24)
  s_barrier
  s_waitcnt lgkmcnt(4)
  v_mfma_f32_16x16x32_bf16 v[144:147], v[248:251], v[96:99], v[144:147]
  s_mov_b32 s35, 196608
  v_cvt_pk_bf16_f32 v192, v192, v193
  v_cvt_pk_bf16_f32 v193, v194, v195
  v_mfma_f32_16x16x32_bf16 v[152:155], v[248:251], v[100:103], v[152:155]
  s_add_u32 m0, s34, 16896
  v_exp_f32 v198, v198
  v_mfma_f32_16x16x32_bf16 v[160:163], v[248:251], v[104:107], v[160:163]
  buffer_load_dwordx4 v10, s[12:15], s35 offen offset:0 nt lds
  v_mfma_f32_16x16x32_bf16 v[168:171], v[248:251], v[108:111], v[168:171]
  s_add_u32 m0, s34, 17440
  v_add_u32 v1, 101376, v1
  ds_read_b128 v[248:251], v1 offset:33792
  v_mfma_f32_16x16x32_bf16 v[148:151], v[252:255], v[96:99], v[148:151]
  v_accvgpr_write_b32 a216, v192
  v_accvgpr_write_b32 a217, v193
  v_mfma_f32_16x16x32_bf16 v[156:159], v[252:255], v[100:103], v[156:159]
  v_exp_f32 v199, v199
  v_mfma_f32_16x16x32_bf16 v[164:167], v[252:255], v[104:107], v[164:167]
  v_exp_f32 v200, v200
  v_mfma_f32_16x16x32_bf16 v[172:175], v[252:255], v[108:111], v[172:175]
  ds_read_b128 v[252:255], v1 offset:34304
  s_waitcnt lgkmcnt(4)
  v_mfma_f32_16x16x32_bf16 v[144:147], v[232:235], v[112:115], v[144:147]
  v_cvt_pk_bf16_f32 v194, v196, v197
  v_accvgpr_write_b32 a218, v194
  v_mfma_f32_16x16x32_bf16 v[152:155], v[232:235], v[116:119], v[152:155]
  v_exp_f32 v201, v201
  v_mfma_f32_16x16x32_bf16 v[160:163], v[232:235], v[120:123], v[160:163]
  v_cvt_pk_bf16_f32 v195, v198, v199
  v_accvgpr_write_b32 a219, v195
  v_mfma_f32_16x16x32_bf16 v[168:171], v[232:235], v[124:127], v[168:171]
  ds_read_b128 v[232:235], v1 offset:33824
  buffer_load_dwordx4 v10, s[12:15], s35 offen offset:512 nt lds
  v_mfma_f32_16x16x32_bf16 v[148:151], v[236:239], v[112:115], v[148:151]
  s_add_u32 m0, s34, 17984
  v_exp_f32 v202, v202
  v_mfma_f32_16x16x32_bf16 v[156:159], v[236:239], v[116:119], v[156:159]
  v_exp_f32 v203, v203
  v_mfma_f32_16x16x32_bf16 v[164:167], v[236:239], v[120:123], v[164:167]
  v_exp_f32 v204, v204
  v_mfma_f32_16x16x32_bf16 v[172:175], v[236:239], v[124:127], v[172:175]
  ds_read_b128 v[236:239], v1 offset:34336
  s_waitcnt lgkmcnt(4)
  v_mfma_f32_16x16x32_bf16 v[144:147], v[240:243], v[128:131], v[144:147]
  v_exp_f32 v205, v205
  v_mfma_f32_16x16x32_bf16 v[152:155], v[240:243], v[132:135], v[152:155]
  v_cvt_pk_bf16_f32 v200, v200, v201
  v_cvt_pk_bf16_f32 v201, v202, v203
  v_mfma_f32_16x16x32_bf16 v[160:163], v[240:243], v[136:139], v[160:163]
  v_exp_f32 v206, v206
  v_mfma_f32_16x16x32_bf16 v[168:171], v[240:243], v[140:143], v[168:171]
  ds_read_b128 v[240:243], v1 offset:33856
  buffer_load_dwordx4 v10, s[12:15], s35 offen offset:1024 nt lds
  v_mfma_f32_16x16x32_bf16 v[148:151], v[244:247], v[128:131], v[148:151]
  s_add_u32 m0, s34, 18528
  v_accvgpr_write_b32 a220, v200
  v_accvgpr_write_b32 a221, v201
  v_mfma_f32_16x16x32_bf16 v[156:159], v[244:247], v[132:135], v[156:159]
  v_exp_f32 v207, v207
  v_mfma_f32_16x16x32_bf16 v[164:167], v[244:247], v[136:139], v[164:167]
  v_cvt_pk_bf16_f32 v202, v204, v205
  v_accvgpr_write_b32 a222, v202
  v_cvt_pk_bf16_f32 v203, v206, v207
  v_accvgpr_write_b32 a223, v203
  v_mfma_f32_16x16x32_bf16 v[172:175], v[244:247], v[140:143], v[172:175]
  ds_read_b128 v[244:247], v1 offset:34368
  s_waitcnt lgkmcnt(4)
  v_mfma_f32_16x16x32_bf16 v[176:179], v[248:251], v[16:19], v[208:211]
  buffer_load_dwordx4 v10, s[12:15], s35 offen offset:1536 nt lds
  v_mfma_f32_16x16x32_bf16 v[184:187], v[248:251], v[20:23], v[212:215]
  v_mfma_f32_16x16x32_bf16 v[192:195], v[248:251], v[24:27], v[216:219]
  v_mfma_f32_16x16x32_bf16 v[200:203], v[248:251], v[28:31], v[220:223]
  ds_read_b128 v[248:251], v1 offset:33888
  v_mfma_f32_16x16x32_bf16 v[180:183], v[252:255], v[16:19], v[208:211]
  v_exp_f32 v144, v144
  v_mfma_f32_16x16x32_bf16 v[188:191], v[252:255], v[20:23], v[212:215]
  v_exp_f32 v145, v145
  v_mfma_f32_16x16x32_bf16 v[196:199], v[252:255], v[24:27], v[216:219]
  v_exp_f32 v146, v146
  v_mfma_f32_16x16x32_bf16 v[204:207], v[252:255], v[28:31], v[220:223]
  ds_read_b128 v[252:255], v1 offset:34400
  s_waitcnt lgkmcnt(4)
  v_mfma_f32_16x16x32_bf16 v[176:179], v[232:235], v[32:35], v[176:179]
  v_exp_f32 v147, v147
  v_mfma_f32_16x16x32_bf16 v[184:187], v[232:235], v[36:39], v[184:187]
  v_exp_f32 v148, v148
  v_mfma_f32_16x16x32_bf16 v[192:195], v[232:235], v[40:43], v[192:195]
  v_exp_f32 v149, v149
  v_mfma_f32_16x16x32_bf16 v[200:203], v[232:235], v[44:47], v[200:203]
  ds_read_b128 v[232:235], v1 offset:33920
  v_mfma_f32_16x16x32_bf16 v[180:183], v[236:239], v[32:35], v[180:183]
  v_cvt_pk_bf16_f32 v144, v144, v145
  v_cvt_pk_bf16_f32 v145, v146, v147
  v_mfma_f32_16x16x32_bf16 v[188:191], v[236:239], v[36:39], v[188:191]
  v_exp_f32 v150, v150
  v_mfma_f32_16x16x32_bf16 v[196:199], v[236:239], v[40:43], v[196:199]
  v_accvgpr_write_b32 a224, v144
  v_accvgpr_write_b32 a225, v145
  v_mfma_f32_16x16x32_bf16 v[204:207], v[236:239], v[44:47], v[204:207]
  ds_read_b128 v[236:239], v1 offset:34432
  s_waitcnt lgkmcnt(4)
  v_mfma_f32_16x16x32_bf16 v[176:179], v[240:243], v[48:51], v[176:179]
  v_exp_f32 v151, v151
  v_mfma_f32_16x16x32_bf16 v[184:187], v[240:243], v[52:55], v[184:187]
  v_exp_f32 v152, v152
  v_mfma_f32_16x16x32_bf16 v[192:195], v[240:243], v[56:59], v[192:195]
  v_cvt_pk_bf16_f32 v146, v148, v149
  v_accvgpr_write_b32 a226, v146
  v_mfma_f32_16x16x32_bf16 v[200:203], v[240:243], v[60:63], v[200:203]
  ds_read_b128 v[240:243], v1 offset:33952
  v_mfma_f32_16x16x32_bf16 v[180:183], v[244:247], v[48:51], v[180:183]
  v_exp_f32 v153, v153
  v_mfma_f32_16x16x32_bf16 v[188:191], v[244:247], v[52:55], v[188:191]
  v_cvt_pk_bf16_f32 v147, v150, v151
  v_accvgpr_write_b32 a227, v147
  v_mfma_f32_16x16x32_bf16 v[196:199], v[244:247], v[56:59], v[196:199]
  v_exp_f32 v154, v154
  v_mfma_f32_16x16x32_bf16 v[204:207], v[244:247], v[60:63], v[204:207]
  ds_read_b128 v[244:247], v1 offset:34464
  s_waitcnt lgkmcnt(4)
  v_mfma_f32_16x16x32_bf16 v[176:179], v[248:251], v[64:67], v[176:179]
  v_exp_f32 v155, v155
  v_mfma_f32_16x16x32_bf16 v[184:187], v[248:251], v[68:71], v[184:187]
  v_exp_f32 v156, v156
  v_mfma_f32_16x16x32_bf16 v[192:195], v[248:251], v[72:75], v[192:195]
  v_exp_f32 v157, v157
  v_mfma_f32_16x16x32_bf16 v[200:203], v[248:251], v[76:79], v[200:203]
  ds_read_b128 v[248:251], v1 offset:33984
  v_mfma_f32_16x16x32_bf16 v[180:183], v[252:255], v[64:67], v[180:183]
  v_cvt_pk_bf16_f32 v152, v152, v153
  v_cvt_pk_bf16_f32 v153, v154, v155
  v_mfma_f32_16x16x32_bf16 v[188:191], v[252:255], v[68:71], v[188:191]
  v_exp_f32 v158, v158
  v_mfma_f32_16x16x32_bf16 v[196:199], v[252:255], v[72:75], v[196:199]
  v_accvgpr_write_b32 a228, v152
  v_accvgpr_write_b32 a229, v153
  v_mfma_f32_16x16x32_bf16 v[204:207], v[252:255], v[76:79], v[204:207]
  ds_read_b128 v[252:255], v1 offset:34496
  v_mfma_f32_16x16x32_bf16 a[240:243], v[224:227], a[208:211], a[240:243]
  v_exp_f32 v159, v159
  v_mfma_f32_16x16x32_bf16 a[244:247], v[224:227], a[212:215], a[244:247]
  v_exp_f32 v160, v160
  v_mfma_f32_16x16x32_bf16 a[248:251], v[224:227], a[216:219], a[248:251]
  v_cvt_pk_bf16_f32 v154, v156, v157
  v_accvgpr_write_b32 a230, v154
  v_mfma_f32_16x16x32_bf16 a[252:255], v[224:227], a[220:223], a[252:255]
  s_waitcnt lgkmcnt(4)
  v_mfma_f32_16x16x32_bf16 v[176:179], v[232:235], v[80:83], v[176:179]
  v_exp_f32 v161, v161
  v_mfma_f32_16x16x32_bf16 v[184:187], v[232:235], v[84:87], v[184:187]
  v_cvt_pk_bf16_f32 v155, v158, v159
  v_accvgpr_write_b32 a231, v155
  v_mfma_f32_16x16x32_bf16 v[192:195], v[232:235], v[88:91], v[192:195]
  v_exp_f32 v162, v162
  v_mfma_f32_16x16x32_bf16 v[200:203], v[232:235], v[92:95], v[200:203]
  ds_read_b128 v[232:235], v1 offset:34016
  v_mfma_f32_16x16x32_bf16 v[180:183], v[236:239], v[80:83], v[180:183]
  v_exp_f32 v163, v163
  v_mfma_f32_16x16x32_bf16 v[188:191], v[236:239], v[84:87], v[188:191]
  v_exp_f32 v164, v164
  v_mfma_f32_16x16x32_bf16 v[196:199], v[236:239], v[88:91], v[196:199]
  v_exp_f32 v165, v165
  v_mfma_f32_16x16x32_bf16 v[204:207], v[236:239], v[92:95], v[204:207]
  ds_read_b128 v[236:239], v1 offset:34528
  s_waitcnt vmcnt(24)
  s_barrier
  s_waitcnt lgkmcnt(4)
  v_mfma_f32_16x16x32_bf16 v[176:179], v[240:243], v[96:99], v[176:179]
  s_mov_b32 s35, 229376
  v_cvt_pk_bf16_f32 v160, v160, v161
  v_cvt_pk_bf16_f32 v161, v162, v163
  v_mfma_f32_16x16x32_bf16 v[184:187], v[240:243], v[100:103], v[184:187]
  s_add_u32 m0, s34, 33792
  v_exp_f32 v166, v166
  v_mfma_f32_16x16x32_bf16 v[192:195], v[240:243], v[104:107], v[192:195]
  buffer_load_dwordx4 v10, s[12:15], s35 offen offset:0 nt lds
  v_mfma_f32_16x16x32_bf16 v[200:203], v[240:243], v[108:111], v[200:203]
  s_add_u32 m0, s34, 34336
  ds_read_b64_tr_b16 v[240:241], v0 offset:0
  v_mfma_f32_16x16x32_bf16 v[180:183], v[244:247], v[96:99], v[180:183]
  ds_read_b64_tr_b16 v[242:243], v0 offset:256
  v_mfma_f32_16x16x32_bf16 v[188:191], v[244:247], v[100:103], v[188:191]
  v_accvgpr_write_b32 a232, v160
  v_accvgpr_write_b32 a233, v161
  v_mfma_f32_16x16x32_bf16 v[196:199], v[244:247], v[104:107], v[196:199]
  v_exp_f32 v167, v167
  v_mfma_f32_16x16x32_bf16 v[204:207], v[244:247], v[108:111], v[204:207]
  ds_read_b64_tr_b16 v[244:245], v0 offset:512
  s_waitcnt lgkmcnt(5)
  v_mfma_f32_16x16x32_bf16 v[176:179], v[248:251], v[112:115], v[176:179]
  ds_read_b64_tr_b16 v[246:247], v0 offset:768
  buffer_load_dwordx4 v10, s[12:15], s35 offen offset:512 nt lds
  v_mfma_f32_16x16x32_bf16 v[184:187], v[248:251], v[116:119], v[184:187]
  s_add_u32 m0, s34, 34880
  v_exp_f32 v168, v168
  v_mfma_f32_16x16x32_bf16 v[192:195], v[248:251], v[120:123], v[192:195]
  v_cvt_pk_bf16_f32 v162, v164, v165
  v_accvgpr_write_b32 a234, v162
  v_mfma_f32_16x16x32_bf16 v[200:203], v[248:251], v[124:127], v[200:203]
  ds_read_b64_tr_b16 v[248:249], v0 offset:32
  v_mfma_f32_16x16x32_bf16 v[180:183], v[252:255], v[112:115], v[180:183]
  ds_read_b64_tr_b16 v[250:251], v0 offset:288
  v_mfma_f32_16x16x32_bf16 v[188:191], v[252:255], v[116:119], v[188:191]
  v_exp_f32 v169, v169
  v_mfma_f32_16x16x32_bf16 v[196:199], v[252:255], v[120:123], v[196:199]
  v_cvt_pk_bf16_f32 v163, v166, v167
  v_accvgpr_write_b32 a235, v163
  v_mfma_f32_16x16x32_bf16 v[204:207], v[252:255], v[124:127], v[204:207]
  ds_read_b64_tr_b16 v[252:253], v0 offset:544
  s_waitcnt lgkmcnt(7)
  v_mfma_f32_16x16x32_bf16 v[176:179], v[232:235], v[128:131], v[176:179]
  ds_read_b64_tr_b16 v[254:255], v0 offset:800
  buffer_load_dwordx4 v10, s[12:15], s35 offen offset:1024 nt lds
  v_mfma_f32_16x16x32_bf16 v[184:187], v[232:235], v[132:135], v[184:187]
  s_add_u32 m0, s34, 35424
  v_exp_f32 v170, v170
  v_mfma_f32_16x16x32_bf16 v[192:195], v[232:235], v[136:139], v[192:195]
  v_exp_f32 v171, v171
  v_mfma_f32_16x16x32_bf16 v[200:203], v[232:235], v[140:143], v[200:203]
  ds_read_b64_tr_b16 v[232:233], v0 offset:64
  v_mfma_f32_16x16x32_bf16 v[180:183], v[236:239], v[128:131], v[180:183]
  ds_read_b64_tr_b16 v[234:235], v0 offset:320
  v_mfma_f32_16x16x32_bf16 v[188:191], v[236:239], v[132:135], v[188:191]
  v_exp_f32 v172, v172
  v_mfma_f32_16x16x32_bf16 v[196:199], v[236:239], v[136:139], v[196:199]
  v_exp_f32 v173, v173
  v_cvt_pk_bf16_f32 v168, v168, v169
  v_cvt_pk_bf16_f32 v169, v170, v171
  v_exp_f32 v174, v174
  v_accvgpr_write_b32 a236, v168
  v_accvgpr_write_b32 a237, v169
  v_exp_f32 v175, v175
  v_cvt_pk_bf16_f32 v170, v172, v173
  v_accvgpr_write_b32 a238, v170
  v_cvt_pk_bf16_f32 v171, v174, v175
  v_accvgpr_write_b32 a239, v171
  v_mfma_f32_16x16x32_bf16 v[204:207], v[236:239], v[140:143], v[204:207]
  ds_read_b64_tr_b16 v[236:237], v0 offset:576
  buffer_load_dwordx4 v10, s[12:15], s35 offen offset:1536 nt lds
  v_mfma_f32_16x16x32_bf16 a[240:243], v[224:227], a[224:227], a[240:243]
  ds_read_b64_tr_b16 v[238:239], v0 offset:832
  v_mfma_f32_16x16x32_bf16 a[244:247], v[224:227], a[228:231], a[244:247]
  v_mfma_f32_16x16x32_bf16 a[248:251], v[224:227], a[232:235], a[248:251]
  v_mfma_f32_16x16x32_bf16 a[252:255], v[224:227], a[236:239], a[252:255]
  v_max3_f32 v14, v176, v177, v178
  v_max3_f32 v15, v192, v193, v194
  v_max3_f32 v14, v14, v179, v180
  v_max3_f32 v15, v15, v195, v196
  v_max3_f32 v14, v14, v181, v182
  v_max3_f32 v15, v15, v197, v198
  v_max3_f32 v14, v14, v183, v184
  v_max3_f32 v15, v15, v199, v200
  v_max3_f32 v14, v14, v185, v186
  v_max3_f32 v15, v15, v201, v202
  v_max3_f32 v14, v14, v187, v188
  v_max3_f32 v15, v15, v203, v204
  v_max3_f32 v14, v14, v189, v190
  v_max3_f32 v15, v15, v205, v206
  v_max3_f32 v14, v14, v191, v207
  v_max_f32 v14, v14, v15
  v_accvgpr_read_b32 v6, a240
  v_accvgpr_read_b32 v7, a244
  v_accvgpr_read_b32 v8, a248
  v_accvgpr_read_b32 v9, a252
  v_cmp_lt_f32 s[56:57], 4.0, v14
  v_max3_f32 v15, v6, v7, v8
  v_max_f32 v15, v15, v9
  v_cmp_lt_f32 vcc, s36, v15
  s_nop 0
  s_or_b64 vcc, vcc, s[56:57]
  s_cbranch_vccnz mha_attn_kernel_redo
mha_attn_kernel_ret:
  s_waitcnt lgkmcnt(8)
  v_mfma_f32_16x16x32_bf16 v[16:19], v[240:243], a[0:3], 0
  v_mfma_f32_16x16x32_bf16 v[20:23], v[240:243], a[4:7], 0
  v_exp_f32 v176, v176
  v_mfma_f32_16x16x32_bf16 v[24:27], v[240:243], a[8:11], 0
  v_mfma_f32_16x16x32_bf16 v[28:31], v[240:243], a[12:15], 0
  ds_read_b64_tr_b16 v[240:241], v0 offset:96
  v_mfma_f32_16x16x32_bf16 v[16:19], v[244:247], a[16:19], v[16:19]
  ds_read_b64_tr_b16 v[242:243], v0 offset:352
  v_mfma_f32_16x16x32_bf16 v[20:23], v[244:247], a[20:23], v[20:23]
  v_exp_f32 v177, v177
  v_mfma_f32_16x16x32_bf16 v[24:27], v[244:247], a[24:27], v[24:27]
  v_exp_f32 v178, v178
  v_mfma_f32_16x16x32_bf16 v[28:31], v[244:247], a[28:31], v[28:31]
  ds_read_b64_tr_b16 v[244:245], v0 offset:608
  s_waitcnt lgkmcnt(7)
  v_mfma_f32_16x16x32_bf16 v[32:35], v[248:251], a[0:3], 0
  ds_read_b64_tr_b16 v[246:247], v0 offset:864
  v_mfma_f32_16x16x32_bf16 v[36:39], v[248:251], a[4:7], 0
  v_exp_f32 v179, v179
  v_mfma_f32_16x16x32_bf16 v[40:43], v[248:251], a[8:11], 0
  v_exp_f32 v180, v180
  v_mfma_f32_16x16x32_bf16 v[44:47], v[248:251], a[12:15], 0
  ds_read_b64_tr_b16 v[248:249], v0 offset:128
  v_mfma_f32_16x16x32_bf16 v[32:35], v[252:255], a[16:19], v[32:35]
  ds_read_b64_tr_b16 v[250:251], v0 offset:384
  v_mfma_f32_16x16x32_bf16 v[36:39], v[252:255], a[20:23], v[36:39]
  v_exp_f32 v181, v181
  v_mfma_f32_16x16x32_bf16 v[40:43], v[252:255], a[24:27], v[40:43]
  v_cvt_pk_bf16_f32 v176, v176, v177
  v_cvt_pk_bf16_f32 v177, v178, v179
  v_mfma_f32_16x16x32_bf16 v[44:47], v[252:255], a[28:31], v[44:47]
  ds_read_b64_tr_b16 v[252:253], v0 offset:640
  s_waitcnt lgkmcnt(7)
  v_mfma_f32_16x16x32_bf16 v[48:51], v[232:235], a[0:3], 0
  ds_read_b64_tr_b16 v[254:255], v0 offset:896
  v_mfma_f32_16x16x32_bf16 v[52:55], v[232:235], a[4:7], 0
  v_exp_f32 v182, v182
  v_mfma_f32_16x16x32_bf16 v[56:59], v[232:235], a[8:11], 0
  v_accvgpr_write_b32 a240, v176
  v_accvgpr_write_b32 a241, v177
  v_mfma_f32_16x16x32_bf16 v[60:63], v[232:235], a[12:15], 0
  ds_read_b64_tr_b16 v[232:233], v0 offset:160
  v_mfma_f32_16x16x32_bf16 v[48:51], v[236:239], a[16:19], v[48:51]
  ds_read_b64_tr_b16 v[234:235], v0 offset:416
  v_mfma_f32_16x16x32_bf16 v[52:55], v[236:239], a[20:23], v[52:55]
  v_exp_f32 v183, v183
  v_mfma_f32_16x16x32_bf16 v[56:59], v[236:239], a[24:27], v[56:59]
  v_exp_f32 v184, v184
  v_mfma_f32_16x16x32_bf16 v[60:63], v[236:239], a[28:31], v[60:63]
  ds_read_b64_tr_b16 v[236:237], v0 offset:672
  s_waitcnt lgkmcnt(7)
  v_mfma_f32_16x16x32_bf16 v[64:67], v[240:243], a[0:3], 0
  ds_read_b64_tr_b16 v[238:239], v0 offset:928
  v_mfma_f32_16x16x32_bf16 v[68:71], v[240:243], a[4:7], 0
  v_cvt_pk_bf16_f32 v178, v180, v181
  v_accvgpr_write_b32 a242, v178
  v_mfma_f32_16x16x32_bf16 v[72:75], v[240:243], a[8:11], 0
  v_exp_f32 v185, v185
  v_mfma_f32_16x16x32_bf16 v[76:79], v[240:243], a[12:15], 0
  ds_read_b64_tr_b16 v[240:241], v0 offset:192
  v_mfma_f32_16x16x32_bf16 v[64:67], v[244:247], a[16:19], v[64:67]
  ds_read_b64_tr_b16 v[242:243], v0 offset:448
  v_mfma_f32_16x16x32_bf16 v[68:71], v[244:247], a[20:23], v[68:71]
  v_cvt_pk_bf16_f32 v179, v182, v183
  v_accvgpr_write_b32 a243, v179
  v_mfma_f32_16x16x32_bf16 v[72:75], v[244:247], a[24:27], v[72:75]
  v_exp_f32 v186, v186
  v_mfma_f32_16x16x32_bf16 v[76:79], v[244:247], a[28:31], v[76:79]
  ds_read_b64_tr_b16 v[244:245], v0 offset:704
  s_waitcnt lgkmcnt(7)
  v_mfma_f32_16x16x32_bf16 v[80:83], v[248:251], a[0:3], 0
  ds_read_b64_tr_b16 v[246:247], v0 offset:960
  v_mfma_f32_16x16x32_bf16 v[84:87], v[248:251], a[4:7], 0
  v_exp_f32 v187, v187
  v_mfma_f32_16x16x32_bf16 v[88:91], v[248:251], a[8:11], 0
  v_exp_f32 v188, v188
  v_mfma_f32_16x16x32_bf16 v[92:95], v[248:251], a[12:15], 0
  ds_read_b64_tr_b16 v[248:249], v0 offset:224
  v_mfma_f32_16x16x32_bf16 v[80:83], v[252:255], a[16:19], v[80:83]
  ds_read_b64_tr_b16 v[250:251], v0 offset:480
  v_mfma_f32_16x16x32_bf16 v[84:87], v[252:255], a[20:23], v[84:87]
  v_exp_f32 v189, v189
  v_mfma_f32_16x16x32_bf16 v[88:91], v[252:255], a[24:27], v[88:91]
  v_cvt_pk_bf16_f32 v184, v184, v185
  v_cvt_pk_bf16_f32 v185, v186, v187
  v_mfma_f32_16x16x32_bf16 v[92:95], v[252:255], a[28:31], v[92:95]
  ds_read_b64_tr_b16 v[252:253], v0 offset:736
  s_waitcnt vmcnt(24)
  s_barrier
  s_waitcnt lgkmcnt(7)
  v_mfma_f32_16x16x32_bf16 v[96:99], v[232:235], a[0:3], 0
  s_mov_b32 s35, 256
  ds_read_b64_tr_b16 v[254:255], v0 offset:992
  v_mfma_f32_16x16x32_bf16 v[100:103], v[232:235], a[4:7], 0
  s_add_u32 m0, s34, 135168
  v_exp_f32 v190, v190
  v_mfma_f32_16x16x32_bf16 v[104:107], v[232:235], a[8:11], 0
  buffer_load_dwordx4 v10, s[12:15], s35 offen offset:0 nt lds
  v_mfma_f32_16x16x32_bf16 v[108:111], v[232:235], a[12:15], 0
  s_add_u32 m0, s34, 135712
  v_add_u32 v0, 101376, v0
  ds_read_b64_tr_b16 v[232:233], v0 offset:0
  v_mfma_f32_16x16x32_bf16 v[96:99], v[236:239], a[16:19], v[96:99]
  ds_read_b64_tr_b16 v[234:235], v0 offset:256
  v_mfma_f32_16x16x32_bf16 v[100:103], v[236:239], a[20:23], v[100:103]
  v_accvgpr_write_b32 a244, v184
  v_accvgpr_write_b32 a245, v185
  v_mfma_f32_16x16x32_bf16 v[104:107], v[236:239], a[24:27], v[104:107]
  v_exp_f32 v191, v191
  v_mfma_f32_16x16x32_bf16 v[108:111], v[236:239], a[28:31], v[108:111]
  ds_read_b64_tr_b16 v[236:237], v0 offset:512
  s_waitcnt lgkmcnt(7)
  v_mfma_f32_16x16x32_bf16 v[112:115], v[240:243], a[0:3], 0
  ds_read_b64_tr_b16 v[238:239], v0 offset:768
  buffer_load_dwordx4 v10, s[12:15], s35 offen offset:512 nt lds
  v_mfma_f32_16x16x32_bf16 v[116:119], v[240:243], a[4:7], 0
  s_add_u32 m0, s34, 136256
  v_exp_f32 v192, v192
  v_mfma_f32_16x16x32_bf16 v[120:123], v[240:243], a[8:11], 0
  v_cvt_pk_bf16_f32 v186, v188, v189
  v_accvgpr_write_b32 a246, v186
  v_mfma_f32_16x16x32_bf16 v[124:127], v[240:243], a[12:15], 0
  ds_read_b64_tr_b16 v[240:241], v0 offset:32
  v_mfma_f32_16x16x32_bf16 v[112:115], v[244:247], a[16:19], v[112:115]
  ds_read_b64_tr_b16 v[242:243], v0 offset:288
  v_mfma_f32_16x16x32_bf16 v[116:119], v[244:247], a[20:23], v[116:119]
  v_exp_f32 v193, v193
  v_mfma_f32_16x16x32_bf16 v[120:123], v[244:247], a[24:27], v[120:123]
  v_cvt_pk_bf16_f32 v187, v190, v191
  v_accvgpr_write_b32 a247, v187
  v_mfma_f32_16x16x32_bf16 v[124:127], v[244:247], a[28:31], v[124:127]
  ds_read_b64_tr_b16 v[244:245], v0 offset:544
  s_waitcnt lgkmcnt(7)
  v_mfma_f32_16x16x32_bf16 v[128:131], v[248:251], a[0:3], 0
  ds_read_b64_tr_b16 v[246:247], v0 offset:800
  buffer_load_dwordx4 v10, s[12:15], s35 offen offset:1024 nt lds
  v_mfma_f32_16x16x32_bf16 v[132:135], v[248:251], a[4:7], 0
  s_add_u32 m0, s34, 136800
  v_exp_f32 v194, v194
  v_mfma_f32_16x16x32_bf16 v[136:139], v[248:251], a[8:11], 0
  v_exp_f32 v195, v195
  v_mfma_f32_16x16x32_bf16 v[140:143], v[248:251], a[12:15], 0
  ds_read_b64_tr_b16 v[248:249], v0 offset:64
  v_mfma_f32_16x16x32_bf16 v[128:131], v[252:255], a[16:19], v[128:131]
  ds_read_b64_tr_b16 v[250:251], v0 offset:320
  v_mfma_f32_16x16x32_bf16 v[132:135], v[252:255], a[20:23], v[132:135]
  v_exp_f32 v196, v196
  v_mfma_f32_16x16x32_bf16 v[136:139], v[252:255], a[24:27], v[136:139]
  v_exp_f32 v197, v197
  v_mfma_f32_16x16x32_bf16 v[140:143], v[252:255], a[28:31], v[140:143]
  ds_read_b64_tr_b16 v[252:253], v0 offset:576
  s_waitcnt lgkmcnt(7)
  v_mfma_f32_16x16x32_bf16 v[16:19], v[232:235], a[32:35], v[16:19]
  ds_read_b64_tr_b16 v[254:255], v0 offset:832
  buffer_load_dwordx4 v10, s[12:15], s35 offen offset:1536 nt lds
  v_mfma_f32_16x16x32_bf16 v[20:23], v[232:235], a[36:39], v[20:23]
  v_cvt_pk_bf16_f32 v192, v192, v193
  v_cvt_pk_bf16_f32 v193, v194, v195
  v_mfma_f32_16x16x32_bf16 v[24:27], v[232:235], a[40:43], v[24:27]
  v_exp_f32 v198, v198
  v_mfma_f32_16x16x32_bf16 v[28:31], v[232:235], a[44:47], v[28:31]
  ds_read_b64_tr_b16 v[232:233], v0 offset:96
  v_mfma_f32_16x16x32_bf16 v[16:19], v[236:239], a[48:51], v[16:19]
  ds_read_b64_tr_b16 v[234:235], v0 offset:352
  v_mfma_f32_16x16x32_bf16 v[20:23], v[236:239], a[52:55], v[20:23]
  v_accvgpr_write_b32 a248, v192
  v_accvgpr_write_b32 a249, v193
  v_mfma_f32_16x16x32_bf16 v[24:27], v[236:239], a[56:59], v[24:27]
  v_exp_f32 v199, v199
  v_mfma_f32_16x16x32_bf16 v[28:31], v[236:239], a[60:63], v[28:31]
  ds_read_b64_tr_b16 v[236:237], v0 offset:608
  s_waitcnt lgkmcnt(7)
  v_mfma_f32_16x16x32_bf16 v[32:35], v[240:243], a[32:35], v[32:35]
  ds_read_b64_tr_b16 v[238:239], v0 offset:864
  v_mfma_f32_16x16x32_bf16 v[36:39], v[240:243], a[36:39], v[36:39]
  v_exp_f32 v200, v200
  v_mfma_f32_16x16x32_bf16 v[40:43], v[240:243], a[40:43], v[40:43]
  v_cvt_pk_bf16_f32 v194, v196, v197
  v_accvgpr_write_b32 a250, v194
  v_mfma_f32_16x16x32_bf16 v[44:47], v[240:243], a[44:47], v[44:47]
  ds_read_b64_tr_b16 v[240:241], v0 offset:128
  v_mfma_f32_16x16x32_bf16 v[32:35], v[244:247], a[48:51], v[32:35]
  ds_read_b64_tr_b16 v[242:243], v0 offset:384
  v_mfma_f32_16x16x32_bf16 v[36:39], v[244:247], a[52:55], v[36:39]
  v_exp_f32 v201, v201
  v_mfma_f32_16x16x32_bf16 v[40:43], v[244:247], a[56:59], v[40:43]
  v_cvt_pk_bf16_f32 v195, v198, v199
  v_accvgpr_write_b32 a251, v195
  v_mfma_f32_16x16x32_bf16 v[44:47], v[244:247], a[60:63], v[44:47]
  ds_read_b64_tr_b16 v[244:245], v0 offset:640
  s_waitcnt lgkmcnt(7)
  v_mfma_f32_16x16x32_bf16 v[48:51], v[248:251], a[32:35], v[48:51]
  ds_read_b64_tr_b16 v[246:247], v0 offset:896
  v_mfma_f32_16x16x32_bf16 v[52:55], v[248:251], a[36:39], v[52:55]
  v_exp_f32 v202, v202
  v_mfma_f32_16x16x32_bf16 v[56:59], v[248:251], a[40:43], v[56:59]
  v_exp_f32 v203, v203
  v_mfma_f32_16x16x32_bf16 v[60:63], v[248:251], a[44:47], v[60:63]
  ds_read_b64_tr_b16 v[248:249], v0 offset:160
  v_mfma_f32_16x16x32_bf16 v[48:51], v[252:255], a[48:51], v[48:51]
  ds_read_b64_tr_b16 v[250:251], v0 offset:416
  v_mfma_f32_16x16x32_bf16 v[52:55], v[252:255], a[52:55], v[52:55]
  v_exp_f32 v204, v204
  v_mfma_f32_16x16x32_bf16 v[56:59], v[252:255], a[56:59], v[56:59]
  v_exp_f32 v205, v205
  v_mfma_f32_16x16x32_bf16 v[60:63], v[252:255], a[60:63], v[60:63]
  ds_read_b64_tr_b16 v[252:253], v0 offset:672
  s_waitcnt lgkmcnt(7)
  v_mfma_f32_16x16x32_bf16 v[64:67], v[232:235], a[32:35], v[64:67]
  ds_read_b64_tr_b16 v[254:255], v0 offset:928
  v_mfma_f32_16x16x32_bf16 v[68:71], v[232:235], a[36:39], v[68:71]
  v_cvt_pk_bf16_f32 v200, v200, v201
  v_cvt_pk_bf16_f32 v201, v202, v203
  v_mfma_f32_16x16x32_bf16 v[72:75], v[232:235], a[40:43], v[72:75]
  v_exp_f32 v206, v206
  v_mfma_f32_16x16x32_bf16 v[76:79], v[232:235], a[44:47], v[76:79]
  ds_read_b64_tr_b16 v[232:233], v0 offset:192
  v_mfma_f32_16x16x32_bf16 v[64:67], v[236:239], a[48:51], v[64:67]
  ds_read_b64_tr_b16 v[234:235], v0 offset:448
  v_mfma_f32_16x16x32_bf16 v[68:71], v[236:239], a[52:55], v[68:71]
  v_accvgpr_write_b32 a252, v200
  v_accvgpr_write_b32 a253, v201
  v_mfma_f32_16x16x32_bf16 v[72:75], v[236:239], a[56:59], v[72:75]
  v_exp_f32 v207, v207
  v_mfma_f32_16x16x32_bf16 v[76:79], v[236:239], a[60:63], v[76:79]
  ds_read_b64_tr_b16 v[236:237], v0 offset:704
  s_waitcnt lgkmcnt(7)
  v_mfma_f32_16x16x32_bf16 v[80:83], v[240:243], a[32:35], v[80:83]
  ds_read_b64_tr_b16 v[238:239], v0 offset:960
  v_mfma_f32_16x16x32_bf16 v[84:87], v[240:243], a[36:39], v[84:87]
  v_cvt_pk_bf16_f32 v202, v204, v205
  v_accvgpr_write_b32 a254, v202
  v_mfma_f32_16x16x32_bf16 v[88:91], v[240:243], a[40:43], v[88:91]
  v_cvt_pk_bf16_f32 v203, v206, v207
  v_accvgpr_write_b32 a255, v203
  v_mfma_f32_16x16x32_bf16 v[92:95], v[240:243], a[44:47], v[92:95]
  ds_read_b64_tr_b16 v[240:241], v0 offset:224
  v_mfma_f32_16x16x32_bf16 v[80:83], v[244:247], a[48:51], v[80:83]
  ds_read_b64_tr_b16 v[242:243], v0 offset:480
  v_mfma_f32_16x16x32_bf16 v[84:87], v[244:247], a[52:55], v[84:87]
  v_mfma_f32_16x16x32_bf16 v[88:91], v[244:247], a[56:59], v[88:91]
  v_mfma_f32_16x16x32_bf16 v[92:95], v[244:247], a[60:63], v[92:95]
  ds_read_b64_tr_b16 v[244:245], v0 offset:736
  s_waitcnt vmcnt(24)
  s_barrier
  s_waitcnt lgkmcnt(7)
  v_mfma_f32_16x16x32_bf16 v[96:99], v[248:251], a[32:35], v[96:99]
  s_mov_b32 s35, 33024
  ds_read_b64_tr_b16 v[246:247], v0 offset:992
  v_mfma_f32_16x16x32_bf16 v[100:103], v[248:251], a[36:39], v[100:103]
  s_add_u32 m0, s34, 0
  v_mfma_f32_16x16x32_bf16 v[104:107], v[248:251], a[40:43], v[104:107]
  buffer_load_dwordx4 v10, s[12:15], s35 offen offset:0 nt lds
  v_mfma_f32_16x16x32_bf16 v[108:111], v[248:251], a[44:47], v[108:111]
  s_add_u32 m0, s34, 544
  v_subrev_u32 v0, 50688, v0
  ds_read_b64_tr_b16 v[248:249], v0 offset:16896
  v_mfma_f32_16x16x32_bf16 v[96:99], v[252:255], a[48:51], v[96:99]
  ds_read_b64_tr_b16 v[250:251], v0 offset:17152
  v_mfma_f32_16x16x32_bf16 v[100:103], v[252:255], a[52:55], v[100:103]
  v_mfma_f32_16x16x32_bf16 v[104:107], v[252:255], a[56:59], v[104:107]
  v_mfma_f32_16x16x32_bf16 v[108:111], v[252:255], a[60:63], v[108:111]
  ds_read_b64_tr_b16 v[252:253], v0 offset:17408
  s_waitcnt lgkmcnt(7)
  v_mfma_f32_16x16x32_bf16 v[112:115], v[232:235], a[32:35], v[112:115]
  ds_read_b64_tr_b16 v[254:255], v0 offset:17664
  buffer_load_dwordx4 v10, s[12:15], s35 offen offset:512 nt lds
  v_mfma_f32_16x16x32_bf16 v[116:119], v[232:235], a[36:39], v[116:119]
  s_add_u32 m0, s34, 1088
  v_mfma_f32_16x16x32_bf16 v[120:123], v[232:235], a[40:43], v[120:123]
  v_mfma_f32_16x16x32_bf16 v[124:127], v[232:235], a[44:47], v[124:127]
  ds_read_b64_tr_b16 v[232:233], v0 offset:16928
  v_mfma_f32_16x16x32_bf16 v[112:115], v[236:239], a[48:51], v[112:115]
  ds_read_b64_tr_b16 v[234:235], v0 offset:17184
  v_mfma_f32_16x16x32_bf16 v[116:119], v[236:239], a[52:55], v[116:119]
  buffer_load_dwordx4 v10, s[12:15], s35 offen offset:1024 nt lds
  v_mfma_f32_16x16x32_bf16 v[120:123], v[236:239], a[56:59], v[120:123]
  s_add_u32 m0, s34, 1632
  v_mfma_f32_16x16x32_bf16 v[124:127], v[236:239], a[60:63], v[124:127]
  ds_read_b64_tr_b16 v[236:237], v0 offset:17440
  s_waitcnt lgkmcnt(7)
  v_mfma_f32_16x16x32_bf16 v[128:131], v[240:243], a[32:35], v[128:131]
  ds_read_b64_tr_b16 v[238:239], v0 offset:17696
  v_mfma_f32_16x16x32_bf16 v[132:135], v[240:243], a[36:39], v[132:135]
  v_mfma_f32_16x16x32_bf16 v[136:139], v[240:243], a[40:43], v[136:139]
  buffer_load_dwordx4 v10, s[12:15], s35 offen offset:1536 nt lds
  v_mfma_f32_16x16x32_bf16 v[140:143], v[240:243], a[44:47], v[140:143]
  ds_read_b64_tr_b16 v[240:241], v0 offset:16960
  v_mfma_f32_16x16x32_bf16 v[128:131], v[244:247], a[48:51], v[128:131]
  ds_read_b64_tr_b16 v[242:243], v0 offset:17216
  v_mfma_f32_16x16x32_bf16 v[132:135], v[244:247], a[52:55], v[132:135]
  v_mfma_f32_16x16x32_bf16 v[136:139], v[244:247], a[56:59], v[136:139]
  v_mfma_f32_16x16x32_bf16 v[140:143], v[244:247], a[60:63], v[140:143]
  ds_read_b64_tr_b16 v[244:245], v0 offset:17472
  v_mfma_f32_16x16x32_bf16 v[208:211], v[224:227], a[240:243], 0
  ds_read_b64_tr_b16 v[246:247], v0 offset:17728
  v_mfma_f32_16x16x32_bf16 v[212:215], v[224:227], a[244:247], 0
  v_mfma_f32_16x16x32_bf16 v[216:219], v[224:227], a[248:251], 0
  v_mfma_f32_16x16x32_bf16 v[220:223], v[224:227], a[252:255], 0
  s_waitcnt lgkmcnt(8)
  v_mfma_f32_16x16x32_bf16 v[16:19], v[248:251], a[64:67], v[16:19]
  s_lshl_b32 s42, s32, 6
  v_mbcnt_lo_u32_b32 v194, -1, 0
  v_mfma_f32_16x16x32_bf16 v[20:23], v[248:251], a[68:71], v[20:23]
  v_mbcnt_hi_u32_b32 v194, -1, v194
  v_lshlrev_b32 v12, 8, v194
  v_mfma_f32_16x16x32_bf16 v[24:27], v[248:251], a[72:75], v[24:27]
  v_mov_b32 v13, 1
  v_add_u32 v194, s42, v194
  v_mfma_f32_16x16x32_bf16 v[28:31], v[248:251], a[76:79], v[28:31]
  ds_read_b64_tr_b16 v[248:249], v0 offset:16992
  v_min_u32 v194, 223, v194
  v_mfma_f32_16x16x32_bf16 v[16:19], v[252:255], a[80:83], v[16:19]
  ds_read_b64_tr_b16 v[250:251], v0 offset:17248
  v_and_b32 v195, 3, v194
  v_mfma_f32_16x16x32_bf16 v[20:23], v[252:255], a[84:87], v[20:23]
  v_bfe_u32 v196, v194, 2, 2
  v_lshrrev_b32 v197, 4, v194
  v_mfma_f32_16x16x32_bf16 v[24:27], v[252:255], a[88:91], v[24:27]
  s_lshr_b32 s42, s2, 1
  s_and_b32 s43, s2, 1
  v_mfma_f32_16x16x32_bf16 v[28:31], v[252:255], a[92:95], v[28:31]
  ds_read_b64_tr_b16 v[252:253], v0 offset:17504
  s_waitcnt lgkmcnt(7)
  v_mfma_f32_16x16x32_bf16 v[32:35], v[232:235], a[64:67], v[32:35]
  ds_read_b64_tr_b16 v[254:255], v0 offset:17760
  s_mul_i32 s43, s43, 14
  v_mfma_f32_16x16x32_bf16 v[36:39], v[232:235], a[68:71], v[36:39]
  v_add_u32 v197, s43, v197
  s_lshl_b32 s43, s42, 5
  v_mfma_f32_16x16x32_bf16 v[40:43], v[232:235], a[72:75], v[40:43]
  v_lshlrev_b32 v194, 2, v195
  v_add_u32 v194, s43, v194
  v_mfma_f32_16x16x32_bf16 v[44:47], v[232:235], a[76:79], v[44:47]
  ds_read_b64_tr_b16 v[232:233], v0 offset:17024
  v_mul_u32_u24 v194, 896, v194
  v_mfma_f32_16x16x32_bf16 v[32:35], v[236:239], a[80:83], v[32:35]
  ds_read_b64_tr_b16 v[234:235], v0 offset:17280
  v_lshl_add_u32 v192, v197, 5, v194
  v_mfma_f32_16x16x32_bf16 v[36:39], v[236:239], a[84:87], v[36:39]
  v_lshl_add_u32 v192, v196, 3, v192
  v_lshlrev_b32 v193, 17, v197
  v_mfma_f32_16x16x32_bf16 v[40:43], v[236:239], a[88:91], v[40:43]
  s_lshl_b32 s43, s42, 10
  v_add_u32 v193, s43, v193
  v_mfma_f32_16x16x32_bf16 v[44:47], v[236:239], a[92:95], v[44:47]
  ds_read_b64_tr_b16 v[236:237], v0 offset:17536
  s_waitcnt lgkmcnt(7)
  v_mfma_f32_16x16x32_bf16 v[48:51], v[240:243], a[64:67], v[48:51]
  ds_read_b64_tr_b16 v[238:239], v0 offset:17792
  v_lshl_add_u32 v193, v195, 8, v193
  v_mfma_f32_16x16x32_bf16 v[52:55], v[240:243], a[68:71], v[52:55]
  v_lshl_add_u32 v193, v196, 6, v193
  s_mov_b32 s42, 14336
  v_mfma_f32_16x16x32_bf16 v[56:59], v[240:243], a[72:75], v[56:59]
  v_add_f32 v6, v6, v208
  v_add_f32 v7, v7, v212
  v_mfma_f32_16x16x32_bf16 v[60:63], v[240:243], a[76:79], v[60:63]
  ds_read_b64_tr_b16 v[240:241], v0 offset:17056
  v_add_f32 v8, v8, v216
  v_mfma_f32_16x16x32_bf16 v[48:51], v[244:247], a[80:83], v[48:51]
  ds_read_b64_tr_b16 v[242:243], v0 offset:17312
  v_add_f32 v9, v9, v220
  v_mfma_f32_16x16x32_bf16 v[52:55], v[244:247], a[84:87], v[52:55]
  v_rcp_f32 v6, v6
  v_mfma_f32_16x16x32_bf16 v[56:59], v[244:247], a[88:91], v[56:59]
  v_rcp_f32 v7, v7
  v_mfma_f32_16x16x32_bf16 v[60:63], v[244:247], a[92:95], v[60:63]
  ds_read_b64_tr_b16 v[244:245], v0 offset:17568
  s_waitcnt lgkmcnt(7)
  v_mfma_f32_16x16x32_bf16 v[64:67], v[248:251], a[64:67], v[64:67]
  ds_read_b64_tr_b16 v[246:247], v0 offset:17824
  v_mfma_f32_16x16x32_bf16 v[68:71], v[248:251], a[68:71], v[68:71]
  v_rcp_f32 v8, v8
  v_mfma_f32_16x16x32_bf16 v[72:75], v[248:251], a[72:75], v[72:75]
  v_rcp_f32 v9, v9
  v_mfma_f32_16x16x32_bf16 v[76:79], v[248:251], a[76:79], v[76:79]
  ds_read_b64_tr_b16 v[248:249], v0 offset:17088
  v_mfma_f32_16x16x32_bf16 v[64:67], v[252:255], a[80:83], v[64:67]
  ds_read_b64_tr_b16 v[250:251], v0 offset:17344
  v_mfma_f32_16x16x32_bf16 v[68:71], v[252:255], a[84:87], v[68:71]
  v_mfma_f32_16x16x32_bf16 v[72:75], v[252:255], a[88:91], v[72:75]
  v_mfma_f32_16x16x32_bf16 v[76:79], v[252:255], a[92:95], v[76:79]
  ds_read_b64_tr_b16 v[252:253], v0 offset:17600
  s_waitcnt lgkmcnt(7)
  v_mfma_f32_16x16x32_bf16 v[80:83], v[232:235], a[64:67], v[80:83]
  ds_read_b64_tr_b16 v[254:255], v0 offset:17856
  v_mfma_f32_16x16x32_bf16 v[84:87], v[232:235], a[68:71], v[84:87]
  v_mfma_f32_16x16x32_bf16 v[88:91], v[232:235], a[72:75], v[88:91]
  v_mfma_f32_16x16x32_bf16 v[92:95], v[232:235], a[76:79], v[92:95]
  ds_read_b64_tr_b16 v[232:233], v0 offset:17120
  v_mfma_f32_16x16x32_bf16 v[80:83], v[236:239], a[80:83], v[80:83]
  ds_read_b64_tr_b16 v[234:235], v0 offset:17376
  v_mfma_f32_16x16x32_bf16 v[84:87], v[236:239], a[84:87], v[84:87]
  v_mfma_f32_16x16x32_bf16 v[88:91], v[236:239], a[88:91], v[88:91]
  v_mfma_f32_16x16x32_bf16 v[92:95], v[236:239], a[92:95], v[92:95]
  ds_read_b64_tr_b16 v[236:237], v0 offset:17632
  s_waitcnt vmcnt(24)
  s_barrier
  s_waitcnt lgkmcnt(7)
  v_mfma_f32_16x16x32_bf16 v[96:99], v[240:243], a[64:67], v[96:99]
  s_mov_b32 s35, 65792
  ds_read_b64_tr_b16 v[238:239], v0 offset:17888
  v_mfma_f32_16x16x32_bf16 v[100:103], v[240:243], a[68:71], v[100:103]
  s_add_u32 m0, s34, 101376
  v_mfma_f32_16x16x32_bf16 v[104:107], v[240:243], a[72:75], v[104:107]
  buffer_load_dwordx4 v10, s[12:15], s35 offen offset:0 nt lds
  v_mfma_f32_16x16x32_bf16 v[108:111], v[240:243], a[76:79], v[108:111]
  s_add_u32 m0, s34, 101920
  v_add_u32 v0, 50688, v0
  ds_read_b64_tr_b16 v[240:241], v0 offset:16896
  v_mfma_f32_16x16x32_bf16 v[96:99], v[244:247], a[80:83], v[96:99]
  ds_read_b64_tr_b16 v[242:243], v0 offset:17152
  v_mfma_f32_16x16x32_bf16 v[100:103], v[244:247], a[84:87], v[100:103]
  v_mfma_f32_16x16x32_bf16 v[104:107], v[244:247], a[88:91], v[104:107]
  v_mfma_f32_16x16x32_bf16 v[108:111], v[244:247], a[92:95], v[108:111]
  ds_read_b64_tr_b16 v[244:245], v0 offset:17408
  s_waitcnt lgkmcnt(7)
  v_mfma_f32_16x16x32_bf16 v[112:115], v[248:251], a[64:67], v[112:115]
  ds_read_b64_tr_b16 v[246:247], v0 offset:17664
  buffer_load_dwordx4 v10, s[12:15], s35 offen offset:512 nt lds
  v_mfma_f32_16x16x32_bf16 v[116:119], v[248:251], a[68:71], v[116:119]
  s_add_u32 m0, s34, 102464
  v_mfma_f32_16x16x32_bf16 v[120:123], v[248:251], a[72:75], v[120:123]
  v_mfma_f32_16x16x32_bf16 v[124:127], v[248:251], a[76:79], v[124:127]
  ds_read_b64_tr_b16 v[248:249], v0 offset:16928
  v_mfma_f32_16x16x32_bf16 v[112:115], v[252:255], a[80:83], v[112:115]
  ds_read_b64_tr_b16 v[250:251], v0 offset:17184
  v_mfma_f32_16x16x32_bf16 v[116:119], v[252:255], a[84:87], v[116:119]
  buffer_load_dwordx4 v10, s[12:15], s35 offen offset:1024 nt lds
  v_mfma_f32_16x16x32_bf16 v[120:123], v[252:255], a[88:91], v[120:123]
  s_add_u32 m0, s34, 103008
  v_mfma_f32_16x16x32_bf16 v[124:127], v[252:255], a[92:95], v[124:127]
  ds_read_b64_tr_b16 v[252:253], v0 offset:17440
  s_waitcnt lgkmcnt(7)
  v_mfma_f32_16x16x32_bf16 v[128:131], v[232:235], a[64:67], v[128:131]
  ds_read_b64_tr_b16 v[254:255], v0 offset:17696
  v_mfma_f32_16x16x32_bf16 v[132:135], v[232:235], a[68:71], v[132:135]
  v_mfma_f32_16x16x32_bf16 v[136:139], v[232:235], a[72:75], v[136:139]
  buffer_load_dwordx4 v10, s[12:15], s35 offen offset:1536 nt lds
  v_mfma_f32_16x16x32_bf16 v[140:143], v[232:235], a[76:79], v[140:143]
  ds_read_b64_tr_b16 v[232:233], v0 offset:16960
  v_mfma_f32_16x16x32_bf16 v[128:131], v[236:239], a[80:83], v[128:131]
  ds_read_b64_tr_b16 v[234:235], v0 offset:17216
  v_mfma_f32_16x16x32_bf16 v[132:135], v[236:239], a[84:87], v[132:135]
  v_mfma_f32_16x16x32_bf16 v[136:139], v[236:239], a[88:91], v[136:139]
  v_mfma_f32_16x16x32_bf16 v[140:143], v[236:239], a[92:95], v[140:143]
  ds_read_b64_tr_b16 v[236:237], v0 offset:17472
  s_waitcnt lgkmcnt(7)
  v_mfma_f32_16x16x32_bf16 v[16:19], v[240:243], a[96:99], v[16:19]
  ds_read_b64_tr_b16 v[238:239], v0 offset:17728
  buffer_load_dwordx2 v[160:161], v192, s[20:23], 0 offen offset:0
  v_mfma_f32_16x16x32_bf16 v[20:23], v[240:243], a[100:103], v[20:23]
  v_mfma_f32_16x16x32_bf16 v[24:27], v[240:243], a[104:107], v[24:27]
  v_mfma_f32_16x16x32_bf16 v[28:31], v[240:243], a[108:111], v[28:31]
  ds_read_b64_tr_b16 v[240:241], v0 offset:16992
  v_mfma_f32_16x16x32_bf16 v[16:19], v[244:247], a[112:115], v[16:19]
  ds_read_b64_tr_b16 v[242:243], v0 offset:17248
  v_mfma_f32_16x16x32_bf16 v[20:23], v[244:247], a[116:119], v[20:23]
  v_mfma_f32_16x16x32_bf16 v[24:27], v[244:247], a[120:123], v[24:27]
  buffer_load_dwordx2 v[162:163], v192, s[20:23], 0 offen offset:896
  v_mfma_f32_16x16x32_bf16 v[28:31], v[244:247], a[124:127], v[28:31]
  ds_read_b64_tr_b16 v[244:245], v0 offset:17504
  s_waitcnt lgkmcnt(7)
  v_mfma_f32_16x16x32_bf16 v[32:35], v[248:251], a[96:99], v[32:35]
  ds_read_b64_tr_b16 v[246:247], v0 offset:17760
  v_mfma_f32_16x16x32_bf16 v[36:39], v[248:251], a[100:103], v[36:39]
  v_mfma_f32_16x16x32_bf16 v[40:43], v[248:251], a[104:107], v[40:43]
  v_mfma_f32_16x16x32_bf16 v[44:47], v[248:251], a[108:111], v[44:47]
  ds_read_b64_tr_b16 v[248:249], v0 offset:17024
  v_mfma_f32_16x16x32_bf16 v[32:35], v[252:255], a[112:115], v[32:35]
  ds_read_b64_tr_b16 v[250:251], v0 offset:17280
  buffer_load_dwordx2 v[164:165], v192, s[20:23], 0 offen offset:1792
  v_mfma_f32_16x16x32_bf16 v[36:39], v[252:255], a[116:119], v[36:39]
  v_mfma_f32_16x16x32_bf16 v[40:43], v[252:255], a[120:123], v[40:43]
  v_mfma_f32_16x16x32_bf16 v[44:47], v[252:255], a[124:127], v[44:47]
  ds_read_b64_tr_b16 v[252:253], v0 offset:17536
  s_waitcnt lgkmcnt(7)
  v_mfma_f32_16x16x32_bf16 v[48:51], v[232:235], a[96:99], v[48:51]
  ds_read_b64_tr_b16 v[254:255], v0 offset:17792
  v_mfma_f32_16x16x32_bf16 v[52:55], v[232:235], a[100:103], v[52:55]
  v_mfma_f32_16x16x32_bf16 v[56:59], v[232:235], a[104:107], v[56:59]
  buffer_load_dwordx2 v[166:167], v192, s[20:23], 0 offen offset:2688
  v_mfma_f32_16x16x32_bf16 v[60:63], v[232:235], a[108:111], v[60:63]
  ds_read_b64_tr_b16 v[232:233], v0 offset:17056
  v_mfma_f32_16x16x32_bf16 v[48:51], v[236:239], a[112:115], v[48:51]
  ds_read_b64_tr_b16 v[234:235], v0 offset:17312
  v_mfma_f32_16x16x32_bf16 v[52:55], v[236:239], a[116:119], v[52:55]
  v_mfma_f32_16x16x32_bf16 v[56:59], v[236:239], a[120:123], v[56:59]
  v_mfma_f32_16x16x32_bf16 v[60:63], v[236:239], a[124:127], v[60:63]
  ds_read_b64_tr_b16 v[236:237], v0 offset:17568
  s_waitcnt lgkmcnt(7)
  v_mfma_f32_16x16x32_bf16 v[64:67], v[240:243], a[96:99], v[64:67]
  ds_read_b64_tr_b16 v[238:239], v0 offset:17824
  buffer_load_dwordx2 v[168:169], v192, s[20:23], s42 offen offset:0
  v_mfma_f32_16x16x32_bf16 v[68:71], v[240:243], a[100:103], v[68:71]
  v_mfma_f32_16x16x32_bf16 v[72:75], v[240:243], a[104:107], v[72:75]
  v_mfma_f32_16x16x32_bf16 v[76:79], v[240:243], a[108:111], v[76:79]
  ds_read_b64_tr_b16 v[240:241], v0 offset:17088
  v_mfma_f32_16x16x32_bf16 v[64:67], v[244:247], a[112:115], v[64:67]
  ds_read_b64_tr_b16 v[242:243], v0 offset:17344
  v_mfma_f32_16x16x32_bf16 v[68:71], v[244:247], a[116:119], v[68:71]
  v_mfma_f32_16x16x32_bf16 v[72:75], v[244:247], a[120:123], v[72:75]
  buffer_load_dwordx2 v[170:171], v192, s[20:23], s42 offen offset:896
  v_mfma_f32_16x16x32_bf16 v[76:79], v[244:247], a[124:127], v[76:79]
  ds_read_b64_tr_b16 v[244:245], v0 offset:17600
  s_waitcnt lgkmcnt(7)
  v_mfma_f32_16x16x32_bf16 v[80:83], v[248:251], a[96:99], v[80:83]
  ds_read_b64_tr_b16 v[246:247], v0 offset:17856
  v_mfma_f32_16x16x32_bf16 v[84:87], v[248:251], a[100:103], v[84:87]
  v_mfma_f32_16x16x32_bf16 v[88:91], v[248:251], a[104:107], v[88:91]
  v_mfma_f32_16x16x32_bf16 v[92:95], v[248:251], a[108:111], v[92:95]
  ds_read_b64_tr_b16 v[248:249], v0 offset:17120
  v_mfma_f32_16x16x32_bf16 v[80:83], v[252:255], a[112:115], v[80:83]
  ds_read_b64_tr_b16 v[250:251], v0 offset:17376
  buffer_load_dwordx2 v[172:173], v192, s[20:23], s42 offen offset:1792
  v_mfma_f32_16x16x32_bf16 v[84:87], v[252:255], a[116:119], v[84:87]
  v_mfma_f32_16x16x32_bf16 v[88:91], v[252:255], a[120:123], v[88:91]
  v_mfma_f32_16x16x32_bf16 v[92:95], v[252:255], a[124:127], v[92:95]
  ds_read_b64_tr_b16 v[252:253], v0 offset:17632
  s_waitcnt vmcnt(31)
  s_barrier
  s_waitcnt lgkmcnt(7)
  v_mfma_f32_16x16x32_bf16 v[96:99], v[232:235], a[96:99], v[96:99]
  s_mov_b32 s35, 98560
  ds_read_b64_tr_b16 v[254:255], v0 offset:17888
  v_mfma_f32_16x16x32_bf16 v[100:103], v[232:235], a[100:103], v[100:103]
  s_add_u32 m0, s34, 67584
  v_mfma_f32_16x16x32_bf16 v[104:107], v[232:235], a[104:107], v[104:107]
  buffer_load_dwordx4 v10, s[12:15], s35 offen offset:0 nt lds
  buffer_load_dwordx2 v[174:175], v192, s[20:23], s42 offen offset:2688
  v_mfma_f32_16x16x32_bf16 v[108:111], v[232:235], a[108:111], v[108:111]
  s_add_u32 m0, s34, 68128
  v_subrev_u32 v0, 50688, v0
  ds_read_b64_tr_b16 v[232:233], v0 offset:0
  v_mfma_f32_16x16x32_bf16 v[96:99], v[236:239], a[112:115], v[96:99]
  ds_read_b64_tr_b16 v[234:235], v0 offset:256
  v_mfma_f32_16x16x32_bf16 v[100:103], v[236:239], a[116:119], v[100:103]
  v_mfma_f32_16x16x32_bf16 v[104:107], v[236:239], a[120:123], v[104:107]
  v_mfma_f32_16x16x32_bf16 v[108:111], v[236:239], a[124:127], v[108:111]
  ds_read_b64_tr_b16 v[236:237], v0 offset:512
  s_waitcnt lgkmcnt(7)
  v_mfma_f32_16x16x32_bf16 v[112:115], v[240:243], a[96:99], v[112:115]
  ds_read_b64_tr_b16 v[238:239], v0 offset:768
  buffer_load_dwordx4 v10, s[12:15], s35 offen offset:512 nt lds
  v_mfma_f32_16x16x32_bf16 v[116:119], v[240:243], a[100:103], v[116:119]
  s_add_u32 m0, s34, 68672
  v_mfma_f32_16x16x32_bf16 v[120:123], v[240:243], a[104:107], v[120:123]
  v_mfma_f32_16x16x32_bf16 v[124:127], v[240:243], a[108:111], v[124:127]
  ds_read_b64_tr_b16 v[240:241], v0 offset:32
  v_mfma_f32_16x16x32_bf16 v[112:115], v[244:247], a[112:115], v[112:115]
  ds_read_b64_tr_b16 v[242:243], v0 offset:288
  v_mfma_f32_16x16x32_bf16 v[116:119], v[244:247], a[116:119], v[116:119]
  buffer_load_dwordx4 v10, s[12:15], s35 offen offset:1024 nt lds
  v_mfma_f32_16x16x32_bf16 v[120:123], v[244:247], a[120:123], v[120:123]
  s_add_u32 m0, s34, 69216
  v_mfma_f32_16x16x32_bf16 v[124:127], v[244:247], a[124:127], v[124:127]
  ds_read_b64_tr_b16 v[244:245], v0 offset:544
  s_waitcnt lgkmcnt(7)
  v_mfma_f32_16x16x32_bf16 v[128:131], v[248:251], a[96:99], v[128:131]
  ds_read_b64_tr_b16 v[246:247], v0 offset:800
  v_mfma_f32_16x16x32_bf16 v[132:135], v[248:251], a[100:103], v[132:135]
  v_mfma_f32_16x16x32_bf16 v[136:139], v[248:251], a[104:107], v[136:139]
  buffer_load_dwordx4 v10, s[12:15], s35 offen offset:1536 nt lds
  v_mfma_f32_16x16x32_bf16 v[140:143], v[248:251], a[108:111], v[140:143]
  ds_read_b64_tr_b16 v[248:249], v0 offset:64
  v_mfma_f32_16x16x32_bf16 v[128:131], v[252:255], a[112:115], v[128:131]
  ds_read_b64_tr_b16 v[250:251], v0 offset:320
  v_mfma_f32_16x16x32_bf16 v[132:135], v[252:255], a[116:119], v[132:135]
  v_mfma_f32_16x16x32_bf16 v[136:139], v[252:255], a[120:123], v[136:139]
  v_mfma_f32_16x16x32_bf16 v[140:143], v[252:255], a[124:127], v[140:143]
  ds_read_b64_tr_b16 v[252:253], v0 offset:576
  s_waitcnt lgkmcnt(7)
  v_mfma_f32_16x16x32_bf16 v[16:19], v[232:235], a[128:131], v[16:19]
  ds_read_b64_tr_b16 v[254:255], v0 offset:832
  v_mfma_f32_16x16x32_bf16 v[20:23], v[232:235], a[132:135], v[20:23]
  v_mfma_f32_16x16x32_bf16 v[24:27], v[232:235], a[136:139], v[24:27]
  v_mfma_f32_16x16x32_bf16 v[28:31], v[232:235], a[140:143], v[28:31]
  ds_read_b64_tr_b16 v[232:233], v0 offset:96
  v_mfma_f32_16x16x32_bf16 v[16:19], v[236:239], a[144:147], v[16:19]
  ds_read_b64_tr_b16 v[234:235], v0 offset:352
  v_mfma_f32_16x16x32_bf16 v[20:23], v[236:239], a[148:151], v[20:23]
  v_mfma_f32_16x16x32_bf16 v[24:27], v[236:239], a[152:155], v[24:27]
  v_mfma_f32_16x16x32_bf16 v[28:31], v[236:239], a[156:159], v[28:31]
  ds_read_b64_tr_b16 v[236:237], v0 offset:608
  s_waitcnt lgkmcnt(7)
  v_mfma_f32_16x16x32_bf16 v[32:35], v[240:243], a[128:131], v[32:35]
  ds_read_b64_tr_b16 v[238:239], v0 offset:864
  v_mfma_f32_16x16x32_bf16 v[36:39], v[240:243], a[132:135], v[36:39]
  v_mfma_f32_16x16x32_bf16 v[40:43], v[240:243], a[136:139], v[40:43]
  v_mfma_f32_16x16x32_bf16 v[44:47], v[240:243], a[140:143], v[44:47]
  ds_read_b64_tr_b16 v[240:241], v0 offset:128
  v_mfma_f32_16x16x32_bf16 v[32:35], v[244:247], a[144:147], v[32:35]
  ds_read_b64_tr_b16 v[242:243], v0 offset:384
  v_mfma_f32_16x16x32_bf16 v[36:39], v[244:247], a[148:151], v[36:39]
  v_mfma_f32_16x16x32_bf16 v[40:43], v[244:247], a[152:155], v[40:43]
  v_mfma_f32_16x16x32_bf16 v[44:47], v[244:247], a[156:159], v[44:47]
  ds_read_b64_tr_b16 v[244:245], v0 offset:640
  s_waitcnt lgkmcnt(7)
  v_mfma_f32_16x16x32_bf16 v[48:51], v[248:251], a[128:131], v[48:51]
  ds_read_b64_tr_b16 v[246:247], v0 offset:896
  v_mfma_f32_16x16x32_bf16 v[52:55], v[248:251], a[132:135], v[52:55]
  v_mfma_f32_16x16x32_bf16 v[56:59], v[248:251], a[136:139], v[56:59]
  v_mfma_f32_16x16x32_bf16 v[60:63], v[248:251], a[140:143], v[60:63]
  ds_read_b64_tr_b16 v[248:249], v0 offset:160
  v_mfma_f32_16x16x32_bf16 v[48:51], v[252:255], a[144:147], v[48:51]
  ds_read_b64_tr_b16 v[250:251], v0 offset:416
  v_mfma_f32_16x16x32_bf16 v[52:55], v[252:255], a[148:151], v[52:55]
  v_mfma_f32_16x16x32_bf16 v[56:59], v[252:255], a[152:155], v[56:59]
  v_mfma_f32_16x16x32_bf16 v[60:63], v[252:255], a[156:159], v[60:63]
  ds_read_b64_tr_b16 v[252:253], v0 offset:672
  s_waitcnt lgkmcnt(7)
  v_mfma_f32_16x16x32_bf16 v[64:67], v[232:235], a[128:131], v[64:67]
  ds_read_b64_tr_b16 v[254:255], v0 offset:928
  v_mfma_f32_16x16x32_bf16 v[68:71], v[232:235], a[132:135], v[68:71]
  v_mfma_f32_16x16x32_bf16 v[72:75], v[232:235], a[136:139], v[72:75]
  v_mfma_f32_16x16x32_bf16 v[76:79], v[232:235], a[140:143], v[76:79]
  ds_read_b64_tr_b16 v[232:233], v0 offset:192
  v_mfma_f32_16x16x32_bf16 v[64:67], v[236:239], a[144:147], v[64:67]
  ds_read_b64_tr_b16 v[234:235], v0 offset:448
  v_mfma_f32_16x16x32_bf16 v[68:71], v[236:239], a[148:151], v[68:71]
  v_mfma_f32_16x16x32_bf16 v[72:75], v[236:239], a[152:155], v[72:75]
  v_mfma_f32_16x16x32_bf16 v[76:79], v[236:239], a[156:159], v[76:79]
  ds_read_b64_tr_b16 v[236:237], v0 offset:704
  s_waitcnt lgkmcnt(7)
  v_mfma_f32_16x16x32_bf16 v[80:83], v[240:243], a[128:131], v[80:83]
  ds_read_b64_tr_b16 v[238:239], v0 offset:960
  v_mfma_f32_16x16x32_bf16 v[84:87], v[240:243], a[132:135], v[84:87]
  v_mfma_f32_16x16x32_bf16 v[88:91], v[240:243], a[136:139], v[88:91]
  v_mfma_f32_16x16x32_bf16 v[92:95], v[240:243], a[140:143], v[92:95]
  ds_read_b64_tr_b16 v[240:241], v0 offset:224
  v_mfma_f32_16x16x32_bf16 v[80:83], v[244:247], a[144:147], v[80:83]
  ds_read_b64_tr_b16 v[242:243], v0 offset:480
  v_mfma_f32_16x16x32_bf16 v[84:87], v[244:247], a[148:151], v[84:87]
  v_mfma_f32_16x16x32_bf16 v[88:91], v[244:247], a[152:155], v[88:91]
  v_mfma_f32_16x16x32_bf16 v[92:95], v[244:247], a[156:159], v[92:95]
  ds_read_b64_tr_b16 v[244:245], v0 offset:736
  s_waitcnt vmcnt(32)
  s_barrier
  s_waitcnt lgkmcnt(7)
  v_mfma_f32_16x16x32_bf16 v[96:99], v[248:251], a[128:131], v[96:99]
  s_mov_b32 s35, 131328
  ds_read_b64_tr_b16 v[246:247], v0 offset:992
  v_mfma_f32_16x16x32_bf16 v[100:103], v[248:251], a[132:135], v[100:103]
  s_add_u32 m0, s34, 118272
  v_mfma_f32_16x16x32_bf16 v[104:107], v[248:251], a[136:139], v[104:107]
  buffer_load_dwordx4 v10, s[12:15], s35 offen offset:0 nt lds
  v_mfma_f32_16x16x32_bf16 v[108:111], v[248:251], a[140:143], v[108:111]
  s_add_u32 m0, s34, 118816
  ds_read_b64_tr_b16 v[248:249], v0 offset:33792
  v_mfma_f32_16x16x32_bf16 v[96:99], v[252:255], a[144:147], v[96:99]
  ds_read_b64_tr_b16 v[250:251], v0 offset:34048
  v_mfma_f32_16x16x32_bf16 v[100:103], v[252:255], a[148:151], v[100:103]
  v_mfma_f32_16x16x32_bf16 v[104:107], v[252:255], a[152:155], v[104:107]
  v_mfma_f32_16x16x32_bf16 v[108:111], v[252:255], a[156:159], v[108:111]
  ds_read_b64_tr_b16 v[252:253], v0 offset:34304
  s_waitcnt lgkmcnt(7)
  v_mfma_f32_16x16x32_bf16 v[112:115], v[232:235], a[128:131], v[112:115]
  ds_read_b64_tr_b16 v[254:255], v0 offset:34560
  buffer_load_dwordx4 v10, s[12:15], s35 offen offset:512 nt lds
  v_mfma_f32_16x16x32_bf16 v[116:119], v[232:235], a[132:135], v[116:119]
  s_add_u32 m0, s34, 119360
  v_mfma_f32_16x16x32_bf16 v[120:123], v[232:235], a[136:139], v[120:123]
  v_mfma_f32_16x16x32_bf16 v[124:127], v[232:235], a[140:143], v[124:127]
  ds_read_b64_tr_b16 v[232:233], v0 offset:33824
  v_mfma_f32_16x16x32_bf16 v[112:115], v[236:239], a[144:147], v[112:115]
  ds_read_b64_tr_b16 v[234:235], v0 offset:34080
  v_mfma_f32_16x16x32_bf16 v[116:119], v[236:239], a[148:151], v[116:119]
  buffer_load_dwordx4 v10, s[12:15], s35 offen offset:1024 nt lds
  v_mfma_f32_16x16x32_bf16 v[120:123], v[236:239], a[152:155], v[120:123]
  s_add_u32 m0, s34, 119904
  v_mfma_f32_16x16x32_bf16 v[124:127], v[236:239], a[156:159], v[124:127]
  ds_read_b64_tr_b16 v[236:237], v0 offset:34336
  s_waitcnt lgkmcnt(7)
  v_mfma_f32_16x16x32_bf16 v[128:131], v[240:243], a[128:131], v[128:131]
  ds_read_b64_tr_b16 v[238:239], v0 offset:34592
  v_mfma_f32_16x16x32_bf16 v[132:135], v[240:243], a[132:135], v[132:135]
  v_mfma_f32_16x16x32_bf16 v[136:139], v[240:243], a[136:139], v[136:139]
  buffer_load_dwordx4 v10, s[12:15], s35 offen offset:1536 nt lds
  v_mfma_f32_16x16x32_bf16 v[140:143], v[240:243], a[140:143], v[140:143]
  ds_read_b64_tr_b16 v[240:241], v0 offset:33856
  v_mfma_f32_16x16x32_bf16 v[128:131], v[244:247], a[144:147], v[128:131]
  ds_read_b64_tr_b16 v[242:243], v0 offset:34112
  v_mfma_f32_16x16x32_bf16 v[132:135], v[244:247], a[148:151], v[132:135]
  v_mfma_f32_16x16x32_bf16 v[136:139], v[244:247], a[152:155], v[136:139]
  v_mfma_f32_16x16x32_bf16 v[140:143], v[244:247], a[156:159], v[140:143]
  ds_read_b64_tr_b16 v[244:245], v0 offset:34368
  s_waitcnt lgkmcnt(7)
  v_mfma_f32_16x16x32_bf16 v[16:19], v[248:251], a[160:163], v[16:19]
  ds_read_b64_tr_b16 v[246:247], v0 offset:34624
  v_mfma_f32_16x16x32_bf16 v[20:23], v[248:251], a[164:167], v[20:23]
  v_mfma_f32_16x16x32_bf16 v[24:27], v[248:251], a[168:171], v[24:27]
  v_mfma_f32_16x16x32_bf16 v[28:31], v[248:251], a[172:175], v[28:31]
  ds_read_b64_tr_b16 v[248:249], v0 offset:33888
  v_mfma_f32_16x16x32_bf16 v[16:19], v[252:255], a[176:179], v[16:19]
  ds_read_b64_tr_b16 v[250:251], v0 offset:34144
  v_mfma_f32_16x16x32_bf16 v[20:23], v[252:255], a[180:183], v[20:23]
  v_mfma_f32_16x16x32_bf16 v[24:27], v[252:255], a[184:187], v[24:27]
  v_mfma_f32_16x16x32_bf16 v[28:31], v[252:255], a[188:191], v[28:31]
  ds_read_b64_tr_b16 v[252:253], v0 offset:34400
  s_waitcnt lgkmcnt(7)
  v_mfma_f32_16x16x32_bf16 v[32:35], v[232:235], a[160:163], v[32:35]
  ds_read_b64_tr_b16 v[254:255], v0 offset:34656
  s_waitcnt vmcnt(7)
  v_mfma_f32_16x16x32_bf16 v[36:39], v[232:235], a[164:167], v[36:39]
  v_perm_b32 v176, v162, v160, s44
  v_mfma_f32_16x16x32_bf16 v[40:43], v[232:235], a[168:171], v[40:43]
  v_mfma_f32_16x16x32_bf16 v[44:47], v[232:235], a[172:175], v[44:47]
  ds_read_b64_tr_b16 v[232:233], v0 offset:33920
  v_perm_b32 v177, v166, v164, s44
  v_mfma_f32_16x16x32_bf16 v[32:35], v[236:239], a[176:179], v[32:35]
  ds_read_b64_tr_b16 v[234:235], v0 offset:34176
  v_mfma_f32_16x16x32_bf16 v[36:39], v[236:239], a[180:183], v[36:39]
  v_perm_b32 v178, v170, v168, s44
  v_mfma_f32_16x16x32_bf16 v[40:43], v[236:239], a[184:187], v[40:43]
  v_mfma_f32_16x16x32_bf16 v[44:47], v[236:239], a[188:191], v[44:47]
  ds_read_b64_tr_b16 v[236:237], v0 offset:34432
  s_waitcnt lgkmcnt(7)
  v_mfma_f32_16x16x32_bf16 v[48:51], v[240:243], a[160:163], v[48:51]
  ds_read_b64_tr_b16 v[238:239], v0 offset:34688
  v_perm_b32 v179, v174, v172, s44
  v_mfma_f32_16x16x32_bf16 v[52:55], v[240:243], a[164:167], v[52:55]
  buffer_store_dwordx4 v[176:179], v193, s[28:31], 0 offen offset:0
  v_mfma_f32_16x16x32_bf16 v[56:59], v[240:243], a[168:171], v[56:59]
  v_mfma_f32_16x16x32_bf16 v[60:63], v[240:243], a[172:175], v[60:63]
  ds_read_b64_tr_b16 v[240:241], v0 offset:33952
  v_perm_b32 v180, v162, v160, s45
  v_mfma_f32_16x16x32_bf16 v[48:51], v[244:247], a[176:179], v[48:51]
  ds_read_b64_tr_b16 v[242:243], v0 offset:34208
  v_mfma_f32_16x16x32_bf16 v[52:55], v[244:247], a[180:183], v[52:55]
  v_perm_b32 v181, v166, v164, s45
  v_mfma_f32_16x16x32_bf16 v[56:59], v[244:247], a[184:187], v[56:59]
  v_mfma_f32_16x16x32_bf16 v[60:63], v[244:247], a[188:191], v[60:63]
  ds_read_b64_tr_b16 v[244:245], v0 offset:34464
  s_waitcnt lgkmcnt(7)
  v_mfma_f32_16x16x32_bf16 v[64:67], v[248:251], a[160:163], v[64:67]
  ds_read_b64_tr_b16 v[246:247], v0 offset:34720
  v_perm_b32 v182, v170, v168, s45
  v_mfma_f32_16x16x32_bf16 v[68:71], v[248:251], a[164:167], v[68:71]
  v_perm_b32 v183, v174, v172, s45
  v_mfma_f32_16x16x32_bf16 v[72:75], v[248:251], a[168:171], v[72:75]
  v_mfma_f32_16x16x32_bf16 v[76:79], v[248:251], a[172:175], v[76:79]
  ds_read_b64_tr_b16 v[248:249], v0 offset:33984
  buffer_store_dwordx4 v[180:183], v193, s[28:31], 0 offen offset:16
  v_mfma_f32_16x16x32_bf16 v[64:67], v[252:255], a[176:179], v[64:67]
  ds_read_b64_tr_b16 v[250:251], v0 offset:34240
  v_perm_b32 v184, v163, v161, s44
  v_mfma_f32_16x16x32_bf16 v[68:71], v[252:255], a[180:183], v[68:71]
  v_mfma_f32_16x16x32_bf16 v[72:75], v[252:255], a[184:187], v[72:75]
  v_perm_b32 v185, v167, v165, s44
  v_mfma_f32_16x16x32_bf16 v[76:79], v[252:255], a[188:191], v[76:79]
  ds_read_b64_tr_b16 v[252:253], v0 offset:34496
  s_waitcnt lgkmcnt(7)
  v_mfma_f32_16x16x32_bf16 v[80:83], v[232:235], a[160:163], v[80:83]
  ds_read_b64_tr_b16 v[254:255], v0 offset:34752
  v_perm_b32 v186, v171, v169, s44
  v_mfma_f32_16x16x32_bf16 v[84:87], v[232:235], a[164:167], v[84:87]
  v_mfma_f32_16x16x32_bf16 v[88:91], v[232:235], a[168:171], v[88:91]
  v_perm_b32 v187, v175, v173, s44
  v_mfma_f32_16x16x32_bf16 v[92:95], v[232:235], a[172:175], v[92:95]
  ds_read_b64_tr_b16 v[232:233], v0 offset:34016
  v_mfma_f32_16x16x32_bf16 v[80:83], v[236:239], a[176:179], v[80:83]
  ds_read_b64_tr_b16 v[234:235], v0 offset:34272
  buffer_store_dwordx4 v[184:187], v193, s[28:31], 0 offen offset:32
  v_mfma_f32_16x16x32_bf16 v[84:87], v[236:239], a[180:183], v[84:87]
  v_mfma_f32_16x16x32_bf16 v[88:91], v[236:239], a[184:187], v[88:91]
  v_perm_b32 v188, v163, v161, s45
  v_mfma_f32_16x16x32_bf16 v[92:95], v[236:239], a[188:191], v[92:95]
  ds_read_b64_tr_b16 v[236:237], v0 offset:34528
  s_barrier
  s_waitcnt lgkmcnt(7)
  v_mfma_f32_16x16x32_bf16 v[96:99], v[240:243], a[160:163], v[96:99]
  s_mov_b32 s35, 164096
  ds_read_b64_tr_b16 v[238:239], v0 offset:34784
  v_perm_b32 v189, v167, v165, s45
  v_mfma_f32_16x16x32_bf16 v[100:103], v[240:243], a[164:167], v[100:103]
  s_add_u32 m0, s34, 50688
  v_mfma_f32_16x16x32_bf16 v[104:107], v[240:243], a[168:171], v[104:107]
  buffer_load_dwordx4 v10, s[12:15], s35 offen offset:0 nt lds
  v_perm_b32 v190, v171, v169, s45
  v_mfma_f32_16x16x32_bf16 v[108:111], v[240:243], a[172:175], v[108:111]
  s_add_u32 m0, s34, 51232
  v_subrev_u32 v0, 50688, v0
  ds_read_b64_tr_b16 v[240:241], v0 offset:16896
  v_mfma_f32_16x16x32_bf16 v[96:99], v[244:247], a[176:179], v[96:99]
  ds_read_b64_tr_b16 v[242:243], v0 offset:17152
  v_perm_b32 v191, v175, v173, s45
  v_mfma_f32_16x16x32_bf16 v[100:103], v[244:247], a[180:183], v[100:103]
  v_mfma_f32_16x16x32_bf16 v[104:107], v[244:247], a[184:187], v[104:107]
  buffer_store_dwordx4 v[188:191], v193, s[28:31], 0 offen offset:48
  v_mfma_f32_16x16x32_bf16 v[108:111], v[244:247], a[188:191], v[108:111]
  ds_read_b64_tr_b16 v[244:245], v0 offset:17408
  s_waitcnt lgkmcnt(7)
  v_mfma_f32_16x16x32_bf16 v[112:115], v[248:251], a[160:163], v[112:115]
  ds_read_b64_tr_b16 v[246:247], v0 offset:17664
  buffer_load_dwordx4 v10, s[12:15], s35 offen offset:512 nt lds
  v_mfma_f32_16x16x32_bf16 v[116:119], v[248:251], a[164:167], v[116:119]
  s_add_u32 m0, s34, 51776
  v_mfma_f32_16x16x32_bf16 v[120:123], v[248:251], a[168:171], v[120:123]
  v_mfma_f32_16x16x32_bf16 v[124:127], v[248:251], a[172:175], v[124:127]
  ds_read_b64_tr_b16 v[248:249], v0 offset:16928
  v_mfma_f32_16x16x32_bf16 v[112:115], v[252:255], a[176:179], v[112:115]
  ds_read_b64_tr_b16 v[250:251], v0 offset:17184
  v_mfma_f32_16x16x32_bf16 v[116:119], v[252:255], a[180:183], v[116:119]
  buffer_load_dwordx4 v10, s[12:15], s35 offen offset:1024 nt lds
  v_mfma_f32_16x16x32_bf16 v[120:123], v[252:255], a[184:187], v[120:123]
  s_add_u32 m0, s34, 52320
  v_mfma_f32_16x16x32_bf16 v[124:127], v[252:255], a[188:191], v[124:127]
  ds_read_b64_tr_b16 v[252:253], v0 offset:17440
  s_waitcnt lgkmcnt(7)
  v_mfma_f32_16x16x32_bf16 v[128:131], v[232:235], a[160:163], v[128:131]
  ds_read_b64_tr_b16 v[254:255], v0 offset:17696
  v_mfma_f32_16x16x32_bf16 v[132:135], v[232:235], a[164:167], v[132:135]
  v_mfma_f32_16x16x32_bf16 v[136:139], v[232:235], a[168:171], v[136:139]
  buffer_load_dwordx4 v10, s[12:15], s35 offen offset:1536 nt lds
  v_mfma_f32_16x16x32_bf16 v[140:143], v[232:235], a[172:175], v[140:143]
  ds_read_b64_tr_b16 v[232:233], v0 offset:16960
  v_mfma_f32_16x16x32_bf16 v[128:131], v[236:239], a[176:179], v[128:131]
  ds_read_b64_tr_b16 v[234:235], v0 offset:17216
  v_mfma_f32_16x16x32_bf16 v[132:135], v[236:239], a[180:183], v[132:135]
  v_mfma_f32_16x16x32_bf16 v[136:139], v[236:239], a[184:187], v[136:139]
  v_mfma_f32_16x16x32_bf16 v[140:143], v[236:239], a[188:191], v[140:143]
  ds_read_b64_tr_b16 v[236:237], v0 offset:17472
  s_waitcnt lgkmcnt(7)
  v_mfma_f32_16x16x32_bf16 v[16:19], v[240:243], a[192:195], v[16:19]
  ds_read_b64_tr_b16 v[238:239], v0 offset:17728
  v_mfma_f32_16x16x32_bf16 v[20:23], v[240:243], a[196:199], v[20:23]
  v_mfma_f32_16x16x32_bf16 v[24:27], v[240:243], a[200:203], v[24:27]
  v_mfma_f32_16x16x32_bf16 v[28:31], v[240:243], a[204:207], v[28:31]
  ds_read_b64_tr_b16 v[240:241], v0 offset:16992
  v_mfma_f32_16x16x32_bf16 v[16:19], v[244:247], a[208:211], v[16:19]
  ds_read_b64_tr_b16 v[242:243], v0 offset:17248
  v_mfma_f32_16x16x32_bf16 v[20:23], v[244:247], a[212:215], v[20:23]
  v_mfma_f32_16x16x32_bf16 v[24:27], v[244:247], a[216:219], v[24:27]
  v_mfma_f32_16x16x32_bf16 v[28:31], v[244:247], a[220:223], v[28:31]
  ds_read_b64_tr_b16 v[244:245], v0 offset:17504
  s_waitcnt lgkmcnt(7)
  v_mfma_f32_16x16x32_bf16 v[32:35], v[248:251], a[192:195], v[32:35]
  ds_read_b64_tr_b16 v[246:247], v0 offset:17760
  v_mfma_f32_16x16x32_bf16 v[36:39], v[248:251], a[196:199], v[36:39]
  v_mfma_f32_16x16x32_bf16 v[40:43], v[248:251], a[200:203], v[40:43]
  v_mfma_f32_16x16x32_bf16 v[44:47], v[248:251], a[204:207], v[44:47]
  ds_read_b64_tr_b16 v[248:249], v0 offset:17024
  v_mfma_f32_16x16x32_bf16 v[32:35], v[252:255], a[208:211], v[32:35]
  ds_read_b64_tr_b16 v[250:251], v0 offset:17280
  v_mfma_f32_16x16x32_bf16 v[36:39], v[252:255], a[212:215], v[36:39]
  v_mfma_f32_16x16x32_bf16 v[40:43], v[252:255], a[216:219], v[40:43]
  v_mfma_f32_16x16x32_bf16 v[44:47], v[252:255], a[220:223], v[44:47]
  ds_read_b64_tr_b16 v[252:253], v0 offset:17536
  s_waitcnt lgkmcnt(7)
  v_mfma_f32_16x16x32_bf16 v[48:51], v[232:235], a[192:195], v[48:51]
  ds_read_b64_tr_b16 v[254:255], v0 offset:17792
  v_mfma_f32_16x16x32_bf16 v[52:55], v[232:235], a[196:199], v[52:55]
  v_mfma_f32_16x16x32_bf16 v[56:59], v[232:235], a[200:203], v[56:59]
  v_mfma_f32_16x16x32_bf16 v[60:63], v[232:235], a[204:207], v[60:63]
  ds_read_b64_tr_b16 v[232:233], v0 offset:17056
  v_mfma_f32_16x16x32_bf16 v[48:51], v[236:239], a[208:211], v[48:51]
  ds_read_b64_tr_b16 v[234:235], v0 offset:17312
  v_mfma_f32_16x16x32_bf16 v[52:55], v[236:239], a[212:215], v[52:55]
  v_mfma_f32_16x16x32_bf16 v[56:59], v[236:239], a[216:219], v[56:59]
  v_mfma_f32_16x16x32_bf16 v[60:63], v[236:239], a[220:223], v[60:63]
  ds_read_b64_tr_b16 v[236:237], v0 offset:17568
  s_waitcnt lgkmcnt(7)
  v_mfma_f32_16x16x32_bf16 v[64:67], v[240:243], a[192:195], v[64:67]
  ds_read_b64_tr_b16 v[238:239], v0 offset:17824
  v_mfma_f32_16x16x32_bf16 v[68:71], v[240:243], a[196:199], v[68:71]
  v_mfma_f32_16x16x32_bf16 v[72:75], v[240:243], a[200:203], v[72:75]
  v_mfma_f32_16x16x32_bf16 v[76:79], v[240:243], a[204:207], v[76:79]
  ds_read_b64_tr_b16 v[240:241], v0 offset:17088
  v_mfma_f32_16x16x32_bf16 v[64:67], v[244:247], a[208:211], v[64:67]
  ds_read_b64_tr_b16 v[242:243], v0 offset:17344
  v_mfma_f32_16x16x32_bf16 v[68:71], v[244:247], a[212:215], v[68:71]
  v_mfma_f32_16x16x32_bf16 v[72:75], v[244:247], a[216:219], v[72:75]
  v_mfma_f32_16x16x32_bf16 v[76:79], v[244:247], a[220:223], v[76:79]
  ds_read_b64_tr_b16 v[244:245], v0 offset:17600
  s_waitcnt lgkmcnt(7)
  v_mfma_f32_16x16x32_bf16 v[80:83], v[248:251], a[192:195], v[80:83]
  ds_read_b64_tr_b16 v[246:247], v0 offset:17856
  v_mfma_f32_16x16x32_bf16 v[84:87], v[248:251], a[196:199], v[84:87]
  v_mfma_f32_16x16x32_bf16 v[88:91], v[248:251], a[200:203], v[88:91]
  v_mfma_f32_16x16x32_bf16 v[92:95], v[248:251], a[204:207], v[92:95]
  ds_read_b64_tr_b16 v[248:249], v0 offset:17120
  v_mfma_f32_16x16x32_bf16 v[80:83], v[252:255], a[208:211], v[80:83]
  ds_read_b64_tr_b16 v[250:251], v0 offset:17376
  v_mfma_f32_16x16x32_bf16 v[84:87], v[252:255], a[212:215], v[84:87]
  v_mfma_f32_16x16x32_bf16 v[88:91], v[252:255], a[216:219], v[88:91]
  v_mfma_f32_16x16x32_bf16 v[92:95], v[252:255], a[220:223], v[92:95]
  ds_read_b64_tr_b16 v[252:253], v0 offset:17632
  s_barrier
  s_waitcnt lgkmcnt(7)
  v_mfma_f32_16x16x32_bf16 v[96:99], v[232:235], a[192:195], v[96:99]
  s_mov_b32 s35, 196864
  ds_read_b64_tr_b16 v[254:255], v0 offset:17888
  v_mfma_f32_16x16x32_bf16 v[100:103], v[232:235], a[196:199], v[100:103]
  s_add_u32 m0, s34, 84480
  v_mfma_f32_16x16x32_bf16 v[104:107], v[232:235], a[200:203], v[104:107]
  buffer_load_dwordx4 v10, s[12:15], s35 offen offset:0 nt lds
  v_mfma_f32_16x16x32_bf16 v[108:111], v[232:235], a[204:207], v[108:111]
  s_add_u32 m0, s34, 85024
  ds_read_b64_tr_b16 v[232:233], v0 offset:33792
  v_mfma_f32_16x16x32_bf16 v[96:99], v[236:239], a[208:211], v[96:99]
  ds_read_b64_tr_b16 v[234:235], v0 offset:34048
  v_mfma_f32_16x16x32_bf16 v[100:103], v[236:239], a[212:215], v[100:103]
  v_mfma_f32_16x16x32_bf16 v[104:107], v[236:239], a[216:219], v[104:107]
  v_mfma_f32_16x16x32_bf16 v[108:111], v[236:239], a[220:223], v[108:111]
  ds_read_b64_tr_b16 v[236:237], v0 offset:34304
  s_waitcnt lgkmcnt(7)
  v_mfma_f32_16x16x32_bf16 v[112:115], v[240:243], a[192:195], v[112:115]
  ds_read_b64_tr_b16 v[238:239], v0 offset:34560
  buffer_load_dwordx4 v10, s[12:15], s35 offen offset:512 nt lds
  v_mfma_f32_16x16x32_bf16 v[116:119], v[240:243], a[196:199], v[116:119]
  s_add_u32 m0, s34, 85568
  v_mfma_f32_16x16x32_bf16 v[120:123], v[240:243], a[200:203], v[120:123]
  v_mfma_f32_16x16x32_bf16 v[124:127], v[240:243], a[204:207], v[124:127]
  ds_read_b64_tr_b16 v[240:241], v0 offset:33824
  v_mfma_f32_16x16x32_bf16 v[112:115], v[244:247], a[208:211], v[112:115]
  ds_read_b64_tr_b16 v[242:243], v0 offset:34080
  v_mfma_f32_16x16x32_bf16 v[116:119], v[244:247], a[212:215], v[116:119]
  buffer_load_dwordx4 v10, s[12:15], s35 offen offset:1024 nt lds
  v_mfma_f32_16x16x32_bf16 v[120:123], v[244:247], a[216:219], v[120:123]
  s_add_u32 m0, s34, 86112
  v_mfma_f32_16x16x32_bf16 v[124:127], v[244:247], a[220:223], v[124:127]
  ds_read_b64_tr_b16 v[244:245], v0 offset:34336
  s_waitcnt lgkmcnt(7)
  v_mfma_f32_16x16x32_bf16 v[128:131], v[248:251], a[192:195], v[128:131]
  ds_read_b64_tr_b16 v[246:247], v0 offset:34592
  v_mfma_f32_16x16x32_bf16 v[132:135], v[248:251], a[196:199], v[132:135]
  v_mfma_f32_16x16x32_bf16 v[136:139], v[248:251], a[200:203], v[136:139]
  buffer_load_dwordx4 v10, s[12:15], s35 offen offset:1536 nt lds
  v_mfma_f32_16x16x32_bf16 v[140:143], v[248:251], a[204:207], v[140:143]
  ds_read_b64_tr_b16 v[248:249], v0 offset:33856
  v_mfma_f32_16x16x32_bf16 v[128:131], v[252:255], a[208:211], v[128:131]
  ds_read_b64_tr_b16 v[250:251], v0 offset:34112
  v_mfma_f32_16x16x32_bf16 v[132:135], v[252:255], a[212:215], v[132:135]
  v_mfma_f32_16x16x32_bf16 v[136:139], v[252:255], a[216:219], v[136:139]
  v_mfma_f32_16x16x32_bf16 v[140:143], v[252:255], a[220:223], v[140:143]
  ds_read_b64_tr_b16 v[252:253], v0 offset:34368
  s_waitcnt lgkmcnt(7)
  v_mfma_f32_16x16x32_bf16 v[16:19], v[232:235], a[224:227], v[16:19]
  ds_read_b64_tr_b16 v[254:255], v0 offset:34624
  v_mfma_f32_16x16x32_bf16 v[20:23], v[232:235], a[228:231], v[20:23]
  v_mfma_f32_16x16x32_bf16 v[24:27], v[232:235], a[232:235], v[24:27]
  v_mfma_f32_16x16x32_bf16 v[28:31], v[232:235], a[236:239], v[28:31]
  ds_read_b64_tr_b16 v[232:233], v0 offset:33888
  v_mfma_f32_16x16x32_bf16 v[16:19], v[236:239], a[240:243], v[16:19]
  ds_read_b64_tr_b16 v[234:235], v0 offset:34144
  v_mfma_f32_16x16x32_bf16 v[20:23], v[236:239], a[244:247], v[20:23]
  v_mfma_f32_16x16x32_bf16 v[24:27], v[236:239], a[248:251], v[24:27]
  v_mfma_f32_16x16x32_bf16 v[28:31], v[236:239], a[252:255], v[28:31]
  ds_read_b64_tr_b16 v[236:237], v0 offset:34400
  s_waitcnt lgkmcnt(7)
  v_mfma_f32_16x16x32_bf16 v[32:35], v[240:243], a[224:227], v[32:35]
  ds_read_b64_tr_b16 v[238:239], v0 offset:34656
  v_mfma_f32_16x16x32_bf16 v[36:39], v[240:243], a[228:231], v[36:39]
  v_mfma_f32_16x16x32_bf16 v[40:43], v[240:243], a[232:235], v[40:43]
  v_mfma_f32_16x16x32_bf16 v[44:47], v[240:243], a[236:239], v[44:47]
  ds_read_b64_tr_b16 v[240:241], v0 offset:33920
  v_mfma_f32_16x16x32_bf16 v[32:35], v[244:247], a[240:243], v[32:35]
  ds_read_b64_tr_b16 v[242:243], v0 offset:34176
  v_mfma_f32_16x16x32_bf16 v[36:39], v[244:247], a[244:247], v[36:39]
  v_mfma_f32_16x16x32_bf16 v[40:43], v[244:247], a[248:251], v[40:43]
  v_mfma_f32_16x16x32_bf16 v[44:47], v[244:247], a[252:255], v[44:47]
  ds_read_b64_tr_b16 v[244:245], v0 offset:34432
  s_waitcnt lgkmcnt(7)
  v_mfma_f32_16x16x32_bf16 v[48:51], v[248:251], a[224:227], v[48:51]
  ds_read_b64_tr_b16 v[246:247], v0 offset:34688
  v_mfma_f32_16x16x32_bf16 v[52:55], v[248:251], a[228:231], v[52:55]
  v_mfma_f32_16x16x32_bf16 v[56:59], v[248:251], a[232:235], v[56:59]
  v_mfma_f32_16x16x32_bf16 v[60:63], v[248:251], a[236:239], v[60:63]
  ds_read_b64_tr_b16 v[248:249], v0 offset:33952
  v_mul_f32 v16, v16, v6
  v_mfma_f32_16x16x32_bf16 v[48:51], v[252:255], a[240:243], v[48:51]
  ds_read_b64_tr_b16 v[250:251], v0 offset:34208
  v_mul_f32 v17, v17, v6
  v_mfma_f32_16x16x32_bf16 v[52:55], v[252:255], a[244:247], v[52:55]
  v_mul_f32 v18, v18, v6
  v_mul_f32 v19, v19, v6
  v_mfma_f32_16x16x32_bf16 v[56:59], v[252:255], a[248:251], v[56:59]
  v_mul_f32 v32, v32, v6
  v_mul_f32 v33, v33, v6
  v_mfma_f32_16x16x32_bf16 v[60:63], v[252:255], a[252:255], v[60:63]
  ds_read_b64_tr_b16 v[252:253], v0 offset:34464
  s_waitcnt lgkmcnt(7)
  v_mfma_f32_16x16x32_bf16 v[64:67], v[232:235], a[224:227], v[64:67]
  ds_read_b64_tr_b16 v[254:255], v0 offset:34720
  v_mul_f32 v34, v34, v6
  v_mfma_f32_16x16x32_bf16 v[68:71], v[232:235], a[228:231], v[68:71]
  v_mul_f32 v35, v35, v6
  v_cvt_pk_bf16_f32 v16, v16, v17
  v_mfma_f32_16x16x32_bf16 v[72:75], v[232:235], a[232:235], v[72:75]
  v_cvt_pk_bf16_f32 v17, v18, v19
  v_cvt_pk_bf16_f32 v18, v32, v33
  v_mfma_f32_16x16x32_bf16 v[76:79], v[232:235], a[236:239], v[76:79]
  ds_read_b64_tr_b16 v[232:233], v0 offset:33984
  v_cvt_pk_bf16_f32 v19, v34, v35
  v_mfma_f32_16x16x32_bf16 v[64:67], v[236:239], a[240:243], v[64:67]
  ds_read_b64_tr_b16 v[234:235], v0 offset:34240
  v_mul_f32 v20, v20, v7
  v_mfma_f32_16x16x32_bf16 v[68:71], v[236:239], a[244:247], v[68:71]
  v_mul_f32 v21, v21, v7
  v_mul_f32 v22, v22, v7
  v_mfma_f32_16x16x32_bf16 v[72:75], v[236:239], a[248:251], v[72:75]
  v_mul_f32 v23, v23, v7
  v_mul_f32 v36, v36, v7
  v_mfma_f32_16x16x32_bf16 v[76:79], v[236:239], a[252:255], v[76:79]
  ds_read_b64_tr_b16 v[236:237], v0 offset:34496
  s_waitcnt lgkmcnt(7)
  v_mfma_f32_16x16x32_bf16 v[80:83], v[240:243], a[224:227], v[80:83]
  ds_read_b64_tr_b16 v[238:239], v0 offset:34752
  v_mul_f32 v37, v37, v7
  v_mfma_f32_16x16x32_bf16 v[84:87], v[240:243], a[228:231], v[84:87]
  v_mul_f32 v38, v38, v7
  v_mul_f32 v39, v39, v7
  v_mfma_f32_16x16x32_bf16 v[88:91], v[240:243], a[232:235], v[88:91]
  v_cvt_pk_bf16_f32 v20, v20, v21
  v_cvt_pk_bf16_f32 v21, v22, v23
  v_mfma_f32_16x16x32_bf16 v[92:95], v[240:243], a[236:239], v[92:95]
  ds_read_b64_tr_b16 v[240:241], v0 offset:34016
  v_cvt_pk_bf16_f32 v22, v36, v37
  v_mfma_f32_16x16x32_bf16 v[80:83], v[244:247], a[240:243], v[80:83]
  ds_read_b64_tr_b16 v[242:243], v0 offset:34272
  v_cvt_pk_bf16_f32 v23, v38, v39
  v_mfma_f32_16x16x32_bf16 v[84:87], v[244:247], a[244:247], v[84:87]
  v_mul_f32 v24, v24, v8
  v_mul_f32 v25, v25, v8
  v_mfma_f32_16x16x32_bf16 v[88:91], v[244:247], a[248:251], v[88:91]
  v_mul_f32 v26, v26, v8
  v_mul_f32 v27, v27, v8
  v_mfma_f32_16x16x32_bf16 v[92:95], v[244:247], a[252:255], v[92:95]
  ds_read_b64_tr_b16 v[244:245], v0 offset:34528
  s_barrier
  s_waitcnt lgkmcnt(7)
  v_mfma_f32_16x16x32_bf16 v[96:99], v[248:251], a[224:227], v[96:99]
  s_mov_b32 s35, 229632
  ds_read_b64_tr_b16 v[246:247], v0 offset:34784
  v_mul_f32 v40, v40, v8
  v_mfma_f32_16x16x32_bf16 v[100:103], v[248:251], a[228:231], v[100:103]
  s_add_u32 m0, s34, 16896
  v_mul_f32 v41, v41, v8
  v_mul_f32 v42, v42, v8
  v_mfma_f32_16x16x32_bf16 v[104:107], v[248:251], a[232:235], v[104:107]
  buffer_load_dwordx4 v10, s[12:15], s35 offen offset:0 nt lds
  v_mul_f32 v43, v43, v8
  v_mfma_f32_16x16x32_bf16 v[108:111], v[248:251], a[236:239], v[108:111]
  s_add_u32 m0, s34, 17440
  v_add_u32 v0, 101376, v0
  ds_read_b64_tr_b16 v[248:249], v0 offset:33792
  v_mfma_f32_16x16x32_bf16 v[96:99], v[252:255], a[240:243], v[96:99]
  ds_read_b64_tr_b16 v[250:251], v0 offset:34048
  v_cvt_pk_bf16_f32 v24, v24, v25
  v_mfma_f32_16x16x32_bf16 v[100:103], v[252:255], a[244:247], v[100:103]
  v_cvt_pk_bf16_f32 v25, v26, v27
  v_cvt_pk_bf16_f32 v26, v40, v41
  v_mfma_f32_16x16x32_bf16 v[104:107], v[252:255], a[248:251], v[104:107]
  v_cvt_pk_bf16_f32 v27, v42, v43
  v_mul_f32 v28, v28, v9
  v_mfma_f32_16x16x32_bf16 v[108:111], v[252:255], a[252:255], v[108:111]
  ds_read_b64_tr_b16 v[252:253], v0 offset:34304
  s_waitcnt lgkmcnt(7)
  v_mfma_f32_16x16x32_bf16 v[112:115], v[232:235], a[224:227], v[112:115]
  ds_read_b64_tr_b16 v[254:255], v0 offset:34560
  buffer_load_dwordx4 v10, s[12:15], s35 offen offset:512 nt lds
  v_mfma_f32_16x16x32_bf16 v[116:119], v[232:235], a[228:231], v[116:119]
  s_add_u32 m0, s34, 17984
  v_mul_f32 v29, v29, v9
  v_mul_f32 v30, v30, v9
  v_mfma_f32_16x16x32_bf16 v[120:123], v[232:235], a[232:235], v[120:123]
  v_mul_f32 v31, v31, v9
  v_mul_f32 v44, v44, v9
  v_mfma_f32_16x16x32_bf16 v[124:127], v[232:235], a[236:239], v[124:127]
  ds_read_b64_tr_b16 v[232:233], v0 offset:33824
  v_mul_f32 v45, v45, v9
  v_mfma_f32_16x16x32_bf16 v[112:115], v[236:239], a[240:243], v[112:115]
  ds_read_b64_tr_b16 v[234:235], v0 offset:34080
  v_mul_f32 v46, v46, v9
  v_mfma_f32_16x16x32_bf16 v[116:119], v[236:239], a[244:247], v[116:119]
  buffer_load_dwordx4 v10, s[12:15], s35 offen offset:1024 nt lds
  v_mul_f32 v47, v47, v9
  v_mfma_f32_16x16x32_bf16 v[120:123], v[236:239], a[248:251], v[120:123]
  s_add_u32 m0, s34, 18528
  v_cvt_pk_bf16_f32 v28, v28, v29
  v_cvt_pk_bf16_f32 v29, v30, v31
  v_mfma_f32_16x16x32_bf16 v[124:127], v[236:239], a[252:255], v[124:127]
  ds_read_b64_tr_b16 v[236:237], v0 offset:34336
  s_waitcnt lgkmcnt(7)
  v_mfma_f32_16x16x32_bf16 v[128:131], v[240:243], a[224:227], v[128:131]
  ds_read_b64_tr_b16 v[238:239], v0 offset:34592
  v_cvt_pk_bf16_f32 v30, v44, v45
  v_mfma_f32_16x16x32_bf16 v[132:135], v[240:243], a[228:231], v[132:135]
  v_cvt_pk_bf16_f32 v31, v46, v47
  v_mul_f32 v48, v48, v6
  v_mfma_f32_16x16x32_bf16 v[136:139], v[240:243], a[232:235], v[136:139]
  buffer_load_dwordx4 v10, s[12:15], s35 offen offset:1536 nt lds
  v_mul_f32 v49, v49, v6
  v_mfma_f32_16x16x32_bf16 v[140:143], v[240:243], a[236:239], v[140:143]
  ds_read_b64_tr_b16 v[240:241], v0 offset:33856
  v_mul_f32 v50, v50, v6
  v_mfma_f32_16x16x32_bf16 v[128:131], v[244:247], a[240:243], v[128:131]
  ds_read_b64_tr_b16 v[242:243], v0 offset:34112
  v_mul_f32 v51, v51, v6
  v_mfma_f32_16x16x32_bf16 v[132:135], v[244:247], a[244:247], v[132:135]
  v_mul_f32 v64, v64, v6
  v_mul_f32 v65, v65, v6
  v_mfma_f32_16x16x32_bf16 v[136:139], v[244:247], a[248:251], v[136:139]
  v_mul_f32 v66, v66, v6
  v_mul_f32 v67, v67, v6
  v_mfma_f32_16x16x32_bf16 v[140:143], v[244:247], a[252:255], v[140:143]
  ds_read_b64_tr_b16 v[244:245], v0 offset:34368
  s_waitcnt lgkmcnt(7)
  v_mfma_f32_16x16x32_bf16 v[144:147], v[248:251], a[0:3], 0
  ds_read_b64_tr_b16 v[246:247], v0 offset:34624
  v_cvt_pk_bf16_f32 v48, v48, v49
  v_mfma_f32_16x16x32_bf16 v[148:151], v[248:251], a[4:7], 0
  v_cvt_pk_bf16_f32 v49, v50, v51
  v_cvt_pk_bf16_f32 v50, v64, v65
  v_mfma_f32_16x16x32_bf16 v[152:155], v[248:251], a[8:11], 0
  v_cvt_pk_bf16_f32 v51, v66, v67
  v_mul_f32 v52, v52, v7
  v_mfma_f32_16x16x32_bf16 v[156:159], v[248:251], a[12:15], 0
  ds_read_b64_tr_b16 v[248:249], v0 offset:33888
  v_mul_f32 v53, v53, v7
  v_mfma_f32_16x16x32_bf16 v[144:147], v[252:255], a[16:19], v[144:147]
  ds_read_b64_tr_b16 v[250:251], v0 offset:34144
  v_mul_f32 v54, v54, v7
  v_mfma_f32_16x16x32_bf16 v[148:151], v[252:255], a[20:23], v[148:151]
  v_mul_f32 v55, v55, v7
  v_mul_f32 v68, v68, v7
  v_mfma_f32_16x16x32_bf16 v[152:155], v[252:255], a[24:27], v[152:155]
  v_mul_f32 v69, v69, v7
  v_mul_f32 v70, v70, v7
  v_mfma_f32_16x16x32_bf16 v[156:159], v[252:255], a[28:31], v[156:159]
  ds_read_b64_tr_b16 v[252:253], v0 offset:34400
  s_waitcnt lgkmcnt(7)
  v_mfma_f32_16x16x32_bf16 v[160:163], v[232:235], a[0:3], 0
  ds_read_b64_tr_b16 v[254:255], v0 offset:34656
  v_mul_f32 v71, v71, v7
  v_mfma_f32_16x16x32_bf16 v[164:167], v[232:235], a[4:7], 0
  v_cvt_pk_bf16_f32 v52, v52, v53
  v_cvt_pk_bf16_f32 v53, v54, v55
  v_mfma_f32_16x16x32_bf16 v[168:171], v[232:235], a[8:11], 0
  v_cvt_pk_bf16_f32 v54, v68, v69
  v_cvt_pk_bf16_f32 v55, v70, v71
  v_mfma_f32_16x16x32_bf16 v[172:175], v[232:235], a[12:15], 0
  ds_read_b64_tr_b16 v[232:233], v0 offset:33920
  v_mul_f32 v56, v56, v8
  v_mfma_f32_16x16x32_bf16 v[160:163], v[236:239], a[16:19], v[160:163]
  ds_read_b64_tr_b16 v[234:235], v0 offset:34176
  v_mul_f32 v57, v57, v8
  v_mfma_f32_16x16x32_bf16 v[164:167], v[236:239], a[20:23], v[164:167]
  v_mul_f32 v58, v58, v8
  v_mul_f32 v59, v59, v8
  v_mfma_f32_16x16x32_bf16 v[168:171], v[236:239], a[24:27], v[168:171]
  v_mul_f32 v72, v72, v8
  v_mul_f32 v73, v73, v8
  v_mfma_f32_16x16x32_bf16 v[172:175], v[236:239], a[28:31], v[172:175]
  ds_read_b64_tr_b16 v[236:237], v0 offset:34432
  s_waitcnt lgkmcnt(7)
  v_mfma_f32_16x16x32_bf16 v[176:179], v[240:243], a[0:3], 0
  ds_read_b64_tr_b16 v[238:239], v0 offset:34688
  v_mul_f32 v74, v74, v8
  v_mfma_f32_16x16x32_bf16 v[180:183], v[240:243], a[4:7], 0
  v_mul_f32 v75, v75, v8
  v_cvt_pk_bf16_f32 v56, v56, v57
  v_mfma_f32_16x16x32_bf16 v[184:187], v[240:243], a[8:11], 0
  v_cvt_pk_bf16_f32 v57, v58, v59
  v_cvt_pk_bf16_f32 v58, v72, v73
  v_mfma_f32_16x16x32_bf16 v[188:191], v[240:243], a[12:15], 0
  ds_read_b64_tr_b16 v[240:241], v0 offset:33952
  v_cvt_pk_bf16_f32 v59, v74, v75
  v_mfma_f32_16x16x32_bf16 v[176:179], v[244:247], a[16:19], v[176:179]
  ds_read_b64_tr_b16 v[242:243], v0 offset:34208
  v_mul_f32 v60, v60, v9
  v_mfma_f32_16x16x32_bf16 v[180:183], v[244:247], a[20:23], v[180:183]
  v_mul_f32 v61, v61, v9
  v_mul_f32 v62, v62, v9
  v_mfma_f32_16x16x32_bf16 v[184:187], v[244:247], a[24:27], v[184:187]
  v_mul_f32 v63, v63, v9
  v_mul_f32 v76, v76, v9
  v_mfma_f32_16x16x32_bf16 v[188:191], v[244:247], a[28:31], v[188:191]
  ds_read_b64_tr_b16 v[244:245], v0 offset:34464
  s_waitcnt lgkmcnt(7)
  v_mfma_f32_16x16x32_bf16 v[192:195], v[248:251], a[0:3], 0
  ds_read_b64_tr_b16 v[246:247], v0 offset:34720
  v_mul_f32 v77, v77, v9
  v_mfma_f32_16x16x32_bf16 v[196:199], v[248:251], a[4:7], 0
  v_mul_f32 v78, v78, v9
  v_mul_f32 v79, v79, v9
  v_mfma_f32_16x16x32_bf16 v[200:203], v[248:251], a[8:11], 0
  v_cvt_pk_bf16_f32 v60, v60, v61
  v_cvt_pk_bf16_f32 v61, v62, v63
  v_mfma_f32_16x16x32_bf16 v[204:207], v[248:251], a[12:15], 0
  ds_read_b64_tr_b16 v[248:249], v0 offset:33984
  v_cvt_pk_bf16_f32 v62, v76, v77
  v_mfma_f32_16x16x32_bf16 v[192:195], v[252:255], a[16:19], v[192:195]
  ds_read_b64_tr_b16 v[250:251], v0 offset:34240
  v_cvt_pk_bf16_f32 v63, v78, v79
  v_mfma_f32_16x16x32_bf16 v[196:199], v[252:255], a[20:23], v[196:199]
  v_mul_f32 v80, v80, v6
  v_mul_f32 v81, v81, v6
  v_mfma_f32_16x16x32_bf16 v[200:203], v[252:255], a[24:27], v[200:203]
  v_mul_f32 v82, v82, v6
  v_mul_f32 v83, v83, v6
  v_mfma_f32_16x16x32_bf16 v[204:207], v[252:255], a[28:31], v[204:207]
  ds_read_b64_tr_b16 v[252:253], v0 offset:34496
  s_waitcnt lgkmcnt(7)
  v_mfma_f32_16x16x32_bf16 v[32:35], v[232:235], a[0:3], 0
  ds_read_b64_tr_b16 v[254:255], v0 offset:34752
  v_mul_f32 v96, v96, v6
  v_mfma_f32_16x16x32_bf16 v[36:39], v[232:235], a[4:7], 0
  v_mul_f32 v97, v97, v6
  v_mul_f32 v98, v98, v6
  v_mfma_f32_16x16x32_bf16 v[40:43], v[232:235], a[8:11], 0
  v_mul_f32 v99, v99, v6
  v_cvt_pk_bf16_f32 v80, v80, v81
  v_mfma_f32_16x16x32_bf16 v[44:47], v[232:235], a[12:15], 0
  ds_read_b64_tr_b16 v[232:233], v0 offset:34016
  v_cvt_pk_bf16_f32 v81, v82, v83
  v_mfma_f32_16x16x32_bf16 v[32:35], v[236:239], a[16:19], v[32:35]
  ds_read_b64_tr_b16 v[234:235], v0 offset:34272
  v_cvt_pk_bf16_f32 v82, v96, v97
  v_mfma_f32_16x16x32_bf16 v[36:39], v[236:239], a[20:23], v[36:39]
  v_cvt_pk_bf16_f32 v83, v98, v99
  v_mul_f32 v84, v84, v7
  v_mfma_f32_16x16x32_bf16 v[40:43], v[236:239], a[24:27], v[40:43]
  v_mul_f32 v85, v85, v7
  v_mul_f32 v86, v86, v7
  v_mfma_f32_16x16x32_bf16 v[44:47], v[236:239], a[28:31], v[44:47]
  ds_read_b64_tr_b16 v[236:237], v0 offset:34528
  s_barrier
  s_waitcnt lgkmcnt(7)
  v_mfma_f32_16x16x32_bf16 v[64:67], v[240:243], a[0:3], 0
  ds_read_b64_tr_b16 v[238:239], v0 offset:34784
  v_mul_f32 v87, v87, v7
  v_mfma_f32_16x16x32_bf16 v[68:71], v[240:243], a[4:7], 0
  v_mul_f32 v100, v100, v7
  v_mul_f32 v101, v101, v7
  v_mfma_f32_16x16x32_bf16 v[72:75], v[240:243], a[8:11], 0
  v_mul_f32 v102, v102, v7
  v_mul_f32 v103, v103, v7
  v_mfma_f32_16x16x32_bf16 v[76:79], v[240:243], a[12:15], 0
  v_subrev_u32 v0, 101376, v0
  ds_read_b64_tr_b16 v[240:241], v0 offset:0
  v_mfma_f32_16x16x32_bf16 v[64:67], v[244:247], a[16:19], v[64:67]
  ds_read_b64_tr_b16 v[242:243], v0 offset:256
  v_cvt_pk_bf16_f32 v84, v84, v85
  v_cvt_pk_bf16_f32 v85, v86, v87
  v_cvt_pk_bf16_f32 v86, v100, v101
  v_cvt_pk_bf16_f32 v87, v102, v103
  v_mul_f32 v88, v88, v8
  v_mul_f32 v89, v89, v8
  v_mul_f32 v90, v90, v8
  v_mul_f32 v91, v91, v8
  v_mul_f32 v104, v104, v8
  v_mul_f32 v105, v105, v8
  v_mul_f32 v106, v106, v8
  v_mul_f32 v107, v107, v8
  v_cvt_pk_bf16_f32 v88, v88, v89
  v_cvt_pk_bf16_f32 v89, v90, v91
  v_cvt_pk_bf16_f32 v90, v104, v105
  v_cvt_pk_bf16_f32 v91, v106, v107
  v_mul_f32 v92, v92, v9
  v_mul_f32 v93, v93, v9
  v_mul_f32 v94, v94, v9
  v_mul_f32 v95, v95, v9
  v_mul_f32 v108, v108, v9
  v_mul_f32 v109, v109, v9
  v_mul_f32 v110, v110, v9
  v_mul_f32 v111, v111, v9
  v_cvt_pk_bf16_f32 v92, v92, v93
  v_cvt_pk_bf16_f32 v93, v94, v95
  v_cvt_pk_bf16_f32 v94, v108, v109
  v_cvt_pk_bf16_f32 v95, v110, v111
  v_mfma_f32_16x16x32_bf16 v[68:71], v[244:247], a[20:23], v[68:71]
  v_mul_f32 v112, v112, v6
  v_mul_f32 v113, v113, v6
  v_mfma_f32_16x16x32_bf16 v[72:75], v[244:247], a[24:27], v[72:75]
  v_mul_f32 v114, v114, v6
  v_mul_f32 v115, v115, v6
  v_mfma_f32_16x16x32_bf16 v[76:79], v[244:247], a[28:31], v[76:79]
  ds_read_b64_tr_b16 v[244:245], v0 offset:512
  s_waitcnt lgkmcnt(7)
  v_mfma_f32_16x16x32_bf16 v[96:99], v[248:251], a[0:3], 0
  ds_read_b64_tr_b16 v[246:247], v0 offset:768
  v_mul_f32 v128, v128, v6
  v_mfma_f32_16x16x32_bf16 v[100:103], v[248:251], a[4:7], 0
  v_mul_f32 v129, v129, v6
  v_mul_f32 v130, v130, v6
  v_mfma_f32_16x16x32_bf16 v[104:107], v[248:251], a[8:11], 0
  v_mul_f32 v131, v131, v6
  v_cvt_pk_bf16_f32 v112, v112, v113
  v_mfma_f32_16x16x32_bf16 v[108:111], v[248:251], a[12:15], 0
  ds_read_b64_tr_b16 v[248:249], v0 offset:32
  v_cvt_pk_bf16_f32 v113, v114, v115
  v_mfma_f32_16x16x32_bf16 v[96:99], v[252:255], a[16:19], v[96:99]
  ds_read_b64_tr_b16 v[250:251], v0 offset:288
  v_cvt_pk_bf16_f32 v114, v128, v129
  v_cvt_pk_bf16_f32 v115, v130, v131
  v_mul_f32 v116, v116, v7
  v_mul_f32 v117, v117, v7
  v_mul_f32 v118, v118, v7
  v_mul_f32 v119, v119, v7
  v_mul_f32 v132, v132, v7
  v_mul_f32 v133, v133, v7
  v_mul_f32 v134, v134, v7
  v_mul_f32 v135, v135, v7
  v_cvt_pk_bf16_f32 v116, v116, v117
  v_cvt_pk_bf16_f32 v117, v118, v119
  v_cvt_pk_bf16_f32 v118, v132, v133
  v_cvt_pk_bf16_f32 v119, v134, v135
  v_mul_f32 v120, v120, v8
  v_mul_f32 v121, v121, v8
  v_mul_f32 v122, v122, v8
  v_mul_f32 v123, v123, v8
  v_mul_f32 v136, v136, v8
  v_mul_f32 v137, v137, v8
  v_mul_f32 v138, v138, v8
  v_mul_f32 v139, v139, v8
  v_cvt_pk_bf16_f32 v120, v120, v121
  v_cvt_pk_bf16_f32 v121, v122, v123
  v_cvt_pk_bf16_f32 v122, v136, v137
  v_cvt_pk_bf16_f32 v123, v138, v139
  v_mul_f32 v124, v124, v9
  v_mul_f32 v125, v125, v9
  v_mul_f32 v126, v126, v9
  v_mul_f32 v127, v127, v9
  v_mul_f32 v140, v140, v9
  v_mul_f32 v141, v141, v9
  v_mul_f32 v142, v142, v9
  v_mul_f32 v143, v143, v9
  v_cvt_pk_bf16_f32 v124, v124, v125
  v_cvt_pk_bf16_f32 v125, v126, v127
  v_cvt_pk_bf16_f32 v126, v140, v141
  v_cvt_pk_bf16_f32 v127, v142, v143
  v_mfma_f32_16x16x32_bf16 v[100:103], v[252:255], a[20:23], v[100:103]
  buffer_store_dwordx4 v[16:19], v5, s[24:27], s48 offen offset:0 sc1
  buffer_store_dwordx4 v[20:23], v5, s[24:27], s50 offen offset:0 sc1
  v_mfma_f32_16x16x32_bf16 v[104:107], v[252:255], a[24:27], v[104:107]
  v_mfma_f32_16x16x32_bf16 v[108:111], v[252:255], a[28:31], v[108:111]
  ds_read_b64_tr_b16 v[252:253], v0 offset:544
  s_waitcnt lgkmcnt(7)
  v_mfma_f32_16x16x32_bf16 v[128:131], v[232:235], a[0:3], 0
  ds_read_b64_tr_b16 v[254:255], v0 offset:800
  v_mfma_f32_16x16x32_bf16 v[132:135], v[232:235], a[4:7], 0
  v_mfma_f32_16x16x32_bf16 v[136:139], v[232:235], a[8:11], 0
  v_mfma_f32_16x16x32_bf16 v[140:143], v[232:235], a[12:15], 0
  ds_read_b64_tr_b16 v[232:233], v0 offset:64
  v_mfma_f32_16x16x32_bf16 v[128:131], v[236:239], a[16:19], v[128:131]
  ds_read_b64_tr_b16 v[234:235], v0 offset:320
  v_mfma_f32_16x16x32_bf16 v[132:135], v[236:239], a[20:23], v[132:135]
  v_mfma_f32_16x16x32_bf16 v[136:139], v[236:239], a[24:27], v[136:139]
  v_mfma_f32_16x16x32_bf16 v[140:143], v[236:239], a[28:31], v[140:143]
  ds_read_b64_tr_b16 v[236:237], v0 offset:576
  s_waitcnt lgkmcnt(7)
  v_mfma_f32_16x16x32_bf16 v[144:147], v[240:243], a[32:35], v[144:147]
  ds_read_b64_tr_b16 v[238:239], v0 offset:832
  buffer_store_dwordx4 v[24:27], v5, s[24:27], s52 offen offset:0 sc1
  v_mfma_f32_16x16x32_bf16 v[148:151], v[240:243], a[36:39], v[148:151]
  v_mfma_f32_16x16x32_bf16 v[152:155], v[240:243], a[40:43], v[152:155]
  v_mfma_f32_16x16x32_bf16 v[156:159], v[240:243], a[44:47], v[156:159]
  ds_read_b64_tr_b16 v[240:241], v0 offset:96
  v_mfma_f32_16x16x32_bf16 v[144:147], v[244:247], a[48:51], v[144:147]
  ds_read_b64_tr_b16 v[242:243], v0 offset:352
  v_mfma_f32_16x16x32_bf16 v[148:151], v[244:247], a[52:55], v[148:151]
  v_mfma_f32_16x16x32_bf16 v[152:155], v[244:247], a[56:59], v[152:155]
  v_mfma_f32_16x16x32_bf16 v[156:159], v[244:247], a[60:63], v[156:159]
  ds_read_b64_tr_b16 v[244:245], v0 offset:608
  s_waitcnt lgkmcnt(7)
  v_mfma_f32_16x16x32_bf16 v[160:163], v[248:251], a[32:35], v[160:163]
  ds_read_b64_tr_b16 v[246:247], v0 offset:864
  v_mfma_f32_16x16x32_bf16 v[164:167], v[248:251], a[36:39], v[164:167]
  v_mfma_f32_16x16x32_bf16 v[168:171], v[248:251], a[40:43], v[168:171]
  v_mfma_f32_16x16x32_bf16 v[172:175], v[248:251], a[44:47], v[172:175]
  ds_read_b64_tr_b16 v[248:249], v0 offset:128
  v_mfma_f32_16x16x32_bf16 v[160:163], v[252:255], a[48:51], v[160:163]
  ds_read_b64_tr_b16 v[250:251], v0 offset:384
  v_mfma_f32_16x16x32_bf16 v[164:167], v[252:255], a[52:55], v[164:167]
  v_mfma_f32_16x16x32_bf16 v[168:171], v[252:255], a[56:59], v[168:171]
  buffer_store_dwordx4 v[28:31], v5, s[24:27], s54 offen offset:0 sc1
  v_mfma_f32_16x16x32_bf16 v[172:175], v[252:255], a[60:63], v[172:175]
  ds_read_b64_tr_b16 v[252:253], v0 offset:640
  s_waitcnt lgkmcnt(7)
  v_mfma_f32_16x16x32_bf16 v[176:179], v[232:235], a[32:35], v[176:179]
  ds_read_b64_tr_b16 v[254:255], v0 offset:896
  v_mfma_f32_16x16x32_bf16 v[180:183], v[232:235], a[36:39], v[180:183]
  v_mfma_f32_16x16x32_bf16 v[184:187], v[232:235], a[40:43], v[184:187]
  v_mfma_f32_16x16x32_bf16 v[188:191], v[232:235], a[44:47], v[188:191]
  ds_read_b64_tr_b16 v[232:233], v0 offset:160
  v_mfma_f32_16x16x32_bf16 v[176:179], v[236:239], a[48:51], v[176:179]
  ds_read_b64_tr_b16 v[234:235], v0 offset:416
  v_mfma_f32_16x16x32_bf16 v[180:183], v[236:239], a[52:55], v[180:183]
  v_mfma_f32_16x16x32_bf16 v[184:187], v[236:239], a[56:59], v[184:187]
  v_mfma_f32_16x16x32_bf16 v[188:191], v[236:239], a[60:63], v[188:191]
  ds_read_b64_tr_b16 v[236:237], v0 offset:672
  s_waitcnt lgkmcnt(7)
  v_mfma_f32_16x16x32_bf16 v[192:195], v[240:243], a[32:35], v[192:195]
  ds_read_b64_tr_b16 v[238:239], v0 offset:928
  v_mfma_f32_16x16x32_bf16 v[196:199], v[240:243], a[36:39], v[196:199]
  v_mfma_f32_16x16x32_bf16 v[200:203], v[240:243], a[40:43], v[200:203]
  v_mfma_f32_16x16x32_bf16 v[204:207], v[240:243], a[44:47], v[204:207]
  ds_read_b64_tr_b16 v[240:241], v0 offset:192
  v_mfma_f32_16x16x32_bf16 v[192:195], v[244:247], a[48:51], v[192:195]
  ds_read_b64_tr_b16 v[242:243], v0 offset:448
  v_mfma_f32_16x16x32_bf16 v[196:199], v[244:247], a[52:55], v[196:199]
  v_mfma_f32_16x16x32_bf16 v[200:203], v[244:247], a[56:59], v[200:203]
  buffer_store_dwordx4 v[48:51], v5, s[24:27], s48 offen offset:1024 sc1
  v_mfma_f32_16x16x32_bf16 v[204:207], v[244:247], a[60:63], v[204:207]
  ds_read_b64_tr_b16 v[244:245], v0 offset:704
  s_waitcnt lgkmcnt(7)
  v_mfma_f32_16x16x32_bf16 v[32:35], v[248:251], a[32:35], v[32:35]
  ds_read_b64_tr_b16 v[246:247], v0 offset:960
  v_mfma_f32_16x16x32_bf16 v[36:39], v[248:251], a[36:39], v[36:39]
  v_mfma_f32_16x16x32_bf16 v[40:43], v[248:251], a[40:43], v[40:43]
  v_mfma_f32_16x16x32_bf16 v[44:47], v[248:251], a[44:47], v[44:47]
  ds_read_b64_tr_b16 v[248:249], v0 offset:224
  v_mfma_f32_16x16x32_bf16 v[32:35], v[252:255], a[48:51], v[32:35]
  ds_read_b64_tr_b16 v[250:251], v0 offset:480
  v_mfma_f32_16x16x32_bf16 v[36:39], v[252:255], a[52:55], v[36:39]
  v_mfma_f32_16x16x32_bf16 v[40:43], v[252:255], a[56:59], v[40:43]
  v_mfma_f32_16x16x32_bf16 v[44:47], v[252:255], a[60:63], v[44:47]
  ds_read_b64_tr_b16 v[252:253], v0 offset:736
  s_barrier
  s_waitcnt lgkmcnt(7)
  v_mfma_f32_16x16x32_bf16 v[64:67], v[232:235], a[32:35], v[64:67]
  ds_read_b64_tr_b16 v[254:255], v0 offset:992
  v_mfma_f32_16x16x32_bf16 v[68:71], v[232:235], a[36:39], v[68:71]
  v_mfma_f32_16x16x32_bf16 v[72:75], v[232:235], a[40:43], v[72:75]
  v_mfma_f32_16x16x32_bf16 v[76:79], v[232:235], a[44:47], v[76:79]
  v_add_u32 v0, 101376, v0
  ds_read_b64_tr_b16 v[232:233], v0 offset:0
  v_mfma_f32_16x16x32_bf16 v[64:67], v[236:239], a[48:51], v[64:67]
  ds_read_b64_tr_b16 v[234:235], v0 offset:256
  v_mfma_f32_16x16x32_bf16 v[68:71], v[236:239], a[52:55], v[68:71]
  v_mfma_f32_16x16x32_bf16 v[72:75], v[236:239], a[56:59], v[72:75]
  buffer_store_dwordx4 v[52:55], v5, s[24:27], s50 offen offset:1024 sc1
  v_mfma_f32_16x16x32_bf16 v[76:79], v[236:239], a[60:63], v[76:79]
  ds_read_b64_tr_b16 v[236:237], v0 offset:512
  s_waitcnt lgkmcnt(7)
  v_mfma_f32_16x16x32_bf16 v[96:99], v[240:243], a[32:35], v[96:99]
  ds_read_b64_tr_b16 v[238:239], v0 offset:768
  v_mfma_f32_16x16x32_bf16 v[100:103], v[240:243], a[36:39], v[100:103]
  v_mfma_f32_16x16x32_bf16 v[104:107], v[240:243], a[40:43], v[104:107]
  v_mfma_f32_16x16x32_bf16 v[108:111], v[240:243], a[44:47], v[108:111]
  ds_read_b64_tr_b16 v[240:241], v0 offset:32
  v_mfma_f32_16x16x32_bf16 v[96:99], v[244:247], a[48:51], v[96:99]
  ds_read_b64_tr_b16 v[242:243], v0 offset:288
  v_mfma_f32_16x16x32_bf16 v[100:103], v[244:247], a[52:55], v[100:103]
  v_mfma_f32_16x16x32_bf16 v[104:107], v[244:247], a[56:59], v[104:107]
  v_mfma_f32_16x16x32_bf16 v[108:111], v[244:247], a[60:63], v[108:111]
  ds_read_b64_tr_b16 v[244:245], v0 offset:544
  s_waitcnt lgkmcnt(7)
  v_mfma_f32_16x16x32_bf16 v[128:131], v[248:251], a[32:35], v[128:131]
  ds_read_b64_tr_b16 v[246:247], v0 offset:800
  v_mfma_f32_16x16x32_bf16 v[132:135], v[248:251], a[36:39], v[132:135]
  v_mfma_f32_16x16x32_bf16 v[136:139], v[248:251], a[40:43], v[136:139]
  v_mfma_f32_16x16x32_bf16 v[140:143], v[248:251], a[44:47], v[140:143]
  ds_read_b64_tr_b16 v[248:249], v0 offset:64
  v_mfma_f32_16x16x32_bf16 v[128:131], v[252:255], a[48:51], v[128:131]
  ds_read_b64_tr_b16 v[250:251], v0 offset:320
  v_mfma_f32_16x16x32_bf16 v[132:135], v[252:255], a[52:55], v[132:135]
  buffer_store_dwordx4 v[56:59], v5, s[24:27], s52 offen offset:1024 sc1
  v_mfma_f32_16x16x32_bf16 v[136:139], v[252:255], a[56:59], v[136:139]
  v_mfma_f32_16x16x32_bf16 v[140:143], v[252:255], a[60:63], v[140:143]
  ds_read_b64_tr_b16 v[252:253], v0 offset:576
  s_waitcnt lgkmcnt(7)
  v_mfma_f32_16x16x32_bf16 v[144:147], v[232:235], a[64:67], v[144:147]
  ds_read_b64_tr_b16 v[254:255], v0 offset:832
  v_mfma_f32_16x16x32_bf16 v[148:151], v[232:235], a[68:71], v[148:151]
  v_mfma_f32_16x16x32_bf16 v[152:155], v[232:235], a[72:75], v[152:155]
  v_mfma_f32_16x16x32_bf16 v[156:159], v[232:235], a[76:79], v[156:159]
  ds_read_b64_tr_b16 v[232:233], v0 offset:96
  v_mfma_f32_16x16x32_bf16 v[144:147], v[236:239], a[80:83], v[144:147]
  ds_read_b64_tr_b16 v[234:235], v0 offset:352
  v_mfma_f32_16x16x32_bf16 v[148:151], v[236:239], a[84:87], v[148:151]
  v_mfma_f32_16x16x32_bf16 v[152:155], v[236:239], a[88:91], v[152:155]
  v_mfma_f32_16x16x32_bf16 v[156:159], v[236:239], a[92:95], v[156:159]
  ds_read_b64_tr_b16 v[236:237], v0 offset:608
  s_waitcnt lgkmcnt(7)
  v_mfma_f32_16x16x32_bf16 v[160:163], v[240:243], a[64:67], v[160:163]
  ds_read_b64_tr_b16 v[238:239], v0 offset:864
  v_mfma_f32_16x16x32_bf16 v[164:167], v[240:243], a[68:71], v[164:167]
  v_mfma_f32_16x16x32_bf16 v[168:171], v[240:243], a[72:75], v[168:171]
  v_mfma_f32_16x16x32_bf16 v[172:175], v[240:243], a[76:79], v[172:175]
  ds_read_b64_tr_b16 v[240:241], v0 offset:128
  v_mfma_f32_16x16x32_bf16 v[160:163], v[244:247], a[80:83], v[160:163]
  ds_read_b64_tr_b16 v[242:243], v0 offset:384
  v_mfma_f32_16x16x32_bf16 v[164:167], v[244:247], a[84:87], v[164:167]
  buffer_store_dwordx4 v[60:63], v5, s[24:27], s54 offen offset:1024 sc1
  v_mfma_f32_16x16x32_bf16 v[168:171], v[244:247], a[88:91], v[168:171]
  v_mfma_f32_16x16x32_bf16 v[172:175], v[244:247], a[92:95], v[172:175]
  ds_read_b64_tr_b16 v[244:245], v0 offset:640
  s_waitcnt lgkmcnt(7)
  v_mfma_f32_16x16x32_bf16 v[176:179], v[248:251], a[64:67], v[176:179]
  ds_read_b64_tr_b16 v[246:247], v0 offset:896
  v_mfma_f32_16x16x32_bf16 v[180:183], v[248:251], a[68:71], v[180:183]
  v_mfma_f32_16x16x32_bf16 v[184:187], v[248:251], a[72:75], v[184:187]
  v_mfma_f32_16x16x32_bf16 v[188:191], v[248:251], a[76:79], v[188:191]
  ds_read_b64_tr_b16 v[248:249], v0 offset:160
  v_mfma_f32_16x16x32_bf16 v[176:179], v[252:255], a[80:83], v[176:179]
  ds_read_b64_tr_b16 v[250:251], v0 offset:416
  v_mfma_f32_16x16x32_bf16 v[180:183], v[252:255], a[84:87], v[180:183]
  v_mfma_f32_16x16x32_bf16 v[184:187], v[252:255], a[88:91], v[184:187]
  v_mfma_f32_16x16x32_bf16 v[188:191], v[252:255], a[92:95], v[188:191]
  ds_read_b64_tr_b16 v[252:253], v0 offset:672
  s_waitcnt lgkmcnt(7)
  v_mfma_f32_16x16x32_bf16 v[192:195], v[232:235], a[64:67], v[192:195]
  ds_read_b64_tr_b16 v[254:255], v0 offset:928
  v_mfma_f32_16x16x32_bf16 v[196:199], v[232:235], a[68:71], v[196:199]
  v_mfma_f32_16x16x32_bf16 v[200:203], v[232:235], a[72:75], v[200:203]
  v_mfma_f32_16x16x32_bf16 v[204:207], v[232:235], a[76:79], v[204:207]
  ds_read_b64_tr_b16 v[232:233], v0 offset:192
  v_mfma_f32_16x16x32_bf16 v[192:195], v[236:239], a[80:83], v[192:195]
  ds_read_b64_tr_b16 v[234:235], v0 offset:448
  v_mfma_f32_16x16x32_bf16 v[196:199], v[236:239], a[84:87], v[196:199]
  buffer_store_dwordx4 v[80:83], v5, s[24:27], s48 offen offset:2048 sc1
  v_mfma_f32_16x16x32_bf16 v[200:203], v[236:239], a[88:91], v[200:203]
  v_mfma_f32_16x16x32_bf16 v[204:207], v[236:239], a[92:95], v[204:207]
  ds_read_b64_tr_b16 v[236:237], v0 offset:704
  s_waitcnt lgkmcnt(7)
  v_mfma_f32_16x16x32_bf16 v[32:35], v[240:243], a[64:67], v[32:35]
  ds_read_b64_tr_b16 v[238:239], v0 offset:960
  v_mfma_f32_16x16x32_bf16 v[36:39], v[240:243], a[68:71], v[36:39]
  v_mfma_f32_16x16x32_bf16 v[40:43], v[240:243], a[72:75], v[40:43]
  v_mfma_f32_16x16x32_bf16 v[44:47], v[240:243], a[76:79], v[44:47]
  ds_read_b64_tr_b16 v[240:241], v0 offset:224
  v_mfma_f32_16x16x32_bf16 v[32:35], v[244:247], a[80:83], v[32:35]
  ds_read_b64_tr_b16 v[242:243], v0 offset:480
  v_mfma_f32_16x16x32_bf16 v[36:39], v[244:247], a[84:87], v[36:39]
  v_mfma_f32_16x16x32_bf16 v[40:43], v[244:247], a[88:91], v[40:43]
  v_mfma_f32_16x16x32_bf16 v[44:47], v[244:247], a[92:95], v[44:47]
  ds_read_b64_tr_b16 v[244:245], v0 offset:736
  s_waitcnt vmcnt(29)
  s_barrier
  s_waitcnt lgkmcnt(7)
  v_mfma_f32_16x16x32_bf16 v[64:67], v[248:251], a[64:67], v[64:67]
  ds_read_b64_tr_b16 v[246:247], v0 offset:992
  v_mfma_f32_16x16x32_bf16 v[68:71], v[248:251], a[68:71], v[68:71]
  v_mfma_f32_16x16x32_bf16 v[72:75], v[248:251], a[72:75], v[72:75]
  v_mfma_f32_16x16x32_bf16 v[76:79], v[248:251], a[76:79], v[76:79]
  v_subrev_u32 v0, 50688, v0
  ds_read_b64_tr_b16 v[248:249], v0 offset:16896
  v_mfma_f32_16x16x32_bf16 v[64:67], v[252:255], a[80:83], v[64:67]
  ds_read_b64_tr_b16 v[250:251], v0 offset:17152
  buffer_store_dwordx4 v[84:87], v5, s[24:27], s50 offen offset:2048 sc1
  v_mfma_f32_16x16x32_bf16 v[68:71], v[252:255], a[84:87], v[68:71]
  v_mfma_f32_16x16x32_bf16 v[72:75], v[252:255], a[88:91], v[72:75]
  v_mfma_f32_16x16x32_bf16 v[76:79], v[252:255], a[92:95], v[76:79]
  ds_read_b64_tr_b16 v[252:253], v0 offset:17408
  s_waitcnt lgkmcnt(7)
  v_mfma_f32_16x16x32_bf16 v[96:99], v[232:235], a[64:67], v[96:99]
  ds_read_b64_tr_b16 v[254:255], v0 offset:17664
  v_mfma_f32_16x16x32_bf16 v[100:103], v[232:235], a[68:71], v[100:103]
  v_mfma_f32_16x16x32_bf16 v[104:107], v[232:235], a[72:75], v[104:107]
  v_mfma_f32_16x16x32_bf16 v[108:111], v[232:235], a[76:79], v[108:111]
  ds_read_b64_tr_b16 v[232:233], v0 offset:16928
  v_mfma_f32_16x16x32_bf16 v[96:99], v[236:239], a[80:83], v[96:99]
  ds_read_b64_tr_b16 v[234:235], v0 offset:17184
  v_mfma_f32_16x16x32_bf16 v[100:103], v[236:239], a[84:87], v[100:103]
  v_mfma_f32_16x16x32_bf16 v[104:107], v[236:239], a[88:91], v[104:107]
  v_mfma_f32_16x16x32_bf16 v[108:111], v[236:239], a[92:95], v[108:111]
  ds_read_b64_tr_b16 v[236:237], v0 offset:17440
  s_waitcnt lgkmcnt(7)
  v_mfma_f32_16x16x32_bf16 v[128:131], v[240:243], a[64:67], v[128:131]
  ds_read_b64_tr_b16 v[238:239], v0 offset:17696
  v_mfma_f32_16x16x32_bf16 v[132:135], v[240:243], a[68:71], v[132:135]
  v_mfma_f32_16x16x32_bf16 v[136:139], v[240:243], a[72:75], v[136:139]
  v_mfma_f32_16x16x32_bf16 v[140:143], v[240:243], a[76:79], v[140:143]
  ds_read_b64_tr_b16 v[240:241], v0 offset:16960
  v_mfma_f32_16x16x32_bf16 v[128:131], v[244:247], a[80:83], v[128:131]
  ds_read_b64_tr_b16 v[242:243], v0 offset:17216
  buffer_store_dwordx4 v[88:91], v5, s[24:27], s52 offen offset:2048 sc1
  v_mfma_f32_16x16x32_bf16 v[132:135], v[244:247], a[84:87], v[132:135]
  v_mfma_f32_16x16x32_bf16 v[136:139], v[244:247], a[88:91], v[136:139]
  v_mfma_f32_16x16x32_bf16 v[140:143], v[244:247], a[92:95], v[140:143]
  ds_read_b64_tr_b16 v[244:245], v0 offset:17472
  s_waitcnt lgkmcnt(7)
  v_mfma_f32_16x16x32_bf16 v[144:147], v[248:251], a[96:99], v[144:147]
  ds_read_b64_tr_b16 v[246:247], v0 offset:17728
  v_mfma_f32_16x16x32_bf16 v[148:151], v[248:251], a[100:103], v[148:151]
  v_mfma_f32_16x16x32_bf16 v[152:155], v[248:251], a[104:107], v[152:155]
  v_mfma_f32_16x16x32_bf16 v[156:159], v[248:251], a[108:111], v[156:159]
  ds_read_b64_tr_b16 v[248:249], v0 offset:16992
  v_mfma_f32_16x16x32_bf16 v[144:147], v[252:255], a[112:115], v[144:147]
  ds_read_b64_tr_b16 v[250:251], v0 offset:17248
  v_mfma_f32_16x16x32_bf16 v[148:151], v[252:255], a[116:119], v[148:151]
  v_mfma_f32_16x16x32_bf16 v[152:155], v[252:255], a[120:123], v[152:155]
  v_mfma_f32_16x16x32_bf16 v[156:159], v[252:255], a[124:127], v[156:159]
  ds_read_b64_tr_b16 v[252:253], v0 offset:17504
  s_waitcnt lgkmcnt(7)
  v_mfma_f32_16x16x32_bf16 v[160:163], v[232:235], a[96:99], v[160:163]
  ds_read_b64_tr_b16 v[254:255], v0 offset:17760
  v_mfma_f32_16x16x32_bf16 v[164:167], v[232:235], a[100:103], v[164:167]
  v_mfma_f32_16x16x32_bf16 v[168:171], v[232:235], a[104:107], v[168:171]
  v_mfma_f32_16x16x32_bf16 v[172:175], v[232:235], a[108:111], v[172:175]
  ds_read_b64_tr_b16 v[232:233], v0 offset:17024
  buffer_store_dwordx4 v[92:95], v5, s[24:27], s54 offen offset:2048 sc1
  v_mfma_f32_16x16x32_bf16 v[160:163], v[236:239], a[112:115], v[160:163]
  ds_read_b64_tr_b16 v[234:235], v0 offset:17280
  v_mfma_f32_16x16x32_bf16 v[164:167], v[236:239], a[116:119], v[164:167]
  v_mfma_f32_16x16x32_bf16 v[168:171], v[236:239], a[120:123], v[168:171]
  v_mfma_f32_16x16x32_bf16 v[172:175], v[236:239], a[124:127], v[172:175]
  ds_read_b64_tr_b16 v[236:237], v0 offset:17536
  s_waitcnt lgkmcnt(7)
  v_mfma_f32_16x16x32_bf16 v[176:179], v[240:243], a[96:99], v[176:179]
  ds_read_b64_tr_b16 v[238:239], v0 offset:17792
  v_mfma_f32_16x16x32_bf16 v[180:183], v[240:243], a[100:103], v[180:183]
  v_mfma_f32_16x16x32_bf16 v[184:187], v[240:243], a[104:107], v[184:187]
  v_mfma_f32_16x16x32_bf16 v[188:191], v[240:243], a[108:111], v[188:191]
  ds_read_b64_tr_b16 v[240:241], v0 offset:17056
  v_mfma_f32_16x16x32_bf16 v[176:179], v[244:247], a[112:115], v[176:179]
  ds_read_b64_tr_b16 v[242:243], v0 offset:17312
  v_mfma_f32_16x16x32_bf16 v[180:183], v[244:247], a[116:119], v[180:183]
  v_mfma_f32_16x16x32_bf16 v[184:187], v[244:247], a[120:123], v[184:187]
  v_mfma_f32_16x16x32_bf16 v[188:191], v[244:247], a[124:127], v[188:191]
  ds_read_b64_tr_b16 v[244:245], v0 offset:17568
  s_waitcnt lgkmcnt(7)
  v_mfma_f32_16x16x32_bf16 v[192:195], v[248:251], a[96:99], v[192:195]
  ds_read_b64_tr_b16 v[246:247], v0 offset:17824
  v_mfma_f32_16x16x32_bf16 v[196:199], v[248:251], a[100:103], v[196:199]
  v_mfma_f32_16x16x32_bf16 v[200:203], v[248:251], a[104:107], v[200:203]
  v_mfma_f32_16x16x32_bf16 v[204:207], v[248:251], a[108:111], v[204:207]
  ds_read_b64_tr_b16 v[248:249], v0 offset:17088
  buffer_store_dwordx4 v[112:115], v5, s[24:27], s48 offen offset:3072 sc1
  v_mfma_f32_16x16x32_bf16 v[192:195], v[252:255], a[112:115], v[192:195]
  ds_read_b64_tr_b16 v[250:251], v0 offset:17344
  v_mfma_f32_16x16x32_bf16 v[196:199], v[252:255], a[116:119], v[196:199]
  v_mfma_f32_16x16x32_bf16 v[200:203], v[252:255], a[120:123], v[200:203]
  v_mfma_f32_16x16x32_bf16 v[204:207], v[252:255], a[124:127], v[204:207]
  ds_read_b64_tr_b16 v[252:253], v0 offset:17600
  s_waitcnt lgkmcnt(7)
  v_mfma_f32_16x16x32_bf16 v[32:35], v[232:235], a[96:99], v[32:35]
  ds_read_b64_tr_b16 v[254:255], v0 offset:17856
  v_mfma_f32_16x16x32_bf16 v[36:39], v[232:235], a[100:103], v[36:39]
  v_mfma_f32_16x16x32_bf16 v[40:43], v[232:235], a[104:107], v[40:43]
  v_mfma_f32_16x16x32_bf16 v[44:47], v[232:235], a[108:111], v[44:47]
  ds_read_b64_tr_b16 v[232:233], v0 offset:17120
  v_mfma_f32_16x16x32_bf16 v[32:35], v[236:239], a[112:115], v[32:35]
  ds_read_b64_tr_b16 v[234:235], v0 offset:17376
  v_mfma_f32_16x16x32_bf16 v[36:39], v[236:239], a[116:119], v[36:39]
  v_mfma_f32_16x16x32_bf16 v[40:43], v[236:239], a[120:123], v[40:43]
  v_mfma_f32_16x16x32_bf16 v[44:47], v[236:239], a[124:127], v[44:47]
  ds_read_b64_tr_b16 v[236:237], v0 offset:17632
  s_waitcnt vmcnt(13)
  s_barrier
  s_waitcnt lgkmcnt(7)
  v_mfma_f32_16x16x32_bf16 v[64:67], v[240:243], a[96:99], v[64:67]
  ds_read_b64_tr_b16 v[238:239], v0 offset:17888
  v_mfma_f32_16x16x32_bf16 v[68:71], v[240:243], a[100:103], v[68:71]
  v_mfma_f32_16x16x32_bf16 v[72:75], v[240:243], a[104:107], v[72:75]
  v_mfma_f32_16x16x32_bf16 v[76:79], v[240:243], a[108:111], v[76:79]
  v_add_u32 v0, 50688, v0
  ds_read_b64_tr_b16 v[240:241], v0 offset:16896
  v_mfma_f32_16x16x32_bf16 v[64:67], v[244:247], a[112:115], v[64:67]
  ds_read_b64_tr_b16 v[242:243], v0 offset:17152
  buffer_store_dwordx4 v[116:119], v5, s[24:27], s50 offen offset:3072 sc1
  v_mfma_f32_16x16x32_bf16 v[68:71], v[244:247], a[116:119], v[68:71]
  v_mfma_f32_16x16x32_bf16 v[72:75], v[244:247], a[120:123], v[72:75]
  v_mfma_f32_16x16x32_bf16 v[76:79], v[244:247], a[124:127], v[76:79]
  ds_read_b64_tr_b16 v[244:245], v0 offset:17408
  s_waitcnt lgkmcnt(7)
  v_mfma_f32_16x16x32_bf16 v[96:99], v[248:251], a[96:99], v[96:99]
  ds_read_b64_tr_b16 v[246:247], v0 offset:17664
  v_mfma_f32_16x16x32_bf16 v[100:103], v[248:251], a[100:103], v[100:103]
  v_mfma_f32_16x16x32_bf16 v[104:107], v[248:251], a[104:107], v[104:107]
  v_mfma_f32_16x16x32_bf16 v[108:111], v[248:251], a[108:111], v[108:111]
  v_subrev_u32 v0, 50688, v0
  ds_read_b64_tr_b16 v[248:249], v0 offset:0
  v_mfma_f32_16x16x32_bf16 v[96:99], v[252:255], a[112:115], v[96:99]
  ds_read_b64_tr_b16 v[250:251], v0 offset:256
  v_mfma_f32_16x16x32_bf16 v[100:103], v[252:255], a[116:119], v[100:103]
  v_mfma_f32_16x16x32_bf16 v[104:107], v[252:255], a[120:123], v[104:107]
  v_mfma_f32_16x16x32_bf16 v[108:111], v[252:255], a[124:127], v[108:111]
  ds_read_b64_tr_b16 v[252:253], v0 offset:512
  s_waitcnt lgkmcnt(7)
  v_mfma_f32_16x16x32_bf16 v[128:131], v[232:235], a[96:99], v[128:131]
  ds_read_b64_tr_b16 v[254:255], v0 offset:768
  v_mfma_f32_16x16x32_bf16 v[132:135], v[232:235], a[100:103], v[132:135]
  v_mfma_f32_16x16x32_bf16 v[136:139], v[232:235], a[104:107], v[136:139]
  buffer_store_dwordx4 v[120:123], v5, s[24:27], s52 offen offset:3072 sc1
  v_mfma_f32_16x16x32_bf16 v[140:143], v[232:235], a[108:111], v[140:143]
  ds_read_b64_tr_b16 v[232:233], v0 offset:33792
  v_mfma_f32_16x16x32_bf16 v[128:131], v[236:239], a[112:115], v[128:131]
  ds_read_b64_tr_b16 v[234:235], v0 offset:34048
  v_mfma_f32_16x16x32_bf16 v[132:135], v[236:239], a[116:119], v[132:135]
  v_mfma_f32_16x16x32_bf16 v[136:139], v[236:239], a[120:123], v[136:139]
  v_mfma_f32_16x16x32_bf16 v[140:143], v[236:239], a[124:127], v[140:143]
  ds_read_b64_tr_b16 v[236:237], v0 offset:34304
  s_waitcnt lgkmcnt(7)
  v_mfma_f32_16x16x32_bf16 v[144:147], v[240:243], a[128:131], v[144:147]
  ds_read_b64_tr_b16 v[238:239], v0 offset:34560
  v_mfma_f32_16x16x32_bf16 v[148:151], v[240:243], a[132:135], v[148:151]
  v_mfma_f32_16x16x32_bf16 v[152:155], v[240:243], a[136:139], v[152:155]
  v_mfma_f32_16x16x32_bf16 v[156:159], v[240:243], a[140:143], v[156:159]
  v_subrev_u32 v0, 50688, v0
  ds_read_b64_tr_b16 v[240:241], v0 offset:16896
  v_mfma_f32_16x16x32_bf16 v[144:147], v[244:247], a[144:147], v[144:147]
  ds_read_b64_tr_b16 v[242:243], v0 offset:17152
  v_mfma_f32_16x16x32_bf16 v[148:151], v[244:247], a[148:151], v[148:151]
  v_mfma_f32_16x16x32_bf16 v[152:155], v[244:247], a[152:155], v[152:155]
  v_mfma_f32_16x16x32_bf16 v[156:159], v[244:247], a[156:159], v[156:159]
  ds_read_b64_tr_b16 v[244:245], v0 offset:17408
  s_waitcnt lgkmcnt(7)
  v_mfma_f32_16x16x32_bf16 v[144:147], v[248:251], a[160:163], v[144:147]
  ds_read_b64_tr_b16 v[246:247], v0 offset:17664
  v_mfma_f32_16x16x32_bf16 v[148:151], v[248:251], a[164:167], v[148:151]
  v_mfma_f32_16x16x32_bf16 v[152:155], v[248:251], a[168:171], v[152:155]
  buffer_store_dwordx4 v[124:127], v5, s[24:27], s54 offen offset:3072 sc1
  v_mfma_f32_16x16x32_bf16 v[156:159], v[248:251], a[172:175], v[156:159]
  v_add_u32 v0, 101376, v0
  ds_read_b64_tr_b16 v[248:249], v0 offset:16928
  v_mfma_f32_16x16x32_bf16 v[144:147], v[252:255], a[176:179], v[144:147]
  ds_read_b64_tr_b16 v[250:251], v0 offset:17184
  v_mfma_f32_16x16x32_bf16 v[148:151], v[252:255], a[180:183], v[148:151]
  v_mfma_f32_16x16x32_bf16 v[152:155], v[252:255], a[184:187], v[152:155]
  v_mfma_f32_16x16x32_bf16 v[156:159], v[252:255], a[188:191], v[156:159]
  ds_read_b64_tr_b16 v[252:253], v0 offset:17440
  s_waitcnt lgkmcnt(7)
  v_mfma_f32_16x16x32_bf16 v[144:147], v[232:235], a[192:195], v[144:147]
  ds_read_b64_tr_b16 v[254:255], v0 offset:17696
  v_mfma_f32_16x16x32_bf16 v[148:151], v[232:235], a[196:199], v[148:151]
  v_mfma_f32_16x16x32_bf16 v[152:155], v[232:235], a[200:203], v[152:155]
  v_mfma_f32_16x16x32_bf16 v[156:159], v[232:235], a[204:207], v[156:159]
  v_subrev_u32 v0, 50688, v0
  ds_read_b64_tr_b16 v[232:233], v0 offset:32
  v_mfma_f32_16x16x32_bf16 v[144:147], v[236:239], a[208:211], v[144:147]
  ds_read_b64_tr_b16 v[234:235], v0 offset:288
  v_mfma_f32_16x16x32_bf16 v[148:151], v[236:239], a[212:215], v[148:151]
  v_mfma_f32_16x16x32_bf16 v[152:155], v[236:239], a[216:219], v[152:155]
  v_mfma_f32_16x16x32_bf16 v[156:159], v[236:239], a[220:223], v[156:159]
  ds_read_b64_tr_b16 v[236:237], v0 offset:544
  s_waitcnt lgkmcnt(7)
  v_mfma_f32_16x16x32_bf16 v[144:147], v[240:243], a[224:227], v[144:147]
  ds_read_b64_tr_b16 v[238:239], v0 offset:800
  v_mfma_f32_16x16x32_bf16 v[148:151], v[240:243], a[228:231], v[148:151]
  v_mfma_f32_16x16x32_bf16 v[152:155], v[240:243], a[232:235], v[152:155]
  v_mfma_f32_16x16x32_bf16 v[156:159], v[240:243], a[236:239], v[156:159]
  ds_read_b64_tr_b16 v[240:241], v0 offset:33824
  v_mfma_f32_16x16x32_bf16 v[144:147], v[244:247], a[240:243], v[144:147]
  ds_read_b64_tr_b16 v[242:243], v0 offset:34080
  v_mfma_f32_16x16x32_bf16 v[148:151], v[244:247], a[244:247], v[148:151]
  v_mfma_f32_16x16x32_bf16 v[152:155], v[244:247], a[248:251], v[152:155]
  v_mfma_f32_16x16x32_bf16 v[156:159], v[244:247], a[252:255], v[156:159]
  ds_read_b64_tr_b16 v[244:245], v0 offset:34336
  s_waitcnt lgkmcnt(7)
  v_mfma_f32_16x16x32_bf16 v[160:163], v[248:251], a[128:131], v[160:163]
  ds_read_b64_tr_b16 v[246:247], v0 offset:34592
  v_mfma_f32_16x16x32_bf16 v[164:167], v[248:251], a[132:135], v[164:167]
  v_mfma_f32_16x16x32_bf16 v[168:171], v[248:251], a[136:139], v[168:171]
  v_mfma_f32_16x16x32_bf16 v[172:175], v[248:251], a[140:143], v[172:175]
  v_subrev_u32 v0, 50688, v0
  ds_read_b64_tr_b16 v[248:249], v0 offset:16928
  v_mfma_f32_16x16x32_bf16 v[160:163], v[252:255], a[144:147], v[160:163]
  ds_read_b64_tr_b16 v[250:251], v0 offset:17184
  v_mfma_f32_16x16x32_bf16 v[164:167], v[252:255], a[148:151], v[164:167]
  v_mfma_f32_16x16x32_bf16 v[168:171], v[252:255], a[152:155], v[168:171]
  v_mfma_f32_16x16x32_bf16 v[172:175], v[252:255], a[156:159], v[172:175]
  ds_read_b64_tr_b16 v[252:253], v0 offset:17440
  s_waitcnt lgkmcnt(7)
  v_mfma_f32_16x16x32_bf16 v[160:163], v[232:235], a[160:163], v[160:163]
  ds_read_b64_tr_b16 v[254:255], v0 offset:17696
  v_mfma_f32_16x16x32_bf16 v[164:167], v[232:235], a[164:167], v[164:167]
  v_mfma_f32_16x16x32_bf16 v[168:171], v[232:235], a[168:171], v[168:171]
  v_mfma_f32_16x16x32_bf16 v[172:175], v[232:235], a[172:175], v[172:175]
  v_add_u32 v0, 101376, v0
  ds_read_b64_tr_b16 v[232:233], v0 offset:16960
  v_mfma_f32_16x16x32_bf16 v[160:163], v[236:239], a[176:179], v[160:163]
  ds_read_b64_tr_b16 v[234:235], v0 offset:17216
  v_mfma_f32_16x16x32_bf16 v[164:167], v[236:239], a[180:183], v[164:167]
  v_mfma_f32_16x16x32_bf16 v[168:171], v[236:239], a[184:187], v[168:171]
  v_mfma_f32_16x16x32_bf16 v[172:175], v[236:239], a[188:191], v[172:175]
  ds_read_b64_tr_b16 v[236:237], v0 offset:17472
  s_waitcnt lgkmcnt(7)
  v_mfma_f32_16x16x32_bf16 v[160:163], v[240:243], a[192:195], v[160:163]
  ds_read_b64_tr_b16 v[238:239], v0 offset:17728
  v_mfma_f32_16x16x32_bf16 v[164:167], v[240:243], a[196:199], v[164:167]
  v_mfma_f32_16x16x32_bf16 v[168:171], v[240:243], a[200:203], v[168:171]
  v_mfma_f32_16x16x32_bf16 v[172:175], v[240:243], a[204:207], v[172:175]
  v_subrev_u32 v0, 50688, v0
  ds_read_b64_tr_b16 v[240:241], v0 offset:64
  v_mfma_f32_16x16x32_bf16 v[160:163], v[244:247], a[208:211], v[160:163]
  ds_read_b64_tr_b16 v[242:243], v0 offset:320
  v_mfma_f32_16x16x32_bf16 v[164:167], v[244:247], a[212:215], v[164:167]
  v_mfma_f32_16x16x32_bf16 v[168:171], v[244:247], a[216:219], v[168:171]
  v_mfma_f32_16x16x32_bf16 v[172:175], v[244:247], a[220:223], v[172:175]
  ds_read_b64_tr_b16 v[244:245], v0 offset:576
  s_waitcnt lgkmcnt(7)
  v_mfma_f32_16x16x32_bf16 v[160:163], v[248:251], a[224:227], v[160:163]
  ds_read_b64_tr_b16 v[246:247], v0 offset:832
  v_mfma_f32_16x16x32_bf16 v[164:167], v[248:251], a[228:231], v[164:167]
  v_mfma_f32_16x16x32_bf16 v[168:171], v[248:251], a[232:235], v[168:171]
  v_mfma_f32_16x16x32_bf16 v[172:175], v[248:251], a[236:239], v[172:175]
  ds_read_b64_tr_b16 v[248:249], v0 offset:33856
  v_mfma_f32_16x16x32_bf16 v[160:163], v[252:255], a[240:243], v[160:163]
  ds_read_b64_tr_b16 v[250:251], v0 offset:34112
  v_mfma_f32_16x16x32_bf16 v[164:167], v[252:255], a[244:247], v[164:167]
  v_mfma_f32_16x16x32_bf16 v[168:171], v[252:255], a[248:251], v[168:171]
  v_mfma_f32_16x16x32_bf16 v[172:175], v[252:255], a[252:255], v[172:175]
  ds_read_b64_tr_b16 v[252:253], v0 offset:34368
  s_waitcnt lgkmcnt(7)
  v_mfma_f32_16x16x32_bf16 v[176:179], v[232:235], a[128:131], v[176:179]
  ds_read_b64_tr_b16 v[254:255], v0 offset:34624
  v_mfma_f32_16x16x32_bf16 v[180:183], v[232:235], a[132:135], v[180:183]
  v_mfma_f32_16x16x32_bf16 v[184:187], v[232:235], a[136:139], v[184:187]
  v_mfma_f32_16x16x32_bf16 v[188:191], v[232:235], a[140:143], v[188:191]
  v_subrev_u32 v0, 50688, v0
  ds_read_b64_tr_b16 v[232:233], v0 offset:16960
  v_mfma_f32_16x16x32_bf16 v[176:179], v[236:239], a[144:147], v[176:179]
  ds_read_b64_tr_b16 v[234:235], v0 offset:17216
  v_mul_f32 v144, v144, v6
  v_mfma_f32_16x16x32_bf16 v[180:183], v[236:239], a[148:151], v[180:183]
  v_mul_f32 v145, v145, v6
  v_mul_f32 v146, v146, v6
  v_mfma_f32_16x16x32_bf16 v[184:187], v[236:239], a[152:155], v[184:187]
  v_mul_f32 v147, v147, v6
  v_mul_f32 v160, v160, v6
  v_mfma_f32_16x16x32_bf16 v[188:191], v[236:239], a[156:159], v[188:191]
  ds_read_b64_tr_b16 v[236:237], v0 offset:17472
  s_waitcnt lgkmcnt(7)
  v_mfma_f32_16x16x32_bf16 v[176:179], v[240:243], a[160:163], v[176:179]
  ds_read_b64_tr_b16 v[238:239], v0 offset:17728
  v_mul_f32 v161, v161, v6
  v_mfma_f32_16x16x32_bf16 v[180:183], v[240:243], a[164:167], v[180:183]
  v_mul_f32 v162, v162, v6
  v_mul_f32 v163, v163, v6
  v_mfma_f32_16x16x32_bf16 v[184:187], v[240:243], a[168:171], v[184:187]
  v_cvt_pk_bf16_f32 v144, v144, v145
  v_cvt_pk_bf16_f32 v145, v146, v147
  v_mfma_f32_16x16x32_bf16 v[188:191], v[240:243], a[172:175], v[188:191]
  v_add_u32 v0, 101376, v0
  ds_read_b64_tr_b16 v[240:241], v0 offset:16992
  v_mfma_f32_16x16x32_bf16 v[176:179], v[244:247], a[176:179], v[176:179]
  ds_read_b64_tr_b16 v[242:243], v0 offset:17248
  v_cvt_pk_bf16_f32 v146, v160, v161
  v_mfma_f32_16x16x32_bf16 v[180:183], v[244:247], a[180:183], v[180:183]
  v_cvt_pk_bf16_f32 v147, v162, v163
  buffer_store_dwordx4 v[144:147], v5, s[24:27], s49 offen offset:0 sc1
  v_mfma_f32_16x16x32_bf16 v[184:187], v[244:247], a[184:187], v[184:187]
  v_mul_f32 v148, v148, v7
  v_mul_f32 v149, v149, v7
  v_mfma_f32_16x16x32_bf16 v[188:191], v[244:247], a[188:191], v[188:191]
  ds_read_b64_tr_b16 v[244:245], v0 offset:17504
  s_waitcnt lgkmcnt(7)
  v_mfma_f32_16x16x32_bf16 v[176:179], v[248:251], a[192:195], v[176:179]
  ds_read_b64_tr_b16 v[246:247], v0 offset:17760
  v_mul_f32 v150, v150, v7
  v_mfma_f32_16x16x32_bf16 v[180:183], v[248:251], a[196:199], v[180:183]
  v_mul_f32 v151, v151, v7
  v_mul_f32 v164, v164, v7
  v_mfma_f32_16x16x32_bf16 v[184:187], v[248:251], a[200:203], v[184:187]
  v_mul_f32 v165, v165, v7
  v_mul_f32 v166, v166, v7
  v_mfma_f32_16x16x32_bf16 v[188:191], v[248:251], a[204:207], v[188:191]
  v_subrev_u32 v0, 50688, v0
  ds_read_b64_tr_b16 v[248:249], v0 offset:96
  v_mfma_f32_16x16x32_bf16 v[176:179], v[252:255], a[208:211], v[176:179]
  ds_read_b64_tr_b16 v[250:251], v0 offset:352
  v_mul_f32 v167, v167, v7
  v_mfma_f32_16x16x32_bf16 v[180:183], v[252:255], a[212:215], v[180:183]
  v_cvt_pk_bf16_f32 v148, v148, v149
  v_cvt_pk_bf16_f32 v149, v150, v151
  v_mfma_f32_16x16x32_bf16 v[184:187], v[252:255], a[216:219], v[184:187]
  v_cvt_pk_bf16_f32 v150, v164, v165
  v_cvt_pk_bf16_f32 v151, v166, v167
  v_mfma_f32_16x16x32_bf16 v[188:191], v[252:255], a[220:223], v[188:191]
  ds_read_b64_tr_b16 v[252:253], v0 offset:608
  s_waitcnt lgkmcnt(7)
  v_mfma_f32_16x16x32_bf16 v[176:179], v[232:235], a[224:227], v[176:179]
  ds_read_b64_tr_b16 v[254:255], v0 offset:864
  buffer_store_dwordx4 v[148:151], v5, s[24:27], s51 offen offset:0 sc1
  v_mfma_f32_16x16x32_bf16 v[180:183], v[232:235], a[228:231], v[180:183]
  v_mul_f32 v152, v152, v8
  v_mul_f32 v153, v153, v8
  v_mfma_f32_16x16x32_bf16 v[184:187], v[232:235], a[232:235], v[184:187]
  v_mul_f32 v154, v154, v8
  v_mul_f32 v155, v155, v8
  v_mfma_f32_16x16x32_bf16 v[188:191], v[232:235], a[236:239], v[188:191]
  ds_read_b64_tr_b16 v[232:233], v0 offset:33888
  v_mul_f32 v168, v168, v8
  v_mfma_f32_16x16x32_bf16 v[176:179], v[236:239], a[240:243], v[176:179]
  ds_read_b64_tr_b16 v[234:235], v0 offset:34144
  v_mul_f32 v169, v169, v8
  v_mfma_f32_16x16x32_bf16 v[180:183], v[236:239], a[244:247], v[180:183]
  v_mul_f32 v170, v170, v8
  v_mul_f32 v171, v171, v8
  v_mfma_f32_16x16x32_bf16 v[184:187], v[236:239], a[248:251], v[184:187]
  v_cvt_pk_bf16_f32 v152, v152, v153
  v_cvt_pk_bf16_f32 v153, v154, v155
  v_mfma_f32_16x16x32_bf16 v[188:191], v[236:239], a[252:255], v[188:191]
  ds_read_b64_tr_b16 v[236:237], v0 offset:34400
  s_waitcnt lgkmcnt(7)
  v_mfma_f32_16x16x32_bf16 v[192:195], v[240:243], a[128:131], v[192:195]
  ds_read_b64_tr_b16 v[238:239], v0 offset:34656
  v_cvt_pk_bf16_f32 v154, v168, v169
  v_mfma_f32_16x16x32_bf16 v[196:199], v[240:243], a[132:135], v[196:199]
  v_cvt_pk_bf16_f32 v155, v170, v171
  buffer_store_dwordx4 v[152:155], v5, s[24:27], s53 offen offset:0 sc1
  v_mfma_f32_16x16x32_bf16 v[200:203], v[240:243], a[136:139], v[200:203]
  v_mul_f32 v156, v156, v9
  v_mul_f32 v157, v157, v9
  v_mfma_f32_16x16x32_bf16 v[204:207], v[240:243], a[140:143], v[204:207]
  v_subrev_u32 v0, 50688, v0
  ds_read_b64_tr_b16 v[240:241], v0 offset:16992
  v_mfma_f32_16x16x32_bf16 v[192:195], v[244:247], a[144:147], v[192:195]
  ds_read_b64_tr_b16 v[242:243], v0 offset:17248
  v_mul_f32 v158, v158, v9
  v_mfma_f32_16x16x32_bf16 v[196:199], v[244:247], a[148:151], v[196:199]
  v_mul_f32 v159, v159, v9
  v_mul_f32 v172, v172, v9
  v_mfma_f32_16x16x32_bf16 v[200:203], v[244:247], a[152:155], v[200:203]
  v_mul_f32 v173, v173, v9
  v_mul_f32 v174, v174, v9
  v_mfma_f32_16x16x32_bf16 v[204:207], v[244:247], a[156:159], v[204:207]
  ds_read_b64_tr_b16 v[244:245], v0 offset:17504
  s_waitcnt lgkmcnt(7)
  v_mfma_f32_16x16x32_bf16 v[192:195], v[248:251], a[160:163], v[192:195]
  ds_read_b64_tr_b16 v[246:247], v0 offset:17760
  v_mul_f32 v175, v175, v9
  v_mfma_f32_16x16x32_bf16 v[196:199], v[248:251], a[164:167], v[196:199]
  v_cvt_pk_bf16_f32 v156, v156, v157
  v_cvt_pk_bf16_f32 v157, v158, v159
  v_mfma_f32_16x16x32_bf16 v[200:203], v[248:251], a[168:171], v[200:203]
  v_cvt_pk_bf16_f32 v158, v172, v173
  v_cvt_pk_bf16_f32 v159, v174, v175
  v_mfma_f32_16x16x32_bf16 v[204:207], v[248:251], a[172:175], v[204:207]
  v_add_u32 v0, 101376, v0
  ds_read_b64_tr_b16 v[248:249], v0 offset:17024
  v_mfma_f32_16x16x32_bf16 v[192:195], v[252:255], a[176:179], v[192:195]
  ds_read_b64_tr_b16 v[250:251], v0 offset:17280
  buffer_store_dwordx4 v[156:159], v5, s[24:27], s55 offen offset:0 sc1
  v_mfma_f32_16x16x32_bf16 v[196:199], v[252:255], a[180:183], v[196:199]
  v_mfma_f32_16x16x32_bf16 v[200:203], v[252:255], a[184:187], v[200:203]
  v_mfma_f32_16x16x32_bf16 v[204:207], v[252:255], a[188:191], v[204:207]
  ds_read_b64_tr_b16 v[252:253], v0 offset:17536
  s_waitcnt lgkmcnt(7)
  v_mfma_f32_16x16x32_bf16 v[192:195], v[232:235], a[192:195], v[192:195]
  ds_read_b64_tr_b16 v[254:255], v0 offset:17792
  v_mfma_f32_16x16x32_bf16 v[196:199], v[232:235], a[196:199], v[196:199]
  v_mfma_f32_16x16x32_bf16 v[200:203], v[232:235], a[200:203], v[200:203]
  v_mfma_f32_16x16x32_bf16 v[204:207], v[232:235], a[204:207], v[204:207]
  v_subrev_u32 v0, 50688, v0
  ds_read_b64_tr_b16 v[232:233], v0 offset:128
  v_mfma_f32_16x16x32_bf16 v[192:195], v[236:239], a[208:211], v[192:195]
  ds_read_b64_tr_b16 v[234:235], v0 offset:384
  v_mfma_f32_16x16x32_bf16 v[196:199], v[236:239], a[212:215], v[196:199]
  v_mfma_f32_16x16x32_bf16 v[200:203], v[236:239], a[216:219], v[200:203]
  v_mfma_f32_16x16x32_bf16 v[204:207], v[236:239], a[220:223], v[204:207]
  ds_read_b64_tr_b16 v[236:237], v0 offset:640
  s_waitcnt lgkmcnt(7)
  v_mfma_f32_16x16x32_bf16 v[192:195], v[240:243], a[224:227], v[192:195]
  ds_read_b64_tr_b16 v[238:239], v0 offset:896
  v_mfma_f32_16x16x32_bf16 v[196:199], v[240:243], a[228:231], v[196:199]
  v_mfma_f32_16x16x32_bf16 v[200:203], v[240:243], a[232:235], v[200:203]
  v_mfma_f32_16x16x32_bf16 v[204:207], v[240:243], a[236:239], v[204:207]
  ds_read_b64_tr_b16 v[240:241], v0 offset:33920
  v_mfma_f32_16x16x32_bf16 v[192:195], v[244:247], a[240:243], v[192:195]
  ds_read_b64_tr_b16 v[242:243], v0 offset:34176
  v_mfma_f32_16x16x32_bf16 v[196:199], v[244:247], a[244:247], v[196:199]
  v_mfma_f32_16x16x32_bf16 v[200:203], v[244:247], a[248:251], v[200:203]
  v_mfma_f32_16x16x32_bf16 v[204:207], v[244:247], a[252:255], v[204:207]
  ds_read_b64_tr_b16 v[244:245], v0 offset:34432
  s_waitcnt lgkmcnt(7)
  v_mfma_f32_16x16x32_bf16 v[32:35], v[248:251], a[128:131], v[32:35]
  ds_read_b64_tr_b16 v[246:247], v0 offset:34688
  v_mfma_f32_16x16x32_bf16 v[36:39], v[248:251], a[132:135], v[36:39]
  v_mfma_f32_16x16x32_bf16 v[40:43], v[248:251], a[136:139], v[40:43]
  v_mfma_f32_16x16x32_bf16 v[44:47], v[248:251], a[140:143], v[44:47]
  v_subrev_u32 v0, 50688, v0
  ds_read_b64_tr_b16 v[248:249], v0 offset:17024
  v_mfma_f32_16x16x32_bf16 v[32:35], v[252:255], a[144:147], v[32:35]
  ds_read_b64_tr_b16 v[250:251], v0 offset:17280
  v_mul_f32 v176, v176, v6
  v_mfma_f32_16x16x32_bf16 v[36:39], v[252:255], a[148:151], v[36:39]
  v_mul_f32 v177, v177, v6
  v_mul_f32 v178, v178, v6
  v_mfma_f32_16x16x32_bf16 v[40:43], v[252:255], a[152:155], v[40:43]
  v_mul_f32 v179, v179, v6
  v_mul_f32 v192, v192, v6
  v_mfma_f32_16x16x32_bf16 v[44:47], v[252:255], a[156:159], v[44:47]
  ds_read_b64_tr_b16 v[252:253], v0 offset:17536
  s_waitcnt lgkmcnt(7)
  v_mfma_f32_16x16x32_bf16 v[32:35], v[232:235], a[160:163], v[32:35]
  ds_read_b64_tr_b16 v[254:255], v0 offset:17792
  v_mul_f32 v193, v193, v6
  v_mfma_f32_16x16x32_bf16 v[36:39], v[232:235], a[164:167], v[36:39]
  v_mul_f32 v194, v194, v6
  v_mul_f32 v195, v195, v6
  v_mfma_f32_16x16x32_bf16 v[40:43], v[232:235], a[168:171], v[40:43]
  v_cvt_pk_bf16_f32 v176, v176, v177
  v_cvt_pk_bf16_f32 v177, v178, v179
  v_mfma_f32_16x16x32_bf16 v[44:47], v[232:235], a[172:175], v[44:47]
  v_add_u32 v0, 101376, v0
  ds_read_b64_tr_b16 v[232:233], v0 offset:17056
  v_mfma_f32_16x16x32_bf16 v[32:35], v[236:239], a[176:179], v[32:35]
  ds_read_b64_tr_b16 v[234:235], v0 offset:17312
  v_cvt_pk_bf16_f32 v178, v192, v193
  v_mfma_f32_16x16x32_bf16 v[36:39], v[236:239], a[180:183], v[36:39]
  v_cvt_pk_bf16_f32 v179, v194, v195
  buffer_store_dwordx4 v[176:179], v5, s[24:27], s49 offen offset:1024 sc1
  v_mfma_f32_16x16x32_bf16 v[40:43], v[236:239], a[184:187], v[40:43]
  v_mul_f32 v180, v180, v7
  v_mul_f32 v181, v181, v7
  v_mfma_f32_16x16x32_bf16 v[44:47], v[236:239], a[188:191], v[44:47]
  ds_read_b64_tr_b16 v[236:237], v0 offset:17568
  s_waitcnt lgkmcnt(7)
  v_mfma_f32_16x16x32_bf16 v[32:35], v[240:243], a[192:195], v[32:35]
  ds_read_b64_tr_b16 v[238:239], v0 offset:17824
  v_mul_f32 v182, v182, v7
  v_mfma_f32_16x16x32_bf16 v[36:39], v[240:243], a[196:199], v[36:39]
  v_mul_f32 v183, v183, v7
  v_mul_f32 v196, v196, v7
  v_mfma_f32_16x16x32_bf16 v[40:43], v[240:243], a[200:203], v[40:43]
  v_mul_f32 v197, v197, v7
  v_mul_f32 v198, v198, v7
  v_mfma_f32_16x16x32_bf16 v[44:47], v[240:243], a[204:207], v[44:47]
  v_subrev_u32 v0, 50688, v0
  ds_read_b64_tr_b16 v[240:241], v0 offset:160
  v_mfma_f32_16x16x32_bf16 v[32:35], v[244:247], a[208:211], v[32:35]
  ds_read_b64_tr_b16 v[242:243], v0 offset:416
  v_mul_f32 v199, v199, v7
  v_mfma_f32_16x16x32_bf16 v[36:39], v[244:247], a[212:215], v[36:39]
  v_cvt_pk_bf16_f32 v180, v180, v181
  v_cvt_pk_bf16_f32 v181, v182, v183
  v_mfma_f32_16x16x32_bf16 v[40:43], v[244:247], a[216:219], v[40:43]
  v_cvt_pk_bf16_f32 v182, v196, v197
  v_cvt_pk_bf16_f32 v183, v198, v199
  v_mfma_f32_16x16x32_bf16 v[44:47], v[244:247], a[220:223], v[44:47]
  ds_read_b64_tr_b16 v[244:245], v0 offset:672
  s_waitcnt lgkmcnt(7)
  v_mfma_f32_16x16x32_bf16 v[32:35], v[248:251], a[224:227], v[32:35]
  ds_read_b64_tr_b16 v[246:247], v0 offset:928
  buffer_store_dwordx4 v[180:183], v5, s[24:27], s51 offen offset:1024 sc1
  v_mfma_f32_16x16x32_bf16 v[36:39], v[248:251], a[228:231], v[36:39]
  v_mul_f32 v184, v184, v8
  v_mul_f32 v185, v185, v8
  v_mfma_f32_16x16x32_bf16 v[40:43], v[248:251], a[232:235], v[40:43]
  v_mul_f32 v186, v186, v8
  v_mul_f32 v187, v187, v8
  v_mfma_f32_16x16x32_bf16 v[44:47], v[248:251], a[236:239], v[44:47]
  ds_read_b64_tr_b16 v[248:249], v0 offset:33952
  v_mul_f32 v200, v200, v8
  v_mfma_f32_16x16x32_bf16 v[32:35], v[252:255], a[240:243], v[32:35]
  ds_read_b64_tr_b16 v[250:251], v0 offset:34208
  v_mul_f32 v201, v201, v8
  v_mfma_f32_16x16x32_bf16 v[36:39], v[252:255], a[244:247], v[36:39]
  v_mul_f32 v202, v202, v8
  v_mul_f32 v203, v203, v8
  v_mfma_f32_16x16x32_bf16 v[40:43], v[252:255], a[248:251], v[40:43]
  v_cvt_pk_bf16_f32 v184, v184, v185
  v_cvt_pk_bf16_f32 v185, v186, v187
  v_mfma_f32_16x16x32_bf16 v[44:47], v[252:255], a[252:255], v[44:47]
  ds_read_b64_tr_b16 v[252:253], v0 offset:34464
  s_waitcnt lgkmcnt(7)
  v_mfma_f32_16x16x32_bf16 v[64:67], v[232:235], a[128:131], v[64:67]
  ds_read_b64_tr_b16 v[254:255], v0 offset:34720
  v_cvt_pk_bf16_f32 v186, v200, v201
  v_mfma_f32_16x16x32_bf16 v[68:71], v[232:235], a[132:135], v[68:71]
  v_cvt_pk_bf16_f32 v187, v202, v203
  buffer_store_dwordx4 v[184:187], v5, s[24:27], s53 offen offset:1024 sc1
  v_mfma_f32_16x16x32_bf16 v[72:75], v[232:235], a[136:139], v[72:75]
  v_mul_f32 v188, v188, v9
  v_mul_f32 v189, v189, v9
  v_mfma_f32_16x16x32_bf16 v[76:79], v[232:235], a[140:143], v[76:79]
  v_subrev_u32 v0, 50688, v0
  ds_read_b64_tr_b16 v[232:233], v0 offset:17056
  v_mfma_f32_16x16x32_bf16 v[64:67], v[236:239], a[144:147], v[64:67]
  ds_read_b64_tr_b16 v[234:235], v0 offset:17312
  v_mul_f32 v190, v190, v9
  v_mfma_f32_16x16x32_bf16 v[68:71], v[236:239], a[148:151], v[68:71]
  v_mul_f32 v191, v191, v9
  v_mul_f32 v204, v204, v9
  v_mfma_f32_16x16x32_bf16 v[72:75], v[236:239], a[152:155], v[72:75]
  v_mul_f32 v205, v205, v9
  v_mul_f32 v206, v206, v9
  v_mfma_f32_16x16x32_bf16 v[76:79], v[236:239], a[156:159], v[76:79]
  ds_read_b64_tr_b16 v[236:237], v0 offset:17568
  s_waitcnt lgkmcnt(7)
  v_mfma_f32_16x16x32_bf16 v[64:67], v[240:243], a[160:163], v[64:67]
  ds_read_b64_tr_b16 v[238:239], v0 offset:17824
  v_mul_f32 v207, v207, v9
  v_mfma_f32_16x16x32_bf16 v[68:71], v[240:243], a[164:167], v[68:71]
  v_cvt_pk_bf16_f32 v188, v188, v189
  v_cvt_pk_bf16_f32 v189, v190, v191
  v_mfma_f32_16x16x32_bf16 v[72:75], v[240:243], a[168:171], v[72:75]
  v_cvt_pk_bf16_f32 v190, v204, v205
  v_cvt_pk_bf16_f32 v191, v206, v207
  v_mfma_f32_16x16x32_bf16 v[76:79], v[240:243], a[172:175], v[76:79]
  v_add_u32 v0, 101376, v0
  ds_read_b64_tr_b16 v[240:241], v0 offset:17088
  v_mfma_f32_16x16x32_bf16 v[64:67], v[244:247], a[176:179], v[64:67]
  ds_read_b64_tr_b16 v[242:243], v0 offset:17344
  buffer_store_dwordx4 v[188:191], v5, s[24:27], s55 offen offset:1024 sc1
  v_mfma_f32_16x16x32_bf16 v[68:71], v[244:247], a[180:183], v[68:71]
  v_mfma_f32_16x16x32_bf16 v[72:75], v[244:247], a[184:187], v[72:75]
  v_mfma_f32_16x16x32_bf16 v[76:79], v[244:247], a[188:191], v[76:79]
  ds_read_b64_tr_b16 v[244:245], v0 offset:17600
  s_waitcnt lgkmcnt(7)
  v_mfma_f32_16x16x32_bf16 v[64:67], v[248:251], a[192:195], v[64:67]
  ds_read_b64_tr_b16 v[246:247], v0 offset:17856
  v_mfma_f32_16x16x32_bf16 v[68:71], v[248:251], a[196:199], v[68:71]
  v_mfma_f32_16x16x32_bf16 v[72:75], v[248:251], a[200:203], v[72:75]
  v_mfma_f32_16x16x32_bf16 v[76:79], v[248:251], a[204:207], v[76:79]
  v_subrev_u32 v0, 50688, v0
  ds_read_b64_tr_b16 v[248:249], v0 offset:192
  v_mfma_f32_16x16x32_bf16 v[64:67], v[252:255], a[208:211], v[64:67]
  ds_read_b64_tr_b16 v[250:251], v0 offset:448
  v_mfma_f32_16x16x32_bf16 v[68:71], v[252:255], a[212:215], v[68:71]
  v_mfma_f32_16x16x32_bf16 v[72:75], v[252:255], a[216:219], v[72:75]
  v_mfma_f32_16x16x32_bf16 v[76:79], v[252:255], a[220:223], v[76:79]
  ds_read_b64_tr_b16 v[252:253], v0 offset:704
  s_waitcnt lgkmcnt(7)
  v_mfma_f32_16x16x32_bf16 v[64:67], v[232:235], a[224:227], v[64:67]
  ds_read_b64_tr_b16 v[254:255], v0 offset:960
  v_mfma_f32_16x16x32_bf16 v[68:71], v[232:235], a[228:231], v[68:71]
  v_mfma_f32_16x16x32_bf16 v[72:75], v[232:235], a[232:235], v[72:75]
  v_mfma_f32_16x16x32_bf16 v[76:79], v[232:235], a[236:239], v[76:79]
  ds_read_b64_tr_b16 v[232:233], v0 offset:33984
  v_mfma_f32_16x16x32_bf16 v[64:67], v[236:239], a[240:243], v[64:67]
  ds_read_b64_tr_b16 v[234:235], v0 offset:34240
  v_mfma_f32_16x16x32_bf16 v[68:71], v[236:239], a[244:247], v[68:71]
  v_mfma_f32_16x16x32_bf16 v[72:75], v[236:239], a[248:251], v[72:75]
  v_mfma_f32_16x16x32_bf16 v[76:79], v[236:239], a[252:255], v[76:79]
  ds_read_b64_tr_b16 v[236:237], v0 offset:34496
  s_waitcnt lgkmcnt(7)
  v_mfma_f32_16x16x32_bf16 v[96:99], v[240:243], a[128:131], v[96:99]
  ds_read_b64_tr_b16 v[238:239], v0 offset:34752
  v_mfma_f32_16x16x32_bf16 v[100:103], v[240:243], a[132:135], v[100:103]
  v_mfma_f32_16x16x32_bf16 v[104:107], v[240:243], a[136:139], v[104:107]
  v_mfma_f32_16x16x32_bf16 v[108:111], v[240:243], a[140:143], v[108:111]
  v_subrev_u32 v0, 50688, v0
  ds_read_b64_tr_b16 v[240:241], v0 offset:17088
  v_mfma_f32_16x16x32_bf16 v[96:99], v[244:247], a[144:147], v[96:99]
  ds_read_b64_tr_b16 v[242:243], v0 offset:17344
  v_mul_f32 v32, v32, v6
  v_mfma_f32_16x16x32_bf16 v[100:103], v[244:247], a[148:151], v[100:103]
  v_mul_f32 v33, v33, v6
  v_mul_f32 v34, v34, v6
  v_mfma_f32_16x16x32_bf16 v[104:107], v[244:247], a[152:155], v[104:107]
  v_mul_f32 v35, v35, v6
  v_mul_f32 v64, v64, v6
  v_mfma_f32_16x16x32_bf16 v[108:111], v[244:247], a[156:159], v[108:111]
  ds_read_b64_tr_b16 v[244:245], v0 offset:17600
  s_waitcnt lgkmcnt(7)
  v_mfma_f32_16x16x32_bf16 v[96:99], v[248:251], a[160:163], v[96:99]
  ds_read_b64_tr_b16 v[246:247], v0 offset:17856
  v_mul_f32 v65, v65, v6
  v_mfma_f32_16x16x32_bf16 v[100:103], v[248:251], a[164:167], v[100:103]
  v_mul_f32 v66, v66, v6
  v_mul_f32 v67, v67, v6
  v_mfma_f32_16x16x32_bf16 v[104:107], v[248:251], a[168:171], v[104:107]
  v_cvt_pk_bf16_f32 v32, v32, v33
  v_cvt_pk_bf16_f32 v33, v34, v35
  v_mfma_f32_16x16x32_bf16 v[108:111], v[248:251], a[172:175], v[108:111]
  v_add_u32 v0, 101376, v0
  ds_read_b64_tr_b16 v[248:249], v0 offset:17120
  v_mfma_f32_16x16x32_bf16 v[96:99], v[252:255], a[176:179], v[96:99]
  ds_read_b64_tr_b16 v[250:251], v0 offset:17376
  v_cvt_pk_bf16_f32 v34, v64, v65
  v_mfma_f32_16x16x32_bf16 v[100:103], v[252:255], a[180:183], v[100:103]
  v_cvt_pk_bf16_f32 v35, v66, v67
  buffer_store_dwordx4 v[32:35], v5, s[24:27], s49 offen offset:2048 sc1
  v_mfma_f32_16x16x32_bf16 v[104:107], v[252:255], a[184:187], v[104:107]
  v_mul_f32 v36, v36, v7
  v_mul_f32 v37, v37, v7
  v_mfma_f32_16x16x32_bf16 v[108:111], v[252:255], a[188:191], v[108:111]
  ds_read_b64_tr_b16 v[252:253], v0 offset:17632
  s_waitcnt lgkmcnt(7)
  v_mfma_f32_16x16x32_bf16 v[96:99], v[232:235], a[192:195], v[96:99]
  ds_read_b64_tr_b16 v[254:255], v0 offset:17888
  v_mul_f32 v38, v38, v7
  v_mfma_f32_16x16x32_bf16 v[100:103], v[232:235], a[196:199], v[100:103]
  v_mul_f32 v39, v39, v7
  v_mul_f32 v68, v68, v7
  v_mfma_f32_16x16x32_bf16 v[104:107], v[232:235], a[200:203], v[104:107]
  v_mul_f32 v69, v69, v7
  v_mul_f32 v70, v70, v7
  v_mfma_f32_16x16x32_bf16 v[108:111], v[232:235], a[204:207], v[108:111]
  v_subrev_u32 v0, 50688, v0
  ds_read_b64_tr_b16 v[232:233], v0 offset:224
  v_mfma_f32_16x16x32_bf16 v[96:99], v[236:239], a[208:211], v[96:99]
  ds_read_b64_tr_b16 v[234:235], v0 offset:480
  v_mul_f32 v71, v71, v7
  v_mfma_f32_16x16x32_bf16 v[100:103], v[236:239], a[212:215], v[100:103]
  v_cvt_pk_bf16_f32 v36, v36, v37
  v_cvt_pk_bf16_f32 v37, v38, v39
  v_mfma_f32_16x16x32_bf16 v[104:107], v[236:239], a[216:219], v[104:107]
  v_cvt_pk_bf16_f32 v38, v68, v69
  v_cvt_pk_bf16_f32 v39, v70, v71
  v_mfma_f32_16x16x32_bf16 v[108:111], v[236:239], a[220:223], v[108:111]
  ds_read_b64_tr_b16 v[236:237], v0 offset:736
  s_waitcnt lgkmcnt(7)
  v_mfma_f32_16x16x32_bf16 v[96:99], v[240:243], a[224:227], v[96:99]
  ds_read_b64_tr_b16 v[238:239], v0 offset:992
  buffer_store_dwordx4 v[36:39], v5, s[24:27], s51 offen offset:2048 sc1
  v_mfma_f32_16x16x32_bf16 v[100:103], v[240:243], a[228:231], v[100:103]
  v_mul_f32 v40, v40, v8
  v_mul_f32 v41, v41, v8
  v_mfma_f32_16x16x32_bf16 v[104:107], v[240:243], a[232:235], v[104:107]
  v_mul_f32 v42, v42, v8
  v_mul_f32 v43, v43, v8
  v_mfma_f32_16x16x32_bf16 v[108:111], v[240:243], a[236:239], v[108:111]
  ds_read_b64_tr_b16 v[240:241], v0 offset:34016
  v_mul_f32 v72, v72, v8
  v_mfma_f32_16x16x32_bf16 v[96:99], v[244:247], a[240:243], v[96:99]
  ds_read_b64_tr_b16 v[242:243], v0 offset:34272
  v_mul_f32 v73, v73, v8
  v_mfma_f32_16x16x32_bf16 v[100:103], v[244:247], a[244:247], v[100:103]
  v_mul_f32 v74, v74, v8
  v_mul_f32 v75, v75, v8
  v_mfma_f32_16x16x32_bf16 v[104:107], v[244:247], a[248:251], v[104:107]
  v_cvt_pk_bf16_f32 v40, v40, v41
  v_cvt_pk_bf16_f32 v41, v42, v43
  v_mfma_f32_16x16x32_bf16 v[108:111], v[244:247], a[252:255], v[108:111]
  ds_read_b64_tr_b16 v[244:245], v0 offset:34528
  s_waitcnt lgkmcnt(7)
  v_mfma_f32_16x16x32_bf16 v[128:131], v[248:251], a[128:131], v[128:131]
  ds_read_b64_tr_b16 v[246:247], v0 offset:34784
  v_cvt_pk_bf16_f32 v42, v72, v73
  v_mfma_f32_16x16x32_bf16 v[132:135], v[248:251], a[132:135], v[132:135]
  v_cvt_pk_bf16_f32 v43, v74, v75
  buffer_store_dwordx4 v[40:43], v5, s[24:27], s53 offen offset:2048 sc1
  v_mfma_f32_16x16x32_bf16 v[136:139], v[248:251], a[136:139], v[136:139]
  v_mul_f32 v44, v44, v9
  v_mul_f32 v45, v45, v9
  v_mfma_f32_16x16x32_bf16 v[140:143], v[248:251], a[140:143], v[140:143]
  v_subrev_u32 v0, 50688, v0
  ds_read_b64_tr_b16 v[248:249], v0 offset:17120
  v_mfma_f32_16x16x32_bf16 v[128:131], v[252:255], a[144:147], v[128:131]
  ds_read_b64_tr_b16 v[250:251], v0 offset:17376
  v_mul_f32 v46, v46, v9
  v_mfma_f32_16x16x32_bf16 v[132:135], v[252:255], a[148:151], v[132:135]
  v_mul_f32 v47, v47, v9
  v_mul_f32 v76, v76, v9
  v_mfma_f32_16x16x32_bf16 v[136:139], v[252:255], a[152:155], v[136:139]
  v_mul_f32 v77, v77, v9
  v_mul_f32 v78, v78, v9
  v_mfma_f32_16x16x32_bf16 v[140:143], v[252:255], a[156:159], v[140:143]
  ds_read_b64_tr_b16 v[252:253], v0 offset:17632
  s_waitcnt lgkmcnt(7)
  v_mfma_f32_16x16x32_bf16 v[128:131], v[232:235], a[160:163], v[128:131]
  ds_read_b64_tr_b16 v[254:255], v0 offset:17888
  v_mul_f32 v79, v79, v9
  v_mfma_f32_16x16x32_bf16 v[132:135], v[232:235], a[164:167], v[132:135]
  v_cvt_pk_bf16_f32 v44, v44, v45
  v_cvt_pk_bf16_f32 v45, v46, v47
  v_mfma_f32_16x16x32_bf16 v[136:139], v[232:235], a[168:171], v[136:139]
  v_cvt_pk_bf16_f32 v46, v76, v77
  v_cvt_pk_bf16_f32 v47, v78, v79
  v_mfma_f32_16x16x32_bf16 v[140:143], v[232:235], a[172:175], v[140:143]
  buffer_store_dwordx4 v[44:47], v5, s[24:27], s55 offen offset:2048 sc1
  v_mfma_f32_16x16x32_bf16 v[128:131], v[236:239], a[176:179], v[128:131]
  v_mfma_f32_16x16x32_bf16 v[132:135], v[236:239], a[180:183], v[132:135]
  v_mfma_f32_16x16x32_bf16 v[136:139], v[236:239], a[184:187], v[136:139]
  v_mfma_f32_16x16x32_bf16 v[140:143], v[236:239], a[188:191], v[140:143]
  s_waitcnt lgkmcnt(4)
  v_mfma_f32_16x16x32_bf16 v[128:131], v[240:243], a[192:195], v[128:131]
  v_mfma_f32_16x16x32_bf16 v[132:135], v[240:243], a[196:199], v[132:135]
  v_mfma_f32_16x16x32_bf16 v[136:139], v[240:243], a[200:203], v[136:139]
  v_mfma_f32_16x16x32_bf16 v[140:143], v[240:243], a[204:207], v[140:143]
  v_mfma_f32_16x16x32_bf16 v[128:131], v[244:247], a[208:211], v[128:131]
  v_mfma_f32_16x16x32_bf16 v[132:135], v[244:247], a[212:215], v[132:135]
  v_mfma_f32_16x16x32_bf16 v[136:139], v[244:247], a[216:219], v[136:139]
  v_mfma_f32_16x16x32_bf16 v[140:143], v[244:247], a[220:223], v[140:143]
  s_waitcnt lgkmcnt(2)
  v_mfma_f32_16x16x32_bf16 v[128:131], v[248:251], a[224:227], v[128:131]
  v_mfma_f32_16x16x32_bf16 v[132:135], v[248:251], a[228:231], v[132:135]
  v_mfma_f32_16x16x32_bf16 v[136:139], v[248:251], a[232:235], v[136:139]
  v_mfma_f32_16x16x32_bf16 v[140:143], v[248:251], a[236:239], v[140:143]
  s_waitcnt lgkmcnt(0)
  v_mfma_f32_16x16x32_bf16 v[128:131], v[252:255], a[240:243], v[128:131]
  v_mfma_f32_16x16x32_bf16 v[132:135], v[252:255], a[244:247], v[132:135]
  v_mfma_f32_16x16x32_bf16 v[136:139], v[252:255], a[248:251], v[136:139]
  v_mfma_f32_16x16x32_bf16 v[140:143], v[252:255], a[252:255], v[140:143]
  v_mul_f32 v96, v96, v6
  v_mul_f32 v97, v97, v6
  v_mul_f32 v98, v98, v6
  v_mul_f32 v99, v99, v6
  s_nop 0
  v_mul_f32 v128, v128, v6
  v_mul_f32 v129, v129, v6
  v_mul_f32 v130, v130, v6
  v_mul_f32 v131, v131, v6
  v_cvt_pk_bf16_f32 v96, v96, v97
  v_cvt_pk_bf16_f32 v97, v98, v99
  v_cvt_pk_bf16_f32 v98, v128, v129
  v_cvt_pk_bf16_f32 v99, v130, v131
  buffer_store_dwordx4 v[96:99], v5, s[24:27], s49 offen offset:3072 sc1
  v_mul_f32 v100, v100, v7
  v_mul_f32 v101, v101, v7
  v_mul_f32 v102, v102, v7
  v_mul_f32 v103, v103, v7
  v_mul_f32 v132, v132, v7
  v_mul_f32 v133, v133, v7
  v_mul_f32 v134, v134, v7
  v_mul_f32 v135, v135, v7
  v_cvt_pk_bf16_f32 v100, v100, v101
  v_cvt_pk_bf16_f32 v101, v102, v103
  v_cvt_pk_bf16_f32 v102, v132, v133
  v_cvt_pk_bf16_f32 v103, v134, v135
  buffer_store_dwordx4 v[100:103], v5, s[24:27], s51 offen offset:3072 sc1
  v_mul_f32 v104, v104, v8
  v_mul_f32 v105, v105, v8
  v_mul_f32 v106, v106, v8
  v_mul_f32 v107, v107, v8
  v_mul_f32 v136, v136, v8
  v_mul_f32 v137, v137, v8
  v_mul_f32 v138, v138, v8
  v_mul_f32 v139, v139, v8
  v_cvt_pk_bf16_f32 v104, v104, v105
  v_cvt_pk_bf16_f32 v105, v106, v107
  v_cvt_pk_bf16_f32 v106, v136, v137
  v_cvt_pk_bf16_f32 v107, v138, v139
  buffer_store_dwordx4 v[104:107], v5, s[24:27], s53 offen offset:3072 sc1
  v_mul_f32 v108, v108, v9
  v_mul_f32 v109, v109, v9
  v_mul_f32 v110, v110, v9
  v_mul_f32 v111, v111, v9
  v_mul_f32 v140, v140, v9
  v_mul_f32 v141, v141, v9
  v_mul_f32 v142, v142, v9
  v_mul_f32 v143, v143, v9
  v_cvt_pk_bf16_f32 v108, v108, v109
  v_cvt_pk_bf16_f32 v109, v110, v111
  v_cvt_pk_bf16_f32 v110, v140, v141
  v_cvt_pk_bf16_f32 v111, v142, v143
  buffer_store_dwordx4 v[108:111], v5, s[24:27], s55 offen offset:3072 sc1
mha_attn_kernel_exit:
  s_endpgm
mha_attn_kernel_redo:
  s_nop 15
  v_mbcnt_lo_u32_b32 v14, -1, 0
  v_mbcnt_hi_u32_b32 v14, -1, v14
  v_and_b32 v15, 15, v14
  v_lshlrev_b32 v15, 9, v15
  v_bfe_u32 v6, v14, 4, 1
  v_lshl_add_u32 v15, v6, 8, v15
  v_lshrrev_b32 v6, 5, v14
  v_lshl_add_u32 v15, v6, 4, v15
  v_add_u32 v14, 8192, v15
  s_mov_b32 s60, 0
  v_mov_b32 v208, 0
  v_mov_b32 v209, 0
  v_mov_b32 v210, 0
  v_mov_b32 v211, 0
  v_mov_b32 v212, 0
  v_mov_b32 v213, 0
  v_mov_b32 v214, 0
  v_mov_b32 v215, 0
  v_mov_b32 v216, 0
  v_mov_b32 v217, 0
  v_mov_b32 v218, 0
  v_mov_b32 v219, 0
  v_mov_b32 v220, 0
  v_mov_b32 v221, 0
  v_mov_b32 v222, 0
  v_mov_b32 v223, 0
  v_mov_b32 v6, 0xff800000
  v_mov_b32 v7, 0xff800000
  v_mov_b32 v8, 0xff800000
  v_mov_b32 v9, 0xff800000
mha_attn_kernel_p1:
  s_call_b64 s[40:41], mha_attn_kernel_subS
  v_max3_f32 v6, v6, v144, v145
  v_max3_f32 v6, v6, v146, v147
  v_max3_f32 v6, v6, v148, v149
  v_max3_f32 v6, v6, v150, v151
  v_max3_f32 v7, v7, v152, v153
  v_max3_f32 v7, v7, v154, v155
  v_max3_f32 v7, v7, v156, v157
  v_max3_f32 v7, v7, v158, v159
  v_max3_f32 v8, v8, v160, v161
  v_max3_f32 v8, v8, v162, v163
  v_max3_f32 v8, v8, v164, v165
  v_max3_f32 v8, v8, v166, v167
  v_max3_f32 v9, v9, v168, v169
  v_max3_f32 v9, v9, v170, v171
  v_max3_f32 v9, v9, v172, v173
  v_max3_f32 v9, v9, v174, v175
  s_add_u32 s60, s60, 16384
  s_cmp_lt_u32 s60, 262144
  s_cbranch_scc1 mha_attn_kernel_p1
  v_mov_b32 v228, v6
  s_nop 1
  v_permlane16_swap_b32 v228, v6
  v_max_f32 v6, v6, v228
  v_mov_b32 v228, v6
  s_nop 1
  v_permlane32_swap_b32 v228, v6
  v_max_f32 v6, v6, v228
  v_sub_f32 v208, 0, v6
  v_sub_f32 v209, 0, v6
  v_sub_f32 v210, 0, v6
  v_sub_f32 v211, 0, v6
  v_mov_b32 v228, v7
  s_nop 1
  v_permlane16_swap_b32 v228, v7
  v_max_f32 v7, v7, v228
  v_mov_b32 v228, v7
  s_nop 1
  v_permlane32_swap_b32 v228, v7
  v_max_f32 v7, v7, v228
  v_sub_f32 v212, 0, v7
  v_sub_f32 v213, 0, v7
  v_sub_f32 v214, 0, v7
  v_sub_f32 v215, 0, v7
  v_mov_b32 v228, v8
  s_nop 1
  v_permlane16_swap_b32 v228, v8
  v_max_f32 v8, v8, v228
  v_mov_b32 v228, v8
  s_nop 1
  v_permlane32_swap_b32 v228, v8
  v_max_f32 v8, v8, v228
  v_sub_f32 v216, 0, v8
  v_sub_f32 v217, 0, v8
  v_sub_f32 v218, 0, v8
  v_sub_f32 v219, 0, v8
  v_mov_b32 v228, v9
  s_nop 1
  v_permlane16_swap_b32 v228, v9
  v_max_f32 v9, v9, v228
  v_mov_b32 v228, v9
  s_nop 1
  v_permlane32_swap_b32 v228, v9
  v_max_f32 v9, v9, v228
  v_sub_f32 v220, 0, v9
  v_sub_f32 v221, 0, v9
  v_sub_f32 v222, 0, v9
  v_sub_f32 v223, 0, v9
  s_add_u32 s60, s3, 0
  s_and_b32 s60, s60, 0x3fe00
  s_call_b64 s[40:41], mha_attn_kernel_subS
  s_call_b64 s[40:41], mha_attn_kernel_subE
  v_accvgpr_write_b32 a0, v144
  v_accvgpr_write_b32 a1, v145
  v_accvgpr_write_b32 a2, v146
  v_accvgpr_write_b32 a3, v147
  v_accvgpr_write_b32 a4, v152
  v_accvgpr_write_b32 a5, v153
  v_accvgpr_write_b32 a6, v154
  v_accvgpr_write_b32 a7, v155
  v_accvgpr_write_b32 a8, v160
  v_accvgpr_write_b32 a9, v161
  v_accvgpr_write_b32 a10, v162
  v_accvgpr_write_b32 a11, v163
  v_accvgpr_write_b32 a12, v168
  v_accvgpr_write_b32 a13, v169
  v_accvgpr_write_b32 a14, v170
  v_accvgpr_write_b32 a15, v171
  v_mfma_f32_16x16x32_bf16 a[240:243], v[224:227], v[144:147], 0
  v_mfma_f32_16x16x32_bf16 a[244:247], v[224:227], v[152:155], 0
  v_mfma_f32_16x16x32_bf16 a[248:251], v[224:227], v[160:163], 0
  v_mfma_f32_16x16x32_bf16 a[252:255], v[224:227], v[168:171], 0
  s_nop 7
  s_add_u32 s60, s3, 16384
  s_and_b32 s60, s60, 0x3fe00
  s_call_b64 s[40:41], mha_attn_kernel_subS
  s_call_b64 s[40:41], mha_attn_kernel_subE
  v_accvgpr_write_b32 a16, v144
  v_accvgpr_write_b32 a17, v145
  v_accvgpr_write_b32 a18, v146
  v_accvgpr_write_b32 a19, v147
  v_accvgpr_write_b32 a20, v152
  v_accvgpr_write_b32 a21, v153
  v_accvgpr_write_b32 a22, v154
  v_accvgpr_write_b32 a23, v155
  v_accvgpr_write_b32 a24, v160
  v_accvgpr_write_b32 a25, v161
  v_accvgpr_write_b32 a26, v162
  v_accvgpr_write_b32 a27, v163
  v_accvgpr_write_b32 a28, v168
  v_accvgpr_write_b32 a29, v169
  v_accvgpr_write_b32 a30, v170
  v_accvgpr_write_b32 a31, v171
  v_mfma_f32_16x16x32_bf16 a[240:243], v[224:227], v[144:147], a[240:243]
  v_mfma_f32_16x16x32_bf16 a[244:247], v[224:227], v[152:155], a[244:247]
  v_mfma_f32_16x16x32_bf16 a[248:251], v[224:227], v[160:163], a[248:251]
  v_mfma_f32_16x16x32_bf16 a[252:255], v[224:227], v[168:171], a[252:255]
  s_nop 7
  s_add_u32 s60, s3, 32768
  s_and_b32 s60, s60, 0x3fe00
  s_call_b64 s[40:41], mha_attn_kernel_subS
  s_call_b64 s[40:41], mha_attn_kernel_subE
  v_accvgpr_write_b32 a32, v144
  v_accvgpr_write_b32 a33, v145
  v_accvgpr_write_b32 a34, v146
  v_accvgpr_write_b32 a35, v147
  v_accvgpr_write_b32 a36, v152
  v_accvgpr_write_b32 a37, v153
  v_accvgpr_write_b32 a38, v154
  v_accvgpr_write_b32 a39, v155
  v_accvgpr_write_b32 a40, v160
  v_accvgpr_write_b32 a41, v161
  v_accvgpr_write_b32 a42, v162
  v_accvgpr_write_b32 a43, v163
  v_accvgpr_write_b32 a44, v168
  v_accvgpr_write_b32 a45, v169
  v_accvgpr_write_b32 a46, v170
  v_accvgpr_write_b32 a47, v171
  v_mfma_f32_16x16x32_bf16 a[240:243], v[224:227], v[144:147], a[240:243]
  v_mfma_f32_16x16x32_bf16 a[244:247], v[224:227], v[152:155], a[244:247]
  v_mfma_f32_16x16x32_bf16 a[248:251], v[224:227], v[160:163], a[248:251]
  v_mfma_f32_16x16x32_bf16 a[252:255], v[224:227], v[168:171], a[252:255]
  s_nop 7
  s_add_u32 s60, s3, 49152
  s_and_b32 s60, s60, 0x3fe00
  s_call_b64 s[40:41], mha_attn_kernel_subS
  s_call_b64 s[40:41], mha_attn_kernel_subE
  v_accvgpr_write_b32 a48, v144
  v_accvgpr_write_b32 a49, v145
  v_accvgpr_write_b32 a50, v146
  v_accvgpr_write_b32 a51, v147
  v_accvgpr_write_b32 a52, v152
  v_accvgpr_write_b32 a53, v153
  v_accvgpr_write_b32 a54, v154
  v_accvgpr_write_b32 a55, v155
  v_accvgpr_write_b32 a56, v160
  v_accvgpr_write_b32 a57, v161
  v_accvgpr_write_b32 a58, v162
  v_accvgpr_write_b32 a59, v163
  v_accvgpr_write_b32 a60, v168
  v_accvgpr_write_b32 a61, v169
  v_accvgpr_write_b32 a62, v170
  v_accvgpr_write_b32 a63, v171
  v_mfma_f32_16x16x32_bf16 a[240:243], v[224:227], v[144:147], a[240:243]
  v_mfma_f32_16x16x32_bf16 a[244:247], v[224:227], v[152:155], a[244:247]
  v_mfma_f32_16x16x32_bf16 a[248:251], v[224:227], v[160:163], a[248:251]
  v_mfma_f32_16x16x32_bf16 a[252:255], v[224:227], v[168:171], a[252:255]
  s_nop 7
  s_add_u32 s60, s3, 65536
  s_and_b32 s60, s60, 0x3fe00
  s_call_b64 s[40:41], mha_attn_kernel_subS
  s_call_b64 s[40:41], mha_attn_kernel_subE
  v_accvgpr_write_b32 a64, v144
  v_accvgpr_write_b32 a65, v145
  v_accvgpr_write_b32 a66, v146
  v_accvgpr_write_b32 a67, v147
  v_accvgpr_write_b32 a68, v152
  v_accvgpr_write_b32 a69, v153
  v_accvgpr_write_b32 a70, v154
  v_accvgpr_write_b32 a71, v155
  v_accvgpr_write_b32 a72, v160
  v_accvgpr_write_b32 a73, v161
  v_accvgpr_write_b32 a74, v162
  v_accvgpr_write_b32 a75, v163
  v_accvgpr_write_b32 a76, v168
  v_accvgpr_write_b32 a77, v169
  v_accvgpr_write_b32 a78, v170
  v_accvgpr_write_b32 a79, v171
  v_mfma_f32_16x16x32_bf16 a[240:243], v[224:227], v[144:147], a[240:243]
  v_mfma_f32_16x16x32_bf16 a[244:247], v[224:227], v[152:155], a[244:247]
  v_mfma_f32_16x16x32_bf16 a[248:251], v[224:227], v[160:163], a[248:251]
  v_mfma_f32_16x16x32_bf16 a[252:255], v[224:227], v[168:171], a[252:255]
  s_nop 7
  s_add_u32 s60, s3, 81920
  s_and_b32 s60, s60, 0x3fe00
  s_call_b64 s[40:41], mha_attn_kernel_subS
  s_call_b64 s[40:41], mha_attn_kernel_subE
  v_accvgpr_write_b32 a80, v144
  v_accvgpr_write_b32 a81, v145
  v_accvgpr_write_b32 a82, v146
  v_accvgpr_write_b32 a83, v147
  v_accvgpr_write_b32 a84, v152
  v_accvgpr_write_b32 a85, v153
  v_accvgpr_write_b32 a86, v154
  v_accvgpr_write_b32 a87, v155
  v_accvgpr_write_b32 a88, v160
  v_accvgpr_write_b32 a89, v161
  v_accvgpr_write_b32 a90, v162
  v_accvgpr_write_b32 a91, v163
  v_accvgpr_write_b32 a92, v168
  v_accvgpr_write_b32 a93, v169
  v_accvgpr_write_b32 a94, v170
  v_accvgpr_write_b32 a95, v171
  v_mfma_f32_16x16x32_bf16 a[240:243], v[224:227], v[144:147], a[240:243]
  v_mfma_f32_16x16x32_bf16 a[244:247], v[224:227], v[152:155], a[244:247]
  v_mfma_f32_16x16x32_bf16 a[248:251], v[224:227], v[160:163], a[248:251]
  v_mfma_f32_16x16x32_bf16 a[252:255], v[224:227], v[168:171], a[252:255]
  s_nop 7
  s_add_u32 s60, s3, 98304
  s_and_b32 s60, s60, 0x3fe00
  s_call_b64 s[40:41], mha_attn_kernel_subS
  s_call_b64 s[40:41], mha_attn_kernel_subE
  v_accvgpr_write_b32 a96, v144
  v_accvgpr_write_b32 a97, v145
  v_accvgpr_write_b32 a98, v146
  v_accvgpr_write_b32 a99, v147
  v_accvgpr_write_b32 a100, v152
  v_accvgpr_write_b32 a101, v153
  v_accvgpr_write_b32 a102, v154
  v_accvgpr_write_b32 a103, v155
  v_accvgpr_write_b32 a104, v160
  v_accvgpr_write_b32 a105, v161
  v_accvgpr_write_b32 a106, v162
  v_accvgpr_write_b32 a107, v163
  v_accvgpr_write_b32 a108, v168
  v_accvgpr_write_b32 a109, v169
  v_accvgpr_write_b32 a110, v170
  v_accvgpr_write_b32 a111, v171
  v_mfma_f32_16x16x32_bf16 a[240:243], v[224:227], v[144:147], a[240:243]
  v_mfma_f32_16x16x32_bf16 a[244:247], v[224:227], v[152:155], a[244:247]
  v_mfma_f32_16x16x32_bf16 a[248:251], v[224:227], v[160:163], a[248:251]
  v_mfma_f32_16x16x32_bf16 a[252:255], v[224:227], v[168:171], a[252:255]
  s_nop 7
  s_add_u32 s60, s3, 114688
  s_and_b32 s60, s60, 0x3fe00
  s_call_b64 s[40:41], mha_attn_kernel_subS
  s_call_b64 s[40:41], mha_attn_kernel_subE
  v_accvgpr_write_b32 a112, v144
  v_accvgpr_write_b32 a113, v145
  v_accvgpr_write_b32 a114, v146
  v_accvgpr_write_b32 a115, v147
  v_accvgpr_write_b32 a116, v152
  v_accvgpr_write_b32 a117, v153
  v_accvgpr_write_b32 a118, v154
  v_accvgpr_write_b32 a119, v155
  v_accvgpr_write_b32 a120, v160
  v_accvgpr_write_b32 a121, v161
  v_accvgpr_write_b32 a122, v162
  v_accvgpr_write_b32 a123, v163
  v_accvgpr_write_b32 a124, v168
  v_accvgpr_write_b32 a125, v169
  v_accvgpr_write_b32 a126, v170
  v_accvgpr_write_b32 a127, v171
  v_mfma_f32_16x16x32_bf16 a[240:243], v[224:227], v[144:147], a[240:243]
  v_mfma_f32_16x16x32_bf16 a[244:247], v[224:227], v[152:155], a[244:247]
  v_mfma_f32_16x16x32_bf16 a[248:251], v[224:227], v[160:163], a[248:251]
  v_mfma_f32_16x16x32_bf16 a[252:255], v[224:227], v[168:171], a[252:255]
  s_nop 7
  s_add_u32 s60, s3, 131072
  s_and_b32 s60, s60, 0x3fe00
  s_call_b64 s[40:41], mha_attn_kernel_subS
  s_call_b64 s[40:41], mha_attn_kernel_subE
  v_accvgpr_write_b32 a128, v144
  v_accvgpr_write_b32 a129, v145
  v_accvgpr_write_b32 a130, v146
  v_accvgpr_write_b32 a131, v147
  v_accvgpr_write_b32 a132, v152
  v_accvgpr_write_b32 a133, v153
  v_accvgpr_write_b32 a134, v154
  v_accvgpr_write_b32 a135, v155
  v_accvgpr_write_b32 a136, v160
  v_accvgpr_write_b32 a137, v161
  v_accvgpr_write_b32 a138, v162
  v_accvgpr_write_b32 a139, v163
  v_accvgpr_write_b32 a140, v168
  v_accvgpr_write_b32 a141, v169
  v_accvgpr_write_b32 a142, v170
  v_accvgpr_write_b32 a143, v171
  v_mfma_f32_16x16x32_bf16 a[240:243], v[224:227], v[144:147], a[240:243]
  v_mfma_f32_16x16x32_bf16 a[244:247], v[224:227], v[152:155], a[244:247]
  v_mfma_f32_16x16x32_bf16 a[248:251], v[224:227], v[160:163], a[248:251]
  v_mfma_f32_16x16x32_bf16 a[252:255], v[224:227], v[168:171], a[252:255]
  s_nop 7
  s_add_u32 s60, s3, 147456
  s_and_b32 s60, s60, 0x3fe00
  s_call_b64 s[40:41], mha_attn_kernel_subS
  s_call_b64 s[40:41], mha_attn_kernel_subE
  v_accvgpr_write_b32 a144, v144
  v_accvgpr_write_b32 a145, v145
  v_accvgpr_write_b32 a146, v146
  v_accvgpr_write_b32 a147, v147
  v_accvgpr_write_b32 a148, v152
  v_accvgpr_write_b32 a149, v153
  v_accvgpr_write_b32 a150, v154
  v_accvgpr_write_b32 a151, v155
  v_accvgpr_write_b32 a152, v160
  v_accvgpr_write_b32 a153, v161
  v_accvgpr_write_b32 a154, v162
  v_accvgpr_write_b32 a155, v163
  v_accvgpr_write_b32 a156, v168
  v_accvgpr_write_b32 a157, v169
  v_accvgpr_write_b32 a158, v170
  v_accvgpr_write_b32 a159, v171
  v_mfma_f32_16x16x32_bf16 a[240:243], v[224:227], v[144:147], a[240:243]
  v_mfma_f32_16x16x32_bf16 a[244:247], v[224:227], v[152:155], a[244:247]
  v_mfma_f32_16x16x32_bf16 a[248:251], v[224:227], v[160:163], a[248:251]
  v_mfma_f32_16x16x32_bf16 a[252:255], v[224:227], v[168:171], a[252:255]
  s_nop 7
  s_add_u32 s60, s3, 163840
  s_and_b32 s60, s60, 0x3fe00
  s_call_b64 s[40:41], mha_attn_kernel_subS
  s_call_b64 s[40:41], mha_attn_kernel_subE
  v_accvgpr_write_b32 a160, v144
  v_accvgpr_write_b32 a161, v145
  v_accvgpr_write_b32 a162, v146
  v_accvgpr_write_b32 a163, v147
  v_accvgpr_write_b32 a164, v152
  v_accvgpr_write_b32 a165, v153
  v_accvgpr_write_b32 a166, v154
  v_accvgpr_write_b32 a167, v155
  v_accvgpr_write_b32 a168, v160
  v_accvgpr_write_b32 a169, v161
  v_accvgpr_write_b32 a170, v162
  v_accvgpr_write_b32 a171, v163
  v_accvgpr_write_b32 a172, v168
  v_accvgpr_write_b32 a173, v169
  v_accvgpr_write_b32 a174, v170
  v_accvgpr_write_b32 a175, v171
  v_mfma_f32_16x16x32_bf16 a[240:243], v[224:227], v[144:147], a[240:243]
  v_mfma_f32_16x16x32_bf16 a[244:247], v[224:227], v[152:155], a[244:247]
  v_mfma_f32_16x16x32_bf16 a[248:251], v[224:227], v[160:163], a[248:251]
  v_mfma_f32_16x16x32_bf16 a[252:255], v[224:227], v[168:171], a[252:255]
  s_nop 7
  s_add_u32 s60, s3, 180224
  s_and_b32 s60, s60, 0x3fe00
  s_call_b64 s[40:41], mha_attn_kernel_subS
  s_call_b64 s[40:41], mha_attn_kernel_subE
  v_accvgpr_write_b32 a176, v144
  v_accvgpr_write_b32 a177, v145
  v_accvgpr_write_b32 a178, v146
  v_accvgpr_write_b32 a179, v147
  v_accvgpr_write_b32 a180, v152
  v_accvgpr_write_b32 a181, v153
  v_accvgpr_write_b32 a182, v154
  v_accvgpr_write_b32 a183, v155
  v_accvgpr_write_b32 a184, v160
  v_accvgpr_write_b32 a185, v161
  v_accvgpr_write_b32 a186, v162
  v_accvgpr_write_b32 a187, v163
  v_accvgpr_write_b32 a188, v168
  v_accvgpr_write_b32 a189, v169
  v_accvgpr_write_b32 a190, v170
  v_accvgpr_write_b32 a191, v171
  v_mfma_f32_16x16x32_bf16 a[240:243], v[224:227], v[144:147], a[240:243]
  v_mfma_f32_16x16x32_bf16 a[244:247], v[224:227], v[152:155], a[244:247]
  v_mfma_f32_16x16x32_bf16 a[248:251], v[224:227], v[160:163], a[248:251]
  v_mfma_f32_16x16x32_bf16 a[252:255], v[224:227], v[168:171], a[252:255]
  s_nop 7
  s_add_u32 s60, s3, 196608
  s_and_b32 s60, s60, 0x3fe00
  s_call_b64 s[40:41], mha_attn_kernel_subS
  s_call_b64 s[40:41], mha_attn_kernel_subE
  v_accvgpr_write_b32 a192, v144
  v_accvgpr_write_b32 a193, v145
  v_accvgpr_write_b32 a194, v146
  v_accvgpr_write_b32 a195, v147
  v_accvgpr_write_b32 a196, v152
  v_accvgpr_write_b32 a197, v153
  v_accvgpr_write_b32 a198, v154
  v_accvgpr_write_b32 a199, v155
  v_accvgpr_write_b32 a200, v160
  v_accvgpr_write_b32 a201, v161
  v_accvgpr_write_b32 a202, v162
  v_accvgpr_write_b32 a203, v163
  v_accvgpr_write_b32 a204, v168
  v_accvgpr_write_b32 a205, v169
  v_accvgpr_write_b32 a206, v170
  v_accvgpr_write_b32 a207, v171
  v_mfma_f32_16x16x32_bf16 a[240:243], v[224:227], v[144:147], a[240:243]
  v_mfma_f32_16x16x32_bf16 a[244:247], v[224:227], v[152:155], a[244:247]
  v_mfma_f32_16x16x32_bf16 a[248:251], v[224:227], v[160:163], a[248:251]
  v_mfma_f32_16x16x32_bf16 a[252:255], v[224:227], v[168:171], a[252:255]
  s_nop 7
  s_add_u32 s60, s3, 212992
  s_and_b32 s60, s60, 0x3fe00
  s_call_b64 s[40:41], mha_attn_kernel_subS
  s_call_b64 s[40:41], mha_attn_kernel_subE
  v_accvgpr_write_b32 a208, v144
  v_accvgpr_write_b32 a209, v145
  v_accvgpr_write_b32 a210, v146
  v_accvgpr_write_b32 a211, v147
  v_accvgpr_write_b32 a212, v152
  v_accvgpr_write_b32 a213, v153
  v_accvgpr_write_b32 a214, v154
  v_accvgpr_write_b32 a215, v155
  v_accvgpr_write_b32 a216, v160
  v_accvgpr_write_b32 a217, v161
  v_accvgpr_write_b32 a218, v162
  v_accvgpr_write_b32 a219, v163
  v_accvgpr_write_b32 a220, v168
  v_accvgpr_write_b32 a221, v169
  v_accvgpr_write_b32 a222, v170
  v_accvgpr_write_b32 a223, v171
  v_mfma_f32_16x16x32_bf16 a[240:243], v[224:227], v[144:147], a[240:243]
  v_mfma_f32_16x16x32_bf16 a[244:247], v[224:227], v[152:155], a[244:247]
  v_mfma_f32_16x16x32_bf16 a[248:251], v[224:227], v[160:163], a[248:251]
  v_mfma_f32_16x16x32_bf16 a[252:255], v[224:227], v[168:171], a[252:255]
  s_nop 7
  s_add_u32 s60, s3, 229376
  s_and_b32 s60, s60, 0x3fe00
  s_call_b64 s[40:41], mha_attn_kernel_subS
  s_call_b64 s[40:41], mha_attn_kernel_subE
  v_accvgpr_write_b32 a224, v144
  v_accvgpr_write_b32 a225, v145
  v_accvgpr_write_b32 a226, v146
  v_accvgpr_write_b32 a227, v147
  v_accvgpr_write_b32 a228, v152
  v_accvgpr_write_b32 a229, v153
  v_accvgpr_write_b32 a230, v154
  v_accvgpr_write_b32 a231, v155
  v_accvgpr_write_b32 a232, v160
  v_accvgpr_write_b32 a233, v161
  v_accvgpr_write_b32 a234, v162
  v_accvgpr_write_b32 a235, v163
  v_accvgpr_write_b32 a236, v168
  v_accvgpr_write_b32 a237, v169
  v_accvgpr_write_b32 a238, v170
  v_accvgpr_write_b32 a239, v171
  v_mfma_f32_16x16x32_bf16 a[240:243], v[224:227], v[144:147], a[240:243]
  v_mfma_f32_16x16x32_bf16 a[244:247], v[224:227], v[152:155], a[244:247]
  v_mfma_f32_16x16x32_bf16 a[248:251], v[224:227], v[160:163], a[248:251]
  v_mfma_f32_16x16x32_bf16 a[252:255], v[224:227], v[168:171], a[252:255]
  s_nop 7
  s_add_u32 s60, s3, 245760
  s_and_b32 s60, s60, 0x3fe00
  s_call_b64 s[40:41], mha_attn_kernel_subS
  v_mov_b32 v176, v144
  v_mov_b32 v177, v145
  v_mov_b32 v178, v146
  v_mov_b32 v179, v147
  v_mov_b32 v180, v148
  v_mov_b32 v181, v149
  v_mov_b32 v182, v150
  v_mov_b32 v183, v151
  v_mov_b32 v184, v152
  v_mov_b32 v185, v153
  v_mov_b32 v186, v154
  v_mov_b32 v187, v155
  v_mov_b32 v188, v156
  v_mov_b32 v189, v157
  v_mov_b32 v190, v158
  v_mov_b32 v191, v159
  v_mov_b32 v192, v160
  v_mov_b32 v193, v161
  v_mov_b32 v194, v162
  v_mov_b32 v195, v163
  v_mov_b32 v196, v164
  v_mov_b32 v197, v165
  v_mov_b32 v198, v166
  v_mov_b32 v199, v167
  v_mov_b32 v200, v168
  v_mov_b32 v201, v169
  v_mov_b32 v202, v170
  v_mov_b32 v203, v171
  v_mov_b32 v204, v172
  v_mov_b32 v205, v173
  v_mov_b32 v206, v174
  v_mov_b32 v207, v175
  v_accvgpr_read_b32 v6, a240
  v_accvgpr_read_b32 v7, a244
  v_accvgpr_read_b32 v8, a248
  v_accvgpr_read_b32 v9, a252
  s_nop 3
  s_branch mha_attn_kernel_ret
mha_attn_kernel_subS:
  s_nop 3
  buffer_load_dwordx4 v[176:179], v15, s[8:11], s60 offen offset:0
  buffer_load_dwordx4 v[180:183], v14, s[8:11], s60 offen offset:0
  buffer_load_dwordx4 v[184:187], v15, s[8:11], s60 offen offset:32
  buffer_load_dwordx4 v[188:191], v14, s[8:11], s60 offen offset:32
  buffer_load_dwordx4 v[192:195], v15, s[8:11], s60 offen offset:64
  buffer_load_dwordx4 v[196:199], v14, s[8:11], s60 offen offset:64
  buffer_load_dwordx4 v[200:203], v15, s[8:11], s60 offen offset:96
  buffer_load_dwordx4 v[204:207], v14, s[8:11], s60 offen offset:96
  s_waitcnt vmcnt(0)
  v_mfma_f32_16x16x32_bf16 v[144:147], v[176:179], v[16:19], v[208:211]
  v_mfma_f32_16x16x32_bf16 v[152:155], v[176:179], v[20:23], v[212:215]
  v_mfma_f32_16x16x32_bf16 v[160:163], v[176:179], v[24:27], v[216:219]
  v_mfma_f32_16x16x32_bf16 v[168:171], v[176:179], v[28:31], v[220:223]
  v_mfma_f32_16x16x32_bf16 v[148:151], v[180:183], v[16:19], v[208:211]
  v_mfma_f32_16x16x32_bf16 v[156:159], v[180:183], v[20:23], v[212:215]
  v_mfma_f32_16x16x32_bf16 v[164:167], v[180:183], v[24:27], v[216:219]
  v_mfma_f32_16x16x32_bf16 v[172:175], v[180:183], v[28:31], v[220:223]
  v_mfma_f32_16x16x32_bf16 v[144:147], v[184:187], v[32:35], v[144:147]
  v_mfma_f32_16x16x32_bf16 v[152:155], v[184:187], v[36:39], v[152:155]
  v_mfma_f32_16x16x32_bf16 v[160:163], v[184:187], v[40:43], v[160:163]
  v_mfma_f32_16x16x32_bf16 v[168:171], v[184:187], v[44:47], v[168:171]
  v_mfma_f32_16x16x32_bf16 v[148:151], v[188:191], v[32:35], v[148:151]
  v_mfma_f32_16x16x32_bf16 v[156:159], v[188:191], v[36:39], v[156:159]
  v_mfma_f32_16x16x32_bf16 v[164:167], v[188:191], v[40:43], v[164:167]
  v_mfma_f32_16x16x32_bf16 v[172:175], v[188:191], v[44:47], v[172:175]
  v_mfma_f32_16x16x32_bf16 v[144:147], v[192:195], v[48:51], v[144:147]
  v_mfma_f32_16x16x32_bf16 v[152:155], v[192:195], v[52:55], v[152:155]
  v_mfma_f32_16x16x32_bf16 v[160:163], v[192:195], v[56:59], v[160:163]
  v_mfma_f32_16x16x32_bf16 v[168:171], v[192:195], v[60:63], v[168:171]
  v_mfma_f32_16x16x32_bf16 v[148:151], v[196:199], v[48:51], v[148:151]
  v_mfma_f32_16x16x32_bf16 v[156:159], v[196:199], v[52:55], v[156:159]
  v_mfma_f32_16x16x32_bf16 v[164:167], v[196:199], v[56:59], v[164:167]
  v_mfma_f32_16x16x32_bf16 v[172:175], v[196:199], v[60:63], v[172:175]
  v_mfma_f32_16x16x32_bf16 v[144:147], v[200:203], v[64:67], v[144:147]
  v_mfma_f32_16x16x32_bf16 v[152:155], v[200:203], v[68:71], v[152:155]
  v_mfma_f32_16x16x32_bf16 v[160:163], v[200:203], v[72:75], v[160:163]
  v_mfma_f32_16x16x32_bf16 v[168:171], v[200:203], v[76:79], v[168:171]
  v_mfma_f32_16x16x32_bf16 v[148:151], v[204:207], v[64:67], v[148:151]
  v_mfma_f32_16x16x32_bf16 v[156:159], v[204:207], v[68:71], v[156:159]
  v_mfma_f32_16x16x32_bf16 v[164:167], v[204:207], v[72:75], v[164:167]
  v_mfma_f32_16x16x32_bf16 v[172:175], v[204:207], v[76:79], v[172:175]
  s_nop 7
  buffer_load_dwordx4 v[176:179], v15, s[8:11], s60 offen offset:128
  buffer_load_dwordx4 v[180:183], v14, s[8:11], s60 offen offset:128
  buffer_load_dwordx4 v[184:187], v15, s[8:11], s60 offen offset:160
  buffer_load_dwordx4 v[188:191], v14, s[8:11], s60 offen offset:160
  buffer_load_dwordx4 v[192:195], v15, s[8:11], s60 offen offset:192
  buffer_load_dwordx4 v[196:199], v14, s[8:11], s60 offen offset:192
  buffer_load_dwordx4 v[200:203], v15, s[8:11], s60 offen offset:224
  buffer_load_dwordx4 v[204:207], v14, s[8:11], s60 offen offset:224
  s_waitcnt vmcnt(0)
  v_mfma_f32_16x16x32_bf16 v[144:147], v[176:179], v[80:83], v[144:147]
  v_mfma_f32_16x16x32_bf16 v[152:155], v[176:179], v[84:87], v[152:155]
  v_mfma_f32_16x16x32_bf16 v[160:163], v[176:179], v[88:91], v[160:163]
  v_mfma_f32_16x16x32_bf16 v[168:171], v[176:179], v[92:95], v[168:171]
  v_mfma_f32_16x16x32_bf16 v[148:151], v[180:183], v[80:83], v[148:151]
  v_mfma_f32_16x16x32_bf16 v[156:159], v[180:183], v[84:87], v[156:159]
  v_mfma_f32_16x16x32_bf16 v[164:167], v[180:183], v[88:91], v[164:167]
  v_mfma_f32_16x16x32_bf16 v[172:175], v[180:183], v[92:95], v[172:175]
  v_mfma_f32_16x16x32_bf16 v[144:147], v[184:187], v[96:99], v[144:147]
  v_mfma_f32_16x16x32_bf16 v[152:155], v[184:187], v[100:103], v[152:155]
  v_mfma_f32_16x16x32_bf16 v[160:163], v[184:187], v[104:107], v[160:163]
  v_mfma_f32_16x16x32_bf16 v[168:171], v[184:187], v[108:111], v[168:171]
  v_mfma_f32_16x16x32_bf16 v[148:151], v[188:191], v[96:99], v[148:151]
  v_mfma_f32_16x16x32_bf16 v[156:159], v[188:191], v[100:103], v[156:159]
  v_mfma_f32_16x16x32_bf16 v[164:167], v[188:191], v[104:107], v[164:167]
  v_mfma_f32_16x16x32_bf16 v[172:175], v[188:191], v[108:111], v[172:175]
  v_mfma_f32_16x16x32_bf16 v[144:147], v[192:195], v[112:115], v[144:147]
  v_mfma_f32_16x16x32_bf16 v[152:155], v[192:195], v[116:119], v[152:155]
  v_mfma_f32_16x16x32_bf16 v[160:163], v[192:195], v[120:123], v[160:163]
  v_mfma_f32_16x16x32_bf16 v[168:171], v[192:195], v[124:127], v[168:171]
  v_mfma_f32_16x16x32_bf16 v[148:151], v[196:199], v[112:115], v[148:151]
  v_mfma_f32_16x16x32_bf16 v[156:159], v[196:199], v[116:119], v[156:159]
  v_mfma_f32_16x16x32_bf16 v[164:167], v[196:199], v[120:123], v[164:167]
  v_mfma_f32_16x16x32_bf16 v[172:175], v[196:199], v[124:127], v[172:175]
  v_mfma_f32_16x16x32_bf16 v[144:147], v[200:203], v[128:131], v[144:147]
  v_mfma_f32_16x16x32_bf16 v[152:155], v[200:203], v[132:135], v[152:155]
  v_mfma_f32_16x16x32_bf16 v[160:163], v[200:203], v[136:139], v[160:163]
  v_mfma_f32_16x16x32_bf16 v[168:171], v[200:203], v[140:143], v[168:171]
  v_mfma_f32_16x16x32_bf16 v[148:151], v[204:207], v[128:131], v[148:151]
  v_mfma_f32_16x16x32_bf16 v[156:159], v[204:207], v[132:135], v[156:159]
  v_mfma_f32_16x16x32_bf16 v[164:167], v[204:207], v[136:139], v[164:167]
  v_mfma_f32_16x16x32_bf16 v[172:175], v[204:207], v[140:143], v[172:175]
  s_nop 7
  s_nop 15
  s_setpc_b64 s[40:41]
mha_attn_kernel_subE:
  v_exp_f32 v144, v144
  v_exp_f32 v145, v145
  v_exp_f32 v146, v146
  v_exp_f32 v147, v147
  v_cvt_pk_bf16_f32 v144, v144, v145
  v_exp_f32 v148, v148
  v_cvt_pk_bf16_f32 v145, v146, v147
  v_exp_f32 v149, v149
  v_exp_f32 v150, v150
  v_cvt_pk_bf16_f32 v146, v148, v149
  v_exp_f32 v151, v151
  s_nop 0
  v_cvt_pk_bf16_f32 v147, v150, v151
  v_exp_f32 v152, v152
  v_exp_f32 v153, v153
  v_exp_f32 v154, v154
  v_exp_f32 v155, v155
  v_cvt_pk_bf16_f32 v152, v152, v153
  v_exp_f32 v156, v156
  v_cvt_pk_bf16_f32 v153, v154, v155
  v_exp_f32 v157, v157
  v_exp_f32 v158, v158
  v_cvt_pk_bf16_f32 v154, v156, v157
  v_exp_f32 v159, v159
  s_nop 0
  v_cvt_pk_bf16_f32 v155, v158, v159
  v_exp_f32 v160, v160
  v_exp_f32 v161, v161
  v_exp_f32 v162, v162
  v_exp_f32 v163, v163
  v_cvt_pk_bf16_f32 v160, v160, v161
  v_exp_f32 v164, v164
  v_cvt_pk_bf16_f32 v161, v162, v163
  v_exp_f32 v165, v165
  v_exp_f32 v166, v166
  v_cvt_pk_bf16_f32 v162, v164, v165
  v_exp_f32 v167, v167
  s_nop 0
  v_cvt_pk_bf16_f32 v163, v166, v167
  v_exp_f32 v168, v168
  v_exp_f32 v169, v169
  v_exp_f32 v170, v170
  v_exp_f32 v171, v171
  v_cvt_pk_bf16_f32 v168, v168, v169
  v_exp_f32 v172, v172
  v_cvt_pk_bf16_f32 v169, v170, v171
  v_exp_f32 v173, v173
  v_exp_f32 v174, v174
  v_cvt_pk_bf16_f32 v170, v172, v173
  v_exp_f32 v175, v175
  s_nop 0
  v_cvt_pk_bf16_f32 v171, v174, v175
  s_nop 3
  s_setpc_b64 s[40:41]
.globl mha_oproj_kernel
.p2align 8
.type mha_oproj_kernel,@function
mha_oproj_kernel:
  s_cmp_ge_u32 s2, 240
  s_cbranch_scc1 mha_oproj_kernel_exit
  s_load_dwordx2 s[40:41], s[0:1], 40
  s_load_dwordx2 s[42:43], s[0:1], 56
  s_load_dwordx2 s[48:49], s[0:1], 48
  v_lshrrev_b32 v1, 6, v0
  v_and_b32 v0, 63, v0
  s_and_b32 s21, s2, 1
  v_readfirstlane_b32 s16, v1
  s_bfe_u32 s19, s2, 0x20001
  s_lshr_b32 s20, s2, 3
  s_mul_i32 s19, s19, 30
  s_add_u32 s23, s19, s20
  s_lshr_b32 s17, s23, 2
  s_and_b32 s18, s23, 3
  s_lshl_b32 s19, s16, 14
  s_lshl_b32 s20, s21, 16
  s_add_u32 s19, s19, s20
  v_lshlrev_b32 v2, 4, v0
  v_add_u32 v1, s19, v2
  s_lshl_b32 s20, s21, 19
  s_xor_b32 s22, s20, 0x80000
  s_add_u32 s19, s16, 0
  s_and_b32 s19, s19, 3
  s_lshl_b32 s19, s19, 17
  s_add_u32 s24, s19, s22
  s_add_u32 s28, s19, s20
  s_add_u32 s19, s16, 1
  s_and_b32 s19, s19, 3
  s_lshl_b32 s19, s19, 17
  s_add_u32 s25, s19, s22
  s_add_u32 s29, s19, s20
  s_add_u32 s19, s16, 2
  s_and_b32 s19, s19, 3
  s_lshl_b32 s19, s19, 17
  s_add_u32 s26, s19, s22
  s_add_u32 s30, s19, s20
  s_add_u32 s19, s16, 3
  s_and_b32 s19, s19, 3
  s_lshl_b32 s19, s19, 17
  s_add_u32 s27, s19, s22
  s_add_u32 s31, s19, s20
  s_mov_b32 s32, 0
  s_mov_b32 s33, 131072
  s_mov_b32 s34, 262144
  s_mov_b32 s35, 393216
  s_mov_b32 s36, 524288
  s_mov_b32 s37, 655360
  s_mov_b32 s38, 786432
  s_waitcnt lgkmcnt(0)
  s_lshl_b32 s19, s17, 20
  s_add_u32 s4, s42, s19
  s_addc_u32 s5, s43, 0
  s_mov_b32 s6, 1048576
  s_mov_b32 s7, 0x20000
  s_mul_i32 s19, s18, 917504
  s_add_u32 s19, s19, 33554432
  s_add_u32 s8, s42, s19
  s_addc_u32 s9, s43, 0
  s_mov_b32 s10, 917504
  s_mov_b32 s11, 0x20000
  buffer_load_dwordx4 v[40:43], v1, s[8:11], s32 offen offset:0
  buffer_load_dwordx4 v[8:11], v1, s[4:7], s24 offen offset:0
  buffer_load_dwordx4 v[12:15], v1, s[4:7], s25 offen offset:0
  buffer_load_dwordx4 v[16:19], v1, s[4:7], s26 offen offset:0
  buffer_load_dwordx4 v[20:23], v1, s[4:7], s27 offen offset:0
  buffer_load_dwordx4 v[24:27], v1, s[4:7], s28 offen offset:0
  buffer_load_dwordx4 v[28:31], v1, s[4:7], s29 offen offset:0
  buffer_load_dwordx4 v[32:35], v1, s[4:7], s30 offen offset:0
  buffer_load_dwordx4 v[36:39], v1, s[4:7], s31 offen offset:0
  buffer_load_dwordx4 v[44:47], v1, s[8:11], s33 offen offset:0
  buffer_load_dwordx4 v[48:51], v1, s[8:11], s34 offen offset:0
  buffer_load_dwordx4 v[52:55], v1, s[8:11], s35 offen offset:0
  buffer_load_dwordx4 v[56:59], v1, s[8:11], s36 offen offset:0
  buffer_load_dwordx4 v[60:63], v1, s[8:11], s37 offen offset:0
  buffer_load_dwordx4 v[64:67], v1, s[8:11], s38 offen offset:0
  buffer_load_dwordx4 v[100:103], v1, s[8:11], s32 offen offset:1024
  buffer_load_dwordx4 v[68:71], v1, s[4:7], s24 offen offset:1024
  buffer_load_dwordx4 v[72:75], v1, s[4:7], s25 offen offset:1024
  buffer_load_dwordx4 v[76:79], v1, s[4:7], s26 offen offset:1024
  buffer_load_dwordx4 v[80:83], v1, s[4:7], s27 offen offset:1024
  buffer_load_dwordx4 v[84:87], v1, s[4:7], s28 offen offset:1024
  buffer_load_dwordx4 v[88:91], v1, s[4:7], s29 offen offset:1024
  buffer_load_dwordx4 v[92:95], v1, s[4:7], s30 offen offset:1024
  buffer_load_dwordx4 v[96:99], v1, s[4:7], s31 offen offset:1024
  buffer_load_dwordx4 v[104:107], v1, s[8:11], s33 offen offset:1024
  buffer_load_dwordx4 v[108:111], v1, s[8:11], s34 offen offset:1024
  buffer_load_dwordx4 v[112:115], v1, s[8:11], s35 offen offset:1024
  buffer_load_dwordx4 v[116:119], v1, s[8:11], s36 offen offset:1024
  buffer_load_dwordx4 v[120:123], v1, s[8:11], s37 offen offset:1024
  buffer_load_dwordx4 v[124:127], v1, s[8:11], s38 offen offset:1024
  buffer_load_dwordx4 v[160:163], v1, s[8:11], s32 offen offset:2048
  buffer_load_dwordx4 v[128:131], v1, s[4:7], s24 offen offset:2048
  buffer_load_dwordx4 v[132:135], v1, s[4:7], s25 offen offset:2048
  buffer_load_dwordx4 v[136:139], v1, s[4:7], s26 offen offset:2048
  buffer_load_dwordx4 v[140:143], v1, s[4:7], s27 offen offset:2048
  buffer_load_dwordx4 v[144:147], v1, s[4:7], s28 offen offset:2048
  buffer_load_dwordx4 v[148:151], v1, s[4:7], s29 offen offset:2048
  buffer_load_dwordx4 v[152:155], v1, s[4:7], s30 offen offset:2048
  buffer_load_dwordx4 v[156:159], v1, s[4:7], s31 offen offset:2048
  buffer_load_dwordx4 v[164:167], v1, s[8:11], s33 offen offset:2048
  buffer_load_dwordx4 v[168:171], v1, s[8:11], s34 offen offset:2048
  buffer_load_dwordx4 v[172:175], v1, s[8:11], s35 offen offset:2048
  buffer_load_dwordx4 v[176:179], v1, s[8:11], s36 offen offset:2048
  buffer_load_dwordx4 v[180:183], v1, s[8:11], s37 offen offset:2048
  buffer_load_dwordx4 v[184:187], v1, s[8:11], s38 offen offset:2048
  s_mov_b32 s12, s40
  s_mov_b32 s13, s41
  s_mov_b32 s14, 3440640
  s_mov_b32 s15, 0x20000
  s_add_u32 s44, s42, 41943040
  s_addc_u32 s45, s43, 0
  s_mov_b32 s46, 6881280
  s_mov_b32 s47, 0x20000
  s_lshl_b32 s19, s17, 7
  s_lshl_b32 s20, s16, 4
  s_add_u32 s19, s19, s20
  s_lshl_b32 s20, s21, 6
  s_add_u32 s19, s19, s20
  v_and_b32 v3, 15, v0
  v_add_u32 v3, s19, v3
  v_mul_u32_u24 v5, 896, v3
  v_lshrrev_b32 v3, 4, v0
  v_lshl_add_u32 v5, v3, 3, v5
  s_mul_i32 s19, s18, 224
  v_add_u32 v5, s19, v5
  s_mul_i32 s19, s16, 21504
  v_add_u32 v4, s19, v2
  s_lshl_b32 s19, s23, 1
  s_add_u32 s19, s19, s21
  s_xor_b32 s20, s19, 1
  s_lshl_b32 s53, s19, 2
  s_add_u32 s53, s53, s16
  s_lshr_b32 s52, s53, 5
  s_lshl_b32 s52, s52, 2
  s_and_b32 s53, s53, 31
  s_xor_b32 s55, s53, 4
  s_lshl_b32 s53, 1, s53
  s_lshl_b32 s55, 1, s55
  s_mov_b32 s50, 256
  s_mov_b32 s51, 0x20000
  s_mov_b32 s54, s52
  s_mul_i32 s19, s19, 28672
  s_mul_i32 s20, s20, 28672
  s_mul_i32 s22, s16, 7168
  s_add_u32 s19, s19, s22
  s_add_u32 s20, s20, s22
  v_add_u32 v7, s19, v2
  v_add_u32 v6, s20, v2
  v_add_u32 v255, 0x1000, v7
  v_add_u32 v254, 0x1000, v6
  s_add_u32 s19, s16, 1
  s_and_b32 s19, s19, 3
  s_mul_i32 s19, s19, 21504
  s_add_u32 s19, s19, 0
  v_add_u32 v248, s19, v2
  s_add_u32 s19, s16, 3
  s_and_b32 s19, s19, 3
  s_mul_i32 s19, s19, 21504
  s_add_u32 s19, s19, 0
  v_add_u32 v251, s19, v2
  s_add_u32 s19, s16, 2
  s_and_b32 s19, s19, 3
  s_mul_i32 s19, s19, 21504
  s_add_u32 s19, s19, 7168
  v_add_u32 v249, s19, v2
  s_add_u32 s19, s16, 2
  s_and_b32 s19, s19, 3
  s_mul_i32 s19, s19, 21504
  s_add_u32 s19, s19, 7168
  v_add_u32 v252, s19, v2
  s_add_u32 s19, s16, 3
  s_and_b32 s19, s19, 3
  s_mul_i32 s19, s19, 21504
  s_add_u32 s19, s19, 14336
  v_add_u32 v250, s19, v2
  s_add_u32 s19, s16, 1
  s_and_b32 s19, s19, 3
  s_mul_i32 s19, s19, 21504
  s_add_u32 s19, s19, 14336
  v_add_u32 v253, s19, v2
  s_waitcnt vmcnt(44)
  s_waitcnt vmcnt(43)
  v_mfma_f32_16x16x32_bf16 a[0:3], v[40:43], v[8:11], 0
  s_waitcnt vmcnt(42)
  v_mfma_f32_16x16x32_bf16 a[4:7], v[40:43], v[12:15], 0
  buffer_load_dwordx4 v[220:223], v1, s[8:11], s32 offen offset:3072
  s_waitcnt vmcnt(42)
  v_mfma_f32_16x16x32_bf16 a[8:11], v[40:43], v[16:19], 0
  s_waitcnt vmcnt(41)
  v_mfma_f32_16x16x32_bf16 a[12:15], v[40:43], v[20:23], 0
  buffer_load_dwordx4 v[188:191], v1, s[4:7], s24 offen offset:3072
  s_waitcnt vmcnt(41)
  v_mfma_f32_16x16x32_bf16 a[16:19], v[40:43], v[24:27], 0
  s_waitcnt vmcnt(40)
  v_mfma_f32_16x16x32_bf16 a[20:23], v[40:43], v[28:31], 0
  buffer_load_dwordx4 v[192:195], v1, s[4:7], s25 offen offset:3072
  s_waitcnt vmcnt(40)
  v_mfma_f32_16x16x32_bf16 a[24:27], v[40:43], v[32:35], 0
  s_waitcnt vmcnt(39)
  v_mfma_f32_16x16x32_bf16 a[28:31], v[40:43], v[36:39], 0
  buffer_load_dwordx4 v[196:199], v1, s[4:7], s26 offen offset:3072
  s_waitcnt vmcnt(39)
  v_mfma_f32_16x16x32_bf16 a[32:35], v[44:47], v[8:11], 0
  v_mfma_f32_16x16x32_bf16 a[36:39], v[44:47], v[12:15], 0
  buffer_load_dwordx4 v[200:203], v1, s[4:7], s27 offen offset:3072
  v_mfma_f32_16x16x32_bf16 a[40:43], v[44:47], v[16:19], 0
  v_mfma_f32_16x16x32_bf16 a[44:47], v[44:47], v[20:23], 0
  buffer_load_dwordx4 v[204:207], v1, s[4:7], s28 offen offset:3072
  v_mfma_f32_16x16x32_bf16 a[48:51], v[44:47], v[24:27], 0
  v_mfma_f32_16x16x32_bf16 a[52:55], v[44:47], v[28:31], 0
  buffer_load_dwordx4 v[208:211], v1, s[4:7], s29 offen offset:3072
  v_mfma_f32_16x16x32_bf16 a[56:59], v[44:47], v[32:35], 0
  v_mfma_f32_16x16x32_bf16 a[60:63], v[44:47], v[36:39], 0
  buffer_load_dwordx4 v[212:215], v1, s[4:7], s30 offen offset:3072
  s_waitcnt vmcnt(42)
  v_mfma_f32_16x16x32_bf16 a[64:67], v[48:51], v[8:11], 0
  v_mfma_f32_16x16x32_bf16 a[68:71], v[48:51], v[12:15], 0
  buffer_load_dwordx4 v[216:219], v1, s[4:7], s31 offen offset:3072
  v_mfma_f32_16x16x32_bf16 a[72:75], v[48:51], v[16:19], 0
  v_mfma_f32_16x16x32_bf16 a[76:79], v[48:51], v[20:23], 0
  buffer_load_dwordx4 v[224:227], v1, s[8:11], s33 offen offset:3072
  v_mfma_f32_16x16x32_bf16 a[80:83], v[48:51], v[24:27], 0
  v_mfma_f32_16x16x32_bf16 a[84:87], v[48:51], v[28:31], 0
  buffer_load_dwordx4 v[228:231], v1, s[8:11], s34 offen offset:3072
  v_mfma_f32_16x16x32_bf16 a[88:91], v[48:51], v[32:35], 0
  v_mfma_f32_16x16x32_bf16 a[92:95], v[48:51], v[36:39], 0
  buffer_load_dwordx4 v[232:235], v1, s[8:11], s35 offen offset:3072
  s_waitcnt vmcnt(45)
  v_mfma_f32_16x16x32_bf16 a[96:99], v[52:55], v[8:11], 0
  v_mfma_f32_16x16x32_bf16 a[100:103], v[52:55], v[12:15], 0
  buffer_load_dwordx4 v[236:239], v1, s[8:11], s36 offen offset:3072
  v_mfma_f32_16x16x32_bf16 a[104:107], v[52:55], v[16:19], 0
  v_mfma_f32_16x16x32_bf16 a[108:111], v[52:55], v[20:23], 0
  buffer_load_dwordx4 v[240:243], v1, s[8:11], s37 offen offset:3072
  v_mfma_f32_16x16x32_bf16 a[112:115], v[52:55], v[24:27], 0
  v_mfma_f32_16x16x32_bf16 a[116:119], v[52:55], v[28:31], 0
  buffer_load_dwordx4 v[244:247], v1, s[8:11], s38 offen offset:3072
  v_mfma_f32_16x16x32_bf16 a[120:123], v[52:55], v[32:35], 0
  v_mfma_f32_16x16x32_bf16 a[124:127], v[52:55], v[36:39], 0
  s_waitcnt vmcnt(47)
  v_mfma_f32_16x16x32_bf16 a[128:131], v[56:59], v[8:11], 0
  v_mfma_f32_16x16x32_bf16 a[132:135], v[56:59], v[12:15], 0
  v_mfma_f32_16x16x32_bf16 a[136:139], v[56:59], v[16:19], 0
  v_mfma_f32_16x16x32_bf16 a[140:143], v[56:59], v[20:23], 0
  v_mfma_f32_16x16x32_bf16 a[144:147], v[56:59], v[24:27], 0
  v_mfma_f32_16x16x32_bf16 a[148:151], v[56:59], v[28:31], 0
  v_mfma_f32_16x16x32_bf16 a[152:155], v[56:59], v[32:35], 0
  v_mfma_f32_16x16x32_bf16 a[156:159], v[56:59], v[36:39], 0
  s_waitcnt vmcnt(46)
  v_mfma_f32_16x16x32_bf16 a[160:163], v[60:63], v[8:11], 0
  v_mfma_f32_16x16x32_bf16 a[164:167], v[60:63], v[12:15], 0
  v_mfma_f32_16x16x32_bf16 a[168:171], v[60:63], v[16:19], 0
  v_mfma_f32_16x16x32_bf16 a[172:175], v[60:63], v[20:23], 0
  v_mfma_f32_16x16x32_bf16 a[176:179], v[60:63], v[24:27], 0
  v_mfma_f32_16x16x32_bf16 a[180:183], v[60:63], v[28:31], 0
  v_mfma_f32_16x16x32_bf16 a[184:187], v[60:63], v[32:35], 0
  v_mfma_f32_16x16x32_bf16 a[188:191], v[60:63], v[36:39], 0
  s_waitcnt vmcnt(45)
  v_mfma_f32_16x16x32_bf16 a[192:195], v[64:67], v[8:11], 0
  v_mfma_f32_16x16x32_bf16 a[196:199], v[64:67], v[12:15], 0
  v_mfma_f32_16x16x32_bf16 a[200:203], v[64:67], v[16:19], 0
  v_mfma_f32_16x16x32_bf16 a[204:207], v[64:67], v[20:23], 0
  v_mfma_f32_16x16x32_bf16 a[208:211], v[64:67], v[24:27], 0
  v_mfma_f32_16x16x32_bf16 a[212:215], v[64:67], v[28:31], 0
  v_mfma_f32_16x16x32_bf16 a[216:219], v[64:67], v[32:35], 0
  v_mfma_f32_16x16x32_bf16 a[220:223], v[64:67], v[36:39], 0
  s_waitcnt vmcnt(44)
  s_waitcnt vmcnt(43)
  v_mfma_f32_16x16x32_bf16 a[0:3], v[100:103], v[68:71], a[0:3]
  s_waitcnt vmcnt(42)
  v_mfma_f32_16x16x32_bf16 a[4:7], v[100:103], v[72:75], a[4:7]
  s_add_u32 s24, s24, 4096
  s_add_u32 s25, s25, 4096
  s_add_u32 s26, s26, 4096
  s_add_u32 s27, s27, 4096
  s_add_u32 s28, s28, 4096
  s_add_u32 s29, s29, 4096
  s_add_u32 s30, s30, 4096
  s_add_u32 s31, s31, 4096
  s_add_u32 s32, s32, 4096
  s_add_u32 s33, s33, 4096
  s_add_u32 s34, s34, 4096
  s_add_u32 s35, s35, 4096
  s_add_u32 s36, s36, 4096
  s_add_u32 s37, s37, 4096
  s_add_u32 s38, s38, 4096
  buffer_load_dwordx4 v[40:43], v1, s[8:11], s32 offen offset:0
  s_waitcnt vmcnt(42)
  v_mfma_f32_16x16x32_bf16 a[8:11], v[100:103], v[76:79], a[8:11]
  s_waitcnt vmcnt(41)
  v_mfma_f32_16x16x32_bf16 a[12:15], v[100:103], v[80:83], a[12:15]
  buffer_load_dwordx4 v[8:11], v1, s[4:7], s24 offen offset:0
  s_waitcnt vmcnt(41)
  v_mfma_f32_16x16x32_bf16 a[16:19], v[100:103], v[84:87], a[16:19]
  s_waitcnt vmcnt(40)
  v_mfma_f32_16x16x32_bf16 a[20:23], v[100:103], v[88:91], a[20:23]
  buffer_load_dwordx4 v[12:15], v1, s[4:7], s25 offen offset:0
  s_waitcnt vmcnt(40)
  v_mfma_f32_16x16x32_bf16 a[24:27], v[100:103], v[92:95], a[24:27]
  s_waitcnt vmcnt(39)
  v_mfma_f32_16x16x32_bf16 a[28:31], v[100:103], v[96:99], a[28:31]
  buffer_load_dwordx4 v[16:19], v1, s[4:7], s26 offen offset:0
  s_waitcnt vmcnt(39)
  v_mfma_f32_16x16x32_bf16 a[32:35], v[104:107], v[68:71], a[32:35]
  v_mfma_f32_16x16x32_bf16 a[36:39], v[104:107], v[72:75], a[36:39]
  buffer_load_dwordx4 v[20:23], v1, s[4:7], s27 offen offset:0
  v_mfma_f32_16x16x32_bf16 a[40:43], v[104:107], v[76:79], a[40:43]
  v_mfma_f32_16x16x32_bf16 a[44:47], v[104:107], v[80:83], a[44:47]
  buffer_load_dwordx4 v[24:27], v1, s[4:7], s28 offen offset:0
  v_mfma_f32_16x16x32_bf16 a[48:51], v[104:107], v[84:87], a[48:51]
  v_mfma_f32_16x16x32_bf16 a[52:55], v[104:107], v[88:91], a[52:55]
  buffer_load_dwordx4 v[28:31], v1, s[4:7], s29 offen offset:0
  v_mfma_f32_16x16x32_bf16 a[56:59], v[104:107], v[92:95], a[56:59]
  v_mfma_f32_16x16x32_bf16 a[60:63], v[104:107], v[96:99], a[60:63]
  buffer_load_dwordx4 v[32:35], v1, s[4:7], s30 offen offset:0
  s_waitcnt vmcnt(42)
  v_mfma_f32_16x16x32_bf16 a[64:67], v[108:111], v[68:71], a[64:67]
  v_mfma_f32_16x16x32_bf16 a[68:71], v[108:111], v[72:75], a[68:71]
  buffer_load_dwordx4 v[36:39], v1, s[4:7], s31 offen offset:0
  v_mfma_f32_16x16x32_bf16 a[72:75], v[108:111], v[76:79], a[72:75]
  v_mfma_f32_16x16x32_bf16 a[76:79], v[108:111], v[80:83], a[76:79]
  buffer_load_dwordx4 v[44:47], v1, s[8:11], s33 offen offset:0
  v_mfma_f32_16x16x32_bf16 a[80:83], v[108:111], v[84:87], a[80:83]
  v_mfma_f32_16x16x32_bf16 a[84:87], v[108:111], v[88:91], a[84:87]
  buffer_load_dwordx4 v[48:51], v1, s[8:11], s34 offen offset:0
  v_mfma_f32_16x16x32_bf16 a[88:91], v[108:111], v[92:95], a[88:91]
  v_mfma_f32_16x16x32_bf16 a[92:95], v[108:111], v[96:99], a[92:95]
  buffer_load_dwordx4 v[52:55], v1, s[8:11], s35 offen offset:0
  s_waitcnt vmcnt(45)
  v_mfma_f32_16x16x32_bf16 a[96:99], v[112:115], v[68:71], a[96:99]
  v_mfma_f32_16x16x32_bf16 a[100:103], v[112:115], v[72:75], a[100:103]
  buffer_load_dwordx4 v[56:59], v1, s[8:11], s36 offen offset:0
  v_mfma_f32_16x16x32_bf16 a[104:107], v[112:115], v[76:79], a[104:107]
  v_mfma_f32_16x16x32_bf16 a[108:111], v[112:115], v[80:83], a[108:111]
  buffer_load_dwordx4 v[60:63], v1, s[8:11], s37 offen offset:0
  v_mfma_f32_16x16x32_bf16 a[112:115], v[112:115], v[84:87], a[112:115]
  v_mfma_f32_16x16x32_bf16 a[116:119], v[112:115], v[88:91], a[116:119]
  buffer_load_dwordx4 v[64:67], v1, s[8:11], s38 offen offset:0
  v_mfma_f32_16x16x32_bf16 a[120:123], v[112:115], v[92:95], a[120:123]
  v_mfma_f32_16x16x32_bf16 a[124:127], v[112:115], v[96:99], a[124:127]
  s_waitcnt vmcnt(47)
  v_mfma_f32_16x16x32_bf16 a[128:131], v[116:119], v[68:71], a[128:131]
  v_mfma_f32_16x16x32_bf16 a[132:135], v[116:119], v[72:75], a[132:135]
  v_mfma_f32_16x16x32_bf16 a[136:139], v[116:119], v[76:79], a[136:139]
  v_mfma_f32_16x16x32_bf16 a[140:143], v[116:119], v[80:83], a[140:143]
  v_mfma_f32_16x16x32_bf16 a[144:147], v[116:119], v[84:87], a[144:147]
  v_mfma_f32_16x16x32_bf16 a[148:151], v[116:119], v[88:91], a[148:151]
  v_mfma_f32_16x16x32_bf16 a[152:155], v[116:119], v[92:95], a[152:155]
  v_mfma_f32_16x16x32_bf16 a[156:159], v[116:119], v[96:99], a[156:159]
  s_waitcnt vmcnt(46)
  v_mfma_f32_16x16x32_bf16 a[160:163], v[120:123], v[68:71], a[160:163]
  v_mfma_f32_16x16x32_bf16 a[164:167], v[120:123], v[72:75], a[164:167]
  v_mfma_f32_16x16x32_bf16 a[168:171], v[120:123], v[76:79], a[168:171]
  v_mfma_f32_16x16x32_bf16 a[172:175], v[120:123], v[80:83], a[172:175]
  v_mfma_f32_16x16x32_bf16 a[176:179], v[120:123], v[84:87], a[176:179]
  v_mfma_f32_16x16x32_bf16 a[180:183], v[120:123], v[88:91], a[180:183]
  v_mfma_f32_16x16x32_bf16 a[184:187], v[120:123], v[92:95], a[184:187]
  v_mfma_f32_16x16x32_bf16 a[188:191], v[120:123], v[96:99], a[188:191]
  s_waitcnt vmcnt(45)
  v_mfma_f32_16x16x32_bf16 a[192:195], v[124:127], v[68:71], a[192:195]
  v_mfma_f32_16x16x32_bf16 a[196:199], v[124:127], v[72:75], a[196:199]
  v_mfma_f32_16x16x32_bf16 a[200:203], v[124:127], v[76:79], a[200:203]
  v_mfma_f32_16x16x32_bf16 a[204:207], v[124:127], v[80:83], a[204:207]
  v_mfma_f32_16x16x32_bf16 a[208:211], v[124:127], v[84:87], a[208:211]
  v_mfma_f32_16x16x32_bf16 a[212:215], v[124:127], v[88:91], a[212:215]
  v_mfma_f32_16x16x32_bf16 a[216:219], v[124:127], v[92:95], a[216:219]
  v_mfma_f32_16x16x32_bf16 a[220:223], v[124:127], v[96:99], a[220:223]
  s_waitcnt vmcnt(44)
  s_waitcnt vmcnt(43)
  v_mfma_f32_16x16x32_bf16 a[0:3], v[160:163], v[128:131], a[0:3]
  s_waitcnt vmcnt(42)
  v_mfma_f32_16x16x32_bf16 a[4:7], v[160:163], v[132:135], a[4:7]
  buffer_load_dwordx4 v[100:103], v1, s[8:11], s32 offen offset:1024
  s_waitcnt vmcnt(42)
  v_mfma_f32_16x16x32_bf16 a[8:11], v[160:163], v[136:139], a[8:11]
  s_waitcnt vmcnt(41)
  v_mfma_f32_16x16x32_bf16 a[12:15], v[160:163], v[140:143], a[12:15]
  buffer_load_dwordx4 v[68:71], v1, s[4:7], s24 offen offset:1024
  s_waitcnt vmcnt(41)
  v_mfma_f32_16x16x32_bf16 a[16:19], v[160:163], v[144:147], a[16:19]
  s_waitcnt vmcnt(40)
  v_mfma_f32_16x16x32_bf16 a[20:23], v[160:163], v[148:151], a[20:23]
  buffer_load_dwordx4 v[72:75], v1, s[4:7], s25 offen offset:1024
  s_waitcnt vmcnt(40)
  v_mfma_f32_16x16x32_bf16 a[24:27], v[160:163], v[152:155], a[24:27]
  s_waitcnt vmcnt(39)
  v_mfma_f32_16x16x32_bf16 a[28:31], v[160:163], v[156:159], a[28:31]
  buffer_load_dwordx4 v[76:79], v1, s[4:7], s26 offen offset:1024
  s_waitcnt vmcnt(39)
  v_mfma_f32_16x16x32_bf16 a[32:35], v[164:167], v[128:131], a[32:35]
  v_mfma_f32_16x16x32_bf16 a[36:39], v[164:167], v[132:135], a[36:39]
  buffer_load_dwordx4 v[80:83], v1, s[4:7], s27 offen offset:1024
  v_mfma_f32_16x16x32_bf16 a[40:43], v[164:167], v[136:139], a[40:43]
  v_mfma_f32_16x16x32_bf16 a[44:47], v[164:167], v[140:143], a[44:47]
  buffer_load_dwordx4 v[84:87], v1, s[4:7], s28 offen offset:1024
  v_mfma_f32_16x16x32_bf16 a[48:51], v[164:167], v[144:147], a[48:51]
  v_mfma_f32_16x16x32_bf16 a[52:55], v[164:167], v[148:151], a[52:55]
  buffer_load_dwordx4 v[88:91], v1, s[4:7], s29 offen offset:1024
  v_mfma_f32_16x16x32_bf16 a[56:59], v[164:167], v[152:155], a[56:59]
  v_mfma_f32_16x16x32_bf16 a[60:63], v[164:167], v[156:159], a[60:63]
  buffer_load_dwordx4 v[92:95], v1, s[4:7], s30 offen offset:1024
  s_waitcnt vmcnt(42)
  v_mfma_f32_16x16x32_bf16 a[64:67], v[168:171], v[128:131], a[64:67]
  v_mfma_f32_16x16x32_bf16 a[68:71], v[168:171], v[132:135], a[68:71]
  buffer_load_dwordx4 v[96:99], v1, s[4:7], s31 offen offset:1024
  v_mfma_f32_16x16x32_bf16 a[72:75], v[168:171], v[136:139], a[72:75]
  v_mfma_f32_16x16x32_bf16 a[76:79], v[168:171], v[140:143], a[76:79]
  buffer_load_dwordx4 v[104:107], v1, s[8:11], s33 offen offset:1024
  v_mfma_f32_16x16x32_bf16 a[80:83], v[168:171], v[144:147], a[80:83]
  v_mfma_f32_16x16x32_bf16 a[84:87], v[168:171], v[148:151], a[84:87]
  buffer_load_dwordx4 v[108:111], v1, s[8:11], s34 offen offset:1024
  v_mfma_f32_16x16x32_bf16 a[88:91], v[168:171], v[152:155], a[88:91]
  v_mfma_f32_16x16x32_bf16 a[92:95], v[168:171], v[156:159], a[92:95]
  buffer_load_dwordx4 v[112:115], v1, s[8:11], s35 offen offset:1024
  s_waitcnt vmcnt(45)
  v_mfma_f32_16x16x32_bf16 a[96:99], v[172:175], v[128:131], a[96:99]
  v_mfma_f32_16x16x32_bf16 a[100:103], v[172:175], v[132:135], a[100:103]
  buffer_load_dwordx4 v[116:119], v1, s[8:11], s36 offen offset:1024
  v_mfma_f32_16x16x32_bf16 a[104:107], v[172:175], v[136:139], a[104:107]
  v_mfma_f32_16x16x32_bf16 a[108:111], v[172:175], v[140:143], a[108:111]
  buffer_load_dwordx4 v[120:123], v1, s[8:11], s37 offen offset:1024
  v_mfma_f32_16x16x32_bf16 a[112:115], v[172:175], v[144:147], a[112:115]
  v_mfma_f32_16x16x32_bf16 a[116:119], v[172:175], v[148:151], a[116:119]
  buffer_load_dwordx4 v[124:127], v1, s[8:11], s38 offen offset:1024
  v_mfma_f32_16x16x32_bf16 a[120:123], v[172:175], v[152:155], a[120:123]
  v_mfma_f32_16x16x32_bf16 a[124:127], v[172:175], v[156:159], a[124:127]
  s_waitcnt vmcnt(47)
  v_mfma_f32_16x16x32_bf16 a[128:131], v[176:179], v[128:131], a[128:131]
  v_mfma_f32_16x16x32_bf16 a[132:135], v[176:179], v[132:135], a[132:135]
  v_mfma_f32_16x16x32_bf16 a[136:139], v[176:179], v[136:139], a[136:139]
  v_mfma_f32_16x16x32_bf16 a[140:143], v[176:179], v[140:143], a[140:143]
  v_mfma_f32_16x16x32_bf16 a[144:147], v[176:179], v[144:147], a[144:147]
  v_mfma_f32_16x16x32_bf16 a[148:151], v[176:179], v[148:151], a[148:151]
  v_mfma_f32_16x16x32_bf16 a[152:155], v[176:179], v[152:155], a[152:155]
  v_mfma_f32_16x16x32_bf16 a[156:159], v[176:179], v[156:159], a[156:159]
  s_waitcnt vmcnt(46)
  v_mfma_f32_16x16x32_bf16 a[160:163], v[180:183], v[128:131], a[160:163]
  v_mfma_f32_16x16x32_bf16 a[164:167], v[180:183], v[132:135], a[164:167]
  v_mfma_f32_16x16x32_bf16 a[168:171], v[180:183], v[136:139], a[168:171]
  v_mfma_f32_16x16x32_bf16 a[172:175], v[180:183], v[140:143], a[172:175]
  v_mfma_f32_16x16x32_bf16 a[176:179], v[180:183], v[144:147], a[176:179]
  v_mfma_f32_16x16x32_bf16 a[180:183], v[180:183], v[148:151], a[180:183]
  v_mfma_f32_16x16x32_bf16 a[184:187], v[180:183], v[152:155], a[184:187]
  v_mfma_f32_16x16x32_bf16 a[188:191], v[180:183], v[156:159], a[188:191]
  s_waitcnt vmcnt(45)
  v_mfma_f32_16x16x32_bf16 a[192:195], v[184:187], v[128:131], a[192:195]
  v_mfma_f32_16x16x32_bf16 a[196:199], v[184:187], v[132:135], a[196:199]
  v_mfma_f32_16x16x32_bf16 a[200:203], v[184:187], v[136:139], a[200:203]
  v_mfma_f32_16x16x32_bf16 a[204:207], v[184:187], v[140:143], a[204:207]
  v_mfma_f32_16x16x32_bf16 a[208:211], v[184:187], v[144:147], a[208:211]
  v_mfma_f32_16x16x32_bf16 a[212:215], v[184:187], v[148:151], a[212:215]
  v_mfma_f32_16x16x32_bf16 a[216:219], v[184:187], v[152:155], a[216:219]
  v_mfma_f32_16x16x32_bf16 a[220:223], v[184:187], v[156:159], a[220:223]
  s_waitcnt vmcnt(44)
  s_waitcnt vmcnt(43)
  v_mfma_f32_16x16x32_bf16 a[0:3], v[220:223], v[188:191], a[0:3]
  s_waitcnt vmcnt(42)
  v_mfma_f32_16x16x32_bf16 a[4:7], v[220:223], v[192:195], a[4:7]
  buffer_load_dwordx4 v[160:163], v1, s[8:11], s32 offen offset:2048
  s_waitcnt vmcnt(42)
  v_mfma_f32_16x16x32_bf16 a[8:11], v[220:223], v[196:199], a[8:11]
  s_waitcnt vmcnt(41)
  v_mfma_f32_16x16x32_bf16 a[12:15], v[220:223], v[200:203], a[12:15]
  buffer_load_dwordx4 v[128:131], v1, s[4:7], s24 offen offset:2048
  s_waitcnt vmcnt(41)
  v_mfma_f32_16x16x32_bf16 a[16:19], v[220:223], v[204:207], a[16:19]
  s_waitcnt vmcnt(40)
  v_mfma_f32_16x16x32_bf16 a[20:23], v[220:223], v[208:211], a[20:23]
  buffer_load_dwordx4 v[132:135], v1, s[4:7], s25 offen offset:2048
  s_waitcnt vmcnt(40)
  v_mfma_f32_16x16x32_bf16 a[24:27], v[220:223], v[212:215], a[24:27]
  s_waitcnt vmcnt(39)
  v_mfma_f32_16x16x32_bf16 a[28:31], v[220:223], v[216:219], a[28:31]
  buffer_load_dwordx4 v[136:139], v1, s[4:7], s26 offen offset:2048
  s_waitcnt vmcnt(39)
  v_mfma_f32_16x16x32_bf16 a[32:35], v[224:227], v[188:191], a[32:35]
  v_mfma_f32_16x16x32_bf16 a[36:39], v[224:227], v[192:195], a[36:39]
  buffer_load_dwordx4 v[140:143], v1, s[4:7], s27 offen offset:2048
  v_mfma_f32_16x16x32_bf16 a[40:43], v[224:227], v[196:199], a[40:43]
  v_mfma_f32_16x16x32_bf16 a[44:47], v[224:227], v[200:203], a[44:47]
  buffer_load_dwordx4 v[144:147], v1, s[4:7], s28 offen offset:2048
  v_mfma_f32_16x16x32_bf16 a[48:51], v[224:227], v[204:207], a[48:51]
  v_mfma_f32_16x16x32_bf16 a[52:55], v[224:227], v[208:211], a[52:55]
  buffer_load_dwordx4 v[148:151], v1, s[4:7], s29 offen offset:2048
  v_mfma_f32_16x16x32_bf16 a[56:59], v[224:227], v[212:215], a[56:59]
  v_mfma_f32_16x16x32_bf16 a[60:63], v[224:227], v[216:219], a[60:63]
  buffer_load_dwordx4 v[152:155], v1, s[4:7], s30 offen offset:2048
  s_waitcnt vmcnt(42)
  v_mfma_f32_16x16x32_bf16 a[64:67], v[228:231], v[188:191], a[64:67]
  v_mfma_f32_16x16x32_bf16 a[68:71], v[228:231], v[192:195], a[68:71]
  buffer_load_dwordx4 v[156:159], v1, s[4:7], s31 offen offset:2048
  v_mfma_f32_16x16x32_bf16 a[72:75], v[228:231], v[196:199], a[72:75]
  v_mfma_f32_16x16x32_bf16 a[76:79], v[228:231], v[200:203], a[76:79]
  buffer_load_dwordx4 v[164:167], v1, s[8:11], s33 offen offset:2048
  v_mfma_f32_16x16x32_bf16 a[80:83], v[228:231], v[204:207], a[80:83]
  v_mfma_f32_16x16x32_bf16 a[84:87], v[228:231], v[208:211], a[84:87]
  buffer_load_dwordx4 v[168:171], v1, s[8:11], s34 offen offset:2048
  v_mfma_f32_16x16x32_bf16 a[88:91], v[228:231], v[212:215], a[88:91]
  v_mfma_f32_16x16x32_bf16 a[92:95], v[228:231], v[216:219], a[92:95]
  buffer_load_dwordx4 v[172:175], v1, s[8:11], s35 offen offset:2048
  s_waitcnt vmcnt(45)
  v_mfma_f32_16x16x32_bf16 a[96:99], v[232:235], v[188:191], a[96:99]
  v_mfma_f32_16x16x32_bf16 a[100:103], v[232:235], v[192:195], a[100:103]
  buffer_load_dwordx4 v[176:179], v1, s[8:11], s36 offen offset:2048
  v_mfma_f32_16x16x32_bf16 a[104:107], v[232:235], v[196:199], a[104:107]
  v_mfma_f32_16x16x32_bf16 a[108:111], v[232:235], v[200:203], a[108:111]
  buffer_load_dwordx4 v[180:183], v1, s[8:11], s37 offen offset:2048
  v_mfma_f32_16x16x32_bf16 a[112:115], v[232:235], v[204:207], a[112:115]
  v_mfma_f32_16x16x32_bf16 a[116:119], v[232:235], v[208:211], a[116:119]
  buffer_load_dwordx4 v[184:187], v1, s[8:11], s38 offen offset:2048
  v_mfma_f32_16x16x32_bf16 a[120:123], v[232:235], v[212:215], a[120:123]
  v_mfma_f32_16x16x32_bf16 a[124:127], v[232:235], v[216:219], a[124:127]
  s_waitcnt vmcnt(47)
  v_mfma_f32_16x16x32_bf16 a[128:131], v[236:239], v[188:191], a[128:131]
  v_mfma_f32_16x16x32_bf16 a[132:135], v[236:239], v[192:195], a[132:135]
  v_mfma_f32_16x16x32_bf16 a[136:139], v[236:239], v[196:199], a[136:139]
  v_mfma_f32_16x16x32_bf16 a[140:143], v[236:239], v[200:203], a[140:143]
  v_mfma_f32_16x16x32_bf16 a[144:147], v[236:239], v[204:207], a[144:147]
  v_mfma_f32_16x16x32_bf16 a[148:151], v[236:239], v[208:211], a[148:151]
  v_mfma_f32_16x16x32_bf16 a[152:155], v[236:239], v[212:215], a[152:155]
  v_mfma_f32_16x16x32_bf16 a[156:159], v[236:239], v[216:219], a[156:159]
  s_waitcnt vmcnt(46)
  v_mfma_f32_16x16x32_bf16 a[160:163], v[240:243], v[188:191], a[160:163]
  v_mfma_f32_16x16x32_bf16 a[164:167], v[240:243], v[192:195], a[164:167]
  v_mfma_f32_16x16x32_bf16 a[168:171], v[240:243], v[196:199], a[168:171]
  v_mfma_f32_16x16x32_bf16 a[172:175], v[240:243], v[200:203], a[172:175]
  v_mfma_f32_16x16x32_bf16 a[176:179], v[240:243], v[204:207], a[176:179]
  v_mfma_f32_16x16x32_bf16 a[180:183], v[240:243], v[208:211], a[180:183]
  v_mfma_f32_16x16x32_bf16 a[184:187], v[240:243], v[212:215], a[184:187]
  v_mfma_f32_16x16x32_bf16 a[188:191], v[240:243], v[216:219], a[188:191]
  s_waitcnt vmcnt(45)
  v_mfma_f32_16x16x32_bf16 a[192:195], v[244:247], v[188:191], a[192:195]
  v_mfma_f32_16x16x32_bf16 a[196:199], v[244:247], v[192:195], a[196:199]
  v_mfma_f32_16x16x32_bf16 a[200:203], v[244:247], v[196:199], a[200:203]
  v_mfma_f32_16x16x32_bf16 a[204:207], v[244:247], v[200:203], a[204:207]
  v_mfma_f32_16x16x32_bf16 a[208:211], v[244:247], v[204:207], a[208:211]
  v_mfma_f32_16x16x32_bf16 a[212:215], v[244:247], v[208:211], a[212:215]
  v_mfma_f32_16x16x32_bf16 a[216:219], v[244:247], v[212:215], a[216:219]
  v_mfma_f32_16x16x32_bf16 a[220:223], v[244:247], v[216:219], a[220:223]
  s_waitcnt vmcnt(44)
  s_waitcnt vmcnt(43)
  v_mfma_f32_16x16x32_bf16 a[0:3], v[40:43], v[8:11], a[0:3]
  s_waitcnt vmcnt(42)
  v_mfma_f32_16x16x32_bf16 a[4:7], v[40:43], v[12:15], a[4:7]
  buffer_load_dwordx4 v[220:223], v1, s[8:11], s32 offen offset:3072
  s_waitcnt vmcnt(42)
  v_mfma_f32_16x16x32_bf16 a[8:11], v[40:43], v[16:19], a[8:11]
  s_waitcnt vmcnt(41)
  v_mfma_f32_16x16x32_bf16 a[12:15], v[40:43], v[20:23], a[12:15]
  buffer_load_dwordx4 v[188:191], v1, s[4:7], s24 offen offset:3072
  s_waitcnt vmcnt(41)
  v_mfma_f32_16x16x32_bf16 a[16:19], v[40:43], v[24:27], a[16:19]
  s_waitcnt vmcnt(40)
  v_mfma_f32_16x16x32_bf16 a[20:23], v[40:43], v[28:31], a[20:23]
  buffer_load_dwordx4 v[192:195], v1, s[4:7], s25 offen offset:3072
  s_waitcnt vmcnt(40)
  v_mfma_f32_16x16x32_bf16 a[24:27], v[40:43], v[32:35], a[24:27]
  s_waitcnt vmcnt(39)
  v_mfma_f32_16x16x32_bf16 a[28:31], v[40:43], v[36:39], a[28:31]
  buffer_load_dwordx4 v[196:199], v1, s[4:7], s26 offen offset:3072
  s_waitcnt vmcnt(39)
  v_mfma_f32_16x16x32_bf16 a[32:35], v[44:47], v[8:11], a[32:35]
  v_mfma_f32_16x16x32_bf16 a[36:39], v[44:47], v[12:15], a[36:39]
  buffer_load_dwordx4 v[200:203], v1, s[4:7], s27 offen offset:3072
  v_mfma_f32_16x16x32_bf16 a[40:43], v[44:47], v[16:19], a[40:43]
  v_mfma_f32_16x16x32_bf16 a[44:47], v[44:47], v[20:23], a[44:47]
  buffer_load_dwordx4 v[204:207], v1, s[4:7], s28 offen offset:3072
  v_mfma_f32_16x16x32_bf16 a[48:51], v[44:47], v[24:27], a[48:51]
  v_mfma_f32_16x16x32_bf16 a[52:55], v[44:47], v[28:31], a[52:55]
  buffer_load_dwordx4 v[208:211], v1, s[4:7], s29 offen offset:3072
  v_mfma_f32_16x16x32_bf16 a[56:59], v[44:47], v[32:35], a[56:59]
  v_mfma_f32_16x16x32_bf16 a[60:63], v[44:47], v[36:39], a[60:63]
  buffer_load_dwordx4 v[212:215], v1, s[4:7], s30 offen offset:3072
  s_waitcnt vmcnt(42)
  v_mfma_f32_16x16x32_bf16 a[64:67], v[48:51], v[8:11], a[64:67]
  v_mfma_f32_16x16x32_bf16 a[68:71], v[48:51], v[12:15], a[68:71]
  buffer_load_dwordx4 v[216:219], v1, s[4:7], s31 offen offset:3072
  v_mfma_f32_16x16x32_bf16 a[72:75], v[48:51], v[16:19], a[72:75]
  v_mfma_f32_16x16x32_bf16 a[76:79], v[48:51], v[20:23], a[76:79]
  buffer_load_dwordx4 v[224:227], v1, s[8:11], s33 offen offset:3072
  v_mfma_f32_16x16x32_bf16 a[80:83], v[48:51], v[24:27], a[80:83]
  v_mfma_f32_16x16x32_bf16 a[84:87], v[48:51], v[28:31], a[84:87]
  buffer_load_dwordx4 v[228:231], v1, s[8:11], s34 offen offset:3072
  v_mfma_f32_16x16x32_bf16 a[88:91], v[48:51], v[32:35], a[88:91]
  v_mfma_f32_16x16x32_bf16 a[92:95], v[48:51], v[36:39], a[92:95]
  buffer_load_dwordx4 v[232:235], v1, s[8:11], s35 offen offset:3072
  s_waitcnt vmcnt(45)
  v_mfma_f32_16x16x32_bf16 a[96:99], v[52:55], v[8:11], a[96:99]
  v_mfma_f32_16x16x32_bf16 a[100:103], v[52:55], v[12:15], a[100:103]
  buffer_load_dwordx4 v[236:239], v1, s[8:11], s36 offen offset:3072
  v_mfma_f32_16x16x32_bf16 a[104:107], v[52:55], v[16:19], a[104:107]
  v_mfma_f32_16x16x32_bf16 a[108:111], v[52:55], v[20:23], a[108:111]
  buffer_load_dwordx4 v[240:243], v1, s[8:11], s37 offen offset:3072
  v_mfma_f32_16x16x32_bf16 a[112:115], v[52:55], v[24:27], a[112:115]
  v_mfma_f32_16x16x32_bf16 a[116:119], v[52:55], v[28:31], a[116:119]
  buffer_load_dwordx4 v[244:247], v1, s[8:11], s38 offen offset:3072
  v_mfma_f32_16x16x32_bf16 a[120:123], v[52:55], v[32:35], a[120:123]
  v_mfma_f32_16x16x32_bf16 a[124:127], v[52:55], v[36:39], a[124:127]
  s_waitcnt vmcnt(47)
  v_mfma_f32_16x16x32_bf16 a[128:131], v[56:59], v[8:11], a[128:131]
  v_mfma_f32_16x16x32_bf16 a[132:135], v[56:59], v[12:15], a[132:135]
  v_mfma_f32_16x16x32_bf16 a[136:139], v[56:59], v[16:19], a[136:139]
  v_mfma_f32_16x16x32_bf16 a[140:143], v[56:59], v[20:23], a[140:143]
  v_mfma_f32_16x16x32_bf16 a[144:147], v[56:59], v[24:27], a[144:147]
  v_mfma_f32_16x16x32_bf16 a[148:151], v[56:59], v[28:31], a[148:151]
  v_mfma_f32_16x16x32_bf16 a[152:155], v[56:59], v[32:35], a[152:155]
  v_mfma_f32_16x16x32_bf16 a[156:159], v[56:59], v[36:39], a[156:159]
  s_waitcnt vmcnt(46)
  v_mfma_f32_16x16x32_bf16 a[160:163], v[60:63], v[8:11], a[160:163]
  v_mfma_f32_16x16x32_bf16 a[164:167], v[60:63], v[12:15], a[164:167]
  v_mfma_f32_16x16x32_bf16 a[168:171], v[60:63], v[16:19], a[168:171]
  v_mfma_f32_16x16x32_bf16 a[172:175], v[60:63], v[20:23], a[172:175]
  v_mfma_f32_16x16x32_bf16 a[176:179], v[60:63], v[24:27], a[176:179]
  v_mfma_f32_16x16x32_bf16 a[180:183], v[60:63], v[28:31], a[180:183]
  v_mfma_f32_16x16x32_bf16 a[184:187], v[60:63], v[32:35], a[184:187]
  v_mfma_f32_16x16x32_bf16 a[188:191], v[60:63], v[36:39], a[188:191]
  s_waitcnt vmcnt(45)
  v_mfma_f32_16x16x32_bf16 a[192:195], v[64:67], v[8:11], a[192:195]
  v_mfma_f32_16x16x32_bf16 a[196:199], v[64:67], v[12:15], a[196:199]
  v_mfma_f32_16x16x32_bf16 a[200:203], v[64:67], v[16:19], a[200:203]
  v_mfma_f32_16x16x32_bf16 a[204:207], v[64:67], v[20:23], a[204:207]
  v_mfma_f32_16x16x32_bf16 a[208:211], v[64:67], v[24:27], a[208:211]
  v_mfma_f32_16x16x32_bf16 a[212:215], v[64:67], v[28:31], a[212:215]
  v_mfma_f32_16x16x32_bf16 a[216:219], v[64:67], v[32:35], a[216:219]
  v_mfma_f32_16x16x32_bf16 a[220:223], v[64:67], v[36:39], a[220:223]
  s_waitcnt vmcnt(44)
  s_waitcnt vmcnt(43)
  v_mfma_f32_16x16x32_bf16 a[0:3], v[100:103], v[68:71], a[0:3]
  s_waitcnt vmcnt(42)
  v_mfma_f32_16x16x32_bf16 a[4:7], v[100:103], v[72:75], a[4:7]
  s_add_u32 s24, s24, 4096
  s_add_u32 s25, s25, 4096
  s_add_u32 s26, s26, 4096
  s_add_u32 s27, s27, 4096
  s_add_u32 s28, s28, 4096
  s_add_u32 s29, s29, 4096
  s_add_u32 s30, s30, 4096
  s_add_u32 s31, s31, 4096
  s_add_u32 s32, s32, 4096
  s_add_u32 s33, s33, 4096
  s_add_u32 s34, s34, 4096
  s_add_u32 s35, s35, 4096
  s_add_u32 s36, s36, 4096
  s_add_u32 s37, s37, 4096
  s_add_u32 s38, s38, 4096
  buffer_load_dwordx4 v[40:43], v1, s[8:11], s32 offen offset:0
  s_waitcnt vmcnt(42)
  v_mfma_f32_16x16x32_bf16 a[8:11], v[100:103], v[76:79], a[8:11]
  s_waitcnt vmcnt(41)
  v_mfma_f32_16x16x32_bf16 a[12:15], v[100:103], v[80:83], a[12:15]
  buffer_load_dwordx4 v[8:11], v1, s[4:7], s24 offen offset:0
  s_waitcnt vmcnt(41)
  v_mfma_f32_16x16x32_bf16 a[16:19], v[100:103], v[84:87], a[16:19]
  s_waitcnt vmcnt(40)
  v_mfma_f32_16x16x32_bf16 a[20:23], v[100:103], v[88:91], a[20:23]
  buffer_load_dwordx4 v[12:15], v1, s[4:7], s25 offen offset:0
  s_waitcnt vmcnt(40)
  v_mfma_f32_16x16x32_bf16 a[24:27], v[100:103], v[92:95], a[24:27]
  s_waitcnt vmcnt(39)
  v_mfma_f32_16x16x32_bf16 a[28:31], v[100:103], v[96:99], a[28:31]
  buffer_load_dwordx4 v[16:19], v1, s[4:7], s26 offen offset:0
  s_waitcnt vmcnt(39)
  v_mfma_f32_16x16x32_bf16 a[32:35], v[104:107], v[68:71], a[32:35]
  v_mfma_f32_16x16x32_bf16 a[36:39], v[104:107], v[72:75], a[36:39]
  buffer_load_dwordx4 v[20:23], v1, s[4:7], s27 offen offset:0
  v_mfma_f32_16x16x32_bf16 a[40:43], v[104:107], v[76:79], a[40:43]
  v_mfma_f32_16x16x32_bf16 a[44:47], v[104:107], v[80:83], a[44:47]
  buffer_load_dwordx4 v[24:27], v1, s[4:7], s28 offen offset:0
  v_mfma_f32_16x16x32_bf16 a[48:51], v[104:107], v[84:87], a[48:51]
  v_mfma_f32_16x16x32_bf16 a[52:55], v[104:107], v[88:91], a[52:55]
  buffer_load_dwordx4 v[28:31], v1, s[4:7], s29 offen offset:0
  v_mfma_f32_16x16x32_bf16 a[56:59], v[104:107], v[92:95], a[56:59]
  v_mfma_f32_16x16x32_bf16 a[60:63], v[104:107], v[96:99], a[60:63]
  buffer_load_dwordx4 v[32:35], v1, s[4:7], s30 offen offset:0
  s_waitcnt vmcnt(42)
  v_mfma_f32_16x16x32_bf16 a[64:67], v[108:111], v[68:71], a[64:67]
  v_mfma_f32_16x16x32_bf16 a[68:71], v[108:111], v[72:75], a[68:71]
  buffer_load_dwordx4 v[36:39], v1, s[4:7], s31 offen offset:0
  v_mfma_f32_16x16x32_bf16 a[72:75], v[108:111], v[76:79], a[72:75]
  v_mfma_f32_16x16x32_bf16 a[76:79], v[108:111], v[80:83], a[76:79]
  buffer_load_dwordx4 v[44:47], v1, s[8:11], s33 offen offset:0
  v_mfma_f32_16x16x32_bf16 a[80:83], v[108:111], v[84:87], a[80:83]
  v_mfma_f32_16x16x32_bf16 a[84:87], v[108:111], v[88:91], a[84:87]
  buffer_load_dwordx4 v[48:51], v1, s[8:11], s34 offen offset:0
  v_mfma_f32_16x16x32_bf16 a[88:91], v[108:111], v[92:95], a[88:91]
  v_mfma_f32_16x16x32_bf16 a[92:95], v[108:111], v[96:99], a[92:95]
  buffer_load_dwordx4 v[52:55], v1, s[8:11], s35 offen offset:0
  s_waitcnt vmcnt(45)
  v_mfma_f32_16x16x32_bf16 a[96:99], v[112:115], v[68:71], a[96:99]
  v_mfma_f32_16x16x32_bf16 a[100:103], v[112:115], v[72:75], a[100:103]
  buffer_load_dwordx4 v[56:59], v1, s[8:11], s36 offen offset:0
  v_mfma_f32_16x16x32_bf16 a[104:107], v[112:115], v[76:79], a[104:107]
  v_mfma_f32_16x16x32_bf16 a[108:111], v[112:115], v[80:83], a[108:111]
  buffer_load_dwordx4 v[60:63], v1, s[8:11], s37 offen offset:0
  v_mfma_f32_16x16x32_bf16 a[112:115], v[112:115], v[84:87], a[112:115]
  v_mfma_f32_16x16x32_bf16 a[116:119], v[112:115], v[88:91], a[116:119]
  buffer_load_dwordx4 v[64:67], v1, s[8:11], s38 offen offset:0
  v_mfma_f32_16x16x32_bf16 a[120:123], v[112:115], v[92:95], a[120:123]
  v_mfma_f32_16x16x32_bf16 a[124:127], v[112:115], v[96:99], a[124:127]
  s_waitcnt vmcnt(47)
  v_mfma_f32_16x16x32_bf16 a[128:131], v[116:119], v[68:71], a[128:131]
  v_mfma_f32_16x16x32_bf16 a[132:135], v[116:119], v[72:75], a[132:135]
  v_mfma_f32_16x16x32_bf16 a[136:139], v[116:119], v[76:79], a[136:139]
  v_mfma_f32_16x16x32_bf16 a[140:143], v[116:119], v[80:83], a[140:143]
  v_mfma_f32_16x16x32_bf16 a[144:147], v[116:119], v[84:87], a[144:147]
  v_mfma_f32_16x16x32_bf16 a[148:151], v[116:119], v[88:91], a[148:151]
  v_mfma_f32_16x16x32_bf16 a[152:155], v[116:119], v[92:95], a[152:155]
  v_mfma_f32_16x16x32_bf16 a[156:159], v[116:119], v[96:99], a[156:159]
  s_waitcnt vmcnt(46)
  v_mfma_f32_16x16x32_bf16 a[160:163], v[120:123], v[68:71], a[160:163]
  v_mfma_f32_16x16x32_bf16 a[164:167], v[120:123], v[72:75], a[164:167]
  v_mfma_f32_16x16x32_bf16 a[168:171], v[120:123], v[76:79], a[168:171]
  v_mfma_f32_16x16x32_bf16 a[172:175], v[120:123], v[80:83], a[172:175]
  v_mfma_f32_16x16x32_bf16 a[176:179], v[120:123], v[84:87], a[176:179]
  v_mfma_f32_16x16x32_bf16 a[180:183], v[120:123], v[88:91], a[180:183]
  v_mfma_f32_16x16x32_bf16 a[184:187], v[120:123], v[92:95], a[184:187]
  v_mfma_f32_16x16x32_bf16 a[188:191], v[120:123], v[96:99], a[188:191]
  s_waitcnt vmcnt(45)
  v_mfma_f32_16x16x32_bf16 a[192:195], v[124:127], v[68:71], a[192:195]
  v_mfma_f32_16x16x32_bf16 a[196:199], v[124:127], v[72:75], a[196:199]
  v_mfma_f32_16x16x32_bf16 a[200:203], v[124:127], v[76:79], a[200:203]
  v_mfma_f32_16x16x32_bf16 a[204:207], v[124:127], v[80:83], a[204:207]
  v_mfma_f32_16x16x32_bf16 a[208:211], v[124:127], v[84:87], a[208:211]
  v_mfma_f32_16x16x32_bf16 a[212:215], v[124:127], v[88:91], a[212:215]
  v_mfma_f32_16x16x32_bf16 a[216:219], v[124:127], v[92:95], a[216:219]
  v_mfma_f32_16x16x32_bf16 a[220:223], v[124:127], v[96:99], a[220:223]
  s_waitcnt vmcnt(44)
  s_waitcnt vmcnt(43)
  v_mfma_f32_16x16x32_bf16 a[0:3], v[160:163], v[128:131], a[0:3]
  s_waitcnt vmcnt(42)
  v_mfma_f32_16x16x32_bf16 a[4:7], v[160:163], v[132:135], a[4:7]
  buffer_load_dwordx4 v[100:103], v1, s[8:11], s32 offen offset:1024
  s_waitcnt vmcnt(42)
  v_mfma_f32_16x16x32_bf16 a[8:11], v[160:163], v[136:139], a[8:11]
  s_waitcnt vmcnt(41)
  v_mfma_f32_16x16x32_bf16 a[12:15], v[160:163], v[140:143], a[12:15]
  buffer_load_dwordx4 v[68:71], v1, s[4:7], s24 offen offset:1024
  s_waitcnt vmcnt(41)
  v_mfma_f32_16x16x32_bf16 a[16:19], v[160:163], v[144:147], a[16:19]
  s_waitcnt vmcnt(40)
  v_mfma_f32_16x16x32_bf16 a[20:23], v[160:163], v[148:151], a[20:23]
  buffer_load_dwordx4 v[72:75], v1, s[4:7], s25 offen offset:1024
  s_waitcnt vmcnt(40)
  v_mfma_f32_16x16x32_bf16 a[24:27], v[160:163], v[152:155], a[24:27]
  s_waitcnt vmcnt(39)
  v_mfma_f32_16x16x32_bf16 a[28:31], v[160:163], v[156:159], a[28:31]
  buffer_load_dwordx4 v[76:79], v1, s[4:7], s26 offen offset:1024
  s_waitcnt vmcnt(39)
  v_mfma_f32_16x16x32_bf16 a[32:35], v[164:167], v[128:131], a[32:35]
  v_mfma_f32_16x16x32_bf16 a[36:39], v[164:167], v[132:135], a[36:39]
  buffer_load_dwordx4 v[80:83], v1, s[4:7], s27 offen offset:1024
  v_mfma_f32_16x16x32_bf16 a[40:43], v[164:167], v[136:139], a[40:43]
  v_mfma_f32_16x16x32_bf16 a[44:47], v[164:167], v[140:143], a[44:47]
  buffer_load_dwordx4 v[84:87], v1, s[4:7], s28 offen offset:1024
  v_mfma_f32_16x16x32_bf16 a[48:51], v[164:167], v[144:147], a[48:51]
  v_mfma_f32_16x16x32_bf16 a[52:55], v[164:167], v[148:151], a[52:55]
  buffer_load_dwordx4 v[88:91], v1, s[4:7], s29 offen offset:1024
  v_mfma_f32_16x16x32_bf16 a[56:59], v[164:167], v[152:155], a[56:59]
  v_mfma_f32_16x16x32_bf16 a[60:63], v[164:167], v[156:159], a[60:63]
  buffer_load_dwordx4 v[92:95], v1, s[4:7], s30 offen offset:1024
  s_waitcnt vmcnt(42)
  v_mfma_f32_16x16x32_bf16 a[64:67], v[168:171], v[128:131], a[64:67]
  v_mfma_f32_16x16x32_bf16 a[68:71], v[168:171], v[132:135], a[68:71]
  buffer_load_dwordx4 v[96:99], v1, s[4:7], s31 offen offset:1024
  v_mfma_f32_16x16x32_bf16 a[72:75], v[168:171], v[136:139], a[72:75]
  v_mfma_f32_16x16x32_bf16 a[76:79], v[168:171], v[140:143], a[76:79]
  buffer_load_dwordx4 v[104:107], v1, s[8:11], s33 offen offset:1024
  v_mfma_f32_16x16x32_bf16 a[80:83], v[168:171], v[144:147], a[80:83]
  v_mfma_f32_16x16x32_bf16 a[84:87], v[168:171], v[148:151], a[84:87]
  buffer_load_dwordx4 v[108:111], v1, s[8:11], s34 offen offset:1024
  v_mfma_f32_16x16x32_bf16 a[88:91], v[168:171], v[152:155], a[88:91]
  v_mfma_f32_16x16x32_bf16 a[92:95], v[168:171], v[156:159], a[92:95]
  buffer_load_dwordx4 v[112:115], v1, s[8:11], s35 offen offset:1024
  s_waitcnt vmcnt(45)
  v_mfma_f32_16x16x32_bf16 a[96:99], v[172:175], v[128:131], a[96:99]
  v_mfma_f32_16x16x32_bf16 a[100:103], v[172:175], v[132:135], a[100:103]
  buffer_load_dwordx4 v[116:119], v1, s[8:11], s36 offen offset:1024
  v_mfma_f32_16x16x32_bf16 a[104:107], v[172:175], v[136:139], a[104:107]
  v_mfma_f32_16x16x32_bf16 a[108:111], v[172:175], v[140:143], a[108:111]
  buffer_load_dwordx4 v[120:123], v1, s[8:11], s37 offen offset:1024
  v_mfma_f32_16x16x32_bf16 a[112:115], v[172:175], v[144:147], a[112:115]
  v_mfma_f32_16x16x32_bf16 a[116:119], v[172:175], v[148:151], a[116:119]
  buffer_load_dwordx4 v[124:127], v1, s[8:11], s38 offen offset:1024
  v_mfma_f32_16x16x32_bf16 a[120:123], v[172:175], v[152:155], a[120:123]
  v_mfma_f32_16x16x32_bf16 a[124:127], v[172:175], v[156:159], a[124:127]
  s_waitcnt vmcnt(47)
  v_mfma_f32_16x16x32_bf16 a[128:131], v[176:179], v[128:131], a[128:131]
  v_mfma_f32_16x16x32_bf16 a[132:135], v[176:179], v[132:135], a[132:135]
  v_mfma_f32_16x16x32_bf16 a[136:139], v[176:179], v[136:139], a[136:139]
  v_mfma_f32_16x16x32_bf16 a[140:143], v[176:179], v[140:143], a[140:143]
  v_mfma_f32_16x16x32_bf16 a[144:147], v[176:179], v[144:147], a[144:147]
  v_mfma_f32_16x16x32_bf16 a[148:151], v[176:179], v[148:151], a[148:151]
  v_mfma_f32_16x16x32_bf16 a[152:155], v[176:179], v[152:155], a[152:155]
  v_mfma_f32_16x16x32_bf16 a[156:159], v[176:179], v[156:159], a[156:159]
  s_waitcnt vmcnt(46)
  v_mfma_f32_16x16x32_bf16 a[160:163], v[180:183], v[128:131], a[160:163]
  v_mfma_f32_16x16x32_bf16 a[164:167], v[180:183], v[132:135], a[164:167]
  v_mfma_f32_16x16x32_bf16 a[168:171], v[180:183], v[136:139], a[168:171]
  v_mfma_f32_16x16x32_bf16 a[172:175], v[180:183], v[140:143], a[172:175]
  v_mfma_f32_16x16x32_bf16 a[176:179], v[180:183], v[144:147], a[176:179]
  v_mfma_f32_16x16x32_bf16 a[180:183], v[180:183], v[148:151], a[180:183]
  v_mfma_f32_16x16x32_bf16 a[184:187], v[180:183], v[152:155], a[184:187]
  v_mfma_f32_16x16x32_bf16 a[188:191], v[180:183], v[156:159], a[188:191]
  s_waitcnt vmcnt(45)
  v_mfma_f32_16x16x32_bf16 a[192:195], v[184:187], v[128:131], a[192:195]
  v_mfma_f32_16x16x32_bf16 a[196:199], v[184:187], v[132:135], a[196:199]
  v_mfma_f32_16x16x32_bf16 a[200:203], v[184:187], v[136:139], a[200:203]
  v_mfma_f32_16x16x32_bf16 a[204:207], v[184:187], v[140:143], a[204:207]
  v_mfma_f32_16x16x32_bf16 a[208:211], v[184:187], v[144:147], a[208:211]
  v_mfma_f32_16x16x32_bf16 a[212:215], v[184:187], v[148:151], a[212:215]
  v_mfma_f32_16x16x32_bf16 a[216:219], v[184:187], v[152:155], a[216:219]
  v_mfma_f32_16x16x32_bf16 a[220:223], v[184:187], v[156:159], a[220:223]
  s_waitcnt vmcnt(44)
  s_waitcnt vmcnt(43)
  v_mfma_f32_16x16x32_bf16 a[0:3], v[220:223], v[188:191], a[0:3]
  s_waitcnt vmcnt(42)
  v_mfma_f32_16x16x32_bf16 a[4:7], v[220:223], v[192:195], a[4:7]
  buffer_load_dwordx4 v[160:163], v1, s[8:11], s32 offen offset:2048
  s_waitcnt vmcnt(42)
  v_mfma_f32_16x16x32_bf16 a[8:11], v[220:223], v[196:199], a[8:11]
  s_waitcnt vmcnt(41)
  v_mfma_f32_16x16x32_bf16 a[12:15], v[220:223], v[200:203], a[12:15]
  buffer_load_dwordx4 v[128:131], v1, s[4:7], s24 offen offset:2048
  s_waitcnt vmcnt(41)
  v_mfma_f32_16x16x32_bf16 a[16:19], v[220:223], v[204:207], a[16:19]
  s_waitcnt vmcnt(40)
  v_mfma_f32_16x16x32_bf16 a[20:23], v[220:223], v[208:211], a[20:23]
  buffer_load_dwordx4 v[132:135], v1, s[4:7], s25 offen offset:2048
  s_waitcnt vmcnt(40)
  v_mfma_f32_16x16x32_bf16 a[24:27], v[220:223], v[212:215], a[24:27]
  s_waitcnt vmcnt(39)
  v_mfma_f32_16x16x32_bf16 a[28:31], v[220:223], v[216:219], a[28:31]
  buffer_load_dwordx4 v[136:139], v1, s[4:7], s26 offen offset:2048
  s_waitcnt vmcnt(39)
  v_mfma_f32_16x16x32_bf16 a[32:35], v[224:227], v[188:191], a[32:35]
  v_mfma_f32_16x16x32_bf16 a[36:39], v[224:227], v[192:195], a[36:39]
  buffer_load_dwordx4 v[140:143], v1, s[4:7], s27 offen offset:2048
  v_mfma_f32_16x16x32_bf16 a[40:43], v[224:227], v[196:199], a[40:43]
  v_mfma_f32_16x16x32_bf16 a[44:47], v[224:227], v[200:203], a[44:47]
  buffer_load_dwordx4 v[144:147], v1, s[4:7], s28 offen offset:2048
  v_mfma_f32_16x16x32_bf16 a[48:51], v[224:227], v[204:207], a[48:51]
  v_mfma_f32_16x16x32_bf16 a[52:55], v[224:227], v[208:211], a[52:55]
  buffer_load_dwordx4 v[148:151], v1, s[4:7], s29 offen offset:2048
  v_mfma_f32_16x16x32_bf16 a[56:59], v[224:227], v[212:215], a[56:59]
  v_mfma_f32_16x16x32_bf16 a[60:63], v[224:227], v[216:219], a[60:63]
  buffer_load_dwordx4 v[152:155], v1, s[4:7], s30 offen offset:2048
  s_waitcnt vmcnt(42)
  v_mfma_f32_16x16x32_bf16 a[64:67], v[228:231], v[188:191], a[64:67]
  v_mfma_f32_16x16x32_bf16 a[68:71], v[228:231], v[192:195], a[68:71]
  buffer_load_dwordx4 v[156:159], v1, s[4:7], s31 offen offset:2048
  v_mfma_f32_16x16x32_bf16 a[72:75], v[228:231], v[196:199], a[72:75]
  v_mfma_f32_16x16x32_bf16 a[76:79], v[228:231], v[200:203], a[76:79]
  buffer_load_dwordx4 v[164:167], v1, s[8:11], s33 offen offset:2048
  v_mfma_f32_16x16x32_bf16 a[80:83], v[228:231], v[204:207], a[80:83]
  v_mfma_f32_16x16x32_bf16 a[84:87], v[228:231], v[208:211], a[84:87]
  buffer_load_dwordx4 v[168:171], v1, s[8:11], s34 offen offset:2048
  v_mfma_f32_16x16x32_bf16 a[88:91], v[228:231], v[212:215], a[88:91]
  v_mfma_f32_16x16x32_bf16 a[92:95], v[228:231], v[216:219], a[92:95]
  buffer_load_dwordx4 v[172:175], v1, s[8:11], s35 offen offset:2048
  s_waitcnt vmcnt(45)
  v_mfma_f32_16x16x32_bf16 a[96:99], v[232:235], v[188:191], a[96:99]
  v_mfma_f32_16x16x32_bf16 a[100:103], v[232:235], v[192:195], a[100:103]
  buffer_load_dwordx4 v[176:179], v1, s[8:11], s36 offen offset:2048
  v_mfma_f32_16x16x32_bf16 a[104:107], v[232:235], v[196:199], a[104:107]
  v_mfma_f32_16x16x32_bf16 a[108:111], v[232:235], v[200:203], a[108:111]
  buffer_load_dwordx4 v[180:183], v1, s[8:11], s37 offen offset:2048
  v_mfma_f32_16x16x32_bf16 a[112:115], v[232:235], v[204:207], a[112:115]
  v_mfma_f32_16x16x32_bf16 a[116:119], v[232:235], v[208:211], a[116:119]
  buffer_load_dwordx4 v[184:187], v1, s[8:11], s38 offen offset:2048
  v_mfma_f32_16x16x32_bf16 a[120:123], v[232:235], v[212:215], a[120:123]
  v_mfma_f32_16x16x32_bf16 a[124:127], v[232:235], v[216:219], a[124:127]
  s_waitcnt vmcnt(47)
  v_mfma_f32_16x16x32_bf16 a[128:131], v[236:239], v[188:191], a[128:131]
  v_mfma_f32_16x16x32_bf16 a[132:135], v[236:239], v[192:195], a[132:135]
  v_mfma_f32_16x16x32_bf16 a[136:139], v[236:239], v[196:199], a[136:139]
  v_mfma_f32_16x16x32_bf16 a[140:143], v[236:239], v[200:203], a[140:143]
  v_mfma_f32_16x16x32_bf16 a[144:147], v[236:239], v[204:207], a[144:147]
  v_mfma_f32_16x16x32_bf16 a[148:151], v[236:239], v[208:211], a[148:151]
  v_mfma_f32_16x16x32_bf16 a[152:155], v[236:239], v[212:215], a[152:155]
  v_mfma_f32_16x16x32_bf16 a[156:159], v[236:239], v[216:219], a[156:159]
  s_waitcnt vmcnt(46)
  v_mfma_f32_16x16x32_bf16 a[160:163], v[240:243], v[188:191], a[160:163]
  v_mfma_f32_16x16x32_bf16 a[164:167], v[240:243], v[192:195], a[164:167]
  v_mfma_f32_16x16x32_bf16 a[168:171], v[240:243], v[196:199], a[168:171]
  v_mfma_f32_16x16x32_bf16 a[172:175], v[240:243], v[200:203], a[172:175]
  v_mfma_f32_16x16x32_bf16 a[176:179], v[240:243], v[204:207], a[176:179]
  v_mfma_f32_16x16x32_bf16 a[180:183], v[240:243], v[208:211], a[180:183]
  v_mfma_f32_16x16x32_bf16 a[184:187], v[240:243], v[212:215], a[184:187]
  v_mfma_f32_16x16x32_bf16 a[188:191], v[240:243], v[216:219], a[188:191]
  s_waitcnt vmcnt(45)
  v_mfma_f32_16x16x32_bf16 a[192:195], v[244:247], v[188:191], a[192:195]
  v_mfma_f32_16x16x32_bf16 a[196:199], v[244:247], v[192:195], a[196:199]
  v_mfma_f32_16x16x32_bf16 a[200:203], v[244:247], v[196:199], a[200:203]
  v_mfma_f32_16x16x32_bf16 a[204:207], v[244:247], v[200:203], a[204:207]
  v_mfma_f32_16x16x32_bf16 a[208:211], v[244:247], v[204:207], a[208:211]
  v_mfma_f32_16x16x32_bf16 a[212:215], v[244:247], v[208:211], a[212:215]
  v_mfma_f32_16x16x32_bf16 a[216:219], v[244:247], v[212:215], a[216:219]
  v_mfma_f32_16x16x32_bf16 a[220:223], v[244:247], v[216:219], a[220:223]
  s_waitcnt vmcnt(44)
  s_waitcnt vmcnt(43)
  v_mfma_f32_16x16x32_bf16 a[0:3], v[40:43], v[8:11], a[0:3]
  s_waitcnt vmcnt(42)
  v_mfma_f32_16x16x32_bf16 a[4:7], v[40:43], v[12:15], a[4:7]
  buffer_load_dwordx4 v[220:223], v1, s[8:11], s32 offen offset:3072
  s_waitcnt vmcnt(42)
  v_mfma_f32_16x16x32_bf16 a[8:11], v[40:43], v[16:19], a[8:11]
  s_waitcnt vmcnt(41)
  v_mfma_f32_16x16x32_bf16 a[12:15], v[40:43], v[20:23], a[12:15]
  buffer_load_dwordx4 v[188:191], v1, s[4:7], s24 offen offset:3072
  s_waitcnt vmcnt(41)
  v_mfma_f32_16x16x32_bf16 a[16:19], v[40:43], v[24:27], a[16:19]
  s_waitcnt vmcnt(40)
  v_mfma_f32_16x16x32_bf16 a[20:23], v[40:43], v[28:31], a[20:23]
  buffer_load_dwordx4 v[192:195], v1, s[4:7], s25 offen offset:3072
  s_waitcnt vmcnt(40)
  v_mfma_f32_16x16x32_bf16 a[24:27], v[40:43], v[32:35], a[24:27]
  s_waitcnt vmcnt(39)
  v_mfma_f32_16x16x32_bf16 a[28:31], v[40:43], v[36:39], a[28:31]
  buffer_load_dwordx4 v[196:199], v1, s[4:7], s26 offen offset:3072
  s_waitcnt vmcnt(39)
  v_mfma_f32_16x16x32_bf16 a[32:35], v[44:47], v[8:11], a[32:35]
  v_mfma_f32_16x16x32_bf16 a[36:39], v[44:47], v[12:15], a[36:39]
  buffer_load_dwordx4 v[200:203], v1, s[4:7], s27 offen offset:3072
  v_mfma_f32_16x16x32_bf16 a[40:43], v[44:47], v[16:19], a[40:43]
  v_mfma_f32_16x16x32_bf16 a[44:47], v[44:47], v[20:23], a[44:47]
  buffer_load_dwordx4 v[204:207], v1, s[4:7], s28 offen offset:3072
  v_mfma_f32_16x16x32_bf16 a[48:51], v[44:47], v[24:27], a[48:51]
  v_mfma_f32_16x16x32_bf16 a[52:55], v[44:47], v[28:31], a[52:55]
  buffer_load_dwordx4 v[208:211], v1, s[4:7], s29 offen offset:3072
  v_mfma_f32_16x16x32_bf16 a[56:59], v[44:47], v[32:35], a[56:59]
  v_mfma_f32_16x16x32_bf16 a[60:63], v[44:47], v[36:39], a[60:63]
  buffer_load_dwordx4 v[212:215], v1, s[4:7], s30 offen offset:3072
  s_waitcnt vmcnt(42)
  v_mfma_f32_16x16x32_bf16 a[64:67], v[48:51], v[8:11], a[64:67]
  v_mfma_f32_16x16x32_bf16 a[68:71], v[48:51], v[12:15], a[68:71]
  buffer_load_dwordx4 v[216:219], v1, s[4:7], s31 offen offset:3072
  v_mfma_f32_16x16x32_bf16 a[72:75], v[48:51], v[16:19], a[72:75]
  v_mfma_f32_16x16x32_bf16 a[76:79], v[48:51], v[20:23], a[76:79]
  buffer_load_dwordx4 v[224:227], v1, s[8:11], s33 offen offset:3072
  v_mfma_f32_16x16x32_bf16 a[80:83], v[48:51], v[24:27], a[80:83]
  v_mfma_f32_16x16x32_bf16 a[84:87], v[48:51], v[28:31], a[84:87]
  buffer_load_dwordx4 v[228:231], v1, s[8:11], s34 offen offset:3072
  v_mfma_f32_16x16x32_bf16 a[88:91], v[48:51], v[32:35], a[88:91]
  v_mfma_f32_16x16x32_bf16 a[92:95], v[48:51], v[36:39], a[92:95]
  buffer_load_dwordx4 v[232:235], v1, s[8:11], s35 offen offset:3072
  s_waitcnt vmcnt(45)
  v_mfma_f32_16x16x32_bf16 a[96:99], v[52:55], v[8:11], a[96:99]
  v_mfma_f32_16x16x32_bf16 a[100:103], v[52:55], v[12:15], a[100:103]
  buffer_load_dwordx4 v[236:239], v1, s[8:11], s36 offen offset:3072
  v_mfma_f32_16x16x32_bf16 a[104:107], v[52:55], v[16:19], a[104:107]
  v_mfma_f32_16x16x32_bf16 a[108:111], v[52:55], v[20:23], a[108:111]
  buffer_load_dwordx4 v[240:243], v1, s[8:11], s37 offen offset:3072
  v_mfma_f32_16x16x32_bf16 a[112:115], v[52:55], v[24:27], a[112:115]
  v_mfma_f32_16x16x32_bf16 a[116:119], v[52:55], v[28:31], a[116:119]
  buffer_load_dwordx4 v[244:247], v1, s[8:11], s38 offen offset:3072
  v_mfma_f32_16x16x32_bf16 a[120:123], v[52:55], v[32:35], a[120:123]
  v_mfma_f32_16x16x32_bf16 a[124:127], v[52:55], v[36:39], a[124:127]
  s_waitcnt vmcnt(47)
  v_mfma_f32_16x16x32_bf16 a[128:131], v[56:59], v[8:11], a[128:131]
  v_mfma_f32_16x16x32_bf16 a[132:135], v[56:59], v[12:15], a[132:135]
  v_mfma_f32_16x16x32_bf16 a[136:139], v[56:59], v[16:19], a[136:139]
  v_mfma_f32_16x16x32_bf16 a[140:143], v[56:59], v[20:23], a[140:143]
  v_mfma_f32_16x16x32_bf16 a[144:147], v[56:59], v[24:27], a[144:147]
  v_mfma_f32_16x16x32_bf16 a[148:151], v[56:59], v[28:31], a[148:151]
  v_mfma_f32_16x16x32_bf16 a[152:155], v[56:59], v[32:35], a[152:155]
  v_mfma_f32_16x16x32_bf16 a[156:159], v[56:59], v[36:39], a[156:159]
  s_waitcnt vmcnt(46)
  v_mfma_f32_16x16x32_bf16 a[160:163], v[60:63], v[8:11], a[160:163]
  v_mfma_f32_16x16x32_bf16 a[164:167], v[60:63], v[12:15], a[164:167]
  v_mfma_f32_16x16x32_bf16 a[168:171], v[60:63], v[16:19], a[168:171]
  v_mfma_f32_16x16x32_bf16 a[172:175], v[60:63], v[20:23], a[172:175]
  v_mfma_f32_16x16x32_bf16 a[176:179], v[60:63], v[24:27], a[176:179]
  v_mfma_f32_16x16x32_bf16 a[180:183], v[60:63], v[28:31], a[180:183]
  v_mfma_f32_16x16x32_bf16 a[184:187], v[60:63], v[32:35], a[184:187]
  v_mfma_f32_16x16x32_bf16 a[188:191], v[60:63], v[36:39], a[188:191]
  s_waitcnt vmcnt(45)
  v_mfma_f32_16x16x32_bf16 a[192:195], v[64:67], v[8:11], a[192:195]
  v_mfma_f32_16x16x32_bf16 a[196:199], v[64:67], v[12:15], a[196:199]
  v_mfma_f32_16x16x32_bf16 a[200:203], v[64:67], v[16:19], a[200:203]
  v_mfma_f32_16x16x32_bf16 a[204:207], v[64:67], v[20:23], a[204:207]
  v_mfma_f32_16x16x32_bf16 a[208:211], v[64:67], v[24:27], a[208:211]
  v_mfma_f32_16x16x32_bf16 a[212:215], v[64:67], v[28:31], a[212:215]
  v_mfma_f32_16x16x32_bf16 a[216:219], v[64:67], v[32:35], a[216:219]
  v_mfma_f32_16x16x32_bf16 a[220:223], v[64:67], v[36:39], a[220:223]
  s_waitcnt vmcnt(44)
  s_waitcnt vmcnt(43)
  v_mfma_f32_16x16x32_bf16 a[0:3], v[100:103], v[68:71], a[0:3]
  s_waitcnt vmcnt(42)
  v_mfma_f32_16x16x32_bf16 a[4:7], v[100:103], v[72:75], a[4:7]
  s_add_u32 s24, s24, 4096
  s_add_u32 s25, s25, 4096
  s_add_u32 s26, s26, 4096
  s_add_u32 s27, s27, 4096
  s_add_u32 s28, s28, 4096
  s_add_u32 s29, s29, 4096
  s_add_u32 s30, s30, 4096
  s_add_u32 s31, s31, 4096
  s_add_u32 s32, s32, 4096
  s_add_u32 s33, s33, 4096
  s_add_u32 s34, s34, 4096
  s_add_u32 s35, s35, 4096
  s_add_u32 s36, s36, 4096
  s_add_u32 s37, s37, 4096
  s_add_u32 s38, s38, 4096
  buffer_load_dwordx4 v[40:43], v1, s[8:11], s32 offen offset:0
  s_waitcnt vmcnt(42)
  v_mfma_f32_16x16x32_bf16 a[8:11], v[100:103], v[76:79], a[8:11]
  s_waitcnt vmcnt(41)
  v_mfma_f32_16x16x32_bf16 a[12:15], v[100:103], v[80:83], a[12:15]
  buffer_load_dwordx4 v[8:11], v1, s[4:7], s24 offen offset:0
  s_waitcnt vmcnt(41)
  v_mfma_f32_16x16x32_bf16 a[16:19], v[100:103], v[84:87], a[16:19]
  s_waitcnt vmcnt(40)
  v_mfma_f32_16x16x32_bf16 a[20:23], v[100:103], v[88:91], a[20:23]
  buffer_load_dwordx4 v[12:15], v1, s[4:7], s25 offen offset:0
  s_waitcnt vmcnt(40)
  v_mfma_f32_16x16x32_bf16 a[24:27], v[100:103], v[92:95], a[24:27]
  s_waitcnt vmcnt(39)
  v_mfma_f32_16x16x32_bf16 a[28:31], v[100:103], v[96:99], a[28:31]
  buffer_load_dwordx4 v[16:19], v1, s[4:7], s26 offen offset:0
  s_waitcnt vmcnt(39)
  v_mfma_f32_16x16x32_bf16 a[32:35], v[104:107], v[68:71], a[32:35]
  v_mfma_f32_16x16x32_bf16 a[36:39], v[104:107], v[72:75], a[36:39]
  buffer_load_dwordx4 v[20:23], v1, s[4:7], s27 offen offset:0
  v_mfma_f32_16x16x32_bf16 a[40:43], v[104:107], v[76:79], a[40:43]
  v_mfma_f32_16x16x32_bf16 a[44:47], v[104:107], v[80:83], a[44:47]
  buffer_load_dwordx4 v[24:27], v1, s[4:7], s28 offen offset:0
  v_mfma_f32_16x16x32_bf16 a[48:51], v[104:107], v[84:87], a[48:51]
  v_mfma_f32_16x16x32_bf16 a[52:55], v[104:107], v[88:91], a[52:55]
  buffer_load_dwordx4 v[28:31], v1, s[4:7], s29 offen offset:0
  v_mfma_f32_16x16x32_bf16 a[56:59], v[104:107], v[92:95], a[56:59]
  v_mfma_f32_16x16x32_bf16 a[60:63], v[104:107], v[96:99], a[60:63]
  buffer_load_dwordx4 v[32:35], v1, s[4:7], s30 offen offset:0
  s_waitcnt vmcnt(42)
  v_mfma_f32_16x16x32_bf16 a[64:67], v[108:111], v[68:71], a[64:67]
  v_mfma_f32_16x16x32_bf16 a[68:71], v[108:111], v[72:75], a[68:71]
  buffer_load_dwordx4 v[36:39], v1, s[4:7], s31 offen offset:0
  v_mfma_f32_16x16x32_bf16 a[72:75], v[108:111], v[76:79], a[72:75]
  v_mfma_f32_16x16x32_bf16 a[76:79], v[108:111], v[80:83], a[76:79]
  buffer_load_dwordx4 v[44:47], v1, s[8:11], s33 offen offset:0
  v_mfma_f32_16x16x32_bf16 a[80:83], v[108:111], v[84:87], a[80:83]
  v_mfma_f32_16x16x32_bf16 a[84:87], v[108:111], v[88:91], a[84:87]
  buffer_load_dwordx4 v[48:51], v1, s[8:11], s34 offen offset:0
  v_mfma_f32_16x16x32_bf16 a[88:91], v[108:111], v[92:95], a[88:91]
  v_mfma_f32_16x16x32_bf16 a[92:95], v[108:111], v[96:99], a[92:95]
  buffer_load_dwordx4 v[52:55], v1, s[8:11], s35 offen offset:0
  s_waitcnt vmcnt(45)
  v_mfma_f32_16x16x32_bf16 a[96:99], v[112:115], v[68:71], a[96:99]
  v_mfma_f32_16x16x32_bf16 a[100:103], v[112:115], v[72:75], a[100:103]
  buffer_load_dwordx4 v[56:59], v1, s[8:11], s36 offen offset:0
  v_mfma_f32_16x16x32_bf16 a[104:107], v[112:115], v[76:79], a[104:107]
  v_mfma_f32_16x16x32_bf16 a[108:111], v[112:115], v[80:83], a[108:111]
  buffer_load_dwordx4 v[60:63], v1, s[8:11], s37 offen offset:0
  v_mfma_f32_16x16x32_bf16 a[112:115], v[112:115], v[84:87], a[112:115]
  v_mfma_f32_16x16x32_bf16 a[116:119], v[112:115], v[88:91], a[116:119]
  buffer_load_dwordx4 v[64:67], v1, s[8:11], s38 offen offset:0
  v_mfma_f32_16x16x32_bf16 a[120:123], v[112:115], v[92:95], a[120:123]
  v_mfma_f32_16x16x32_bf16 a[124:127], v[112:115], v[96:99], a[124:127]
  s_waitcnt vmcnt(47)
  v_mfma_f32_16x16x32_bf16 a[128:131], v[116:119], v[68:71], a[128:131]
  v_mfma_f32_16x16x32_bf16 a[132:135], v[116:119], v[72:75], a[132:135]
  v_mfma_f32_16x16x32_bf16 a[136:139], v[116:119], v[76:79], a[136:139]
  v_mfma_f32_16x16x32_bf16 a[140:143], v[116:119], v[80:83], a[140:143]
  v_mfma_f32_16x16x32_bf16 a[144:147], v[116:119], v[84:87], a[144:147]
  v_mfma_f32_16x16x32_bf16 a[148:151], v[116:119], v[88:91], a[148:151]
  v_mfma_f32_16x16x32_bf16 a[152:155], v[116:119], v[92:95], a[152:155]
  v_mfma_f32_16x16x32_bf16 a[156:159], v[116:119], v[96:99], a[156:159]
  s_waitcnt vmcnt(46)
  v_mfma_f32_16x16x32_bf16 a[160:163], v[120:123], v[68:71], a[160:163]
  v_mfma_f32_16x16x32_bf16 a[164:167], v[120:123], v[72:75], a[164:167]
  v_mfma_f32_16x16x32_bf16 a[168:171], v[120:123], v[76:79], a[168:171]
  v_mfma_f32_16x16x32_bf16 a[172:175], v[120:123], v[80:83], a[172:175]
  v_mfma_f32_16x16x32_bf16 a[176:179], v[120:123], v[84:87], a[176:179]
  v_mfma_f32_16x16x32_bf16 a[180:183], v[120:123], v[88:91], a[180:183]
  v_mfma_f32_16x16x32_bf16 a[184:187], v[120:123], v[92:95], a[184:187]
  v_mfma_f32_16x16x32_bf16 a[188:191], v[120:123], v[96:99], a[188:191]
  s_waitcnt vmcnt(45)
  v_mfma_f32_16x16x32_bf16 a[192:195], v[124:127], v[68:71], a[192:195]
  v_mfma_f32_16x16x32_bf16 a[196:199], v[124:127], v[72:75], a[196:199]
  v_mfma_f32_16x16x32_bf16 a[200:203], v[124:127], v[76:79], a[200:203]
  v_mfma_f32_16x16x32_bf16 a[204:207], v[124:127], v[80:83], a[204:207]
  v_mfma_f32_16x16x32_bf16 a[208:211], v[124:127], v[84:87], a[208:211]
  v_mfma_f32_16x16x32_bf16 a[212:215], v[124:127], v[88:91], a[212:215]
  v_mfma_f32_16x16x32_bf16 a[216:219], v[124:127], v[92:95], a[216:219]
  v_mfma_f32_16x16x32_bf16 a[220:223], v[124:127], v[96:99], a[220:223]
  s_waitcnt vmcnt(44)
  s_waitcnt vmcnt(43)
  v_mfma_f32_16x16x32_bf16 a[0:3], v[160:163], v[128:131], a[0:3]
  s_waitcnt vmcnt(42)
  v_mfma_f32_16x16x32_bf16 a[4:7], v[160:163], v[132:135], a[4:7]
  buffer_load_dwordx4 v[100:103], v1, s[8:11], s32 offen offset:1024
  s_waitcnt vmcnt(42)
  v_mfma_f32_16x16x32_bf16 a[8:11], v[160:163], v[136:139], a[8:11]
  s_waitcnt vmcnt(41)
  v_mfma_f32_16x16x32_bf16 a[12:15], v[160:163], v[140:143], a[12:15]
  buffer_load_dwordx4 v[68:71], v1, s[4:7], s24 offen offset:1024
  s_waitcnt vmcnt(41)
  v_mfma_f32_16x16x32_bf16 a[16:19], v[160:163], v[144:147], a[16:19]
  s_waitcnt vmcnt(40)
  v_mfma_f32_16x16x32_bf16 a[20:23], v[160:163], v[148:151], a[20:23]
  buffer_load_dwordx4 v[72:75], v1, s[4:7], s25 offen offset:1024
  s_waitcnt vmcnt(40)
  v_mfma_f32_16x16x32_bf16 a[24:27], v[160:163], v[152:155], a[24:27]
  s_waitcnt vmcnt(39)
  v_mfma_f32_16x16x32_bf16 a[28:31], v[160:163], v[156:159], a[28:31]
  buffer_load_dwordx4 v[76:79], v1, s[4:7], s26 offen offset:1024
  s_waitcnt vmcnt(39)
  v_mfma_f32_16x16x32_bf16 a[32:35], v[164:167], v[128:131], a[32:35]
  v_mfma_f32_16x16x32_bf16 a[36:39], v[164:167], v[132:135], a[36:39]
  buffer_load_dwordx4 v[80:83], v1, s[4:7], s27 offen offset:1024
  v_mfma_f32_16x16x32_bf16 a[40:43], v[164:167], v[136:139], a[40:43]
  v_mfma_f32_16x16x32_bf16 a[44:47], v[164:167], v[140:143], a[44:47]
  buffer_load_dwordx4 v[84:87], v1, s[4:7], s28 offen offset:1024
  v_mfma_f32_16x16x32_bf16 a[48:51], v[164:167], v[144:147], a[48:51]
  v_mfma_f32_16x16x32_bf16 a[52:55], v[164:167], v[148:151], a[52:55]
  buffer_load_dwordx4 v[88:91], v1, s[4:7], s29 offen offset:1024
  v_mfma_f32_16x16x32_bf16 a[56:59], v[164:167], v[152:155], a[56:59]
  v_mfma_f32_16x16x32_bf16 a[60:63], v[164:167], v[156:159], a[60:63]
  buffer_load_dwordx4 v[92:95], v1, s[4:7], s30 offen offset:1024
  s_waitcnt vmcnt(42)
  v_mfma_f32_16x16x32_bf16 a[64:67], v[168:171], v[128:131], a[64:67]
  v_mfma_f32_16x16x32_bf16 a[68:71], v[168:171], v[132:135], a[68:71]
  buffer_load_dwordx4 v[96:99], v1, s[4:7], s31 offen offset:1024
  v_mfma_f32_16x16x32_bf16 a[72:75], v[168:171], v[136:139], a[72:75]
  v_mfma_f32_16x16x32_bf16 a[76:79], v[168:171], v[140:143], a[76:79]
  buffer_load_dwordx4 v[104:107], v1, s[8:11], s33 offen offset:1024
  v_mfma_f32_16x16x32_bf16 a[80:83], v[168:171], v[144:147], a[80:83]
  v_mfma_f32_16x16x32_bf16 a[84:87], v[168:171], v[148:151], a[84:87]
  buffer_load_dwordx4 v[108:111], v1, s[8:11], s34 offen offset:1024
  v_mfma_f32_16x16x32_bf16 a[88:91], v[168:171], v[152:155], a[88:91]
  v_mfma_f32_16x16x32_bf16 a[92:95], v[168:171], v[156:159], a[92:95]
  buffer_load_dwordx4 v[112:115], v1, s[8:11], s35 offen offset:1024
  s_waitcnt vmcnt(45)
  v_mfma_f32_16x16x32_bf16 a[96:99], v[172:175], v[128:131], a[96:99]
  v_mfma_f32_16x16x32_bf16 a[100:103], v[172:175], v[132:135], a[100:103]
  buffer_load_dwordx4 v[116:119], v1, s[8:11], s36 offen offset:1024
  v_mfma_f32_16x16x32_bf16 a[104:107], v[172:175], v[136:139], a[104:107]
  v_mfma_f32_16x16x32_bf16 a[108:111], v[172:175], v[140:143], a[108:111]
  buffer_load_dwordx4 v[120:123], v1, s[8:11], s37 offen offset:1024
  v_mfma_f32_16x16x32_bf16 a[112:115], v[172:175], v[144:147], a[112:115]
  v_mfma_f32_16x16x32_bf16 a[116:119], v[172:175], v[148:151], a[116:119]
  buffer_load_dwordx4 v[124:127], v1, s[8:11], s38 offen offset:1024
  v_mfma_f32_16x16x32_bf16 a[120:123], v[172:175], v[152:155], a[120:123]
  v_mfma_f32_16x16x32_bf16 a[124:127], v[172:175], v[156:159], a[124:127]
  s_waitcnt vmcnt(47)
  v_mfma_f32_16x16x32_bf16 a[128:131], v[176:179], v[128:131], a[128:131]
  v_mfma_f32_16x16x32_bf16 a[132:135], v[176:179], v[132:135], a[132:135]
  v_mfma_f32_16x16x32_bf16 a[136:139], v[176:179], v[136:139], a[136:139]
  v_mfma_f32_16x16x32_bf16 a[140:143], v[176:179], v[140:143], a[140:143]
  v_mfma_f32_16x16x32_bf16 a[144:147], v[176:179], v[144:147], a[144:147]
  v_mfma_f32_16x16x32_bf16 a[148:151], v[176:179], v[148:151], a[148:151]
  v_mfma_f32_16x16x32_bf16 a[152:155], v[176:179], v[152:155], a[152:155]
  v_mfma_f32_16x16x32_bf16 a[156:159], v[176:179], v[156:159], a[156:159]
  s_waitcnt vmcnt(46)
  v_mfma_f32_16x16x32_bf16 a[160:163], v[180:183], v[128:131], a[160:163]
  v_mfma_f32_16x16x32_bf16 a[164:167], v[180:183], v[132:135], a[164:167]
  v_mfma_f32_16x16x32_bf16 a[168:171], v[180:183], v[136:139], a[168:171]
  v_mfma_f32_16x16x32_bf16 a[172:175], v[180:183], v[140:143], a[172:175]
  v_mfma_f32_16x16x32_bf16 a[176:179], v[180:183], v[144:147], a[176:179]
  v_mfma_f32_16x16x32_bf16 a[180:183], v[180:183], v[148:151], a[180:183]
  v_mfma_f32_16x16x32_bf16 a[184:187], v[180:183], v[152:155], a[184:187]
  v_mfma_f32_16x16x32_bf16 a[188:191], v[180:183], v[156:159], a[188:191]
  s_waitcnt vmcnt(45)
  v_mfma_f32_16x16x32_bf16 a[192:195], v[184:187], v[128:131], a[192:195]
  v_mfma_f32_16x16x32_bf16 a[196:199], v[184:187], v[132:135], a[196:199]
  v_mfma_f32_16x16x32_bf16 a[200:203], v[184:187], v[136:139], a[200:203]
  v_mfma_f32_16x16x32_bf16 a[204:207], v[184:187], v[140:143], a[204:207]
  v_mfma_f32_16x16x32_bf16 a[208:211], v[184:187], v[144:147], a[208:211]
  v_mfma_f32_16x16x32_bf16 a[212:215], v[184:187], v[148:151], a[212:215]
  v_mfma_f32_16x16x32_bf16 a[216:219], v[184:187], v[152:155], a[216:219]
  v_mfma_f32_16x16x32_bf16 a[220:223], v[184:187], v[156:159], a[220:223]
  s_waitcnt vmcnt(44)
  s_waitcnt vmcnt(43)
  v_mfma_f32_16x16x32_bf16 a[0:3], v[220:223], v[188:191], a[0:3]
  s_waitcnt vmcnt(42)
  v_mfma_f32_16x16x32_bf16 a[4:7], v[220:223], v[192:195], a[4:7]
  buffer_load_dwordx4 v[160:163], v1, s[8:11], s32 offen offset:2048
  s_waitcnt vmcnt(42)
  v_mfma_f32_16x16x32_bf16 a[8:11], v[220:223], v[196:199], a[8:11]
  s_waitcnt vmcnt(41)
  v_mfma_f32_16x16x32_bf16 a[12:15], v[220:223], v[200:203], a[12:15]
  buffer_load_dwordx4 v[128:131], v1, s[4:7], s24 offen offset:2048
  s_waitcnt vmcnt(41)
  v_mfma_f32_16x16x32_bf16 a[16:19], v[220:223], v[204:207], a[16:19]
  s_waitcnt vmcnt(40)
  v_mfma_f32_16x16x32_bf16 a[20:23], v[220:223], v[208:211], a[20:23]
  buffer_load_dwordx4 v[132:135], v1, s[4:7], s25 offen offset:2048
  s_waitcnt vmcnt(40)
  v_mfma_f32_16x16x32_bf16 a[24:27], v[220:223], v[212:215], a[24:27]
  s_waitcnt vmcnt(39)
  v_mfma_f32_16x16x32_bf16 a[28:31], v[220:223], v[216:219], a[28:31]
  buffer_load_dwordx4 v[136:139], v1, s[4:7], s26 offen offset:2048
  s_waitcnt vmcnt(39)
  v_mfma_f32_16x16x32_bf16 a[32:35], v[224:227], v[188:191], a[32:35]
  v_mfma_f32_16x16x32_bf16 a[36:39], v[224:227], v[192:195], a[36:39]
  buffer_load_dwordx4 v[140:143], v1, s[4:7], s27 offen offset:2048
  v_mfma_f32_16x16x32_bf16 a[40:43], v[224:227], v[196:199], a[40:43]
  v_mfma_f32_16x16x32_bf16 a[44:47], v[224:227], v[200:203], a[44:47]
  buffer_load_dwordx4 v[144:147], v1, s[4:7], s28 offen offset:2048
  v_mfma_f32_16x16x32_bf16 a[48:51], v[224:227], v[204:207], a[48:51]
  v_mfma_f32_16x16x32_bf16 a[52:55], v[224:227], v[208:211], a[52:55]
  buffer_load_dwordx4 v[148:151], v1, s[4:7], s29 offen offset:2048
  v_mfma_f32_16x16x32_bf16 a[56:59], v[224:227], v[212:215], a[56:59]
  v_mfma_f32_16x16x32_bf16 a[60:63], v[224:227], v[216:219], a[60:63]
  buffer_load_dwordx4 v[152:155], v1, s[4:7], s30 offen offset:2048
  s_waitcnt vmcnt(42)
  v_mfma_f32_16x16x32_bf16 a[64:67], v[228:231], v[188:191], a[64:67]
  v_mfma_f32_16x16x32_bf16 a[68:71], v[228:231], v[192:195], a[68:71]
  buffer_load_dwordx4 v[156:159], v1, s[4:7], s31 offen offset:2048
  v_mfma_f32_16x16x32_bf16 a[72:75], v[228:231], v[196:199], a[72:75]
  v_mfma_f32_16x16x32_bf16 a[76:79], v[228:231], v[200:203], a[76:79]
  buffer_load_dwordx4 v[164:167], v1, s[8:11], s33 offen offset:2048
  v_mfma_f32_16x16x32_bf16 a[80:83], v[228:231], v[204:207], a[80:83]
  v_mfma_f32_16x16x32_bf16 a[84:87], v[228:231], v[208:211], a[84:87]
  buffer_load_dwordx4 v[168:171], v1, s[8:11], s34 offen offset:2048
  v_mfma_f32_16x16x32_bf16 a[88:91], v[228:231], v[212:215], a[88:91]
  v_mfma_f32_16x16x32_bf16 a[92:95], v[228:231], v[216:219], a[92:95]
  buffer_load_dwordx4 v[172:175], v1, s[8:11], s35 offen offset:2048
  s_waitcnt vmcnt(45)
  v_mfma_f32_16x16x32_bf16 a[96:99], v[232:235], v[188:191], a[96:99]
  v_mfma_f32_16x16x32_bf16 a[100:103], v[232:235], v[192:195], a[100:103]
  buffer_load_dwordx4 v[176:179], v1, s[8:11], s36 offen offset:2048
  v_mfma_f32_16x16x32_bf16 a[104:107], v[232:235], v[196:199], a[104:107]
  v_mfma_f32_16x16x32_bf16 a[108:111], v[232:235], v[200:203], a[108:111]
  buffer_load_dwordx4 v[180:183], v1, s[8:11], s37 offen offset:2048
  v_mfma_f32_16x16x32_bf16 a[112:115], v[232:235], v[204:207], a[112:115]
  v_mfma_f32_16x16x32_bf16 a[116:119], v[232:235], v[208:211], a[116:119]
  buffer_load_dwordx4 v[184:187], v1, s[8:11], s38 offen offset:2048
  v_mfma_f32_16x16x32_bf16 a[120:123], v[232:235], v[212:215], a[120:123]
  v_mfma_f32_16x16x32_bf16 a[124:127], v[232:235], v[216:219], a[124:127]
  s_waitcnt vmcnt(47)
  v_mfma_f32_16x16x32_bf16 a[128:131], v[236:239], v[188:191], a[128:131]
  v_mfma_f32_16x16x32_bf16 a[132:135], v[236:239], v[192:195], a[132:135]
  v_mfma_f32_16x16x32_bf16 a[136:139], v[236:239], v[196:199], a[136:139]
  v_mfma_f32_16x16x32_bf16 a[140:143], v[236:239], v[200:203], a[140:143]
  v_mfma_f32_16x16x32_bf16 a[144:147], v[236:239], v[204:207], a[144:147]
  v_mfma_f32_16x16x32_bf16 a[148:151], v[236:239], v[208:211], a[148:151]
  v_mfma_f32_16x16x32_bf16 a[152:155], v[236:239], v[212:215], a[152:155]
  v_mfma_f32_16x16x32_bf16 a[156:159], v[236:239], v[216:219], a[156:159]
  s_waitcnt vmcnt(46)
  v_mfma_f32_16x16x32_bf16 a[160:163], v[240:243], v[188:191], a[160:163]
  v_mfma_f32_16x16x32_bf16 a[164:167], v[240:243], v[192:195], a[164:167]
  v_mfma_f32_16x16x32_bf16 a[168:171], v[240:243], v[196:199], a[168:171]
  v_mfma_f32_16x16x32_bf16 a[172:175], v[240:243], v[200:203], a[172:175]
  v_mfma_f32_16x16x32_bf16 a[176:179], v[240:243], v[204:207], a[176:179]
  v_mfma_f32_16x16x32_bf16 a[180:183], v[240:243], v[208:211], a[180:183]
  v_mfma_f32_16x16x32_bf16 a[184:187], v[240:243], v[212:215], a[184:187]
  v_mfma_f32_16x16x32_bf16 a[188:191], v[240:243], v[216:219], a[188:191]
  s_waitcnt vmcnt(45)
  v_mfma_f32_16x16x32_bf16 a[192:195], v[244:247], v[188:191], a[192:195]
  v_mfma_f32_16x16x32_bf16 a[196:199], v[244:247], v[192:195], a[196:199]
  v_mfma_f32_16x16x32_bf16 a[200:203], v[244:247], v[196:199], a[200:203]
  v_mfma_f32_16x16x32_bf16 a[204:207], v[244:247], v[200:203], a[204:207]
  v_mfma_f32_16x16x32_bf16 a[208:211], v[244:247], v[204:207], a[208:211]
  v_mfma_f32_16x16x32_bf16 a[212:215], v[244:247], v[208:211], a[212:215]
  v_mfma_f32_16x16x32_bf16 a[216:219], v[244:247], v[212:215], a[216:219]
  v_mfma_f32_16x16x32_bf16 a[220:223], v[244:247], v[216:219], a[220:223]
  s_waitcnt vmcnt(44)
  s_waitcnt vmcnt(43)
  v_mfma_f32_16x16x32_bf16 a[0:3], v[40:43], v[8:11], a[0:3]
  s_waitcnt vmcnt(42)
  v_mfma_f32_16x16x32_bf16 a[4:7], v[40:43], v[12:15], a[4:7]
  buffer_load_dwordx4 v[220:223], v1, s[8:11], s32 offen offset:3072
  s_waitcnt vmcnt(42)
  v_mfma_f32_16x16x32_bf16 a[8:11], v[40:43], v[16:19], a[8:11]
  s_waitcnt vmcnt(41)
  v_mfma_f32_16x16x32_bf16 a[12:15], v[40:43], v[20:23], a[12:15]
  buffer_load_dwordx4 v[188:191], v1, s[4:7], s24 offen offset:3072
  s_waitcnt vmcnt(41)
  v_mfma_f32_16x16x32_bf16 a[16:19], v[40:43], v[24:27], a[16:19]
  s_waitcnt vmcnt(40)
  v_mfma_f32_16x16x32_bf16 a[20:23], v[40:43], v[28:31], a[20:23]
  buffer_load_dwordx4 v[192:195], v1, s[4:7], s25 offen offset:3072
  s_waitcnt vmcnt(40)
  v_mfma_f32_16x16x32_bf16 a[24:27], v[40:43], v[32:35], a[24:27]
  s_waitcnt vmcnt(39)
  v_mfma_f32_16x16x32_bf16 a[28:31], v[40:43], v[36:39], a[28:31]
  buffer_load_dwordx4 v[196:199], v1, s[4:7], s26 offen offset:3072
  s_waitcnt vmcnt(39)
  v_mfma_f32_16x16x32_bf16 a[32:35], v[44:47], v[8:11], a[32:35]
  v_mfma_f32_16x16x32_bf16 a[36:39], v[44:47], v[12:15], a[36:39]
  buffer_load_dwordx4 v[200:203], v1, s[4:7], s27 offen offset:3072
  v_mfma_f32_16x16x32_bf16 a[40:43], v[44:47], v[16:19], a[40:43]
  v_mfma_f32_16x16x32_bf16 a[44:47], v[44:47], v[20:23], a[44:47]
  buffer_load_dwordx4 v[204:207], v1, s[4:7], s28 offen offset:3072
  v_mfma_f32_16x16x32_bf16 a[48:51], v[44:47], v[24:27], a[48:51]
  v_mfma_f32_16x16x32_bf16 a[52:55], v[44:47], v[28:31], a[52:55]
  buffer_load_dwordx4 v[208:211], v1, s[4:7], s29 offen offset:3072
  v_mfma_f32_16x16x32_bf16 a[56:59], v[44:47], v[32:35], a[56:59]
  v_mfma_f32_16x16x32_bf16 a[60:63], v[44:47], v[36:39], a[60:63]
  buffer_load_dwordx4 v[212:215], v1, s[4:7], s30 offen offset:3072
  s_waitcnt vmcnt(42)
  v_mfma_f32_16x16x32_bf16 a[64:67], v[48:51], v[8:11], a[64:67]
  v_mfma_f32_16x16x32_bf16 a[68:71], v[48:51], v[12:15], a[68:71]
  buffer_load_dwordx4 v[216:219], v1, s[4:7], s31 offen offset:3072
  v_mfma_f32_16x16x32_bf16 a[72:75], v[48:51], v[16:19], a[72:75]
  v_mfma_f32_16x16x32_bf16 a[76:79], v[48:51], v[20:23], a[76:79]
  buffer_load_dwordx4 v[224:227], v1, s[8:11], s33 offen offset:3072
  v_mfma_f32_16x16x32_bf16 a[80:83], v[48:51], v[24:27], a[80:83]
  v_mfma_f32_16x16x32_bf16 a[84:87], v[48:51], v[28:31], a[84:87]
  buffer_load_dwordx4 v[228:231], v1, s[8:11], s34 offen offset:3072
  v_mfma_f32_16x16x32_bf16 a[88:91], v[48:51], v[32:35], a[88:91]
  v_mfma_f32_16x16x32_bf16 a[92:95], v[48:51], v[36:39], a[92:95]
  buffer_load_dwordx4 v[232:235], v1, s[8:11], s35 offen offset:3072
  s_waitcnt vmcnt(45)
  v_mfma_f32_16x16x32_bf16 a[96:99], v[52:55], v[8:11], a[96:99]
  v_mfma_f32_16x16x32_bf16 a[100:103], v[52:55], v[12:15], a[100:103]
  buffer_load_dwordx4 v[236:239], v1, s[8:11], s36 offen offset:3072
  v_mfma_f32_16x16x32_bf16 a[104:107], v[52:55], v[16:19], a[104:107]
  v_mfma_f32_16x16x32_bf16 a[108:111], v[52:55], v[20:23], a[108:111]
  buffer_load_dwordx4 v[240:243], v1, s[8:11], s37 offen offset:3072
  v_mfma_f32_16x16x32_bf16 a[112:115], v[52:55], v[24:27], a[112:115]
  v_mfma_f32_16x16x32_bf16 a[116:119], v[52:55], v[28:31], a[116:119]
  buffer_load_dwordx4 v[244:247], v1, s[8:11], s38 offen offset:3072
  v_mfma_f32_16x16x32_bf16 a[120:123], v[52:55], v[32:35], a[120:123]
  v_mfma_f32_16x16x32_bf16 a[124:127], v[52:55], v[36:39], a[124:127]
  s_waitcnt vmcnt(47)
  v_mfma_f32_16x16x32_bf16 a[128:131], v[56:59], v[8:11], a[128:131]
  v_mfma_f32_16x16x32_bf16 a[132:135], v[56:59], v[12:15], a[132:135]
  v_mfma_f32_16x16x32_bf16 a[136:139], v[56:59], v[16:19], a[136:139]
  v_mfma_f32_16x16x32_bf16 a[140:143], v[56:59], v[20:23], a[140:143]
  v_mfma_f32_16x16x32_bf16 a[144:147], v[56:59], v[24:27], a[144:147]
  v_mfma_f32_16x16x32_bf16 a[148:151], v[56:59], v[28:31], a[148:151]
  v_mfma_f32_16x16x32_bf16 a[152:155], v[56:59], v[32:35], a[152:155]
  v_mfma_f32_16x16x32_bf16 a[156:159], v[56:59], v[36:39], a[156:159]
  s_waitcnt vmcnt(46)
  v_mfma_f32_16x16x32_bf16 a[160:163], v[60:63], v[8:11], a[160:163]
  v_mfma_f32_16x16x32_bf16 a[164:167], v[60:63], v[12:15], a[164:167]
  v_mfma_f32_16x16x32_bf16 a[168:171], v[60:63], v[16:19], a[168:171]
  v_mfma_f32_16x16x32_bf16 a[172:175], v[60:63], v[20:23], a[172:175]
  v_mfma_f32_16x16x32_bf16 a[176:179], v[60:63], v[24:27], a[176:179]
  v_mfma_f32_16x16x32_bf16 a[180:183], v[60:63], v[28:31], a[180:183]
  v_mfma_f32_16x16x32_bf16 a[184:187], v[60:63], v[32:35], a[184:187]
  v_mfma_f32_16x16x32_bf16 a[188:191], v[60:63], v[36:39], a[188:191]
  s_waitcnt vmcnt(45)
  v_mfma_f32_16x16x32_bf16 a[192:195], v[64:67], v[8:11], a[192:195]
  v_mfma_f32_16x16x32_bf16 a[196:199], v[64:67], v[12:15], a[196:199]
  v_mfma_f32_16x16x32_bf16 a[200:203], v[64:67], v[16:19], a[200:203]
  v_mfma_f32_16x16x32_bf16 a[204:207], v[64:67], v[20:23], a[204:207]
  v_mfma_f32_16x16x32_bf16 a[208:211], v[64:67], v[24:27], a[208:211]
  v_mfma_f32_16x16x32_bf16 a[212:215], v[64:67], v[28:31], a[212:215]
  v_mfma_f32_16x16x32_bf16 a[216:219], v[64:67], v[32:35], a[216:219]
  v_mfma_f32_16x16x32_bf16 a[220:223], v[64:67], v[36:39], a[220:223]
  s_waitcnt vmcnt(44)
  s_waitcnt vmcnt(43)
  v_mfma_f32_16x16x32_bf16 a[0:3], v[100:103], v[68:71], a[0:3]
  s_waitcnt vmcnt(42)
  v_mfma_f32_16x16x32_bf16 a[4:7], v[100:103], v[72:75], a[4:7]
  s_waitcnt vmcnt(41)
  v_mfma_f32_16x16x32_bf16 a[8:11], v[100:103], v[76:79], a[8:11]
  s_waitcnt vmcnt(40)
  v_mfma_f32_16x16x32_bf16 a[12:15], v[100:103], v[80:83], a[12:15]
  s_waitcnt vmcnt(39)
  v_mfma_f32_16x16x32_bf16 a[16:19], v[100:103], v[84:87], a[16:19]
  s_waitcnt vmcnt(38)
  v_mfma_f32_16x16x32_bf16 a[20:23], v[100:103], v[88:91], a[20:23]
  s_waitcnt vmcnt(37)
  v_mfma_f32_16x16x32_bf16 a[24:27], v[100:103], v[92:95], a[24:27]
  s_waitcnt vmcnt(36)
  v_mfma_f32_16x16x32_bf16 a[28:31], v[100:103], v[96:99], a[28:31]
  s_waitcnt vmcnt(35)
  v_mfma_f32_16x16x32_bf16 a[32:35], v[104:107], v[68:71], a[32:35]
  v_mfma_f32_16x16x32_bf16 a[36:39], v[104:107], v[72:75], a[36:39]
  v_mfma_f32_16x16x32_bf16 a[40:43], v[104:107], v[76:79], a[40:43]
  v_mfma_f32_16x16x32_bf16 a[44:47], v[104:107], v[80:83], a[44:47]
  v_mfma_f32_16x16x32_bf16 a[48:51], v[104:107], v[84:87], a[48:51]
  v_mfma_f32_16x16x32_bf16 a[52:55], v[104:107], v[88:91], a[52:55]
  v_mfma_f32_16x16x32_bf16 a[56:59], v[104:107], v[92:95], a[56:59]
  v_mfma_f32_16x16x32_bf16 a[60:63], v[104:107], v[96:99], a[60:63]
  s_waitcnt vmcnt(34)
  v_mfma_f32_16x16x32_bf16 a[64:67], v[108:111], v[68:71], a[64:67]
  v_mfma_f32_16x16x32_bf16 a[68:71], v[108:111], v[72:75], a[68:71]
  v_mfma_f32_16x16x32_bf16 a[72:75], v[108:111], v[76:79], a[72:75]
  v_mfma_f32_16x16x32_bf16 a[76:79], v[108:111], v[80:83], a[76:79]
  v_mfma_f32_16x16x32_bf16 a[80:83], v[108:111], v[84:87], a[80:83]
  v_mfma_f32_16x16x32_bf16 a[84:87], v[108:111], v[88:91], a[84:87]
  v_mfma_f32_16x16x32_bf16 a[88:91], v[108:111], v[92:95], a[88:91]
  v_mfma_f32_16x16x32_bf16 a[92:95], v[108:111], v[96:99], a[92:95]
  s_waitcnt vmcnt(33)
  v_mfma_f32_16x16x32_bf16 a[96:99], v[112:115], v[68:71], a[96:99]
  v_mfma_f32_16x16x32_bf16 a[100:103], v[112:115], v[72:75], a[100:103]
  v_mfma_f32_16x16x32_bf16 a[104:107], v[112:115], v[76:79], a[104:107]
  v_mfma_f32_16x16x32_bf16 a[108:111], v[112:115], v[80:83], a[108:111]
  v_mfma_f32_16x16x32_bf16 a[112:115], v[112:115], v[84:87], a[112:115]
  v_mfma_f32_16x16x32_bf16 a[116:119], v[112:115], v[88:91], a[116:119]
  v_mfma_f32_16x16x32_bf16 a[120:123], v[112:115], v[92:95], a[120:123]
  v_mfma_f32_16x16x32_bf16 a[124:127], v[112:115], v[96:99], a[124:127]
  s_waitcnt vmcnt(32)
  v_mfma_f32_16x16x32_bf16 a[128:131], v[116:119], v[68:71], a[128:131]
  v_mfma_f32_16x16x32_bf16 a[132:135], v[116:119], v[72:75], a[132:135]
  v_mfma_f32_16x16x32_bf16 a[136:139], v[116:119], v[76:79], a[136:139]
  v_mfma_f32_16x16x32_bf16 a[140:143], v[116:119], v[80:83], a[140:143]
  v_mfma_f32_16x16x32_bf16 a[144:147], v[116:119], v[84:87], a[144:147]
  v_mfma_f32_16x16x32_bf16 a[148:151], v[116:119], v[88:91], a[148:151]
  v_mfma_f32_16x16x32_bf16 a[152:155], v[116:119], v[92:95], a[152:155]
  v_mfma_f32_16x16x32_bf16 a[156:159], v[116:119], v[96:99], a[156:159]
  s_waitcnt vmcnt(31)
  v_mfma_f32_16x16x32_bf16 a[160:163], v[120:123], v[68:71], a[160:163]
  v_mfma_f32_16x16x32_bf16 a[164:167], v[120:123], v[72:75], a[164:167]
  v_mfma_f32_16x16x32_bf16 a[168:171], v[120:123], v[76:79], a[168:171]
  v_mfma_f32_16x16x32_bf16 a[172:175], v[120:123], v[80:83], a[172:175]
  v_mfma_f32_16x16x32_bf16 a[176:179], v[120:123], v[84:87], a[176:179]
  v_mfma_f32_16x16x32_bf16 a[180:183], v[120:123], v[88:91], a[180:183]
  v_mfma_f32_16x16x32_bf16 a[184:187], v[120:123], v[92:95], a[184:187]
  v_mfma_f32_16x16x32_bf16 a[188:191], v[120:123], v[96:99], a[188:191]
  s_waitcnt vmcnt(30)
  v_mfma_f32_16x16x32_bf16 a[192:195], v[124:127], v[68:71], a[192:195]
  v_mfma_f32_16x16x32_bf16 a[196:199], v[124:127], v[72:75], a[196:199]
  v_mfma_f32_16x16x32_bf16 a[200:203], v[124:127], v[76:79], a[200:203]
  v_mfma_f32_16x16x32_bf16 a[204:207], v[124:127], v[80:83], a[204:207]
  v_mfma_f32_16x16x32_bf16 a[208:211], v[124:127], v[84:87], a[208:211]
  v_mfma_f32_16x16x32_bf16 a[212:215], v[124:127], v[88:91], a[212:215]
  v_mfma_f32_16x16x32_bf16 a[216:219], v[124:127], v[92:95], a[216:219]
  v_mfma_f32_16x16x32_bf16 a[220:223], v[124:127], v[96:99], a[220:223]
  s_waitcnt vmcnt(29)
  s_waitcnt vmcnt(28)
  v_mfma_f32_16x16x32_bf16 a[0:3], v[160:163], v[128:131], a[0:3]
  s_waitcnt vmcnt(27)
  v_mfma_f32_16x16x32_bf16 a[4:7], v[160:163], v[132:135], a[4:7]
  s_waitcnt vmcnt(26)
  v_mfma_f32_16x16x32_bf16 a[8:11], v[160:163], v[136:139], a[8:11]
  s_waitcnt vmcnt(25)
  v_mfma_f32_16x16x32_bf16 a[12:15], v[160:163], v[140:143], a[12:15]
  s_waitcnt vmcnt(24)
  v_mfma_f32_16x16x32_bf16 a[16:19], v[160:163], v[144:147], a[16:19]
  s_waitcnt vmcnt(23)
  v_mfma_f32_16x16x32_bf16 a[20:23], v[160:163], v[148:151], a[20:23]
  s_waitcnt vmcnt(22)
  v_mfma_f32_16x16x32_bf16 a[24:27], v[160:163], v[152:155], a[24:27]
  s_waitcnt vmcnt(21)
  v_mfma_f32_16x16x32_bf16 a[28:31], v[160:163], v[156:159], a[28:31]
  s_waitcnt vmcnt(20)
  v_mfma_f32_16x16x32_bf16 a[32:35], v[164:167], v[128:131], a[32:35]
  v_mfma_f32_16x16x32_bf16 a[36:39], v[164:167], v[132:135], a[36:39]
  v_mfma_f32_16x16x32_bf16 a[40:43], v[164:167], v[136:139], a[40:43]
  v_mfma_f32_16x16x32_bf16 a[44:47], v[164:167], v[140:143], a[44:47]
  v_mfma_f32_16x16x32_bf16 a[48:51], v[164:167], v[144:147], a[48:51]
  v_mfma_f32_16x16x32_bf16 a[52:55], v[164:167], v[148:151], a[52:55]
  v_mfma_f32_16x16x32_bf16 a[56:59], v[164:167], v[152:155], a[56:59]
  v_mfma_f32_16x16x32_bf16 a[60:63], v[164:167], v[156:159], a[60:63]
  s_waitcnt vmcnt(19)
  v_mfma_f32_16x16x32_bf16 a[64:67], v[168:171], v[128:131], a[64:67]
  v_mfma_f32_16x16x32_bf16 a[68:71], v[168:171], v[132:135], a[68:71]
  v_mfma_f32_16x16x32_bf16 a[72:75], v[168:171], v[136:139], a[72:75]
  v_mfma_f32_16x16x32_bf16 a[76:79], v[168:171], v[140:143], a[76:79]
  v_mfma_f32_16x16x32_bf16 a[80:83], v[168:171], v[144:147], a[80:83]
  v_mfma_f32_16x16x32_bf16 a[84:87], v[168:171], v[148:151], a[84:87]
  v_mfma_f32_16x16x32_bf16 a[88:91], v[168:171], v[152:155], a[88:91]
  v_mfma_f32_16x16x32_bf16 a[92:95], v[168:171], v[156:159], a[92:95]
  s_waitcnt vmcnt(18)
  v_mfma_f32_16x16x32_bf16 a[96:99], v[172:175], v[128:131], a[96:99]
  v_mfma_f32_16x16x32_bf16 a[100:103], v[172:175], v[132:135], a[100:103]
  v_mfma_f32_16x16x32_bf16 a[104:107], v[172:175], v[136:139], a[104:107]
  v_mfma_f32_16x16x32_bf16 a[108:111], v[172:175], v[140:143], a[108:111]
  v_mfma_f32_16x16x32_bf16 a[112:115], v[172:175], v[144:147], a[112:115]
  v_mfma_f32_16x16x32_bf16 a[116:119], v[172:175], v[148:151], a[116:119]
  v_mfma_f32_16x16x32_bf16 a[120:123], v[172:175], v[152:155], a[120:123]
  v_mfma_f32_16x16x32_bf16 a[124:127], v[172:175], v[156:159], a[124:127]
  s_waitcnt vmcnt(17)
  v_mfma_f32_16x16x32_bf16 a[128:131], v[176:179], v[128:131], a[128:131]
  v_mfma_f32_16x16x32_bf16 a[132:135], v[176:179], v[132:135], a[132:135]
  v_mfma_f32_16x16x32_bf16 a[136:139], v[176:179], v[136:139], a[136:139]
  v_mfma_f32_16x16x32_bf16 a[140:143], v[176:179], v[140:143], a[140:143]
  v_mfma_f32_16x16x32_bf16 a[144:147], v[176:179], v[144:147], a[144:147]
  v_mfma_f32_16x16x32_bf16 a[148:151], v[176:179], v[148:151], a[148:151]
  v_mfma_f32_16x16x32_bf16 a[152:155], v[176:179], v[152:155], a[152:155]
  v_mfma_f32_16x16x32_bf16 a[156:159], v[176:179], v[156:159], a[156:159]
  s_waitcnt vmcnt(16)
  v_mfma_f32_16x16x32_bf16 a[160:163], v[180:183], v[128:131], a[160:163]
  v_mfma_f32_16x16x32_bf16 a[164:167], v[180:183], v[132:135], a[164:167]
  v_mfma_f32_16x16x32_bf16 a[168:171], v[180:183], v[136:139], a[168:171]
  v_mfma_f32_16x16x32_bf16 a[172:175], v[180:183], v[140:143], a[172:175]
  v_mfma_f32_16x16x32_bf16 a[176:179], v[180:183], v[144:147], a[176:179]
  v_mfma_f32_16x16x32_bf16 a[180:183], v[180:183], v[148:151], a[180:183]
  v_mfma_f32_16x16x32_bf16 a[184:187], v[180:183], v[152:155], a[184:187]
  v_mfma_f32_16x16x32_bf16 a[188:191], v[180:183], v[156:159], a[188:191]
  s_waitcnt vmcnt(15)
  v_mfma_f32_16x16x32_bf16 a[192:195], v[184:187], v[128:131], a[192:195]
  v_mfma_f32_16x16x32_bf16 a[196:199], v[184:187], v[132:135], a[196:199]
  v_mfma_f32_16x16x32_bf16 a[200:203], v[184:187], v[136:139], a[200:203]
  v_mfma_f32_16x16x32_bf16 a[204:207], v[184:187], v[140:143], a[204:207]
  v_mfma_f32_16x16x32_bf16 a[208:211], v[184:187], v[144:147], a[208:211]
  v_mfma_f32_16x16x32_bf16 a[212:215], v[184:187], v[148:151], a[212:215]
  v_mfma_f32_16x16x32_bf16 a[216:219], v[184:187], v[152:155], a[216:219]
  v_mfma_f32_16x16x32_bf16 a[220:223], v[184:187], v[156:159], a[220:223]
  s_waitcnt vmcnt(14)
  s_waitcnt vmcnt(13)
  v_mfma_f32_16x16x32_bf16 a[0:3], v[220:223], v[188:191], a[0:3]
  s_waitcnt vmcnt(12)
  v_mfma_f32_16x16x32_bf16 a[4:7], v[220:223], v[192:195], a[4:7]
  s_waitcnt vmcnt(11)
  v_mfma_f32_16x16x32_bf16 a[8:11], v[220:223], v[196:199], a[8:11]
  s_waitcnt vmcnt(10)
  v_mfma_f32_16x16x32_bf16 a[12:15], v[220:223], v[200:203], a[12:15]
  s_waitcnt vmcnt(5)
  v_mfma_f32_16x16x32_bf16 a[32:35], v[224:227], v[188:191], a[32:35]
  v_mfma_f32_16x16x32_bf16 a[36:39], v[224:227], v[192:195], a[36:39]
  v_mfma_f32_16x16x32_bf16 a[40:43], v[224:227], v[196:199], a[40:43]
  v_mfma_f32_16x16x32_bf16 a[44:47], v[224:227], v[200:203], a[44:47]
  s_waitcnt vmcnt(4)
  v_mfma_f32_16x16x32_bf16 a[64:67], v[228:231], v[188:191], a[64:67]
  v_mfma_f32_16x16x32_bf16 a[68:71], v[228:231], v[192:195], a[68:71]
  v_mfma_f32_16x16x32_bf16 a[72:75], v[228:231], v[196:199], a[72:75]
  v_mfma_f32_16x16x32_bf16 a[76:79], v[228:231], v[200:203], a[76:79]
  s_waitcnt vmcnt(3)
  v_mfma_f32_16x16x32_bf16 a[96:99], v[232:235], v[188:191], a[96:99]
  v_mfma_f32_16x16x32_bf16 a[100:103], v[232:235], v[192:195], a[100:103]
  v_mfma_f32_16x16x32_bf16 a[104:107], v[232:235], v[196:199], a[104:107]
  v_mfma_f32_16x16x32_bf16 a[108:111], v[232:235], v[200:203], a[108:111]
  s_waitcnt vmcnt(2)
  v_mfma_f32_16x16x32_bf16 a[128:131], v[236:239], v[188:191], a[128:131]
  v_mfma_f32_16x16x32_bf16 a[132:135], v[236:239], v[192:195], a[132:135]
  v_mfma_f32_16x16x32_bf16 a[136:139], v[236:239], v[196:199], a[136:139]
  v_mfma_f32_16x16x32_bf16 a[140:143], v[236:239], v[200:203], a[140:143]
  s_waitcnt vmcnt(1)
  v_mfma_f32_16x16x32_bf16 a[160:163], v[240:243], v[188:191], a[160:163]
  v_mfma_f32_16x16x32_bf16 a[164:167], v[240:243], v[192:195], a[164:167]
  v_mfma_f32_16x16x32_bf16 a[168:171], v[240:243], v[196:199], a[168:171]
  v_mfma_f32_16x16x32_bf16 a[172:175], v[240:243], v[200:203], a[172:175]
  s_waitcnt vmcnt(0)
  v_mfma_f32_16x16x32_bf16 a[192:195], v[244:247], v[188:191], a[192:195]
  v_mfma_f32_16x16x32_bf16 a[196:199], v[244:247], v[192:195], a[196:199]
  v_mfma_f32_16x16x32_bf16 a[200:203], v[244:247], v[196:199], a[200:203]
  v_mfma_f32_16x16x32_bf16 a[204:207], v[244:247], v[200:203], a[204:207]
  v_mfma_f32_16x16x32_bf16 a[16:19], v[220:223], v[204:207], a[16:19]
  v_mfma_f32_16x16x32_bf16 a[20:23], v[220:223], v[208:211], a[20:23]
  ds_write_b128 v248, a[4:7] offset:0
  v_mfma_f32_16x16x32_bf16 a[24:27], v[220:223], v[212:215], a[24:27]
  ds_write_b128 v249, a[8:11] offset:0
  v_mfma_f32_16x16x32_bf16 a[28:31], v[220:223], v[216:219], a[28:31]
  ds_write_b128 v250, a[12:15] offset:0
  v_mfma_f32_16x16x32_bf16 a[48:51], v[224:227], v[204:207], a[48:51]
  ds_write_b128 v248, a[36:39] offset:1024
  v_mfma_f32_16x16x32_bf16 a[52:55], v[224:227], v[208:211], a[52:55]
  ds_write_b128 v249, a[40:43] offset:1024
  v_mfma_f32_16x16x32_bf16 a[56:59], v[224:227], v[212:215], a[56:59]
  ds_write_b128 v250, a[44:47] offset:1024
  v_mfma_f32_16x16x32_bf16 a[60:63], v[224:227], v[216:219], a[60:63]
  ds_write_b128 v248, a[68:71] offset:2048
  v_mfma_f32_16x16x32_bf16 a[80:83], v[228:231], v[204:207], a[80:83]
  ds_write_b128 v249, a[72:75] offset:2048
  v_mfma_f32_16x16x32_bf16 a[84:87], v[228:231], v[208:211], a[84:87]
  ds_write_b128 v250, a[76:79] offset:2048
  v_mfma_f32_16x16x32_bf16 a[88:91], v[228:231], v[212:215], a[88:91]
  ds_write_b128 v248, a[100:103] offset:3072
  v_mfma_f32_16x16x32_bf16 a[92:95], v[228:231], v[216:219], a[92:95]
  ds_write_b128 v249, a[104:107] offset:3072
  v_mfma_f32_16x16x32_bf16 a[112:115], v[232:235], v[204:207], a[112:115]
  ds_write_b128 v250, a[108:111] offset:3072
  v_mfma_f32_16x16x32_bf16 a[116:119], v[232:235], v[208:211], a[116:119]
  ds_write_b128 v248, a[132:135] offset:4096
  v_mfma_f32_16x16x32_bf16 a[120:123], v[232:235], v[212:215], a[120:123]
  ds_write_b128 v249, a[136:139] offset:4096
  v_mfma_f32_16x16x32_bf16 a[124:127], v[232:235], v[216:219], a[124:127]
  s_waitcnt lgkmcnt(6)
  ds_write_b128 v250, a[140:143] offset:4096
  v_mfma_f32_16x16x32_bf16 a[144:147], v[236:239], v[204:207], a[144:147]
  ds_write_b128 v248, a[164:167] offset:5120
  v_mfma_f32_16x16x32_bf16 a[148:151], v[236:239], v[208:211], a[148:151]
  ds_write_b128 v249, a[168:171] offset:5120
  v_mfma_f32_16x16x32_bf16 a[152:155], v[236:239], v[212:215], a[152:155]
  ds_write_b128 v250, a[172:175] offset:5120
  v_mfma_f32_16x16x32_bf16 a[156:159], v[236:239], v[216:219], a[156:159]
  ds_write_b128 v248, a[196:199] offset:6144
  v_mfma_f32_16x16x32_bf16 a[176:179], v[240:243], v[204:207], a[176:179]
  ds_write_b128 v249, a[200:203] offset:6144
  v_mfma_f32_16x16x32_bf16 a[180:183], v[240:243], v[208:211], a[180:183]
  ds_write_b128 v250, a[204:207] offset:6144
  v_mfma_f32_16x16x32_bf16 a[184:187], v[240:243], v[212:215], a[184:187]
  v_mfma_f32_16x16x32_bf16 a[188:191], v[240:243], v[216:219], a[188:191]
  v_mfma_f32_16x16x32_bf16 a[208:211], v[244:247], v[204:207], a[208:211]
  v_mfma_f32_16x16x32_bf16 a[212:215], v[244:247], v[208:211], a[212:215]
  v_mfma_f32_16x16x32_bf16 a[216:219], v[244:247], v[212:215], a[216:219]
  v_mfma_f32_16x16x32_bf16 a[220:223], v[244:247], v[216:219], a[220:223]
  v_accvgpr_read_b32 v92, a0
  v_accvgpr_read_b32 v93, a1
  v_accvgpr_read_b32 v94, a2
  v_accvgpr_read_b32 v95, a3
  v_accvgpr_read_b32 v96, a32
  v_accvgpr_read_b32 v97, a33
  v_accvgpr_read_b32 v98, a34
  v_accvgpr_read_b32 v99, a35
  v_accvgpr_read_b32 v100, a64
  v_accvgpr_read_b32 v101, a65
  v_accvgpr_read_b32 v102, a66
  v_accvgpr_read_b32 v103, a67
  v_accvgpr_read_b32 v104, a96
  v_accvgpr_read_b32 v105, a97
  v_accvgpr_read_b32 v106, a98
  v_accvgpr_read_b32 v107, a99
  v_accvgpr_read_b32 v108, a128
  v_accvgpr_read_b32 v109, a129
  v_accvgpr_read_b32 v110, a130
  v_accvgpr_read_b32 v111, a131
  v_accvgpr_read_b32 v112, a160
  v_accvgpr_read_b32 v113, a161
  v_accvgpr_read_b32 v114, a162
  v_accvgpr_read_b32 v115, a163
  v_accvgpr_read_b32 v116, a192
  v_accvgpr_read_b32 v117, a193
  v_accvgpr_read_b32 v118, a194
  v_accvgpr_read_b32 v119, a195
  s_waitcnt lgkmcnt(0)
  s_barrier
  ds_read_b128 v[8:11], v4 offset:0
  ds_read_b128 v[12:15], v4 offset:7168
  ds_read_b128 v[16:19], v4 offset:14336
  ds_read_b128 v[20:23], v4 offset:1024
  ds_read_b128 v[24:27], v4 offset:8192
  ds_read_b128 v[28:31], v4 offset:15360
  ds_read_b128 v[32:35], v4 offset:2048
  ds_read_b128 v[36:39], v4 offset:9216
  ds_read_b128 v[40:43], v4 offset:16384
  ds_read_b128 v[44:47], v4 offset:3072
  ds_read_b128 v[48:51], v4 offset:10240
  ds_read_b128 v[52:55], v4 offset:17408
  ds_read_b128 v[56:59], v4 offset:4096
  ds_read_b128 v[60:63], v4 offset:11264
  s_waitcnt lgkmcnt(13)
  ds_read_b128 v[64:67], v4 offset:18432
  v_add_f32 v92, v92, v8
  v_add_f32 v93, v93, v9
  v_add_f32 v94, v94, v10
  v_add_f32 v95, v95, v11
  s_waitcnt lgkmcnt(13)
  ds_read_b128 v[68:71], v4 offset:5120
  v_add_f32 v92, v92, v12
  v_add_f32 v93, v93, v13
  v_add_f32 v94, v94, v14
  v_add_f32 v95, v95, v15
  s_waitcnt lgkmcnt(13)
  ds_read_b128 v[72:75], v4 offset:12288
  v_add_f32 v92, v92, v16
  v_add_f32 v93, v93, v17
  v_add_f32 v94, v94, v18
  v_add_f32 v95, v95, v19
  v_min_u32 v92, -2, v92
  v_min_u32 v93, -2, v93
  v_min_u32 v94, -2, v94
  v_min_u32 v95, -2, v95
  buffer_store_dwordx4 v[92:95], v6, s[44:47], 0 offen offset:0 sc1
  s_waitcnt lgkmcnt(13)
  ds_read_b128 v[76:79], v4 offset:19456
  v_add_f32 v96, v96, v20
  v_add_f32 v97, v97, v21
  v_add_f32 v98, v98, v22
  v_add_f32 v99, v99, v23
  s_waitcnt lgkmcnt(13)
  ds_read_b128 v[80:83], v4 offset:6144
  v_add_f32 v96, v96, v24
  v_add_f32 v97, v97, v25
  v_add_f32 v98, v98, v26
  v_add_f32 v99, v99, v27
  s_waitcnt lgkmcnt(13)
  ds_read_b128 v[84:87], v4 offset:13312
  v_add_f32 v96, v96, v28
  v_add_f32 v97, v97, v29
  v_add_f32 v98, v98, v30
  v_add_f32 v99, v99, v31
  v_min_u32 v96, -2, v96
  v_min_u32 v97, -2, v97
  v_min_u32 v98, -2, v98
  v_min_u32 v99, -2, v99
  buffer_store_dwordx4 v[96:99], v6, s[44:47], 0 offen offset:1024 sc1
  s_waitcnt lgkmcnt(13)
  ds_read_b128 v[88:91], v4 offset:20480
  v_add_f32 v100, v100, v32
  v_add_f32 v101, v101, v33
  v_add_f32 v102, v102, v34
  v_add_f32 v103, v103, v35
  s_waitcnt lgkmcnt(13)
  v_add_f32 v100, v100, v36
  v_add_f32 v101, v101, v37
  v_add_f32 v102, v102, v38
  v_add_f32 v103, v103, v39
  s_waitcnt lgkmcnt(12)
  v_add_f32 v100, v100, v40
  v_add_f32 v101, v101, v41
  v_add_f32 v102, v102, v42
  v_add_f32 v103, v103, v43
  v_min_u32 v100, -2, v100
  v_min_u32 v101, -2, v101
  v_min_u32 v102, -2, v102
  v_min_u32 v103, -2, v103
  buffer_store_dwordx4 v[100:103], v6, s[44:47], 0 offen offset:2048 sc1
  s_waitcnt lgkmcnt(11)
  v_add_f32 v104, v104, v44
  v_add_f32 v105, v105, v45
  v_add_f32 v106, v106, v46
  v_add_f32 v107, v107, v47
  s_waitcnt lgkmcnt(10)
  v_add_f32 v104, v104, v48
  v_add_f32 v105, v105, v49
  v_add_f32 v106, v106, v50
  v_add_f32 v107, v107, v51
  s_waitcnt lgkmcnt(9)
  v_add_f32 v104, v104, v52
  v_add_f32 v105, v105, v53
  v_add_f32 v106, v106, v54
  v_add_f32 v107, v107, v55
  v_min_u32 v104, -2, v104
  v_min_u32 v105, -2, v105
  v_min_u32 v106, -2, v106
  v_min_u32 v107, -2, v107
  buffer_store_dwordx4 v[104:107], v6, s[44:47], 0 offen offset:3072 sc1
  s_waitcnt lgkmcnt(8)
  v_add_f32 v108, v108, v56
  v_add_f32 v109, v109, v57
  v_add_f32 v110, v110, v58
  v_add_f32 v111, v111, v59
  s_waitcnt lgkmcnt(7)
  v_add_f32 v108, v108, v60
  v_add_f32 v109, v109, v61
  v_add_f32 v110, v110, v62
  v_add_f32 v111, v111, v63
  s_waitcnt lgkmcnt(6)
  v_add_f32 v108, v108, v64
  v_add_f32 v109, v109, v65
  v_add_f32 v110, v110, v66
  v_add_f32 v111, v111, v67
  v_min_u32 v108, -2, v108
  v_min_u32 v109, -2, v109
  v_min_u32 v110, -2, v110
  v_min_u32 v111, -2, v111
  buffer_store_dwordx4 v[108:111], v254, s[44:47], 0 offen offset:0 sc1
  s_waitcnt lgkmcnt(5)
  v_add_f32 v112, v112, v68
  v_add_f32 v113, v113, v69
  v_add_f32 v114, v114, v70
  v_add_f32 v115, v115, v71
  s_waitcnt lgkmcnt(4)
  v_add_f32 v112, v112, v72
  v_add_f32 v113, v113, v73
  v_add_f32 v114, v114, v74
  v_add_f32 v115, v115, v75
  s_waitcnt lgkmcnt(3)
  v_add_f32 v112, v112, v76
  v_add_f32 v113, v113, v77
  v_add_f32 v114, v114, v78
  v_add_f32 v115, v115, v79
  v_min_u32 v112, -2, v112
  v_min_u32 v113, -2, v113
  v_min_u32 v114, -2, v114
  v_min_u32 v115, -2, v115
  buffer_store_dwordx4 v[112:115], v254, s[44:47], 0 offen offset:1024 sc1
  s_waitcnt lgkmcnt(2)
  v_add_f32 v116, v116, v80
  v_add_f32 v117, v117, v81
  v_add_f32 v118, v118, v82
  v_add_f32 v119, v119, v83
  s_waitcnt lgkmcnt(1)
  v_add_f32 v116, v116, v84
  v_add_f32 v117, v117, v85
  v_add_f32 v118, v118, v86
  v_add_f32 v119, v119, v87
  s_waitcnt lgkmcnt(0)
  v_add_f32 v116, v116, v88
  v_add_f32 v117, v117, v89
  v_add_f32 v118, v118, v90
  v_add_f32 v119, v119, v91
  v_min_u32 v116, -2, v116
  v_min_u32 v117, -2, v117
  v_min_u32 v118, -2, v118
  v_min_u32 v119, -2, v119
  buffer_store_dwordx4 v[116:119], v254, s[44:47], 0 offen offset:2048 sc1
  ds_write_b128 v4, a[20:23] offset:0
  ds_write_b128 v4, a[24:27] offset:7168
  ds_write_b128 v4, a[28:31] offset:14336
  ds_write_b128 v4, a[52:55] offset:1024
  ds_write_b128 v4, a[56:59] offset:8192
  ds_write_b128 v4, a[60:63] offset:15360
  ds_write_b128 v4, a[84:87] offset:2048
  ds_write_b128 v4, a[88:91] offset:9216
  ds_write_b128 v4, a[92:95] offset:16384
  ds_write_b128 v4, a[116:119] offset:3072
  ds_write_b128 v4, a[120:123] offset:10240
  ds_write_b128 v4, a[124:127] offset:17408
  ds_write_b128 v4, a[148:151] offset:4096
  ds_write_b128 v4, a[152:155] offset:11264
  s_waitcnt lgkmcnt(7)
  ds_write_b128 v4, a[156:159] offset:18432
  ds_write_b128 v4, a[180:183] offset:5120
  ds_write_b128 v4, a[184:187] offset:12288
  ds_write_b128 v4, a[188:191] offset:19456
  ds_write_b128 v4, a[212:215] offset:6144
  ds_write_b128 v4, a[216:219] offset:13312
  ds_write_b128 v4, a[220:223] offset:20480
  v_accvgpr_read_b32 v148, a16
  v_accvgpr_read_b32 v149, a17
  v_accvgpr_read_b32 v150, a18
  v_accvgpr_read_b32 v151, a19
  v_accvgpr_read_b32 v152, a48
  v_accvgpr_read_b32 v153, a49
  v_accvgpr_read_b32 v154, a50
  v_accvgpr_read_b32 v155, a51
  v_accvgpr_read_b32 v156, a80
  v_accvgpr_read_b32 v157, a81
  v_accvgpr_read_b32 v158, a82
  v_accvgpr_read_b32 v159, a83
  v_accvgpr_read_b32 v160, a112
  v_accvgpr_read_b32 v161, a113
  v_accvgpr_read_b32 v162, a114
  v_accvgpr_read_b32 v163, a115
  v_accvgpr_read_b32 v164, a144
  v_accvgpr_read_b32 v165, a145
  v_accvgpr_read_b32 v166, a146
  v_accvgpr_read_b32 v167, a147
  v_accvgpr_read_b32 v168, a176
  v_accvgpr_read_b32 v169, a177
  v_accvgpr_read_b32 v170, a178
  v_accvgpr_read_b32 v171, a179
  v_accvgpr_read_b32 v172, a208
  v_accvgpr_read_b32 v173, a209
  v_accvgpr_read_b32 v174, a210
  v_accvgpr_read_b32 v175, a211
  s_waitcnt lgkmcnt(0)
  s_barrier
  buffer_load_dwordx4 v[120:123], v7, s[44:47], 0 offen offset:0 sc1
  buffer_load_dwordx4 v[124:127], v7, s[44:47], 0 offen offset:1024 sc1
  buffer_load_dwordx4 v[128:131], v7, s[44:47], 0 offen offset:2048 sc1
  buffer_load_dwordx4 v[132:135], v7, s[44:47], 0 offen offset:3072 sc1
  buffer_load_dwordx4 v[136:139], v255, s[44:47], 0 offen offset:0 sc1
  buffer_load_dwordx4 v[140:143], v255, s[44:47], 0 offen offset:1024 sc1
  buffer_load_dwordx4 v[144:147], v255, s[44:47], 0 offen offset:2048 sc1
  ds_read_b128 v[8:11], v251 offset:0
  ds_read_b128 v[12:15], v252 offset:0
  ds_read_b128 v[16:19], v253 offset:0
  ds_read_b128 v[20:23], v251 offset:1024
  ds_read_b128 v[24:27], v252 offset:1024
  ds_read_b128 v[28:31], v253 offset:1024
  ds_read_b128 v[32:35], v251 offset:2048
  ds_read_b128 v[36:39], v252 offset:2048
  ds_read_b128 v[40:43], v253 offset:2048
  ds_read_b128 v[44:47], v251 offset:3072
  ds_read_b128 v[48:51], v252 offset:3072
  ds_read_b128 v[52:55], v253 offset:3072
  ds_read_b128 v[56:59], v251 offset:4096
  ds_read_b128 v[60:63], v252 offset:4096
  s_waitcnt lgkmcnt(13)
  ds_read_b128 v[64:67], v253 offset:4096
  v_add_f32 v148, v148, v8
  v_add_f32 v149, v149, v9
  v_add_f32 v150, v150, v10
  v_add_f32 v151, v151, v11
  s_waitcnt lgkmcnt(13)
  ds_read_b128 v[68:71], v251 offset:5120
  v_add_f32 v148, v148, v12
  v_add_f32 v149, v149, v13
  v_add_f32 v150, v150, v14
  v_add_f32 v151, v151, v15
  s_waitcnt lgkmcnt(13)
  ds_read_b128 v[72:75], v252 offset:5120
  v_add_f32 v148, v148, v16
  v_add_f32 v149, v149, v17
  v_add_f32 v150, v150, v18
  v_add_f32 v151, v151, v19
  s_waitcnt lgkmcnt(13)
  ds_read_b128 v[76:79], v253 offset:5120
  v_add_f32 v152, v152, v20
  v_add_f32 v153, v153, v21
  v_add_f32 v154, v154, v22
  v_add_f32 v155, v155, v23
  s_waitcnt lgkmcnt(13)
  ds_read_b128 v[80:83], v251 offset:6144
  v_add_f32 v152, v152, v24
  v_add_f32 v153, v153, v25
  v_add_f32 v154, v154, v26
  v_add_f32 v155, v155, v27
  s_waitcnt lgkmcnt(13)
  ds_read_b128 v[84:87], v252 offset:6144
  v_add_f32 v152, v152, v28
  v_add_f32 v153, v153, v29
  v_add_f32 v154, v154, v30
  v_add_f32 v155, v155, v31
  s_waitcnt lgkmcnt(13)
  ds_read_b128 v[88:91], v253 offset:6144
  v_add_f32 v156, v156, v32
  v_add_f32 v157, v157, v33
  v_add_f32 v158, v158, v34
  v_add_f32 v159, v159, v35
  s_waitcnt lgkmcnt(13)
  v_add_f32 v156, v156, v36
  v_add_f32 v157, v157, v37
  v_add_f32 v158, v158, v38
  v_add_f32 v159, v159, v39
  s_waitcnt lgkmcnt(12)
  v_add_f32 v156, v156, v40
  v_add_f32 v157, v157, v41
  v_add_f32 v158, v158, v42
  v_add_f32 v159, v159, v43
  s_waitcnt lgkmcnt(11)
  v_add_f32 v160, v160, v44
  v_add_f32 v161, v161, v45
  v_add_f32 v162, v162, v46
  v_add_f32 v163, v163, v47
  s_waitcnt lgkmcnt(10)
  v_add_f32 v160, v160, v48
  v_add_f32 v161, v161, v49
  v_add_f32 v162, v162, v50
  v_add_f32 v163, v163, v51
  s_waitcnt lgkmcnt(9)
  v_add_f32 v160, v160, v52
  v_add_f32 v161, v161, v53
  v_add_f32 v162, v162, v54
  v_add_f32 v163, v163, v55
  s_waitcnt lgkmcnt(8)
  v_add_f32 v164, v164, v56
  v_add_f32 v165, v165, v57
  v_add_f32 v166, v166, v58
  v_add_f32 v167, v167, v59
  s_waitcnt lgkmcnt(7)
  v_add_f32 v164, v164, v60
  v_add_f32 v165, v165, v61
  v_add_f32 v166, v166, v62
  v_add_f32 v167, v167, v63
  s_waitcnt lgkmcnt(6)
  v_add_f32 v164, v164, v64
  v_add_f32 v165, v165, v65
  v_add_f32 v166, v166, v66
  v_add_f32 v167, v167, v67
  s_waitcnt lgkmcnt(5)
  v_add_f32 v168, v168, v68
  v_add_f32 v169, v169, v69
  v_add_f32 v170, v170, v70
  v_add_f32 v171, v171, v71
  s_waitcnt lgkmcnt(4)
  v_add_f32 v168, v168, v72
  v_add_f32 v169, v169, v73
  v_add_f32 v170, v170, v74
  v_add_f32 v171, v171, v75
  s_waitcnt lgkmcnt(3)
  v_add_f32 v168, v168, v76
  v_add_f32 v169, v169, v77
  v_add_f32 v170, v170, v78
  v_add_f32 v171, v171, v79
  s_waitcnt lgkmcnt(2)
  v_add_f32 v172, v172, v80
  v_add_f32 v173, v173, v81
  v_add_f32 v174, v174, v82
  v_add_f32 v175, v175, v83
  s_waitcnt lgkmcnt(1)
  v_add_f32 v172, v172, v84
  v_add_f32 v173, v173, v85
  v_add_f32 v174, v174, v86
  v_add_f32 v175, v175, v87
  s_waitcnt lgkmcnt(0)
  v_add_f32 v172, v172, v88
  v_add_f32 v173, v173, v89
  v_add_f32 v174, v174, v90
  v_add_f32 v175, v175, v91
  s_mov_b32 s20, 0
  s_branch mha_oproj_kernel_chk
mha_oproj_kernel_poll:
  buffer_load_dwordx4 v[120:123], v7, s[44:47], 0 offen offset:0 sc1
  buffer_load_dwordx4 v[124:127], v7, s[44:47], 0 offen offset:1024 sc1
  buffer_load_dwordx4 v[128:131], v7, s[44:47], 0 offen offset:2048 sc1
  buffer_load_dwordx4 v[132:135], v7, s[44:47], 0 offen offset:3072 sc1
  buffer_load_dwordx4 v[136:139], v255, s[44:47], 0 offen offset:0 sc1
  buffer_load_dwordx4 v[140:143], v255, s[44:47], 0 offen offset:1024 sc1
  buffer_load_dwordx4 v[144:147], v255, s[44:47], 0 offen offset:2048 sc1
mha_oproj_kernel_chk:
  s_add_u32 s20, s20, 1
  s_waitcnt vmcnt(0)
  v_max3_u32 v2, v120, v121, v122
  v_max3_u32 v3, v123, v124, v125
  v_max3_u32 v2, v126, v127, v2
  v_max3_u32 v3, v128, v129, v3
  v_max3_u32 v2, v130, v131, v2
  v_max3_u32 v3, v132, v133, v3
  v_max3_u32 v2, v134, v135, v2
  v_max3_u32 v3, v136, v137, v3
  v_max3_u32 v2, v138, v139, v2
  v_max3_u32 v3, v140, v141, v3
  v_max3_u32 v2, v142, v143, v2
  v_max3_u32 v3, v144, v145, v3
  v_max3_u32 v2, v146, v147, v2
  v_max_u32 v2, v2, v3
  v_cmp_eq_u32 vcc, -1, v2
  s_cmp_gt_u32 s20, 4000
  s_nop 3
  s_cbranch_vccnz mha_oproj_kernel_retry
mha_oproj_kernel_fin:
  v_add_f32 v148, v148, v120
  v_add_f32 v149, v149, v121
  v_add_f32 v150, v150, v122
  v_add_f32 v151, v151, v123
  v_cvt_pk_bf16_f32 v8, v148, v149
  v_cvt_pk_bf16_f32 v9, v150, v151
  buffer_store_dwordx2 v[8:9], v5, s[12:15], 0 offen offset:0
  v_add_f32 v152, v152, v124
  v_add_f32 v153, v153, v125
  v_add_f32 v154, v154, v126
  v_add_f32 v155, v155, v127
  v_cvt_pk_bf16_f32 v10, v152, v153
  v_cvt_pk_bf16_f32 v11, v154, v155
  buffer_store_dwordx2 v[10:11], v5, s[12:15], 0 offen offset:32
  v_add_f32 v156, v156, v128
  v_add_f32 v157, v157, v129
  v_add_f32 v158, v158, v130
  v_add_f32 v159, v159, v131
  v_cvt_pk_bf16_f32 v12, v156, v157
  v_cvt_pk_bf16_f32 v13, v158, v159
  buffer_store_dwordx2 v[12:13], v5, s[12:15], 0 offen offset:64
  v_add_f32 v160, v160, v132
  v_add_f32 v161, v161, v133
  v_add_f32 v162, v162, v134
  v_add_f32 v163, v163, v135
  v_cvt_pk_bf16_f32 v14, v160, v161
  v_cvt_pk_bf16_f32 v15, v162, v163
  buffer_store_dwordx2 v[14:15], v5, s[12:15], 0 offen offset:96
  v_add_f32 v164, v164, v136
  v_add_f32 v165, v165, v137
  v_add_f32 v166, v166, v138
  v_add_f32 v167, v167, v139
  v_cvt_pk_bf16_f32 v16, v164, v165
  v_cvt_pk_bf16_f32 v17, v166, v167
  buffer_store_dwordx2 v[16:17], v5, s[12:15], 0 offen offset:128
  v_add_f32 v168, v168, v140
  v_add_f32 v169, v169, v141
  v_add_f32 v170, v170, v142
  v_add_f32 v171, v171, v143
  v_cvt_pk_bf16_f32 v18, v168, v169
  v_cvt_pk_bf16_f32 v19, v170, v171
  buffer_store_dwordx2 v[18:19], v5, s[12:15], 0 offen offset:160
  v_add_f32 v172, v172, v144
  v_add_f32 v173, v173, v145
  v_add_f32 v174, v174, v146
  v_add_f32 v175, v175, v147
  v_cvt_pk_bf16_f32 v20, v172, v173
  v_cvt_pk_bf16_f32 v21, v174, v175
  buffer_store_dwordx2 v[20:21], v5, s[12:15], 0 offen offset:192
  s_endpgm
mha_oproj_kernel_retry:
  s_cbranch_scc1 mha_oproj_kernel_slow
  s_sleep 2
  s_branch mha_oproj_kernel_poll
mha_oproj_kernel_slow:
  s_xor_b32 s19, s21, 1
  s_lshl_b32 s19, s19, 16
  v_lshlrev_b32 v1, 4, v0
  v_add_u32 v1, s19, v1
  s_lshl_b32 s19, s21, 2
  s_add_u32 s19, s19, s16
  s_lshl_b32 s24, s19, 17
  s_mov_b32 s20, 64
  s_mov_b32 s32, 0
  s_mov_b32 s33, 131072
  s_mov_b32 s34, 262144
  s_mov_b32 s35, 393216
  s_mov_b32 s36, 524288
  s_mov_b32 s37, 655360
  s_mov_b32 s38, 786432
  v_mov_b32 v120, 0
  v_mov_b32 v121, 0
  v_mov_b32 v122, 0
  v_mov_b32 v123, 0
  v_mov_b32 v124, 0
  v_mov_b32 v125, 0
  v_mov_b32 v126, 0
  v_mov_b32 v127, 0
  v_mov_b32 v128, 0
  v_mov_b32 v129, 0
  v_mov_b32 v130, 0
  v_mov_b32 v131, 0
  v_mov_b32 v132, 0
  v_mov_b32 v133, 0
  v_mov_b32 v134, 0
  v_mov_b32 v135, 0
  v_mov_b32 v136, 0
  v_mov_b32 v137, 0
  v_mov_b32 v138, 0
  v_mov_b32 v139, 0
  v_mov_b32 v140, 0
  v_mov_b32 v141, 0
  v_mov_b32 v142, 0
  v_mov_b32 v143, 0
  v_mov_b32 v144, 0
  v_mov_b32 v145, 0
  v_mov_b32 v146, 0
  v_mov_b32 v147, 0
mha_oproj_kernel_sl:
  s_nop 7
  buffer_load_dwordx4 v[8:11], v1, s[4:7], s24 offen
  buffer_load_dwordx4 v[12:15], v1, s[8:11], s32 offen
  buffer_load_dwordx4 v[16:19], v1, s[8:11], s33 offen
  buffer_load_dwordx4 v[20:23], v1, s[8:11], s34 offen
  buffer_load_dwordx4 v[24:27], v1, s[8:11], s35 offen
  buffer_load_dwordx4 v[28:31], v1, s[8:11], s36 offen
  buffer_load_dwordx4 v[32:35], v1, s[8:11], s37 offen
  buffer_load_dwordx4 v[36:39], v1, s[8:11], s38 offen
  s_waitcnt vmcnt(0)
  v_add_u32 v1, 0x400, v1
  v_mfma_f32_16x16x32_bf16 v[120:123], v[12:15], v[8:11], v[120:123]
  v_mfma_f32_16x16x32_bf16 v[124:127], v[16:19], v[8:11], v[124:127]
  v_mfma_f32_16x16x32_bf16 v[128:131], v[20:23], v[8:11], v[128:131]
  v_mfma_f32_16x16x32_bf16 v[132:135], v[24:27], v[8:11], v[132:135]
  v_mfma_f32_16x16x32_bf16 v[136:139], v[28:31], v[8:11], v[136:139]
  v_mfma_f32_16x16x32_bf16 v[140:143], v[32:35], v[8:11], v[140:143]
  v_mfma_f32_16x16x32_bf16 v[144:147], v[36:39], v[8:11], v[144:147]
  s_sub_u32 s20, s20, 1
  s_cmp_lg_u32 s20, 0
  s_nop 7
  s_nop 7
  s_cbranch_scc1 mha_oproj_kernel_sl
  s_nop 7
  s_branch mha_oproj_kernel_fin
mha_oproj_kernel_exit:
  s_endpgm
mha_code_end:
.section .rodata,"a"
.p2align 6
.amdhsa_kernel mha_attn_kernel
  .amdhsa_next_free_vgpr 512
  .amdhsa_next_free_sgpr 102
  .amdhsa_accum_offset 256
  .amdhsa_group_segment_fixed_size 0
  .amdhsa_kernarg_size 64
  .amdhsa_user_sgpr_count 2
  .amdhsa_user_sgpr_kernarg_segment_ptr 1
  .amdhsa_system_sgpr_workgroup_id_x 1
.end_amdhsa_kernel
.p2align 6
.amdhsa_kernel mha_oproj_kernel
  .amdhsa_next_free_vgpr 488
  .amdhsa_next_free_sgpr 56
  .amdhsa_accum_offset 256
  .amdhsa_group_segment_fixed_size 0
  .amdhsa_kernarg_size 64
  .amdhsa_user_sgpr_count 2
  .amdhsa_user_sgpr_kernarg_segment_ptr 1
  .amdhsa_system_sgpr_workgroup_id_x 1
.end_amdhsa_kernel
```
